```python
import torch

def _softmax(x, axis=-1):
    return torch.softmax(x, dim=axis)

def _gelu(x):
    return torch.nn.functional.gelu(x, approximate='tanh')

def _silu(x):
    return torch.nn.functional.silu(x)

def _sigmoid(x):
    return torch.sigmoid(x)

def _layernorm(x, axis=-1, eps=1e-05):
    m = x.mean(dim=axis, keepdim=True)
    v = x.var(dim=axis, keepdim=True, unbiased=False)
    return (x - m) / torch.sqrt(v + eps)

def _scatter_add(tgt, idx, src, axis=0):
    return tgt.clone().index_add_(axis, idx, src)

def _segment_sum(src, seg, n):
    out = torch.zeros((n,) + src.shape[1:], dtype=src.dtype)
    return out.index_add_(0, seg, src)

def _pad(x, pw):
    flat = tuple((v for pair in reversed(pw) for v in pair))
    return torch.nn.functional.pad(x, flat)
kernel_name = 'parallel_sum__compressed_kv_cla__mixer_gmlp__prompt'

def setup_inputs():

    _w = lambda a: (lambda t: t.to(torch.bfloat16) if t.is_floating_point() else t)(torch.as_tensor(a))

    def _A_setup():
        B, H, Sq, Sk, D, M = (1, 32, 2048, 2048, 128, 512)
        Dc = 4 * D
        return {'x': _w((lambda *s: torch.randn(*s, dtype=torch.bfloat16) * 0.05)(B, Sq, M)), 'c_kv': _w((lambda *s: torch.randn(*s, dtype=torch.bfloat16) * 1.6)(B, Sk, Dc)), 'w_q': _w((lambda *s: torch.randn(*s, dtype=torch.bfloat16) * 1.6)(M, H, D) * M ** (-0.5)), 'w_uk': _w((lambda *s: torch.randn(*s, dtype=torch.bfloat16) * 1.6)(Dc, H, D) * Dc ** (-0.5)), 'w_uv': _w((lambda *s: torch.randn(*s, dtype=torch.bfloat16) * 1.6)(Dc, H, D) * Dc ** (-0.5)), 'w_o': _w((lambda *s: torch.randn(*s, dtype=torch.bfloat16) * 1.6)(H, D, M) * (H * D) ** (-0.5))}
    _A_in = _A_setup()

    def _B_setup():
        B, S, D, F = (1, 2048, 512, 1376)
        Fh = F // 2
        return {'x': _w((lambda *s: torch.randn(*s, dtype=torch.bfloat16) * 0.05)(B, S, D)), 'w_in': _w((lambda *s: torch.randn(*s, dtype=torch.bfloat16) * 0.4)(D, 2 * Fh)), 'w_sp': _w(0.01 * (lambda *s: torch.randn(*s, dtype=torch.bfloat16) * 0.4)(S, S)), 'b_sp': _w(1.0 + 0.01 * (lambda *s: torch.randn(*s, dtype=torch.bfloat16) * 0.05)(S)), 'w_out': _w((lambda *s: torch.randn(*s, dtype=torch.bfloat16) * 0.05)(Fh, D))}
    _B_in = _B_setup()
    return {'A_x': _A_in['x'], 'A_c_kv': _A_in['c_kv'], 'A_w_q': _A_in['w_q'], 'A_w_uk': _A_in['w_uk'], 'A_w_uv': _A_in['w_uv'], 'A_w_o': _A_in['w_o'], 'B_x': _B_in['x'], 'B_w_in': _B_in['w_in'], 'B_w_sp': _B_in['w_sp'], 'B_b_sp': _B_in['b_sp'], 'B_w_out': _B_in['w_out']}

def reference(A_x, A_c_kv, A_w_q, A_w_uk, A_w_uv, A_w_o, B_x, B_w_in, B_w_sp, B_b_sp, B_w_out):

    def _A_ref(x, c_kv, w_q, w_uk, w_uv, w_o):
        B, Sq, M = (x.shape[0], x.shape[1], x.shape[2])
        Sk = c_kv.shape[1]
        H, D = (w_q.shape[1], w_q.shape[2])
        q = torch.einsum('bqm,mhd->bhqd', x, w_q)
        k = torch.einsum('bkc,chd->bhkd', c_kv, w_uk)
        v = torch.einsum('bkc,chd->bhkd', c_kv, w_uv)
        scores = torch.einsum('bhqd,bhkd->bhqk', q, k) * D ** (-0.5)
        off = Sk - Sq
        qi = torch.arange(Sq)[:, None]
        kj = torch.arange(Sk)[None, :]
        cmask = kj <= qi + off
        scores = torch.where(cmask[None, None], scores, -1000000000.0)
        p = _softmax(scores, axis=-1)
        ctx = torch.einsum('bhqk,bhkd->bhqd', p, v)
        return torch.einsum('bhqd,hdm->bqm', ctx, w_o)

    def _B_ref(x, w_in, w_sp, b_sp, w_out):
        B, S, D = x.shape
        F = w_in.shape[-1]
        Fh = F // 2
        z = _gelu(torch.einsum('bsd,df->bsf', x, w_in))
        z1 = z[..., :Fh].clone()
        z2 = _layernorm(z[..., Fh:], axis=-1)
        g = torch.einsum('ts,bsf->btf', w_sp, z2) + b_sp[None, :, None]
        return torch.einsum('bsf,fd->bsd', z1 * g, w_out)
    x = A_x
    xn = _layernorm(x, axis=-1)
    return x + _A_ref(xn, A_c_kv, A_w_q, A_w_uk, A_w_uv, A_w_o) + _B_ref(xn, B_w_in, B_w_sp, B_b_sp, B_w_out)
```

```asm
; @launch grid=(256,1,1) block=(256,1,1) lds=163840
.amdgcn_target "amdgcn-amd-amdhsa--gfx950"
.text
.globl parallel_sum__compressed_kv_cla__mixer_gmlp__prompt_kernel
.p2align 8
.type parallel_sum__compressed_kv_cla__mixer_gmlp__prompt_kernel,@function
parallel_sum__compressed_kv_cla__mixer_gmlp__prompt_kernel:
    s_cmp_ge_u32 s2, 256
    s_cbranch_scc1 K2_END
    s_getpc_b64 s[96:97]
L_PC_parallel_sum__compressed_kv_cla__mixer_gmlp__prompt_kernel:
    s_mov_b32 s98, L_CODE_END-L_PC_parallel_sum__compressed_kv_cla__mixer_gmlp__prompt_kernel
    s_mov_b32 s99, 0x20000
    s_lshr_b32 s100, s2, 3
    s_lshl_b32 s100, s100, 12
    v_lshlrev_b32 v124, 4, v0
    buffer_load_dwordx4 v[120:123], v124, s[96:99], s100 offen
    s_load_dwordx4 s[40:43], s[0:1], 0
    s_load_dwordx4 s[44:47], s[0:1], 24
    s_load_dwordx2 s[48:49], s[0:1], 56
    s_load_dwordx4 s[52:55], s[0:1], 96
    v_lshrrev_b32 v1, 6, v0
    v_and_b32 v0, 63, v0
    s_lshr_b32 s33, s2, 3
    s_and_b32 s34, s2, 7
    v_readfirstlane_b32 s32, v1
    s_and_b32 s35, s33, 3
    s_lshl_b32 s56, s34, 2
    s_add_u32 s35, s35, s56
    s_lshr_b32 s36, s33, 2
    s_and_b32 s37, s32, 1
    s_lshr_b32 s38, s32, 1
    s_lshl_b32 s60, s32, 13
    s_lshl_b32 s61, s32, 12
    v_and_b32 v32, 31, v0
    v_lshrrev_b32 v33, 5, v0
    v_lshrrev_b32 v34, 4, v0
    v_bfe_u32 v35, v0, 2, 2
    v_and_b32 v36, 3, v0
    v_bfe_u32 v37, v0, 4, 1
    v_lshlrev_b32 v31, 4, v0
    v_lshrrev_b32 v46, 3, v0
    v_lshlrev_b32 v50, 13, v46
    v_lshlrev_b32 v46, 10, v46
    v_and_b32 v47, 7, v0
    v_xor_b32 v47, v47, v34
    v_lshl_add_u32 v48, v47, 4, v46
    v_xor_b32 v47, 4, v47
    v_lshl_add_u32 v49, v47, 4, v46
    v_add_u32 v1, 0, v48
    v_add_u32 v2, 7168, v49
    v_add_u32 v3, 14336, v48
    v_add_u32 v4, 21504, v49
    v_add_u32 v5, 32768, v48
    v_add_u32 v6, 39936, v49
    v_add_u32 v7, 47104, v48
    v_add_u32 v8, 54272, v49
    v_bfe_u32 v47, v0, 2, 1
    v_xor_b32 v47, v47, v37
    v_lshl_add_u32 v50, v47, 6, v50
    v_lshl_add_u32 v50, v36, 4, v50
    v_add_u32 v9, 0, v50
    v_add_u32 v10, 64512, v50
    v_add_u32 v11, 129024, v50
    v_add_u32 v12, 193536, v50
    v_add_u32 v13, 262144, v50
    v_add_u32 v14, 326656, v50
    v_add_u32 v15, 391168, v50
    v_add_u32 v16, 455680, v50
    s_lshl_b32 s58, s36, 18
    s_lshl_b32 s56, s32, 16
    s_add_u32 s58, s58, s56
    s_and_b32 s56, s35, 15
    s_lshl_b32 s56, s56, 9
    s_lshl_b32 s59, s32, 19
    s_add_u32 s59, s59, s56
    s_lshl_b32 s67, s32, 17
    s_add_u32 s67, s67, s56
    s_lshl_b32 s57, s2, 13
    s_lshl_b32 s56, s32, 11
    s_add_u32 s57, s57, s56
    v_xor_b32 v46, v35, v34
    v_lshlrev_b32 v47, 13, v34
    v_lshl_add_u32 v47, v46, 6, v47
    v_lshl_add_u32 v47, v36, 4, v47
    v_add_u32 v64, 0, v47
    v_add_u32 v65, 31744, v47
    v_add_u32 v66, 63488, v47
    v_add_u32 v67, 95232, v47
    s_waitcnt lgkmcnt(0)
    s_mov_b32 s8, s40
    s_mov_b32 s9, s41
    s_mov_b32 s10, 0x200000
    s_mov_b32 s11, 0x20000
    s_mov_b32 s12, s42
    s_mov_b32 s13, s43
    s_mov_b32 s14, 0x200000
    s_mov_b32 s15, 0x20000
    buffer_load_dwordx4 v[40:43], v31, s[8:11], s57 offen
    buffer_load_dwordx4 v[44:47], v31, s[8:11], s57 offen offset:1024
    s_cmp_lt_u32 s35, 16
    s_cselect_b32 s16, s44, s46
    s_cselect_b32 s17, s45, s47
    s_mov_b32 s18, 0x400000
    s_mov_b32 s19, 0x20000
    s_add_u32 m0, s60, 0
    s_add_u32 s68, s58, 0
    buffer_load_dwordx4 v1, s[12:15], s68 offen offset:0 lds
    buffer_load_dwordx4 v2, s[12:15], s68 offen offset:1024 lds
    buffer_load_dwordx4 v3, s[12:15], s68 offen offset:2048 lds
    buffer_load_dwordx4 v4, s[12:15], s68 offen offset:3072 lds
    s_add_u32 m0, s60, 4096
    s_add_u32 s68, s58, 0
    buffer_load_dwordx4 v5, s[12:15], s68 offen offset:0 lds
    buffer_load_dwordx4 v6, s[12:15], s68 offen offset:1024 lds
    buffer_load_dwordx4 v7, s[12:15], s68 offen offset:2048 lds
    buffer_load_dwordx4 v8, s[12:15], s68 offen offset:3072 lds
    s_add_u32 m0, s61, 32768
    s_add_u32 s68, s67, 0
    buffer_load_dwordx4 v64, s[16:19], s68 offen offset:0 lds
    buffer_load_dwordx4 v65, s[16:19], s68 offen offset:1024 lds
    buffer_load_dwordx4 v66, s[16:19], s68 offen offset:2048 lds
    buffer_load_dwordx4 v67, s[16:19], s68 offen offset:3072 lds
    s_add_u32 m0, s60, 49152
    s_add_u32 s68, s58, 128
    buffer_load_dwordx4 v1, s[12:15], s68 offen offset:0 lds
    buffer_load_dwordx4 v2, s[12:15], s68 offen offset:1024 lds
    buffer_load_dwordx4 v3, s[12:15], s68 offen offset:2048 lds
    buffer_load_dwordx4 v4, s[12:15], s68 offen offset:3072 lds
    s_add_u32 m0, s60, 53248
    s_add_u32 s68, s58, 128
    buffer_load_dwordx4 v5, s[12:15], s68 offen offset:0 lds
    buffer_load_dwordx4 v6, s[12:15], s68 offen offset:1024 lds
    buffer_load_dwordx4 v7, s[12:15], s68 offen offset:2048 lds
    buffer_load_dwordx4 v8, s[12:15], s68 offen offset:3072 lds
    s_add_u32 m0, s61, 81920
    s_add_u32 s68, s67, 524288
    buffer_load_dwordx4 v64, s[16:19], s68 offen offset:0 lds
    buffer_load_dwordx4 v65, s[16:19], s68 offen offset:1024 lds
    buffer_load_dwordx4 v66, s[16:19], s68 offen offset:2048 lds
    buffer_load_dwordx4 v67, s[16:19], s68 offen offset:3072 lds
    s_mov_b32 s20, s48
    s_mov_b32 s21, s49
    s_mov_b32 s22, 0x158000
    s_mov_b32 s23, 0x20000
    s_mov_b32 s24, s54
    s_mov_b32 s25, s55
    s_mov_b32 s26, 0x10000000
    s_mov_b32 s27, 0x20000
    s_mov_b32 s28, s52
    s_mov_b32 s29, s53
    s_mov_b32 s30, 0x100
    s_mov_b32 s31, 0x20000
    s_lshl_b32 s56, s2, 2
    s_add_u32 s56, s56, s32
    s_lshl_b32 s70, s56, 12
    s_lshl_b32 s76, s56, 13
    s_and_b32 s76, s76, 0x3fffff
    s_lshl_b32 s77, s56, 11
    s_and_b32 s76, s77, 0xfffff
    s_cmp_lt_u32 s2, 128
    s_cselect_b32 s72, s44, s46
    s_cselect_b32 s73, s45, s47
    s_mov_b32 s74, 0x400000
    s_mov_b32 s75, 0x20000
    v_lshrrev_b32 v61, 2, v0
    v_lshlrev_b32 v61, 9, v61
    v_lshl_add_u32 v61, v36, 6, v61
    v_lshlrev_b32 v39, 6, v0
    v_lshlrev_b32 v61, 9, v34
    v_and_b32 v48, 15, v0
    v_lshl_add_u32 v61, v48, 4, v61
    s_load_dwordx2 s[44:45], s[0:1], 16
    v_bfe_u32 v48, v0, 1, 3
    v_xor_b32 v48, v48, v33
    v_lshlrev_b32 v49, 7, v32
    v_add_u32 v49, s60, v49
    v_xor_b32 v50, 0, v48
    v_lshl_add_u32 v17, v50, 4, v49
    v_add_u32 v21, 49152, v17
    v_xor_b32 v50, 2, v48
    v_lshl_add_u32 v18, v50, 4, v49
    v_add_u32 v22, 49152, v18
    v_xor_b32 v50, 4, v48
    v_lshl_add_u32 v19, v50, 4, v49
    v_add_u32 v23, 49152, v19
    v_xor_b32 v50, 6, v48
    v_lshl_add_u32 v20, v50, 4, v49
    v_add_u32 v24, 49152, v20
    v_lshl_add_u32 v48, v33, 3, v35
    v_lshlrev_b32 v48, 8, v48
    v_lshl_add_u32 v48, v37, 5, v48
    v_lshl_add_u32 v48, v36, 3, v48
    v_add_u32 v48, 32768, v48
    v_xor_b32 v49, 0, v35
    v_lshl_add_u32 v68, v49, 6, v48
    v_add_u32 v72, 49152, v68
    v_xor_b32 v49, 1, v35
    v_lshl_add_u32 v69, v49, 6, v48
    v_add_u32 v73, 49152, v69
    v_xor_b32 v49, 2, v35
    v_lshl_add_u32 v70, v49, 6, v48
    v_add_u32 v74, 49152, v70
    v_xor_b32 v49, 3, v35
    v_lshl_add_u32 v71, v49, 6, v48
    v_add_u32 v75, 49152, v71
    v_lshl_add_u32 v48, v33, 3, v35
    v_lshlrev_b32 v48, 7, v48
    v_lshl_add_u32 v48, v37, 5, v48
    v_lshl_add_u32 v48, v36, 3, v48
    v_lshrrev_b32 v49, 1, v35
    v_lshl_add_u32 v25, v49, 6, v48
    v_xor_b32 v49, 1, v49
    v_lshl_add_u32 v26, v49, 6, v48
    v_add_u32 v27, 65536, v25
    v_add_u32 v28, 65536, v26
    v_add_u32 v29, 131072, v25
    v_add_u32 v30, 131072, v26
    s_lshl_b32 s62, s35, 7
    s_lshl_b32 s56, s36, 3
    s_add_u32 s62, s62, s56
    s_lshl_b32 s56, s32, 1
    s_add_u32 s62, s62, s56
    s_lshl_b32 s62, s62, 13
    s_add_u32 s62, s62, 2097152
    s_mul_i32 s63, s32, 44032
    s_mul_i32 s56, s34, 192
    s_add_u32 s63, s63, s56
    s_lshl_b32 s64, s33, 16
    s_lshl_b32 s56, s32, 10
    s_add_u32 s64, s64, s56
    s_add_u32 s64, s64, 0
    s_lshl_b32 s65, s33, 3
    s_mov_b32 s66, 0x3f803f80
    s_lshr_b32 s57, s2, 2
    s_lshl_b32 s57, s57, 15
    s_and_b32 s56, s2, 3
    s_lshl_b32 s56, s56, 7
    s_add_u32 s57, s57, s56
    s_add_u32 s57, s57, s60
    s_add_u32 s69, s57, 0
    s_lshl_b32 s56, s32, 5
    s_add_u32 s56, s56, 147456
    v_lshlrev_b32 v58, 7, v0
    v_add_u32 v58, s56, v58
    s_lshl_b32 s56, s32, 11
    s_add_u32 s56, s56, 147456
    v_add_u32 v59, s56, v31
    v_lshrrev_b32 v62, 3, v0
    v_lshlrev_b32 v62, 9, v62
    v_and_b32 v48, 7, v0
    v_lshl_add_u32 v62, v48, 4, v62
    s_waitcnt lgkmcnt(0)
    s_cmp_ge_u32 s35, 16
    s_cbranch_scc1 K1_V
    buffer_load_dwordx4 v[76:79], v31, s[12:15], s77 offen offset:0
    buffer_load_dwordx4 v[76:79], v31, s[12:15], s77 offen offset:1024
    s_add_u32 s56, s76, 1048576
    buffer_load_dwordx4 v[76:79], v61, s[72:75], s56 offen
    s_add_u32 s56, s76, 2097152
    buffer_load_dwordx4 v[76:79], v61, s[72:75], s56 offen
    s_waitcnt vmcnt(16)
    s_barrier
    ds_read_b128 a[0:3], v17 offset:0
    ds_read_b128 a[128:131], v17 offset:4096
    ds_read_b64_tr_b16 v[96:97], v68 offset:0
    ds_read_b64_tr_b16 v[98:99], v68 offset:1024
    ds_read_b64_tr_b16 v[100:101], v69 offset:0
    ds_read_b64_tr_b16 v[102:103], v69 offset:1024
    ds_read_b64_tr_b16 v[104:105], v70 offset:0
    ds_read_b64_tr_b16 v[106:107], v70 offset:1024
    ds_read_b64_tr_b16 v[108:109], v71 offset:0
    ds_read_b64_tr_b16 v[110:111], v71 offset:1024
    s_waitcnt lgkmcnt(0)
    v_mfma_f32_32x32x16_bf16 v[192:207], v[96:99], a[0:3], 0
    ds_read_b128 a[4:7], v18 offset:0
    s_add_u32 m0, s60, 98304
    s_add_u32 s68, s58, 256
    buffer_load_dwordx4 v1, s[12:15], s68 offen offset:0 lds
    v_mfma_f32_32x32x16_bf16 v[224:239], v[96:99], a[128:131], 0
    ds_read_b128 a[132:135], v18 offset:4096
    buffer_load_dwordx4 v2, s[12:15], s68 offen offset:1024 lds
    v_mfma_f32_32x32x16_bf16 v[208:223], v[100:103], a[0:3], 0
    ds_read_b64_tr_b16 v[112:113], v68 offset:4096
    buffer_load_dwordx4 v3, s[12:15], s68 offen offset:2048 lds
    v_mfma_f32_32x32x16_bf16 v[240:255], v[100:103], a[128:131], 0
    ds_read_b64_tr_b16 v[114:115], v68 offset:5120
    v_mfma_f32_32x32x16_bf16 v[128:143], v[104:107], a[0:3], 0
    buffer_load_dwordx4 v4, s[12:15], s68 offen offset:3072 lds
    ds_read_b64_tr_b16 v[116:117], v69 offset:4096
    v_mfma_f32_32x32x16_bf16 v[160:175], v[104:107], a[128:131], 0
    ds_read_b64_tr_b16 v[118:119], v69 offset:5120
    ds_read_b64_tr_b16 v[120:121], v70 offset:4096
    v_mfma_f32_32x32x16_bf16 v[144:159], v[108:111], a[0:3], 0
    ds_read_b64_tr_b16 v[122:123], v70 offset:5120
    ds_read_b64_tr_b16 v[124:125], v71 offset:4096
    v_mfma_f32_32x32x16_bf16 v[176:191], v[108:111], a[128:131], 0
    ds_read_b64_tr_b16 v[126:127], v71 offset:5120
    s_waitcnt lgkmcnt(0)
    v_mfma_f32_32x32x16_bf16 v[192:207], v[112:115], a[4:7], v[192:207]
    ds_read_b128 a[8:11], v19 offset:0
    s_add_u32 s56, s76, 3145728
    buffer_load_dwordx4 v[76:79], v61, s[72:75], s56 offen
    v_mfma_f32_32x32x16_bf16 v[224:239], v[112:115], a[132:135], v[224:239]
    ds_read_b128 a[136:139], v19 offset:4096
    s_add_u32 m0, s60, 102400
    s_add_u32 s68, s58, 256
    buffer_load_dwordx4 v5, s[12:15], s68 offen offset:0 lds
    v_mfma_f32_32x32x16_bf16 v[208:223], v[116:119], a[4:7], v[208:223]
    ds_read_b64_tr_b16 v[96:97], v68 offset:8192
    buffer_load_dwordx4 v6, s[12:15], s68 offen offset:1024 lds
    v_mfma_f32_32x32x16_bf16 v[240:255], v[116:119], a[132:135], v[240:255]
    ds_read_b64_tr_b16 v[98:99], v68 offset:9216
    buffer_load_dwordx4 v7, s[12:15], s68 offen offset:2048 lds
    v_mfma_f32_32x32x16_bf16 v[128:143], v[120:123], a[4:7], v[128:143]
    ds_read_b64_tr_b16 v[100:101], v69 offset:8192
    buffer_load_dwordx4 v8, s[12:15], s68 offen offset:3072 lds
    v_mfma_f32_32x32x16_bf16 v[160:175], v[120:123], a[132:135], v[160:175]
    ds_read_b64_tr_b16 v[102:103], v69 offset:9216
    ds_read_b64_tr_b16 v[104:105], v70 offset:8192
    v_mfma_f32_32x32x16_bf16 v[144:159], v[124:127], a[4:7], v[144:159]
    ds_read_b64_tr_b16 v[106:107], v70 offset:9216
    ds_read_b64_tr_b16 v[108:109], v71 offset:8192
    v_mfma_f32_32x32x16_bf16 v[176:191], v[124:127], a[132:135], v[176:191]
    ds_read_b64_tr_b16 v[110:111], v71 offset:9216
    s_waitcnt lgkmcnt(0)
    v_mfma_f32_32x32x16_bf16 v[192:207], v[96:99], a[8:11], v[192:207]
    ds_read_b128 a[12:15], v20 offset:0
    s_add_u32 m0, s61, 131072
    s_add_u32 s68, s67, 1048576
    buffer_load_dwordx4 v64, s[16:19], s68 offen offset:0 lds
    v_mfma_f32_32x32x16_bf16 v[224:239], v[96:99], a[136:139], v[224:239]
    ds_read_b128 a[140:143], v20 offset:4096
    buffer_load_dwordx4 v65, s[16:19], s68 offen offset:1024 lds
    v_mfma_f32_32x32x16_bf16 v[208:223], v[100:103], a[8:11], v[208:223]
    ds_read_b64_tr_b16 v[112:113], v68 offset:12288
    buffer_load_dwordx4 v66, s[16:19], s68 offen offset:2048 lds
    v_mfma_f32_32x32x16_bf16 v[240:255], v[100:103], a[136:139], v[240:255]
    ds_read_b64_tr_b16 v[114:115], v68 offset:13312
    v_mfma_f32_32x32x16_bf16 v[128:143], v[104:107], a[8:11], v[128:143]
    buffer_load_dwordx4 v67, s[16:19], s68 offen offset:3072 lds
    ds_read_b64_tr_b16 v[116:117], v69 offset:12288
    v_mfma_f32_32x32x16_bf16 v[160:175], v[104:107], a[136:139], v[160:175]
    ds_read_b64_tr_b16 v[118:119], v69 offset:13312
    ds_read_b64_tr_b16 v[120:121], v70 offset:12288
    v_mfma_f32_32x32x16_bf16 v[144:159], v[108:111], a[8:11], v[144:159]
    ds_read_b64_tr_b16 v[122:123], v70 offset:13312
    ds_read_b64_tr_b16 v[124:125], v71 offset:12288
    v_mfma_f32_32x32x16_bf16 v[176:191], v[108:111], a[136:139], v[176:191]
    ds_read_b64_tr_b16 v[126:127], v71 offset:13312
    s_waitcnt lgkmcnt(0)
    s_waitcnt vmcnt(17)
    s_barrier
    v_mfma_f32_32x32x16_bf16 v[192:207], v[112:115], a[12:15], v[192:207]
    ds_read_b128 a[16:19], v21 offset:0
    v_mov_b32 v48, 0
    v_mov_b32 v49, 0
    v_mov_b32 v50, 0
    v_mov_b32 v51, 0
    ds_read_b128 a[144:147], v21 offset:4096
    v_mfma_f32_32x32x16_bf16 v[224:239], v[112:115], a[140:143], v[224:239]
    v_dot2_f32_bf16 v48, v40, s66, v48
    v_dot2_f32_bf16 v50, v40, v40, v50
    v_dot2_f32_bf16 v48, v41, s66, v48
    v_dot2_f32_bf16 v50, v41, v41, v50
    ds_read_b64_tr_b16 v[96:97], v72 offset:0
    v_mfma_f32_32x32x16_bf16 v[208:223], v[116:119], a[12:15], v[208:223]
    v_dot2_f32_bf16 v48, v42, s66, v48
    v_dot2_f32_bf16 v50, v42, v42, v50
    v_dot2_f32_bf16 v48, v43, s66, v48
    v_dot2_f32_bf16 v50, v43, v43, v50
    ds_read_b64_tr_b16 v[98:99], v72 offset:1024
    v_mfma_f32_32x32x16_bf16 v[240:255], v[116:119], a[140:143], v[240:255]
    v_dot2_f32_bf16 v49, v44, s66, v49
    v_dot2_f32_bf16 v51, v44, v44, v51
    v_dot2_f32_bf16 v49, v45, s66, v49
    v_dot2_f32_bf16 v51, v45, v45, v51
    ds_read_b64_tr_b16 v[100:101], v73 offset:0
    v_mfma_f32_32x32x16_bf16 v[128:143], v[120:123], a[12:15], v[128:143]
    s_add_u32 m0, s60, 0
    s_add_u32 s68, s58, 384
    buffer_load_dwordx4 v1, s[12:15], s68 offen offset:0 lds
    ds_read_b64_tr_b16 v[102:103], v73 offset:1024
    v_mfma_f32_32x32x16_bf16 v[160:175], v[120:123], a[140:143], v[160:175]
    buffer_load_dwordx4 v2, s[12:15], s68 offen offset:1024 lds
    ds_read_b64_tr_b16 v[104:105], v74 offset:0
    v_mfma_f32_32x32x16_bf16 v[144:159], v[124:127], a[12:15], v[144:159]
    buffer_load_dwordx4 v3, s[12:15], s68 offen offset:2048 lds
    ds_read_b64_tr_b16 v[106:107], v74 offset:1024
    v_mfma_f32_32x32x16_bf16 v[176:191], v[124:127], a[140:143], v[176:191]
    ds_read_b64_tr_b16 v[108:109], v75 offset:0
    ds_read_b64_tr_b16 v[110:111], v75 offset:1024
    s_waitcnt lgkmcnt(0)
    v_mfma_f32_32x32x16_bf16 v[192:207], v[96:99], a[16:19], v[192:207]
    ds_read_b128 a[20:23], v22 offset:0
    v_dot2_f32_bf16 v49, v46, s66, v49
    v_dot2_f32_bf16 v51, v46, v46, v51
    v_dot2_f32_bf16 v49, v47, s66, v49
    v_dot2_f32_bf16 v51, v47, v47, v51
    v_mfma_f32_32x32x16_bf16 v[224:239], v[96:99], a[144:147], v[224:239]
    ds_read_b128 a[148:151], v22 offset:4096
    s_nop 2
    v_permlane32_swap_b32 v48, v49
    v_permlane32_swap_b32 v50, v51
    s_nop 1
    v_mfma_f32_32x32x16_bf16 v[208:223], v[100:103], a[16:19], v[208:223]
    ds_read_b64_tr_b16 v[112:113], v72 offset:4096
    v_add_f32 v48, v48, v49
    v_add_f32 v50, v50, v51
    s_nop 1
    v_permlane16_swap_b32 v48, v50
    v_mfma_f32_32x32x16_bf16 v[240:255], v[100:103], a[144:147], v[240:255]
    ds_read_b64_tr_b16 v[114:115], v72 offset:5120
    buffer_load_dwordx4 v4, s[12:15], s68 offen offset:3072 lds
    v_mfma_f32_32x32x16_bf16 v[128:143], v[104:107], a[16:19], v[128:143]
    ds_read_b64_tr_b16 v[116:117], v73 offset:4096
    s_add_u32 m0, s60, 4096
    s_add_u32 s68, s58, 384
    buffer_load_dwordx4 v5, s[12:15], s68 offen offset:0 lds
    v_mfma_f32_32x32x16_bf16 v[160:175], v[104:107], a[144:147], v[160:175]
    ds_read_b64_tr_b16 v[118:119], v73 offset:5120
    buffer_load_dwordx4 v6, s[12:15], s68 offen offset:1024 lds
    v_mfma_f32_32x32x16_bf16 v[144:159], v[108:111], a[16:19], v[144:159]
    ds_read_b64_tr_b16 v[120:121], v74 offset:4096
    ds_read_b64_tr_b16 v[122:123], v74 offset:5120
    v_mfma_f32_32x32x16_bf16 v[176:191], v[108:111], a[144:147], v[176:191]
    ds_read_b64_tr_b16 v[124:125], v75 offset:4096
    ds_read_b64_tr_b16 v[126:127], v75 offset:5120
    s_waitcnt lgkmcnt(0)
    v_mfma_f32_32x32x16_bf16 v[192:207], v[112:115], a[20:23], v[192:207]
    ds_read_b128 a[24:27], v23 offset:0
    s_nop 1
    v_add_f32 v48, v48, v50
    s_nop 1
    v_add_f32_dpp v48, v48, v48 row_ror:8 row_mask:0xf bank_mask:0xf
    ds_read_b128 a[152:155], v23 offset:4096
    v_mfma_f32_32x32x16_bf16 v[224:239], v[112:115], a[148:151], v[224:239]
    s_nop 1
    v_add_f32_dpp v48, v48, v48 row_ror:4 row_mask:0xf bank_mask:0xf
    s_nop 1
    v_add_f32_dpp v48, v48, v48 row_ror:2 row_mask:0xf bank_mask:0xf
    ds_read_b64_tr_b16 v[96:97], v72 offset:8192
    v_mfma_f32_32x32x16_bf16 v[208:223], v[116:119], a[20:23], v[208:223]
    s_nop 1
    v_add_f32_dpp v48, v48, v48 row_ror:1 row_mask:0xf bank_mask:0xf
    s_nop 1
    v_mul_f32 v48, 0x3b000000, v48
    ds_read_b64_tr_b16 v[98:99], v72 offset:9216
    v_mfma_f32_32x32x16_bf16 v[240:255], v[116:119], a[148:151], v[240:255]
    s_nop 0
    v_readlane_b32 s40, v48, 0
    v_readlane_b32 s41, v48, 16
    v_readlane_b32 s42, v48, 32
    ds_read_b64_tr_b16 v[100:101], v73 offset:8192
    v_mfma_f32_32x32x16_bf16 v[128:143], v[120:123], a[20:23], v[128:143]
    buffer_load_dwordx4 v7, s[12:15], s68 offen offset:2048 lds
    ds_read_b64_tr_b16 v[102:103], v73 offset:9216
    v_mfma_f32_32x32x16_bf16 v[160:175], v[120:123], a[148:151], v[160:175]
    buffer_load_dwordx4 v8, s[12:15], s68 offen offset:3072 lds
    ds_read_b64_tr_b16 v[104:105], v74 offset:8192
    v_mfma_f32_32x32x16_bf16 v[144:159], v[124:127], a[20:23], v[144:159]
    s_add_u32 m0, s61, 32768
    s_add_u32 s68, s67, 1572864
    buffer_load_dwordx4 v64, s[16:19], s68 offen offset:0 lds
    ds_read_b64_tr_b16 v[106:107], v74 offset:9216
    v_mfma_f32_32x32x16_bf16 v[176:191], v[124:127], a[148:151], v[176:191]
    ds_read_b64_tr_b16 v[108:109], v75 offset:8192
    ds_read_b64_tr_b16 v[110:111], v75 offset:9216
    s_waitcnt lgkmcnt(0)
    v_mfma_f32_32x32x16_bf16 v[192:207], v[96:99], a[24:27], v[192:207]
    ds_read_b128 a[28:31], v24 offset:0
    s_cmp_lg_u32 s32, 0
    s_cbranch_scc1 L_W0_1
    v_mov_b32 v60, 0
    s_lshl_b32 s56, s34, 8
    s_add_u32 s56, s56, s33
    s_add_u32 s56, s56, 42532864
    s_mov_b64 exec, 1
    buffer_store_byte v60, v60, s[24:27], s56 offen sc0 sc1
    s_lshl_b32 s56, s2, 4
    s_add_u32 s56, s56, 42598400
    buffer_store_dword v60, v60, s[24:27], s56 offen sc0 sc1
    s_lshl_b32 s56, s2, 4
    s_add_u32 s56, s56, 42606592
    buffer_store_dword v60, v60, s[24:27], s56 offen sc0 sc1
    s_lshl_b32 s56, s2, 4
    s_add_u32 s56, s56, 42614784
    buffer_store_dword v60, v60, s[24:27], s56 offen sc0 sc1
    s_lshl_b32 s56, s2, 4
    s_add_u32 s56, s56, 42622976
    buffer_store_dword v60, v60, s[24:27], s56 offen sc0 sc1
    s_lshl_b32 s56, s2, 5
    s_add_u32 s56, s56, 42467328
    buffer_store_dword v60, v60, s[24:27], s56 offen sc0 sc1
    s_mov_b64 exec, -1
L_W0_1:
    ds_read_b128 a[156:159], v24 offset:4096
    v_mfma_f32_32x32x16_bf16 v[224:239], v[96:99], a[152:155], v[224:239]
    v_readlane_b32 s43, v48, 48
    s_nop 1
    v_mov_b32 v53, s40
    v_mov_b32 v52, s41
    ds_read_b64_tr_b16 v[112:113], v72 offset:12288
    v_mfma_f32_32x32x16_bf16 v[208:223], v[100:103], a[24:27], v[208:223]
    v_fma_f32 v52, -v53, v53, v52
    v_max_f32 v52, 0, v52
    v_add_f32 v52, 0x3727c5ac, v52
    v_rsq_f32 v52, v52
    ds_read_b64_tr_b16 v[114:115], v72 offset:13312
    v_mfma_f32_32x32x16_bf16 v[240:255], v[100:103], a[152:155], v[240:255]
    s_nop 0
    v_mul_f32 v53, v53, v52
    v_sub_f32 v53, 0, v53
    v_mov_b32 v55, s42
    ds_read_b64_tr_b16 v[116:117], v73 offset:12288
    v_mfma_f32_32x32x16_bf16 v[128:143], v[104:107], a[24:27], v[128:143]
    buffer_load_dwordx4 v65, s[16:19], s68 offen offset:1024 lds
    ds_read_b64_tr_b16 v[118:119], v73 offset:13312
    v_mfma_f32_32x32x16_bf16 v[160:175], v[104:107], a[152:155], v[160:175]
    buffer_load_dwordx4 v66, s[16:19], s68 offen offset:2048 lds
    ds_read_b64_tr_b16 v[120:121], v74 offset:12288
    v_mfma_f32_32x32x16_bf16 v[144:159], v[108:111], a[24:27], v[144:159]
    buffer_load_dwordx4 v67, s[16:19], s68 offen offset:3072 lds
    ds_read_b64_tr_b16 v[122:123], v74 offset:13312
    v_mfma_f32_32x32x16_bf16 v[176:191], v[108:111], a[152:155], v[176:191]
    ds_read_b64_tr_b16 v[124:125], v75 offset:12288
    ds_read_b64_tr_b16 v[126:127], v75 offset:13312
    s_waitcnt lgkmcnt(0)
    s_waitcnt vmcnt(12)
    s_barrier
    v_mfma_f32_32x32x16_bf16 v[192:207], v[112:115], a[28:31], v[192:207]
    ds_read_b128 a[32:35], v21 offset:49152
    v_mov_b32 v54, s43
    v_fma_f32 v54, -v55, v55, v54
    v_max_f32 v54, 0, v54
    v_add_f32 v54, 0x3727c5ac, v54
    v_mfma_f32_32x32x16_bf16 v[224:239], v[112:115], a[156:159], v[224:239]
    ds_read_b128 a[160:163], v21 offset:53248
    v_rsq_f32 v54, v54
    s_nop 0
    v_mul_f32 v55, v55, v54
    v_sub_f32 v55, 0, v55
    v_mfma_f32_32x32x16_bf16 v[208:223], v[116:119], a[28:31], v[208:223]
    ds_read_b64_tr_b16 v[96:97], v72 offset:49152
    v_lshlrev_b32 v56, 16, v40
    v_and_b32 v57, 0xffff0000, v40
    v_fma_f32 v56, v56, v52, v53
    v_fma_f32 v57, v57, v52, v53
    v_mfma_f32_32x32x16_bf16 v[240:255], v[116:119], a[156:159], v[240:255]
    ds_read_b64_tr_b16 v[98:99], v72 offset:50176
    s_add_u32 m0, s60, 49152
    s_add_u32 s68, s58, 512
    buffer_load_dwordx4 v1, s[12:15], s68 offen offset:0 lds
    v_mfma_f32_32x32x16_bf16 v[128:143], v[120:123], a[28:31], v[128:143]
    ds_read_b64_tr_b16 v[100:101], v73 offset:49152
    buffer_load_dwordx4 v2, s[12:15], s68 offen offset:1024 lds
    v_mfma_f32_32x32x16_bf16 v[160:175], v[120:123], a[156:159], v[160:175]
    ds_read_b64_tr_b16 v[102:103], v73 offset:50176
    buffer_load_dwordx4 v3, s[12:15], s68 offen offset:2048 lds
    v_mfma_f32_32x32x16_bf16 v[144:159], v[124:127], a[28:31], v[144:159]
    ds_read_b64_tr_b16 v[104:105], v74 offset:49152
    ds_read_b64_tr_b16 v[106:107], v74 offset:50176
    v_mfma_f32_32x32x16_bf16 v[176:191], v[124:127], a[156:159], v[176:191]
    ds_read_b64_tr_b16 v[108:109], v75 offset:49152
    ds_read_b64_tr_b16 v[110:111], v75 offset:50176
    s_waitcnt lgkmcnt(0)
    v_mfma_f32_32x32x16_bf16 v[192:207], v[96:99], a[32:35], v[192:207]
    ds_read_b128 a[36:39], v22 offset:49152
    s_add_u32 s56, s76, 256
    buffer_load_dwordx4 v[76:79], v61, s[72:75], s56 offen
    ds_read_b128 a[164:167], v22 offset:53248
    v_mfma_f32_32x32x16_bf16 v[224:239], v[96:99], a[160:163], v[224:239]
    s_add_u32 s56, s76, 1048832
    buffer_load_dwordx4 v[76:79], v61, s[72:75], s56 offen
    ds_read_b64_tr_b16 v[112:113], v72 offset:53248
    s_add_u32 s56, s76, 2097408
    buffer_load_dwordx4 v[76:79], v61, s[72:75], s56 offen
    v_mfma_f32_32x32x16_bf16 v[208:223], v[100:103], a[32:35], v[208:223]
    ds_read_b64_tr_b16 v[114:115], v72 offset:54272
    s_add_u32 s56, s76, 3145984
    buffer_load_dwordx4 v[76:79], v61, s[72:75], s56 offen
    ds_read_b64_tr_b16 v[116:117], v73 offset:53248
    v_mfma_f32_32x32x16_bf16 v[240:255], v[100:103], a[160:163], v[240:255]
    buffer_load_dwordx4 v[76:79], v31, s[20:23], s77 offen offset:0
    ds_read_b64_tr_b16 v[118:119], v73 offset:54272
    buffer_load_dwordx4 v[76:79], v31, s[20:23], s77 offen offset:1024
    v_mfma_f32_32x32x16_bf16 v[128:143], v[104:107], a[32:35], v[128:143]
    ds_read_b64_tr_b16 v[120:121], v74 offset:53248
    s_mov_b32 s8, s44
    s_mov_b32 s9, s45
    s_mov_b32 s10, 0x400000
    buffer_load_dword v76, v39, s[8:11], s70 offen offset:0
    ds_read_b64_tr_b16 v[122:123], v74 offset:54272
    v_mfma_f32_32x32x16_bf16 v[160:175], v[104:107], a[160:163], v[160:175]
    v_cvt_pk_bf16_f32 v40, v56, v57
    v_lshlrev_b32 v56, 16, v41
    v_and_b32 v57, 0xffff0000, v41
    v_fma_f32 v56, v56, v52, v53
    ds_read_b64_tr_b16 v[124:125], v75 offset:53248
    v_fma_f32 v57, v57, v52, v53
    v_cvt_pk_bf16_f32 v41, v56, v57
    v_lshlrev_b32 v56, 16, v42
    v_and_b32 v57, 0xffff0000, v42
    v_mfma_f32_32x32x16_bf16 v[144:159], v[108:111], a[32:35], v[144:159]
    ds_read_b64_tr_b16 v[126:127], v75 offset:54272
    v_fma_f32 v56, v56, v52, v53
    v_fma_f32 v57, v57, v52, v53
    v_cvt_pk_bf16_f32 v42, v56, v57
    v_lshlrev_b32 v56, 16, v43
    v_and_b32 v57, 0xffff0000, v43
    v_fma_f32 v56, v56, v52, v53
    v_fma_f32 v57, v57, v52, v53
    v_cvt_pk_bf16_f32 v43, v56, v57
    v_mfma_f32_32x32x16_bf16 v[176:191], v[108:111], a[160:163], v[176:191]
    buffer_load_dwordx4 v4, s[12:15], s68 offen offset:3072 lds
    s_add_u32 m0, s60, 53248
    s_add_u32 s68, s58, 512
    buffer_load_dwordx4 v5, s[12:15], s68 offen offset:0 lds
    buffer_load_dwordx4 v6, s[12:15], s68 offen offset:1024 lds
    s_waitcnt lgkmcnt(0)
    v_mfma_f32_32x32x16_bf16 v[192:207], v[112:115], a[36:39], v[192:207]
    ds_read_b128 a[40:43], v23 offset:49152
    v_lshlrev_b32 v56, 16, v44
    v_and_b32 v57, 0xffff0000, v44
    v_fma_f32 v56, v56, v54, v55
    v_fma_f32 v57, v57, v54, v55
    v_mfma_f32_32x32x16_bf16 v[224:239], v[112:115], a[164:167], v[224:239]
    ds_read_b128 a[168:171], v23 offset:53248
    v_cvt_pk_bf16_f32 v44, v56, v57
    v_lshlrev_b32 v56, 16, v45
    v_and_b32 v57, 0xffff0000, v45
    v_fma_f32 v56, v56, v54, v55
    v_mfma_f32_32x32x16_bf16 v[208:223], v[116:119], a[36:39], v[208:223]
    ds_read_b64_tr_b16 v[96:97], v72 offset:57344
    v_fma_f32 v57, v57, v54, v55
    v_cvt_pk_bf16_f32 v45, v56, v57
    v_lshlrev_b32 v56, 16, v46
    v_and_b32 v57, 0xffff0000, v46
    v_mfma_f32_32x32x16_bf16 v[240:255], v[116:119], a[164:167], v[240:255]
    ds_read_b64_tr_b16 v[98:99], v72 offset:58368
    buffer_load_dwordx4 v7, s[12:15], s68 offen offset:2048 lds
    v_mfma_f32_32x32x16_bf16 v[128:143], v[120:123], a[36:39], v[128:143]
    ds_read_b64_tr_b16 v[100:101], v73 offset:57344
    buffer_load_dwordx4 v8, s[12:15], s68 offen offset:3072 lds
    v_mfma_f32_32x32x16_bf16 v[160:175], v[120:123], a[164:167], v[160:175]
    ds_read_b64_tr_b16 v[102:103], v73 offset:58368
    s_add_u32 m0, s61, 81920
    s_add_u32 s68, s67, 2097152
    buffer_load_dwordx4 v64, s[16:19], s68 offen offset:0 lds
    v_mfma_f32_32x32x16_bf16 v[144:159], v[124:127], a[36:39], v[144:159]
    ds_read_b64_tr_b16 v[104:105], v74 offset:57344
    ds_read_b64_tr_b16 v[106:107], v74 offset:58368
    v_mfma_f32_32x32x16_bf16 v[176:191], v[124:127], a[164:167], v[176:191]
    ds_read_b64_tr_b16 v[108:109], v75 offset:57344
    ds_read_b64_tr_b16 v[110:111], v75 offset:58368
    s_waitcnt lgkmcnt(0)
    v_mfma_f32_32x32x16_bf16 v[192:207], v[96:99], a[40:43], v[192:207]
    ds_read_b128 a[44:47], v24 offset:49152
    v_fma_f32 v56, v56, v54, v55
    v_fma_f32 v57, v57, v54, v55
    v_cvt_pk_bf16_f32 v46, v56, v57
    v_lshlrev_b32 v56, 16, v47
    v_mfma_f32_32x32x16_bf16 v[224:239], v[96:99], a[168:171], v[224:239]
    ds_read_b128 a[172:175], v24 offset:53248
    v_and_b32 v57, 0xffff0000, v47
    v_fma_f32 v56, v56, v54, v55
    v_fma_f32 v57, v57, v54, v55
    v_cvt_pk_bf16_f32 v47, v56, v57
    v_mfma_f32_32x32x16_bf16 v[208:223], v[100:103], a[40:43], v[208:223]
    ds_read_b64_tr_b16 v[112:113], v72 offset:61440
    ds_write_b128 v58, v[40:43]
    ds_write_b128 v58, v[44:47] offset:16
    v_mfma_f32_32x32x16_bf16 v[240:255], v[100:103], a[168:171], v[240:255]
    ds_read_b64_tr_b16 v[114:115], v72 offset:62464
    buffer_load_dwordx4 v65, s[16:19], s68 offen offset:1024 lds
    v_mfma_f32_32x32x16_bf16 v[128:143], v[104:107], a[40:43], v[128:143]
    ds_read_b64_tr_b16 v[116:117], v73 offset:61440
    buffer_load_dwordx4 v66, s[16:19], s68 offen offset:2048 lds
    v_mfma_f32_32x32x16_bf16 v[160:175], v[104:107], a[168:171], v[160:175]
    ds_read_b64_tr_b16 v[118:119], v73 offset:62464
    buffer_load_dwordx4 v67, s[16:19], s68 offen offset:3072 lds
    v_mfma_f32_32x32x16_bf16 v[144:159], v[108:111], a[40:43], v[144:159]
    ds_read_b64_tr_b16 v[120:121], v74 offset:61440
    ds_read_b64_tr_b16 v[122:123], v74 offset:62464
    v_mfma_f32_32x32x16_bf16 v[176:191], v[108:111], a[168:171], v[176:191]
    ds_read_b64_tr_b16 v[124:125], v75 offset:61440
    ds_read_b64_tr_b16 v[126:127], v75 offset:62464
    s_waitcnt lgkmcnt(0)
    s_waitcnt vmcnt(19)
    s_waitcnt lgkmcnt(0)
    s_barrier
    v_mfma_f32_32x32x16_bf16 v[192:207], v[112:115], a[44:47], v[192:207]
    ds_read_b128 a[48:51], v17 offset:0
    s_add_u32 m0, s60, 98304
    s_add_u32 s68, s58, 640
    buffer_load_dwordx4 v1, s[12:15], s68 offen offset:0 lds
    v_mfma_f32_32x32x16_bf16 v[224:239], v[112:115], a[172:175], v[224:239]
    ds_read_b128 a[176:179], v17 offset:4096
    buffer_load_dwordx4 v2, s[12:15], s68 offen offset:1024 lds
    v_mfma_f32_32x32x16_bf16 v[208:223], v[116:119], a[44:47], v[208:223]
    ds_read_b64_tr_b16 v[96:97], v68 offset:0
    v_mfma_f32_32x32x16_bf16 v[240:255], v[116:119], a[172:175], v[240:255]
    buffer_load_dwordx4 v3, s[12:15], s68 offen offset:2048 lds
    ds_read_b64_tr_b16 v[98:99], v68 offset:1024
    v_mfma_f32_32x32x16_bf16 v[128:143], v[120:123], a[44:47], v[128:143]
    ds_read_b64_tr_b16 v[100:101], v69 offset:0
    ds_read_b64_tr_b16 v[102:103], v69 offset:1024
    v_mfma_f32_32x32x16_bf16 v[160:175], v[120:123], a[172:175], v[160:175]
    ds_read_b64_tr_b16 v[104:105], v70 offset:0
    v_mfma_f32_32x32x16_bf16 v[144:159], v[124:127], a[44:47], v[144:159]
    ds_read_b64_tr_b16 v[106:107], v70 offset:1024
    ds_read_b64_tr_b16 v[108:109], v71 offset:0
    v_mfma_f32_32x32x16_bf16 v[176:191], v[124:127], a[172:175], v[176:191]
    ds_read_b64_tr_b16 v[110:111], v71 offset:1024
    s_waitcnt lgkmcnt(0)
    v_mfma_f32_32x32x16_bf16 v[192:207], v[96:99], a[48:51], v[192:207]
    ds_read_b128 a[52:55], v18 offset:0
    ds_read_b128 v[40:43], v59
    ds_read_b128 v[44:47], v59 offset:1024
    v_mfma_f32_32x32x16_bf16 v[224:239], v[96:99], a[176:179], v[224:239]
    ds_read_b128 a[180:183], v18 offset:4096
    buffer_load_dwordx4 v4, s[12:15], s68 offen offset:3072 lds
    v_mfma_f32_32x32x16_bf16 v[208:223], v[100:103], a[48:51], v[208:223]
    ds_read_b64_tr_b16 v[112:113], v68 offset:4096
    s_add_u32 m0, s60, 102400
    s_add_u32 s68, s58, 640
    buffer_load_dwordx4 v5, s[12:15], s68 offen offset:0 lds
    v_mfma_f32_32x32x16_bf16 v[240:255], v[100:103], a[176:179], v[240:255]
    ds_read_b64_tr_b16 v[114:115], v68 offset:5120
    v_mfma_f32_32x32x16_bf16 v[128:143], v[104:107], a[48:51], v[128:143]
    buffer_load_dwordx4 v6, s[12:15], s68 offen offset:1024 lds
    ds_read_b64_tr_b16 v[116:117], v69 offset:4096
    v_mfma_f32_32x32x16_bf16 v[160:175], v[104:107], a[176:179], v[160:175]
    ds_read_b64_tr_b16 v[118:119], v69 offset:5120
    ds_read_b64_tr_b16 v[120:121], v70 offset:4096
    v_mfma_f32_32x32x16_bf16 v[144:159], v[108:111], a[48:51], v[144:159]
    ds_read_b64_tr_b16 v[122:123], v70 offset:5120
    ds_read_b64_tr_b16 v[124:125], v71 offset:4096
    v_mfma_f32_32x32x16_bf16 v[176:191], v[108:111], a[176:179], v[176:191]
    ds_read_b64_tr_b16 v[126:127], v71 offset:5120
    s_waitcnt lgkmcnt(0)
    v_mfma_f32_32x32x16_bf16 v[192:207], v[112:115], a[52:55], v[192:207]
    ds_read_b128 a[56:59], v19 offset:0
    buffer_store_dwordx4 v[40:43], v62, s[24:27], s69 offen sc1
    v_mfma_f32_32x32x16_bf16 v[224:239], v[112:115], a[180:183], v[224:239]
    ds_read_b128 a[184:187], v19 offset:4096
    buffer_load_dwordx4 v7, s[12:15], s68 offen offset:2048 lds
    v_mfma_f32_32x32x16_bf16 v[208:223], v[116:119], a[52:55], v[208:223]
    ds_read_b64_tr_b16 v[96:97], v68 offset:8192
    buffer_load_dwordx4 v8, s[12:15], s68 offen offset:3072 lds
    v_mfma_f32_32x32x16_bf16 v[240:255], v[116:119], a[180:183], v[240:255]
    ds_read_b64_tr_b16 v[98:99], v68 offset:9216
    v_mfma_f32_32x32x16_bf16 v[128:143], v[120:123], a[52:55], v[128:143]
    s_add_u32 m0, s61, 131072
    s_add_u32 s68, s67, 2621440
    buffer_load_dwordx4 v64, s[16:19], s68 offen offset:0 lds
    ds_read_b64_tr_b16 v[100:101], v69 offset:8192
    v_mfma_f32_32x32x16_bf16 v[160:175], v[120:123], a[180:183], v[160:175]
    ds_read_b64_tr_b16 v[102:103], v69 offset:9216
    ds_read_b64_tr_b16 v[104:105], v70 offset:8192
    v_mfma_f32_32x32x16_bf16 v[144:159], v[124:127], a[52:55], v[144:159]
    ds_read_b64_tr_b16 v[106:107], v70 offset:9216
    ds_read_b64_tr_b16 v[108:109], v71 offset:8192
    v_mfma_f32_32x32x16_bf16 v[176:191], v[124:127], a[180:183], v[176:191]
    ds_read_b64_tr_b16 v[110:111], v71 offset:9216
    s_waitcnt lgkmcnt(0)
    v_mfma_f32_32x32x16_bf16 v[192:207], v[96:99], a[56:59], v[192:207]
    ds_read_b128 a[60:63], v20 offset:0
    v_add_u32 v62, 4096, v62
    buffer_store_dwordx4 v[44:47], v62, s[24:27], s69 offen sc1
    v_mfma_f32_32x32x16_bf16 v[224:239], v[96:99], a[184:187], v[224:239]
    ds_read_b128 a[188:191], v20 offset:4096
    buffer_load_dwordx4 v65, s[16:19], s68 offen offset:1024 lds
    v_mfma_f32_32x32x16_bf16 v[208:223], v[100:103], a[56:59], v[208:223]
    ds_read_b64_tr_b16 v[112:113], v68 offset:12288
    buffer_load_dwordx4 v66, s[16:19], s68 offen offset:2048 lds
    v_mfma_f32_32x32x16_bf16 v[240:255], v[100:103], a[184:187], v[240:255]
    ds_read_b64_tr_b16 v[114:115], v68 offset:13312
    v_mfma_f32_32x32x16_bf16 v[128:143], v[104:107], a[56:59], v[128:143]
    buffer_load_dwordx4 v67, s[16:19], s68 offen offset:3072 lds
    ds_read_b64_tr_b16 v[116:117], v69 offset:12288
    v_mfma_f32_32x32x16_bf16 v[160:175], v[104:107], a[184:187], v[160:175]
    ds_read_b64_tr_b16 v[118:119], v69 offset:13312
    ds_read_b64_tr_b16 v[120:121], v70 offset:12288
    v_mfma_f32_32x32x16_bf16 v[144:159], v[108:111], a[56:59], v[144:159]
    ds_read_b64_tr_b16 v[122:123], v70 offset:13312
    ds_read_b64_tr_b16 v[124:125], v71 offset:12288
    v_mfma_f32_32x32x16_bf16 v[176:191], v[108:111], a[184:187], v[176:191]
    ds_read_b64_tr_b16 v[126:127], v71 offset:13312
    s_waitcnt lgkmcnt(0)
    s_waitcnt vmcnt(14)
    s_barrier
    v_mfma_f32_32x32x16_bf16 v[192:207], v[112:115], a[60:63], v[192:207]
    ds_read_b128 a[64:67], v21 offset:0
    s_add_u32 m0, s60, 0
    s_add_u32 s68, s58, 768
    buffer_load_dwordx4 v1, s[12:15], s68 offen offset:0 lds
    v_mfma_f32_32x32x16_bf16 v[224:239], v[112:115], a[188:191], v[224:239]
    ds_read_b128 a[192:195], v21 offset:4096
    buffer_load_dwordx4 v2, s[12:15], s68 offen offset:1024 lds
    v_mfma_f32_32x32x16_bf16 v[208:223], v[116:119], a[60:63], v[208:223]
    ds_read_b64_tr_b16 v[96:97], v72 offset:0
    v_mfma_f32_32x32x16_bf16 v[240:255], v[116:119], a[188:191], v[240:255]
    buffer_load_dwordx4 v3, s[12:15], s68 offen offset:2048 lds
    ds_read_b64_tr_b16 v[98:99], v72 offset:1024
    v_mfma_f32_32x32x16_bf16 v[128:143], v[120:123], a[60:63], v[128:143]
    ds_read_b64_tr_b16 v[100:101], v73 offset:0
    ds_read_b64_tr_b16 v[102:103], v73 offset:1024
    v_mfma_f32_32x32x16_bf16 v[160:175], v[120:123], a[188:191], v[160:175]
    ds_read_b64_tr_b16 v[104:105], v74 offset:0
    v_mfma_f32_32x32x16_bf16 v[144:159], v[124:127], a[60:63], v[144:159]
    ds_read_b64_tr_b16 v[106:107], v74 offset:1024
    ds_read_b64_tr_b16 v[108:109], v75 offset:0
    v_mfma_f32_32x32x16_bf16 v[176:191], v[124:127], a[188:191], v[176:191]
    ds_read_b64_tr_b16 v[110:111], v75 offset:1024
    s_waitcnt lgkmcnt(0)
    v_mfma_f32_32x32x16_bf16 v[192:207], v[96:99], a[64:67], v[192:207]
    ds_read_b128 a[68:71], v22 offset:0
    buffer_load_dwordx4 v4, s[12:15], s68 offen offset:3072 lds
    v_mfma_f32_32x32x16_bf16 v[224:239], v[96:99], a[192:195], v[224:239]
    ds_read_b128 a[196:199], v22 offset:4096
    s_add_u32 m0, s60, 4096
    s_add_u32 s68, s58, 768
    buffer_load_dwordx4 v5, s[12:15], s68 offen offset:0 lds
    v_mfma_f32_32x32x16_bf16 v[208:223], v[100:103], a[64:67], v[208:223]
    ds_read_b64_tr_b16 v[112:113], v72 offset:4096
    v_mfma_f32_32x32x16_bf16 v[240:255], v[100:103], a[192:195], v[240:255]
    buffer_load_dwordx4 v6, s[12:15], s68 offen offset:1024 lds
    ds_read_b64_tr_b16 v[114:115], v72 offset:5120
    v_mfma_f32_32x32x16_bf16 v[128:143], v[104:107], a[64:67], v[128:143]
    ds_read_b64_tr_b16 v[116:117], v73 offset:4096
    ds_read_b64_tr_b16 v[118:119], v73 offset:5120
    v_mfma_f32_32x32x16_bf16 v[160:175], v[104:107], a[192:195], v[160:175]
    ds_read_b64_tr_b16 v[120:121], v74 offset:4096
    v_mfma_f32_32x32x16_bf16 v[144:159], v[108:111], a[64:67], v[144:159]
    ds_read_b64_tr_b16 v[122:123], v74 offset:5120
    ds_read_b64_tr_b16 v[124:125], v75 offset:4096
    v_mfma_f32_32x32x16_bf16 v[176:191], v[108:111], a[192:195], v[176:191]
    ds_read_b64_tr_b16 v[126:127], v75 offset:5120
    s_waitcnt lgkmcnt(0)
    v_mfma_f32_32x32x16_bf16 v[192:207], v[112:115], a[68:71], v[192:207]
    ds_read_b128 a[72:75], v23 offset:0
    buffer_load_dwordx4 v7, s[12:15], s68 offen offset:2048 lds
    v_mfma_f32_32x32x16_bf16 v[224:239], v[112:115], a[196:199], v[224:239]
    ds_read_b128 a[200:203], v23 offset:4096
    buffer_load_dwordx4 v8, s[12:15], s68 offen offset:3072 lds
    v_mfma_f32_32x32x16_bf16 v[208:223], v[116:119], a[68:71], v[208:223]
    ds_read_b64_tr_b16 v[96:97], v72 offset:8192
    v_mfma_f32_32x32x16_bf16 v[240:255], v[116:119], a[196:199], v[240:255]
    s_add_u32 m0, s61, 32768
    s_add_u32 s68, s67, 3145728
    buffer_load_dwordx4 v64, s[16:19], s68 offen offset:0 lds
    ds_read_b64_tr_b16 v[98:99], v72 offset:9216
    v_mfma_f32_32x32x16_bf16 v[128:143], v[120:123], a[68:71], v[128:143]
    ds_read_b64_tr_b16 v[100:101], v73 offset:8192
    ds_read_b64_tr_b16 v[102:103], v73 offset:9216
    v_mfma_f32_32x32x16_bf16 v[160:175], v[120:123], a[196:199], v[160:175]
    ds_read_b64_tr_b16 v[104:105], v74 offset:8192
    v_mfma_f32_32x32x16_bf16 v[144:159], v[124:127], a[68:71], v[144:159]
    ds_read_b64_tr_b16 v[106:107], v74 offset:9216
    ds_read_b64_tr_b16 v[108:109], v75 offset:8192
    v_mfma_f32_32x32x16_bf16 v[176:191], v[124:127], a[196:199], v[176:191]
    ds_read_b64_tr_b16 v[110:111], v75 offset:9216
    s_waitcnt lgkmcnt(0)
    v_mfma_f32_32x32x16_bf16 v[192:207], v[96:99], a[72:75], v[192:207]
    ds_read_b128 a[76:79], v24 offset:0
    buffer_load_dwordx4 v65, s[16:19], s68 offen offset:1024 lds
    v_mfma_f32_32x32x16_bf16 v[224:239], v[96:99], a[200:203], v[224:239]
    ds_read_b128 a[204:207], v24 offset:4096
    buffer_load_dwordx4 v66, s[16:19], s68 offen offset:2048 lds
    v_mfma_f32_32x32x16_bf16 v[208:223], v[100:103], a[72:75], v[208:223]
    ds_read_b64_tr_b16 v[112:113], v72 offset:12288
    v_mfma_f32_32x32x16_bf16 v[240:255], v[100:103], a[200:203], v[240:255]
    buffer_load_dwordx4 v67, s[16:19], s68 offen offset:3072 lds
    ds_read_b64_tr_b16 v[114:115], v72 offset:13312
    v_mfma_f32_32x32x16_bf16 v[128:143], v[104:107], a[72:75], v[128:143]
    ds_read_b64_tr_b16 v[116:117], v73 offset:12288
    ds_read_b64_tr_b16 v[118:119], v73 offset:13312
    v_mfma_f32_32x32x16_bf16 v[160:175], v[104:107], a[200:203], v[160:175]
    ds_read_b64_tr_b16 v[120:121], v74 offset:12288
    v_mfma_f32_32x32x16_bf16 v[144:159], v[108:111], a[72:75], v[144:159]
    ds_read_b64_tr_b16 v[122:123], v74 offset:13312
    ds_read_b64_tr_b16 v[124:125], v75 offset:12288
    v_mfma_f32_32x32x16_bf16 v[176:191], v[108:111], a[200:203], v[176:191]
    ds_read_b64_tr_b16 v[126:127], v75 offset:13312
    s_waitcnt lgkmcnt(0)
    s_waitcnt vmcnt(12)
    s_barrier
    v_mfma_f32_32x32x16_bf16 v[192:207], v[112:115], a[76:79], v[192:207]
    ds_read_b128 a[80:83], v21 offset:49152
    s_add_u32 m0, s60, 49152
    s_add_u32 s68, s58, 896
    buffer_load_dwordx4 v1, s[12:15], s68 offen offset:0 lds
    v_mfma_f32_32x32x16_bf16 v[224:239], v[112:115], a[204:207], v[224:239]
    ds_read_b128 a[208:211], v21 offset:53248
    buffer_load_dwordx4 v2, s[12:15], s68 offen offset:1024 lds
    v_mfma_f32_32x32x16_bf16 v[208:223], v[116:119], a[76:79], v[208:223]
    ds_read_b64_tr_b16 v[96:97], v72 offset:49152
    v_mfma_f32_32x32x16_bf16 v[240:255], v[116:119], a[204:207], v[240:255]
    buffer_load_dwordx4 v3, s[12:15], s68 offen offset:2048 lds
    ds_read_b64_tr_b16 v[98:99], v72 offset:50176
    v_mfma_f32_32x32x16_bf16 v[128:143], v[120:123], a[76:79], v[128:143]
    ds_read_b64_tr_b16 v[100:101], v73 offset:49152
    ds_read_b64_tr_b16 v[102:103], v73 offset:50176
    v_mfma_f32_32x32x16_bf16 v[160:175], v[120:123], a[204:207], v[160:175]
    ds_read_b64_tr_b16 v[104:105], v74 offset:49152
    v_mfma_f32_32x32x16_bf16 v[144:159], v[124:127], a[76:79], v[144:159]
    ds_read_b64_tr_b16 v[106:107], v74 offset:50176
    ds_read_b64_tr_b16 v[108:109], v75 offset:49152
    v_mfma_f32_32x32x16_bf16 v[176:191], v[124:127], a[204:207], v[176:191]
    ds_read_b64_tr_b16 v[110:111], v75 offset:50176
    s_waitcnt lgkmcnt(0)
    v_mfma_f32_32x32x16_bf16 v[192:207], v[96:99], a[80:83], v[192:207]
    ds_read_b128 a[84:87], v22 offset:49152
    buffer_load_dwordx4 v4, s[12:15], s68 offen offset:3072 lds
    v_mfma_f32_32x32x16_bf16 v[224:239], v[96:99], a[208:211], v[224:239]
    ds_read_b128 a[212:215], v22 offset:53248
    s_add_u32 m0, s60, 53248
    s_add_u32 s68, s58, 896
    buffer_load_dwordx4 v5, s[12:15], s68 offen offset:0 lds
    v_mfma_f32_32x32x16_bf16 v[208:223], v[100:103], a[80:83], v[208:223]
    ds_read_b64_tr_b16 v[112:113], v72 offset:53248
    v_mfma_f32_32x32x16_bf16 v[240:255], v[100:103], a[208:211], v[240:255]
    buffer_load_dwordx4 v6, s[12:15], s68 offen offset:1024 lds
    ds_read_b64_tr_b16 v[114:115], v72 offset:54272
    v_mfma_f32_32x32x16_bf16 v[128:143], v[104:107], a[80:83], v[128:143]
    ds_read_b64_tr_b16 v[116:117], v73 offset:53248
    ds_read_b64_tr_b16 v[118:119], v73 offset:54272
    v_mfma_f32_32x32x16_bf16 v[160:175], v[104:107], a[208:211], v[160:175]
    ds_read_b64_tr_b16 v[120:121], v74 offset:53248
    v_mfma_f32_32x32x16_bf16 v[144:159], v[108:111], a[80:83], v[144:159]
    ds_read_b64_tr_b16 v[122:123], v74 offset:54272
    ds_read_b64_tr_b16 v[124:125], v75 offset:53248
    v_mfma_f32_32x32x16_bf16 v[176:191], v[108:111], a[208:211], v[176:191]
    ds_read_b64_tr_b16 v[126:127], v75 offset:54272
    s_waitcnt lgkmcnt(0)
    v_mfma_f32_32x32x16_bf16 v[192:207], v[112:115], a[84:87], v[192:207]
    ds_read_b128 a[88:91], v23 offset:49152
    buffer_load_dwordx4 v7, s[12:15], s68 offen offset:2048 lds
    v_mfma_f32_32x32x16_bf16 v[224:239], v[112:115], a[212:215], v[224:239]
    ds_read_b128 a[216:219], v23 offset:53248
    buffer_load_dwordx4 v8, s[12:15], s68 offen offset:3072 lds
    v_mfma_f32_32x32x16_bf16 v[208:223], v[116:119], a[84:87], v[208:223]
    ds_read_b64_tr_b16 v[96:97], v72 offset:57344
    v_mfma_f32_32x32x16_bf16 v[240:255], v[116:119], a[212:215], v[240:255]
    s_add_u32 m0, s61, 81920
    s_add_u32 s68, s67, 3670016
    buffer_load_dwordx4 v64, s[16:19], s68 offen offset:0 lds
    ds_read_b64_tr_b16 v[98:99], v72 offset:58368
    v_mfma_f32_32x32x16_bf16 v[128:143], v[120:123], a[84:87], v[128:143]
    ds_read_b64_tr_b16 v[100:101], v73 offset:57344
    ds_read_b64_tr_b16 v[102:103], v73 offset:58368
    v_mfma_f32_32x32x16_bf16 v[160:175], v[120:123], a[212:215], v[160:175]
    ds_read_b64_tr_b16 v[104:105], v74 offset:57344
    v_mfma_f32_32x32x16_bf16 v[144:159], v[124:127], a[84:87], v[144:159]
    ds_read_b64_tr_b16 v[106:107], v74 offset:58368
    ds_read_b64_tr_b16 v[108:109], v75 offset:57344
    v_mfma_f32_32x32x16_bf16 v[176:191], v[124:127], a[212:215], v[176:191]
    ds_read_b64_tr_b16 v[110:111], v75 offset:58368
    s_waitcnt lgkmcnt(0)
    v_mfma_f32_32x32x16_bf16 v[192:207], v[96:99], a[88:91], v[192:207]
    ds_read_b128 a[92:95], v24 offset:49152
    buffer_load_dwordx4 v65, s[16:19], s68 offen offset:1024 lds
    v_mfma_f32_32x32x16_bf16 v[224:239], v[96:99], a[216:219], v[224:239]
    ds_read_b128 a[220:223], v24 offset:53248
    buffer_load_dwordx4 v66, s[16:19], s68 offen offset:2048 lds
    v_mfma_f32_32x32x16_bf16 v[208:223], v[100:103], a[88:91], v[208:223]
    ds_read_b64_tr_b16 v[112:113], v72 offset:61440
    v_mfma_f32_32x32x16_bf16 v[240:255], v[100:103], a[216:219], v[240:255]
    buffer_load_dwordx4 v67, s[16:19], s68 offen offset:3072 lds
    ds_read_b64_tr_b16 v[114:115], v72 offset:62464
    v_mfma_f32_32x32x16_bf16 v[128:143], v[104:107], a[88:91], v[128:143]
    ds_read_b64_tr_b16 v[116:117], v73 offset:61440
    ds_read_b64_tr_b16 v[118:119], v73 offset:62464
    v_mfma_f32_32x32x16_bf16 v[160:175], v[104:107], a[216:219], v[160:175]
    ds_read_b64_tr_b16 v[120:121], v74 offset:61440
    v_mfma_f32_32x32x16_bf16 v[144:159], v[108:111], a[88:91], v[144:159]
    ds_read_b64_tr_b16 v[122:123], v74 offset:62464
    ds_read_b64_tr_b16 v[124:125], v75 offset:61440
    v_mfma_f32_32x32x16_bf16 v[176:191], v[108:111], a[216:219], v[176:191]
    ds_read_b64_tr_b16 v[126:127], v75 offset:62464
    s_waitcnt lgkmcnt(0)
    s_waitcnt vmcnt(12)
    s_barrier
    v_mfma_f32_32x32x16_bf16 v[192:207], v[112:115], a[92:95], v[192:207]
    ds_read_b128 a[96:99], v17 offset:0
    s_add_u32 m0, s60, 98304
    s_add_u32 s68, s59, 256
    buffer_load_dwordx4 v9, s[16:19], s68 offen offset:0 lds
    v_mfma_f32_32x32x16_bf16 v[224:239], v[112:115], a[220:223], v[224:239]
    ds_read_b128 a[224:227], v17 offset:4096
    buffer_load_dwordx4 v10, s[16:19], s68 offen offset:1024 lds
    v_mfma_f32_32x32x16_bf16 v[208:223], v[116:119], a[92:95], v[208:223]
    ds_read_b64_tr_b16 v[96:97], v68 offset:0
    buffer_load_dwordx4 v11, s[16:19], s68 offen offset:2048 lds
    v_mfma_f32_32x32x16_bf16 v[240:255], v[116:119], a[220:223], v[240:255]
    ds_read_b64_tr_b16 v[98:99], v68 offset:1024
    v_mfma_f32_32x32x16_bf16 v[128:143], v[120:123], a[92:95], v[128:143]
    buffer_load_dwordx4 v12, s[16:19], s68 offen offset:3072 lds
    ds_read_b64_tr_b16 v[100:101], v69 offset:0
    v_mfma_f32_32x32x16_bf16 v[160:175], v[120:123], a[220:223], v[160:175]
    ds_read_b64_tr_b16 v[102:103], v69 offset:1024
    ds_read_b64_tr_b16 v[104:105], v70 offset:0
    v_mfma_f32_32x32x16_bf16 v[144:159], v[124:127], a[92:95], v[144:159]
    ds_read_b64_tr_b16 v[106:107], v70 offset:1024
    ds_read_b64_tr_b16 v[108:109], v71 offset:0
    v_mfma_f32_32x32x16_bf16 v[176:191], v[124:127], a[220:223], v[176:191]
    ds_read_b64_tr_b16 v[110:111], v71 offset:1024
    s_waitcnt lgkmcnt(0)
    v_mfma_f32_32x32x16_bf16 v[192:207], v[96:99], a[96:99], v[192:207]
    ds_read_b128 a[100:103], v18 offset:0
    s_add_u32 m0, s60, 102400
    s_add_u32 s68, s59, 256
    buffer_load_dwordx4 v13, s[16:19], s68 offen offset:0 lds
    v_mfma_f32_32x32x16_bf16 v[224:239], v[96:99], a[224:227], v[224:239]
    ds_read_b128 a[228:231], v18 offset:4096
    buffer_load_dwordx4 v14, s[16:19], s68 offen offset:1024 lds
    v_mfma_f32_32x32x16_bf16 v[208:223], v[100:103], a[96:99], v[208:223]
    ds_read_b64_tr_b16 v[112:113], v68 offset:4096
    v_mfma_f32_32x32x16_bf16 v[240:255], v[100:103], a[224:227], v[240:255]
    buffer_load_dwordx4 v15, s[16:19], s68 offen offset:2048 lds
    ds_read_b64_tr_b16 v[114:115], v68 offset:5120
    v_mfma_f32_32x32x16_bf16 v[128:143], v[104:107], a[96:99], v[128:143]
    ds_read_b64_tr_b16 v[116:117], v69 offset:4096
    ds_read_b64_tr_b16 v[118:119], v69 offset:5120
    v_mfma_f32_32x32x16_bf16 v[160:175], v[104:107], a[224:227], v[160:175]
    ds_read_b64_tr_b16 v[120:121], v70 offset:4096
    v_mfma_f32_32x32x16_bf16 v[144:159], v[108:111], a[96:99], v[144:159]
    ds_read_b64_tr_b16 v[122:123], v70 offset:5120
    ds_read_b64_tr_b16 v[124:125], v71 offset:4096
    v_mfma_f32_32x32x16_bf16 v[176:191], v[108:111], a[224:227], v[176:191]
    ds_read_b64_tr_b16 v[126:127], v71 offset:5120
    s_waitcnt lgkmcnt(0)
    v_mfma_f32_32x32x16_bf16 v[192:207], v[112:115], a[100:103], v[192:207]
    ds_read_b128 a[104:107], v19 offset:0
    buffer_load_dwordx4 v16, s[16:19], s68 offen offset:3072 lds
    v_mfma_f32_32x32x16_bf16 v[224:239], v[112:115], a[228:231], v[224:239]
    ds_read_b128 a[232:235], v19 offset:4096
    s_add_u32 m0, s60, 131072
    s_add_u32 s68, s59, 2097408
    buffer_load_dwordx4 v9, s[16:19], s68 offen offset:0 lds
    v_mfma_f32_32x32x16_bf16 v[208:223], v[116:119], a[100:103], v[208:223]
    ds_read_b64_tr_b16 v[96:97], v68 offset:8192
    buffer_load_dwordx4 v10, s[16:19], s68 offen offset:1024 lds
    v_mfma_f32_32x32x16_bf16 v[240:255], v[116:119], a[228:231], v[240:255]
    ds_read_b64_tr_b16 v[98:99], v68 offset:9216
    v_mfma_f32_32x32x16_bf16 v[128:143], v[120:123], a[100:103], v[128:143]
    buffer_load_dwordx4 v11, s[16:19], s68 offen offset:2048 lds
    ds_read_b64_tr_b16 v[100:101], v69 offset:8192
    v_mfma_f32_32x32x16_bf16 v[160:175], v[120:123], a[228:231], v[160:175]
    ds_read_b64_tr_b16 v[102:103], v69 offset:9216
    ds_read_b64_tr_b16 v[104:105], v70 offset:8192
    v_mfma_f32_32x32x16_bf16 v[144:159], v[124:127], a[100:103], v[144:159]
    ds_read_b64_tr_b16 v[106:107], v70 offset:9216
    ds_read_b64_tr_b16 v[108:109], v71 offset:8192
    v_mfma_f32_32x32x16_bf16 v[176:191], v[124:127], a[228:231], v[176:191]
    ds_read_b64_tr_b16 v[110:111], v71 offset:9216
    s_waitcnt lgkmcnt(0)
    v_mfma_f32_32x32x16_bf16 v[192:207], v[96:99], a[104:107], v[192:207]
    ds_read_b128 a[108:111], v20 offset:0
    buffer_load_dwordx4 v12, s[16:19], s68 offen offset:3072 lds
    v_mfma_f32_32x32x16_bf16 v[224:239], v[96:99], a[232:235], v[224:239]
    ds_read_b128 a[236:239], v20 offset:4096
    s_cmp_lg_u32 s32, 0
    s_cbranch_scc1 L_W0_2
L_W0_2:
    v_mfma_f32_32x32x16_bf16 v[208:223], v[100:103], a[104:107], v[208:223]
    ds_read_b64_tr_b16 v[112:113], v68 offset:12288
    v_mfma_f32_32x32x16_bf16 v[240:255], v[100:103], a[232:235], v[240:255]
    s_cmp_lg_u32 s32, 0
    s_cbranch_scc1 L_W0_3
    v_mov_b32 v46, 1
    v_mov_b32 v47, 0
    s_mov_b64 exec, 1
    buffer_store_byte v46, v47, s[28:31], s2 offen sc0 sc1
    s_mov_b64 exec, -1
L_W0_3:
    ds_read_b64_tr_b16 v[114:115], v68 offset:13312
    v_mfma_f32_32x32x16_bf16 v[128:143], v[104:107], a[104:107], v[128:143]
    ds_read_b64_tr_b16 v[116:117], v69 offset:12288
    ds_read_b64_tr_b16 v[118:119], v69 offset:13312
    v_mfma_f32_32x32x16_bf16 v[160:175], v[104:107], a[232:235], v[160:175]
    ds_read_b64_tr_b16 v[120:121], v70 offset:12288
    v_mfma_f32_32x32x16_bf16 v[144:159], v[108:111], a[104:107], v[144:159]
    ds_read_b64_tr_b16 v[122:123], v70 offset:13312
    ds_read_b64_tr_b16 v[124:125], v71 offset:12288
    v_mfma_f32_32x32x16_bf16 v[176:191], v[108:111], a[232:235], v[176:191]
    ds_read_b64_tr_b16 v[126:127], v71 offset:13312
    s_waitcnt lgkmcnt(0)
    s_waitcnt vmcnt(12)
    s_barrier
    v_mfma_f32_32x32x16_bf16 v[192:207], v[112:115], a[108:111], v[192:207]
    ds_read_b128 a[112:115], v21 offset:0
    s_add_u32 m0, s60, 135168
    s_add_u32 s68, s59, 2097408
    buffer_load_dwordx4 v13, s[16:19], s68 offen offset:0 lds
    v_mfma_f32_32x32x16_bf16 v[224:239], v[112:115], a[236:239], v[224:239]
    ds_read_b128 a[240:243], v21 offset:4096
    buffer_load_dwordx4 v14, s[16:19], s68 offen offset:1024 lds
    v_mfma_f32_32x32x16_bf16 v[208:223], v[116:119], a[108:111], v[208:223]
    ds_read_b64_tr_b16 v[96:97], v72 offset:0
    v_mfma_f32_32x32x16_bf16 v[240:255], v[116:119], a[236:239], v[240:255]
    buffer_load_dwordx4 v15, s[16:19], s68 offen offset:2048 lds
    ds_read_b64_tr_b16 v[98:99], v72 offset:1024
    v_mfma_f32_32x32x16_bf16 v[128:143], v[120:123], a[108:111], v[128:143]
    ds_read_b64_tr_b16 v[100:101], v73 offset:0
    ds_read_b64_tr_b16 v[102:103], v73 offset:1024
    v_mfma_f32_32x32x16_bf16 v[160:175], v[120:123], a[236:239], v[160:175]
    ds_read_b64_tr_b16 v[104:105], v74 offset:0
    v_mfma_f32_32x32x16_bf16 v[144:159], v[124:127], a[108:111], v[144:159]
    ds_read_b64_tr_b16 v[106:107], v74 offset:1024
    ds_read_b64_tr_b16 v[108:109], v75 offset:0
    v_mfma_f32_32x32x16_bf16 v[176:191], v[124:127], a[236:239], v[176:191]
    ds_read_b64_tr_b16 v[110:111], v75 offset:1024
    s_waitcnt lgkmcnt(0)
    v_mfma_f32_32x32x16_bf16 v[192:207], v[96:99], a[112:115], v[192:207]
    ds_read_b128 a[116:119], v22 offset:0
    buffer_load_dwordx4 v16, s[16:19], s68 offen offset:3072 lds
    v_mfma_f32_32x32x16_bf16 v[224:239], v[96:99], a[240:243], v[224:239]
    ds_read_b128 a[244:247], v22 offset:4096
    s_add_u32 m0, s60, 0
    s_add_u32 s68, s59, 384
    buffer_load_dwordx4 v9, s[16:19], s68 offen offset:0 lds
    v_mfma_f32_32x32x16_bf16 v[208:223], v[100:103], a[112:115], v[208:223]
    ds_read_b64_tr_b16 v[112:113], v72 offset:4096
    v_mfma_f32_32x32x16_bf16 v[240:255], v[100:103], a[240:243], v[240:255]
    buffer_load_dwordx4 v10, s[16:19], s68 offen offset:1024 lds
    ds_read_b64_tr_b16 v[114:115], v72 offset:5120
    v_mfma_f32_32x32x16_bf16 v[128:143], v[104:107], a[112:115], v[128:143]
    ds_read_b64_tr_b16 v[116:117], v73 offset:4096
    ds_read_b64_tr_b16 v[118:119], v73 offset:5120
    v_mfma_f32_32x32x16_bf16 v[160:175], v[104:107], a[240:243], v[160:175]
    ds_read_b64_tr_b16 v[120:121], v74 offset:4096
    v_mfma_f32_32x32x16_bf16 v[144:159], v[108:111], a[112:115], v[144:159]
    ds_read_b64_tr_b16 v[122:123], v74 offset:5120
    ds_read_b64_tr_b16 v[124:125], v75 offset:4096
    v_mfma_f32_32x32x16_bf16 v[176:191], v[108:111], a[240:243], v[176:191]
    ds_read_b64_tr_b16 v[126:127], v75 offset:5120
    s_waitcnt lgkmcnt(0)
    v_mfma_f32_32x32x16_bf16 v[192:207], v[112:115], a[116:119], v[192:207]
    ds_read_b128 a[120:123], v23 offset:0
    buffer_load_dwordx4 v11, s[16:19], s68 offen offset:2048 lds
    v_mfma_f32_32x32x16_bf16 v[224:239], v[112:115], a[244:247], v[224:239]
    ds_read_b128 a[248:251], v23 offset:4096
    buffer_load_dwordx4 v12, s[16:19], s68 offen offset:3072 lds
    v_mfma_f32_32x32x16_bf16 v[208:223], v[116:119], a[116:119], v[208:223]
    ds_read_b64_tr_b16 v[96:97], v72 offset:8192
    v_mfma_f32_32x32x16_bf16 v[240:255], v[116:119], a[244:247], v[240:255]
    s_add_u32 m0, s60, 4096
    s_add_u32 s68, s59, 384
    buffer_load_dwordx4 v13, s[16:19], s68 offen offset:0 lds
    ds_read_b64_tr_b16 v[98:99], v72 offset:9216
    v_mfma_f32_32x32x16_bf16 v[128:143], v[120:123], a[116:119], v[128:143]
    ds_read_b64_tr_b16 v[100:101], v73 offset:8192
    ds_read_b64_tr_b16 v[102:103], v73 offset:9216
    v_mfma_f32_32x32x16_bf16 v[160:175], v[120:123], a[244:247], v[160:175]
    ds_read_b64_tr_b16 v[104:105], v74 offset:8192
    v_mfma_f32_32x32x16_bf16 v[144:159], v[124:127], a[116:119], v[144:159]
    ds_read_b64_tr_b16 v[106:107], v74 offset:9216
    ds_read_b64_tr_b16 v[108:109], v75 offset:8192
    v_mfma_f32_32x32x16_bf16 v[176:191], v[124:127], a[244:247], v[176:191]
    ds_read_b64_tr_b16 v[110:111], v75 offset:9216
    s_waitcnt lgkmcnt(0)
    v_mfma_f32_32x32x16_bf16 v[192:207], v[96:99], a[120:123], v[192:207]
    ds_read_b128 a[124:127], v24 offset:0
    buffer_load_dwordx4 v14, s[16:19], s68 offen offset:1024 lds
    v_mfma_f32_32x32x16_bf16 v[224:239], v[96:99], a[248:251], v[224:239]
    ds_read_b128 a[252:255], v24 offset:4096
    buffer_load_dwordx4 v15, s[16:19], s68 offen offset:2048 lds
    v_mfma_f32_32x32x16_bf16 v[208:223], v[100:103], a[120:123], v[208:223]
    ds_read_b64_tr_b16 v[112:113], v72 offset:12288
    v_mfma_f32_32x32x16_bf16 v[240:255], v[100:103], a[248:251], v[240:255]
    buffer_load_dwordx4 v16, s[16:19], s68 offen offset:3072 lds
    ds_read_b64_tr_b16 v[114:115], v72 offset:13312
    v_mfma_f32_32x32x16_bf16 v[128:143], v[104:107], a[120:123], v[128:143]
    ds_read_b64_tr_b16 v[116:117], v73 offset:12288
    ds_read_b64_tr_b16 v[118:119], v73 offset:13312
    v_mfma_f32_32x32x16_bf16 v[160:175], v[104:107], a[248:251], v[160:175]
    ds_read_b64_tr_b16 v[120:121], v74 offset:12288
    v_mfma_f32_32x32x16_bf16 v[144:159], v[108:111], a[120:123], v[144:159]
    ds_read_b64_tr_b16 v[122:123], v74 offset:13312
    ds_read_b64_tr_b16 v[124:125], v75 offset:12288
    v_mfma_f32_32x32x16_bf16 v[176:191], v[108:111], a[248:251], v[176:191]
    ds_read_b64_tr_b16 v[126:127], v75 offset:13312
    s_waitcnt lgkmcnt(0)
    s_waitcnt vmcnt(16)
    s_barrier
    v_mfma_f32_32x32x16_bf16 v[192:207], v[112:115], a[124:127], v[192:207]
    v_mfma_f32_32x32x16_bf16 v[224:239], v[112:115], a[252:255], v[224:239]
    v_mfma_f32_32x32x16_bf16 v[208:223], v[116:119], a[124:127], v[208:223]
    v_mfma_f32_32x32x16_bf16 v[240:255], v[116:119], a[252:255], v[240:255]
    ds_read_b64_tr_b16 v[96:97], v27 offset:32768
    ds_read_b64_tr_b16 v[98:99], v27 offset:33280
    ds_read_b64_tr_b16 v[100:101], v28 offset:32768
    ds_read_b64_tr_b16 v[102:103], v28 offset:33280
    v_mfma_f32_32x32x16_bf16 v[128:143], v[120:123], a[124:127], v[128:143]
    v_mfma_f32_32x32x16_bf16 v[160:175], v[120:123], a[252:255], v[160:175]
    v_cvt_pk_bf16_f32 v64, v192, v193
    v_cvt_pk_bf16_f32 v65, v194, v195
    v_cvt_pk_bf16_f32 v66, v196, v197
    v_cvt_pk_bf16_f32 v67, v198, v199
    v_cvt_pk_bf16_f32 v68, v200, v201
    v_cvt_pk_bf16_f32 v69, v202, v203
    v_cvt_pk_bf16_f32 v70, v204, v205
    v_cvt_pk_bf16_f32 v71, v206, v207
    v_mfma_f32_32x32x16_bf16 v[144:159], v[124:127], a[124:127], v[144:159]
    v_cvt_pk_bf16_f32 v80, v224, v225
    v_cvt_pk_bf16_f32 v81, v226, v227
    v_cvt_pk_bf16_f32 v82, v228, v229
    v_cvt_pk_bf16_f32 v83, v230, v231
    v_cvt_pk_bf16_f32 v84, v232, v233
    v_cvt_pk_bf16_f32 v85, v234, v235
    v_cvt_pk_bf16_f32 v86, v236, v237
    v_cvt_pk_bf16_f32 v87, v238, v239
    v_mfma_f32_32x32x16_bf16 v[176:191], v[124:127], a[252:255], v[176:191]
    ds_read_b64_tr_b16 v[104:105], v27 offset:34816
    ds_read_b64_tr_b16 v[106:107], v27 offset:35328
    ds_read_b64_tr_b16 v[108:109], v28 offset:34816
    ds_read_b64_tr_b16 v[110:111], v28 offset:35328
    v_cvt_pk_bf16_f32 v72, v208, v209
    v_cvt_pk_bf16_f32 v73, v210, v211
    v_cvt_pk_bf16_f32 v74, v212, v213
    v_cvt_pk_bf16_f32 v75, v214, v215
    v_cvt_pk_bf16_f32 v76, v216, v217
    v_cvt_pk_bf16_f32 v77, v218, v219
    v_cvt_pk_bf16_f32 v78, v220, v221
    v_cvt_pk_bf16_f32 v79, v222, v223
    v_cvt_pk_bf16_f32 v88, v240, v241
    v_cvt_pk_bf16_f32 v89, v242, v243
    v_cvt_pk_bf16_f32 v90, v244, v245
    v_cvt_pk_bf16_f32 v91, v246, v247
    v_cvt_pk_bf16_f32 v92, v248, v249
    v_cvt_pk_bf16_f32 v93, v250, v251
    v_cvt_pk_bf16_f32 v94, v252, v253
    v_cvt_pk_bf16_f32 v95, v254, v255
    s_waitcnt lgkmcnt(4)
    v_mfma_f32_32x32x16_bf16 v[192:207], v[96:99], a[0:3], 0
    ds_read_b64_tr_b16 v[112:113], v27 offset:36864
    s_add_u32 m0, s60, 32768
    s_add_u32 s68, s59, 2097536
    buffer_load_dwordx4 v9, s[16:19], s68 offen offset:0 lds
    ds_read_b64_tr_b16 v[114:115], v27 offset:37376
    v_mfma_f32_32x32x16_bf16 v[224:239], v[96:99], a[128:131], 0
    buffer_load_dwordx4 v10, s[16:19], s68 offen offset:1024 lds
    ds_read_b64_tr_b16 v[116:117], v28 offset:36864
    v_mfma_f32_32x32x16_bf16 v[208:223], v[100:103], a[0:3], 0
    v_add_u32 v46, 0, v0
    v_mul_u32_u24 v47, 43691, v46
    v_lshrrev_b32 v47, 19, v47
    v_mul_u32_u24 v48, 12, v47
    ds_read_b64_tr_b16 v[118:119], v28 offset:37376
    v_mfma_f32_32x32x16_bf16 v[240:255], v[100:103], a[128:131], 0
    v_sub_u32 v48, v46, v48
    v_mul_u32_u24 v47, 2752, v47
    v_lshl_add_u32 v1, v48, 4, v47
    v_subrev_u32 v1, 0, v1
    s_add_u32 s57, s62, 0
    buffer_store_dwordx4 v[64:67], v31, s[24:27], s57 offen offset:0 sc1
    s_waitcnt lgkmcnt(4)
    v_mfma_f32_32x32x16_bf16 v[192:207], v[104:107], a[4:7], v[192:207]
    ds_read_b64_tr_b16 v[120:121], v27 offset:38912
    buffer_load_dwordx4 v11, s[16:19], s68 offen offset:2048 lds
    v_mfma_f32_32x32x16_bf16 v[224:239], v[104:107], a[132:135], v[224:239]
    ds_read_b64_tr_b16 v[122:123], v27 offset:39424
    s_cmp_eq_u32 s34, 7
    s_cselect_b32 s56, 2, 12
    v_cmp_le_u32 vcc, s56, v48
    v_mov_b32 v47, 0x40000000
    s_nop 0
    v_cndmask_b32 v1, v1, v47, vcc
    v_mfma_f32_32x32x16_bf16 v[208:223], v[108:111], a[4:7], v[208:223]
    ds_read_b64_tr_b16 v[124:125], v28 offset:38912
    v_add_u32 v46, 64, v0
    v_mul_u32_u24 v47, 43691, v46
    v_lshrrev_b32 v47, 19, v47
    v_mul_u32_u24 v48, 12, v47
    v_mfma_f32_32x32x16_bf16 v[240:255], v[108:111], a[132:135], v[240:255]
    ds_read_b64_tr_b16 v[126:127], v28 offset:39424
    buffer_store_dwordx4 v[68:71], v31, s[24:27], s57 offen offset:1024 sc1
    s_waitcnt lgkmcnt(4)
    v_mfma_f32_32x32x16_bf16 v[192:207], v[112:115], a[8:11], v[192:207]
    ds_read_b64_tr_b16 v[96:97], v27 offset:40960
    buffer_load_dwordx4 v12, s[16:19], s68 offen offset:3072 lds
    v_mfma_f32_32x32x16_bf16 v[224:239], v[112:115], a[136:139], v[224:239]
    ds_read_b64_tr_b16 v[98:99], v27 offset:41472
    v_sub_u32 v48, v46, v48
    v_mul_u32_u24 v47, 2752, v47
    v_lshl_add_u32 v2, v48, 4, v47
    v_subrev_u32 v2, 1024, v2
    v_mfma_f32_32x32x16_bf16 v[208:223], v[116:119], a[8:11], v[208:223]
    ds_read_b64_tr_b16 v[100:101], v28 offset:40960
    s_cmp_eq_u32 s34, 7
    s_cselect_b32 s56, 2, 12
    v_cmp_le_u32 vcc, s56, v48
    v_mov_b32 v47, 0x40000000
    s_nop 0
    v_cndmask_b32 v2, v2, v47, vcc
    v_mfma_f32_32x32x16_bf16 v[240:255], v[116:119], a[136:139], v[240:255]
    ds_read_b64_tr_b16 v[102:103], v28 offset:41472
    s_waitcnt lgkmcnt(4)
    v_mfma_f32_32x32x16_bf16 v[192:207], v[120:123], a[12:15], v[192:207]
    ds_read_b64_tr_b16 v[104:105], v27 offset:43008
    s_add_u32 m0, s60, 36864
    s_add_u32 s68, s59, 2097536
    buffer_load_dwordx4 v13, s[16:19], s68 offen offset:0 lds
    ds_read_b64_tr_b16 v[106:107], v27 offset:43520
    v_mfma_f32_32x32x16_bf16 v[224:239], v[120:123], a[140:143], v[224:239]
    buffer_load_dwordx4 v14, s[16:19], s68 offen offset:1024 lds
    ds_read_b64_tr_b16 v[108:109], v28 offset:43008
    v_mfma_f32_32x32x16_bf16 v[208:223], v[124:127], a[12:15], v[208:223]
    v_add_u32 v46, 128, v0
    v_mul_u32_u24 v47, 43691, v46
    v_lshrrev_b32 v47, 19, v47
    v_mul_u32_u24 v48, 12, v47
    ds_read_b64_tr_b16 v[110:111], v28 offset:43520
    v_mfma_f32_32x32x16_bf16 v[240:255], v[124:127], a[140:143], v[240:255]
    v_sub_u32 v48, v46, v48
    v_mul_u32_u24 v47, 2752, v47
    v_lshl_add_u32 v3, v48, 4, v47
    v_subrev_u32 v3, 2048, v3
    buffer_store_dwordx4 v[72:75], v31, s[24:27], s57 offen offset:2048 sc1
    s_waitcnt lgkmcnt(4)
    v_mfma_f32_32x32x16_bf16 v[192:207], v[96:99], a[16:19], v[192:207]
    ds_read_b64_tr_b16 v[112:113], v27 offset:45056
    buffer_load_dwordx4 v15, s[16:19], s68 offen offset:2048 lds
    v_mfma_f32_32x32x16_bf16 v[224:239], v[96:99], a[144:147], v[224:239]
    ds_read_b64_tr_b16 v[114:115], v27 offset:45568
    s_cmp_eq_u32 s34, 7
    s_cselect_b32 s56, 2, 12
    v_cmp_le_u32 vcc, s56, v48
    v_mov_b32 v47, 0x40000000
    s_nop 0
    v_cndmask_b32 v3, v3, v47, vcc
    v_mfma_f32_32x32x16_bf16 v[208:223], v[100:103], a[16:19], v[208:223]
    ds_read_b64_tr_b16 v[116:117], v28 offset:45056
    v_lshl_add_u32 v46, v33, 3, v35
    v_mul_u32_u24 v46, 192, v46
    v_lshl_add_u32 v46, v37, 5, v46
    v_lshl_add_u32 v46, v36, 3, v46
    v_mfma_f32_32x32x16_bf16 v[240:255], v[100:103], a[144:147], v[240:255]
    ds_read_b64_tr_b16 v[118:119], v28 offset:45568
    s_waitcnt lgkmcnt(4)
    v_mfma_f32_32x32x16_bf16 v[192:207], v[104:107], a[20:23], v[192:207]
    ds_read_b64_tr_b16 v[120:121], v27 offset:47104
    buffer_load_dwordx4 v16, s[16:19], s68 offen offset:3072 lds
    v_mfma_f32_32x32x16_bf16 v[224:239], v[104:107], a[148:151], v[224:239]
    ds_read_b64_tr_b16 v[122:123], v27 offset:47616
    s_lshl_b32 s56, s38, 12
    v_add_u32 v17, s56, v46
    v_add_u32 v18, 0x10000, v17
    v_add_u32 v19, 0x20000, v17
    v_mfma_f32_32x32x16_bf16 v[208:223], v[108:111], a[20:23], v[208:223]
    ds_read_b64_tr_b16 v[124:125], v28 offset:47104
    s_lshl_b32 s56, s37, 12
    s_add_u32 s56, s56, 3072
    v_add_u32 v20, s56, v31
    v_add_u32 v21, 0x10000, v20
    v_add_u32 v22, 0x20000, v20
    v_mfma_f32_32x32x16_bf16 v[240:255], v[108:111], a[148:151], v[240:255]
    ds_read_b64_tr_b16 v[126:127], v28 offset:47616
    buffer_store_dwordx4 v[76:79], v31, s[24:27], s57 offen offset:3072 sc1
    s_waitcnt lgkmcnt(4)
    v_mfma_f32_32x32x16_bf16 v[192:207], v[112:115], a[24:27], v[192:207]
    ds_read_b64_tr_b16 v[96:97], v27 offset:49152
    v_mfma_f32_32x32x16_bf16 v[224:239], v[112:115], a[152:155], v[224:239]
    ds_read_b64_tr_b16 v[98:99], v27 offset:49664
    v_mfma_f32_32x32x16_bf16 v[208:223], v[116:119], a[24:27], v[208:223]
    ds_read_b64_tr_b16 v[100:101], v28 offset:49152
    v_mfma_f32_32x32x16_bf16 v[240:255], v[116:119], a[152:155], v[240:255]
    ds_read_b64_tr_b16 v[102:103], v28 offset:49664
    s_waitcnt lgkmcnt(4)
    v_mfma_f32_32x32x16_bf16 v[192:207], v[120:123], a[28:31], v[192:207]
    ds_read_b64_tr_b16 v[104:105], v27 offset:51200
    s_add_u32 m0, s60, 65536
    s_add_u32 s68, s63, 0
    buffer_load_dwordx4 v1, s[20:23], s68 offen offset:0 lds
    v_mfma_f32_32x32x16_bf16 v[224:239], v[120:123], a[156:159], v[224:239]
    ds_read_b64_tr_b16 v[106:107], v27 offset:51712
    v_mfma_f32_32x32x16_bf16 v[208:223], v[124:127], a[28:31], v[208:223]
    s_add_u32 s57, s62, 8192
    buffer_store_dwordx4 v[80:83], v31, s[24:27], s57 offen offset:0 sc1
    ds_read_b64_tr_b16 v[108:109], v28 offset:51200
    v_mfma_f32_32x32x16_bf16 v[240:255], v[124:127], a[156:159], v[240:255]
    ds_read_b64_tr_b16 v[110:111], v28 offset:51712
    s_waitcnt lgkmcnt(4)
    v_mfma_f32_32x32x16_bf16 v[192:207], v[96:99], a[32:35], v[192:207]
    ds_read_b64_tr_b16 v[112:113], v27 offset:53248
    buffer_load_dwordx4 v2, s[20:23], s68 offen offset:1024 lds
    v_mfma_f32_32x32x16_bf16 v[224:239], v[96:99], a[160:163], v[224:239]
    ds_read_b64_tr_b16 v[114:115], v27 offset:53760
    v_mfma_f32_32x32x16_bf16 v[208:223], v[100:103], a[32:35], v[208:223]
    ds_read_b64_tr_b16 v[116:117], v28 offset:53248
    v_mfma_f32_32x32x16_bf16 v[240:255], v[100:103], a[160:163], v[240:255]
    ds_read_b64_tr_b16 v[118:119], v28 offset:53760
    s_waitcnt lgkmcnt(4)
    v_mfma_f32_32x32x16_bf16 v[192:207], v[104:107], a[36:39], v[192:207]
    ds_read_b64_tr_b16 v[120:121], v27 offset:55296
    buffer_load_dwordx4 v3, s[20:23], s68 offen offset:2048 lds
    v_mfma_f32_32x32x16_bf16 v[224:239], v[104:107], a[164:167], v[224:239]
    ds_read_b64_tr_b16 v[122:123], v27 offset:55808
    v_mfma_f32_32x32x16_bf16 v[208:223], v[108:111], a[36:39], v[208:223]
    buffer_store_dwordx4 v[84:87], v31, s[24:27], s57 offen offset:1024 sc1
    ds_read_b64_tr_b16 v[124:125], v28 offset:55296
    v_mfma_f32_32x32x16_bf16 v[240:255], v[108:111], a[164:167], v[240:255]
    ds_read_b64_tr_b16 v[126:127], v28 offset:55808
    s_waitcnt lgkmcnt(4)
    v_mfma_f32_32x32x16_bf16 v[192:207], v[112:115], a[40:43], v[192:207]
    ds_read_b64_tr_b16 v[96:97], v27 offset:57344
    s_add_u32 m0, s60, 69632
    s_add_u32 s68, s63, 1376
    buffer_load_dwordx4 v1, s[20:23], s68 offen offset:0 lds
    v_mfma_f32_32x32x16_bf16 v[224:239], v[112:115], a[168:171], v[224:239]
    ds_read_b64_tr_b16 v[98:99], v27 offset:57856
    v_mfma_f32_32x32x16_bf16 v[208:223], v[116:119], a[40:43], v[208:223]
    ds_read_b64_tr_b16 v[100:101], v28 offset:57344
    v_mfma_f32_32x32x16_bf16 v[240:255], v[116:119], a[168:171], v[240:255]
    ds_read_b64_tr_b16 v[102:103], v28 offset:57856
    s_waitcnt lgkmcnt(4)
    v_mfma_f32_32x32x16_bf16 v[192:207], v[120:123], a[44:47], v[192:207]
    ds_read_b64_tr_b16 v[104:105], v27 offset:59392
    buffer_load_dwordx4 v2, s[20:23], s68 offen offset:1024 lds
    v_mfma_f32_32x32x16_bf16 v[224:239], v[120:123], a[172:175], v[224:239]
    ds_read_b64_tr_b16 v[106:107], v27 offset:59904
    v_mfma_f32_32x32x16_bf16 v[208:223], v[124:127], a[44:47], v[208:223]
    buffer_store_dwordx4 v[88:91], v31, s[24:27], s57 offen offset:2048 sc1
    ds_read_b64_tr_b16 v[108:109], v28 offset:59392
    v_mfma_f32_32x32x16_bf16 v[240:255], v[124:127], a[172:175], v[240:255]
    ds_read_b64_tr_b16 v[110:111], v28 offset:59904
    s_waitcnt lgkmcnt(4)
    v_mfma_f32_32x32x16_bf16 v[192:207], v[96:99], a[48:51], v[192:207]
    ds_read_b64_tr_b16 v[112:113], v27 offset:61440
    buffer_load_dwordx4 v3, s[20:23], s68 offen offset:2048 lds
    v_mfma_f32_32x32x16_bf16 v[224:239], v[96:99], a[176:179], v[224:239]
    ds_read_b64_tr_b16 v[114:115], v27 offset:61952
    v_mfma_f32_32x32x16_bf16 v[208:223], v[100:103], a[48:51], v[208:223]
    ds_read_b64_tr_b16 v[116:117], v28 offset:61440
    v_mfma_f32_32x32x16_bf16 v[240:255], v[100:103], a[176:179], v[240:255]
    ds_read_b64_tr_b16 v[118:119], v28 offset:61952
    s_waitcnt lgkmcnt(4)
    v_mfma_f32_32x32x16_bf16 v[192:207], v[104:107], a[52:55], v[192:207]
    ds_read_b64_tr_b16 v[120:121], v27 offset:63488
    buffer_store_dwordx4 v[92:95], v31, s[24:27], s57 offen offset:3072 sc1
    v_mfma_f32_32x32x16_bf16 v[224:239], v[104:107], a[180:183], v[224:239]
    ds_read_b64_tr_b16 v[122:123], v27 offset:64000
    v_mfma_f32_32x32x16_bf16 v[208:223], v[108:111], a[52:55], v[208:223]
    s_cmp_lg_u32 s32, 0
    s_cbranch_scc1 L_W0_4
    v_lshlrev_b32 v50, 2, v0
    buffer_load_dword v51, v50, s[28:31], 0 offen offset:0 sc0 sc1
L_W0_4:
    ds_read_b64_tr_b16 v[124:125], v28 offset:63488
    v_mfma_f32_32x32x16_bf16 v[240:255], v[108:111], a[180:183], v[240:255]
    ds_read_b64_tr_b16 v[126:127], v28 offset:64000
    s_waitcnt lgkmcnt(0)
    s_waitcnt vmcnt(30)
    s_barrier
    v_mfma_f32_32x32x16_bf16 v[192:207], v[112:115], a[56:59], v[192:207]
    ds_read_b64_tr_b16 v[96:97], v29 offset:0
    s_add_u32 m0, s60, 98304
    s_add_u32 s68, s63, 176128
    buffer_load_dwordx4 v1, s[20:23], s68 offen offset:0 lds
    v_mfma_f32_32x32x16_bf16 v[224:239], v[112:115], a[184:187], v[224:239]
    ds_read_b64_tr_b16 v[98:99], v29 offset:512
    v_mfma_f32_32x32x16_bf16 v[208:223], v[116:119], a[56:59], v[208:223]
    ds_read_b64_tr_b16 v[100:101], v30 offset:0
    v_mfma_f32_32x32x16_bf16 v[240:255], v[116:119], a[184:187], v[240:255]
    ds_read_b64_tr_b16 v[102:103], v30 offset:512
    v_mfma_f32_32x32x16_bf16 v[192:207], v[120:123], a[60:63], v[192:207]
    ds_read_b64_tr_b16 v[104:105], v29 offset:2048
    s_add_u32 s57, s62, 4096
    v_cvt_pk_bf16_f32 v128, v128, v129
    v_cvt_pk_bf16_f32 v129, v130, v131
    v_mfma_f32_32x32x16_bf16 v[224:239], v[120:123], a[188:191], v[224:239]
    ds_read_b64_tr_b16 v[106:107], v29 offset:2560
    v_mfma_f32_32x32x16_bf16 v[208:223], v[124:127], a[60:63], v[208:223]
    ds_read_b64_tr_b16 v[108:109], v30 offset:2048
    v_mfma_f32_32x32x16_bf16 v[240:255], v[124:127], a[188:191], v[240:255]
    ds_read_b64_tr_b16 v[110:111], v30 offset:2560
    s_waitcnt lgkmcnt(4)
    v_mfma_f32_32x32x16_bf16 v[192:207], v[96:99], a[64:67], v[192:207]
    ds_read_b64_tr_b16 v[112:113], v29 offset:4096
    v_cvt_pk_bf16_f32 v130, v132, v133
    v_cvt_pk_bf16_f32 v131, v134, v135
    buffer_store_dwordx4 v[128:131], v31, s[24:27], s57 offen offset:0 sc1
    v_mfma_f32_32x32x16_bf16 v[224:239], v[96:99], a[192:195], v[224:239]
    ds_read_b64_tr_b16 v[114:115], v29 offset:4608
    v_mfma_f32_32x32x16_bf16 v[208:223], v[100:103], a[64:67], v[208:223]
    buffer_load_dwordx4 v2, s[20:23], s68 offen offset:1024 lds
    ds_read_b64_tr_b16 v[116:117], v30 offset:4096
    v_mfma_f32_32x32x16_bf16 v[240:255], v[100:103], a[192:195], v[240:255]
    ds_read_b64_tr_b16 v[118:119], v30 offset:4608
    s_waitcnt lgkmcnt(4)
    v_mfma_f32_32x32x16_bf16 v[192:207], v[104:107], a[68:71], v[192:207]
    ds_read_b64_tr_b16 v[120:121], v29 offset:6144
    v_cvt_pk_bf16_f32 v136, v136, v137
    v_cvt_pk_bf16_f32 v137, v138, v139
    v_mfma_f32_32x32x16_bf16 v[224:239], v[104:107], a[196:199], v[224:239]
    ds_read_b64_tr_b16 v[122:123], v29 offset:6656
    v_mfma_f32_32x32x16_bf16 v[208:223], v[108:111], a[68:71], v[208:223]
    ds_read_b64_tr_b16 v[124:125], v30 offset:6144
    v_mfma_f32_32x32x16_bf16 v[240:255], v[108:111], a[196:199], v[240:255]
    ds_read_b64_tr_b16 v[126:127], v30 offset:6656
    s_waitcnt lgkmcnt(4)
    v_mfma_f32_32x32x16_bf16 v[192:207], v[112:115], a[72:75], v[192:207]
    ds_read_b64_tr_b16 v[96:97], v29 offset:8192
    v_cvt_pk_bf16_f32 v138, v140, v141
    v_cvt_pk_bf16_f32 v139, v142, v143
    buffer_store_dwordx4 v[136:139], v31, s[24:27], s57 offen offset:1024 sc1
    v_mfma_f32_32x32x16_bf16 v[224:239], v[112:115], a[200:203], v[224:239]
    ds_read_b64_tr_b16 v[98:99], v29 offset:8704
    v_mfma_f32_32x32x16_bf16 v[208:223], v[116:119], a[72:75], v[208:223]
    buffer_load_dwordx4 v3, s[20:23], s68 offen offset:2048 lds
    ds_read_b64_tr_b16 v[100:101], v30 offset:8192
    v_mfma_f32_32x32x16_bf16 v[240:255], v[116:119], a[200:203], v[240:255]
    ds_read_b64_tr_b16 v[102:103], v30 offset:8704
    s_waitcnt lgkmcnt(4)
    v_mfma_f32_32x32x16_bf16 v[192:207], v[120:123], a[76:79], v[192:207]
    ds_read_b64_tr_b16 v[104:105], v29 offset:10240
    v_cvt_pk_bf16_f32 v144, v144, v145
    v_cvt_pk_bf16_f32 v145, v146, v147
    v_mfma_f32_32x32x16_bf16 v[224:239], v[120:123], a[204:207], v[224:239]
    ds_read_b64_tr_b16 v[106:107], v29 offset:10752
    v_mfma_f32_32x32x16_bf16 v[208:223], v[124:127], a[76:79], v[208:223]
    ds_read_b64_tr_b16 v[108:109], v30 offset:10240
    v_mfma_f32_32x32x16_bf16 v[240:255], v[124:127], a[204:207], v[240:255]
    ds_read_b64_tr_b16 v[110:111], v30 offset:10752
    s_waitcnt lgkmcnt(4)
    v_mfma_f32_32x32x16_bf16 v[192:207], v[96:99], a[80:83], v[192:207]
    ds_read_b64_tr_b16 v[112:113], v29 offset:12288
    v_cvt_pk_bf16_f32 v146, v148, v149
    v_cvt_pk_bf16_f32 v147, v150, v151
    buffer_store_dwordx4 v[144:147], v31, s[24:27], s57 offen offset:2048 sc1
    v_mfma_f32_32x32x16_bf16 v[224:239], v[96:99], a[208:211], v[224:239]
    ds_read_b64_tr_b16 v[114:115], v29 offset:12800
    v_mfma_f32_32x32x16_bf16 v[208:223], v[100:103], a[80:83], v[208:223]
    s_add_u32 m0, s60, 102400
    s_add_u32 s68, s63, 177504
    buffer_load_dwordx4 v1, s[20:23], s68 offen offset:0 lds
    ds_read_b64_tr_b16 v[116:117], v30 offset:12288
    v_mfma_f32_32x32x16_bf16 v[240:255], v[100:103], a[208:211], v[240:255]
    ds_read_b64_tr_b16 v[118:119], v30 offset:12800
    s_waitcnt lgkmcnt(4)
    v_mfma_f32_32x32x16_bf16 v[192:207], v[104:107], a[84:87], v[192:207]
    ds_read_b64_tr_b16 v[120:121], v29 offset:14336
    v_cvt_pk_bf16_f32 v152, v152, v153
    v_cvt_pk_bf16_f32 v153, v154, v155
    v_mfma_f32_32x32x16_bf16 v[224:239], v[104:107], a[212:215], v[224:239]
    ds_read_b64_tr_b16 v[122:123], v29 offset:14848
    v_mfma_f32_32x32x16_bf16 v[208:223], v[108:111], a[84:87], v[208:223]
    ds_read_b64_tr_b16 v[124:125], v30 offset:14336
    v_mfma_f32_32x32x16_bf16 v[240:255], v[108:111], a[212:215], v[240:255]
    ds_read_b64_tr_b16 v[126:127], v30 offset:14848
    s_waitcnt lgkmcnt(4)
    v_mfma_f32_32x32x16_bf16 v[192:207], v[112:115], a[88:91], v[192:207]
    ds_read_b64_tr_b16 v[96:97], v29 offset:16384
    v_cvt_pk_bf16_f32 v154, v156, v157
    v_cvt_pk_bf16_f32 v155, v158, v159
    buffer_store_dwordx4 v[152:155], v31, s[24:27], s57 offen offset:3072 sc1
    v_mfma_f32_32x32x16_bf16 v[224:239], v[112:115], a[216:219], v[224:239]
    ds_read_b64_tr_b16 v[98:99], v29 offset:16896
    v_mfma_f32_32x32x16_bf16 v[208:223], v[116:119], a[88:91], v[208:223]
    buffer_load_dwordx4 v2, s[20:23], s68 offen offset:1024 lds
    ds_read_b64_tr_b16 v[100:101], v30 offset:16384
    v_mfma_f32_32x32x16_bf16 v[240:255], v[116:119], a[216:219], v[240:255]
    ds_read_b64_tr_b16 v[102:103], v30 offset:16896
    s_waitcnt lgkmcnt(4)
    v_mfma_f32_32x32x16_bf16 v[192:207], v[120:123], a[92:95], v[192:207]
    ds_read_b64_tr_b16 v[104:105], v29 offset:18432
    s_add_u32 s57, s62, 12288
    v_cvt_pk_bf16_f32 v160, v160, v161
    v_cvt_pk_bf16_f32 v161, v162, v163
    v_mfma_f32_32x32x16_bf16 v[224:239], v[120:123], a[220:223], v[224:239]
    ds_read_b64_tr_b16 v[106:107], v29 offset:18944
    v_mfma_f32_32x32x16_bf16 v[208:223], v[124:127], a[92:95], v[208:223]
    ds_read_b64_tr_b16 v[108:109], v30 offset:18432
    v_mfma_f32_32x32x16_bf16 v[240:255], v[124:127], a[220:223], v[240:255]
    ds_read_b64_tr_b16 v[110:111], v30 offset:18944
    s_waitcnt lgkmcnt(4)
    v_mfma_f32_32x32x16_bf16 v[192:207], v[96:99], a[96:99], v[192:207]
    ds_read_b64_tr_b16 v[112:113], v29 offset:20480
    v_cvt_pk_bf16_f32 v162, v164, v165
    v_cvt_pk_bf16_f32 v163, v166, v167
    buffer_store_dwordx4 v[160:163], v31, s[24:27], s57 offen offset:0 sc1
    v_mfma_f32_32x32x16_bf16 v[224:239], v[96:99], a[224:227], v[224:239]
    ds_read_b64_tr_b16 v[114:115], v29 offset:20992
    v_mfma_f32_32x32x16_bf16 v[208:223], v[100:103], a[96:99], v[208:223]
    buffer_load_dwordx4 v3, s[20:23], s68 offen offset:2048 lds
    ds_read_b64_tr_b16 v[116:117], v30 offset:20480
    v_mfma_f32_32x32x16_bf16 v[240:255], v[100:103], a[224:227], v[240:255]
    ds_read_b64_tr_b16 v[118:119], v30 offset:20992
    s_waitcnt lgkmcnt(4)
    v_mfma_f32_32x32x16_bf16 v[192:207], v[104:107], a[100:103], v[192:207]
    ds_read_b64_tr_b16 v[120:121], v29 offset:22528
    v_cvt_pk_bf16_f32 v168, v168, v169
    v_cvt_pk_bf16_f32 v169, v170, v171
    v_mfma_f32_32x32x16_bf16 v[224:239], v[104:107], a[228:231], v[224:239]
    ds_read_b64_tr_b16 v[122:123], v29 offset:23040
    v_mfma_f32_32x32x16_bf16 v[208:223], v[108:111], a[100:103], v[208:223]
    ds_read_b64_tr_b16 v[124:125], v30 offset:22528
    v_mfma_f32_32x32x16_bf16 v[240:255], v[108:111], a[228:231], v[240:255]
    ds_read_b64_tr_b16 v[126:127], v30 offset:23040
    s_waitcnt lgkmcnt(4)
    v_mfma_f32_32x32x16_bf16 v[192:207], v[112:115], a[104:107], v[192:207]
    ds_read_b64_tr_b16 v[96:97], v29 offset:24576
    v_cvt_pk_bf16_f32 v170, v172, v173
    v_cvt_pk_bf16_f32 v171, v174, v175
    buffer_store_dwordx4 v[168:171], v31, s[24:27], s57 offen offset:1024 sc1
    v_mfma_f32_32x32x16_bf16 v[224:239], v[112:115], a[232:235], v[224:239]
    ds_read_b64_tr_b16 v[98:99], v29 offset:25088
    v_mfma_f32_32x32x16_bf16 v[208:223], v[116:119], a[104:107], v[208:223]
    ds_read_b64_tr_b16 v[100:101], v30 offset:24576
    v_mfma_f32_32x32x16_bf16 v[240:255], v[116:119], a[232:235], v[240:255]
    ds_read_b64_tr_b16 v[102:103], v30 offset:25088
    s_waitcnt lgkmcnt(4)
    v_mfma_f32_32x32x16_bf16 v[192:207], v[120:123], a[108:111], v[192:207]
    ds_read_b64_tr_b16 v[104:105], v29 offset:26624
    v_cvt_pk_bf16_f32 v176, v176, v177
    v_cvt_pk_bf16_f32 v177, v178, v179
    v_mfma_f32_32x32x16_bf16 v[224:239], v[120:123], a[236:239], v[224:239]
    ds_read_b64_tr_b16 v[106:107], v29 offset:27136
    v_mfma_f32_32x32x16_bf16 v[208:223], v[124:127], a[108:111], v[208:223]
    ds_read_b64_tr_b16 v[108:109], v30 offset:26624
    v_mfma_f32_32x32x16_bf16 v[240:255], v[124:127], a[236:239], v[240:255]
    ds_read_b64_tr_b16 v[110:111], v30 offset:27136
    s_waitcnt lgkmcnt(4)
    v_mfma_f32_32x32x16_bf16 v[192:207], v[96:99], a[112:115], v[192:207]
    ds_read_b64_tr_b16 v[112:113], v29 offset:28672
    v_cvt_pk_bf16_f32 v178, v180, v181
    v_cvt_pk_bf16_f32 v179, v182, v183
    buffer_store_dwordx4 v[176:179], v31, s[24:27], s57 offen offset:2048 sc1
    v_mfma_f32_32x32x16_bf16 v[224:239], v[96:99], a[240:243], v[224:239]
    ds_read_b64_tr_b16 v[114:115], v29 offset:29184
    v_mfma_f32_32x32x16_bf16 v[208:223], v[100:103], a[112:115], v[208:223]
    ds_read_b64_tr_b16 v[116:117], v30 offset:28672
    v_mfma_f32_32x32x16_bf16 v[240:255], v[100:103], a[240:243], v[240:255]
    ds_read_b64_tr_b16 v[118:119], v30 offset:29184
    s_waitcnt lgkmcnt(4)
    v_mfma_f32_32x32x16_bf16 v[192:207], v[104:107], a[116:119], v[192:207]
    ds_read_b64_tr_b16 v[120:121], v29 offset:30720
    v_cvt_pk_bf16_f32 v184, v184, v185
    v_cvt_pk_bf16_f32 v185, v186, v187
    v_mfma_f32_32x32x16_bf16 v[224:239], v[104:107], a[244:247], v[224:239]
    ds_read_b64_tr_b16 v[122:123], v29 offset:31232
    v_mfma_f32_32x32x16_bf16 v[208:223], v[108:111], a[116:119], v[208:223]
    s_cmp_lg_u32 s32, 0
    s_cbranch_scc1 L_W0_6
    s_waitcnt vmcnt(13)
    v_cmp_ne_u32 vcc, 0x1010101, v51
    s_nop 1
    s_cbranch_vccz L_POK_5
L_PLP_5:
    s_sleep 4
    buffer_load_dword v51, v50, s[28:31], 0 offen offset:0 sc0 sc1
    s_waitcnt vmcnt(0)
    v_cmp_ne_u32 vcc, 0x1010101, v51
    s_nop 1
    s_cbranch_vccnz L_PLP_5
L_POK_5:
L_W0_6:
    ds_read_b64_tr_b16 v[124:125], v30 offset:30720
    v_mfma_f32_32x32x16_bf16 v[240:255], v[108:111], a[244:247], v[240:255]
    ds_read_b64_tr_b16 v[126:127], v30 offset:31232
    s_waitcnt lgkmcnt(0)
    s_waitcnt vmcnt(35)
    s_barrier
    v_mfma_f32_32x32x16_bf16 v[192:207], v[112:115], a[120:123], v[192:207]
    ds_read_b64_tr_b16 v[96:97], v25 offset:0
    v_cvt_pk_bf16_f32 v186, v188, v189
    v_cvt_pk_bf16_f32 v187, v190, v191
    buffer_store_dwordx4 v[184:187], v31, s[24:27], s57 offen offset:3072 sc1
    v_mfma_f32_32x32x16_bf16 v[224:239], v[112:115], a[248:251], v[224:239]
    ds_read_b64_tr_b16 v[98:99], v25 offset:512
    v_mfma_f32_32x32x16_bf16 v[208:223], v[116:119], a[120:123], v[208:223]
    s_add_u32 m0, s60, 68608
    s_add_u32 s68, s64, 0
    buffer_load_dwordx4 v31, s[24:27], s68 offen sc1 lds
    ds_read_b64_tr_b16 v[100:101], v26 offset:0
    v_mfma_f32_32x32x16_bf16 v[240:255], v[116:119], a[248:251], v[240:255]
    ds_read_b64_tr_b16 v[102:103], v26 offset:512
    v_mfma_f32_32x32x16_bf16 v[192:207], v[120:123], a[124:127], v[192:207]
    ds_read_b64_tr_b16 v[104:105], v25 offset:2048
    s_add_u32 m0, s60, 72704
    s_add_u32 s68, s64, 32768
    buffer_load_dwordx4 v31, s[24:27], s68 offen sc1 lds
    v_mfma_f32_32x32x16_bf16 v[224:239], v[120:123], a[252:255], v[224:239]
    ds_read_b64_tr_b16 v[106:107], v25 offset:2560
    v_mfma_f32_32x32x16_bf16 v[208:223], v[124:127], a[124:127], v[208:223]
    ds_read_b64_tr_b16 v[108:109], v26 offset:2048
    v_mfma_f32_32x32x16_bf16 v[240:255], v[124:127], a[252:255], v[240:255]
    ds_read_b64_tr_b16 v[110:111], v26 offset:2560
    s_waitcnt lgkmcnt(4)
    v_mfma_f32_32x32x16_bf16 v[128:143], v[96:99], a[0:3], 0
    ds_read_b64_tr_b16 v[112:113], v25 offset:4096
    s_add_u32 m0, s60, 101376
    s_add_u32 s68, s64, 4096
    buffer_load_dwordx4 v31, s[24:27], s68 offen sc1 lds
    v_mfma_f32_32x32x16_bf16 v[160:175], v[96:99], a[128:131], 0
    ds_read_b64_tr_b16 v[114:115], v25 offset:4608
    v_mfma_f32_32x32x16_bf16 v[144:159], v[100:103], a[0:3], 0
    ds_read_b64_tr_b16 v[116:117], v26 offset:4096
    v_mfma_f32_32x32x16_bf16 v[176:191], v[100:103], a[128:131], 0
    ds_read_b64_tr_b16 v[118:119], v26 offset:4608
    s_waitcnt lgkmcnt(4)
    v_mfma_f32_32x32x16_bf16 v[128:143], v[104:107], a[4:7], v[128:143]
    ds_read_b64_tr_b16 v[120:121], v25 offset:6144
    s_add_u32 s57, s62, 524288
    v_cvt_pk_bf16_f32 v192, v192, v193
    v_cvt_pk_bf16_f32 v193, v194, v195
    v_mfma_f32_32x32x16_bf16 v[160:175], v[104:107], a[132:135], v[160:175]
    ds_read_b64_tr_b16 v[122:123], v25 offset:6656
    v_mfma_f32_32x32x16_bf16 v[144:159], v[108:111], a[4:7], v[144:159]
    s_add_u32 m0, s60, 105472
    s_add_u32 s68, s64, 36864
    buffer_load_dwordx4 v31, s[24:27], s68 offen sc1 lds
    ds_read_b64_tr_b16 v[124:125], v26 offset:6144
    v_mfma_f32_32x32x16_bf16 v[176:191], v[108:111], a[132:135], v[176:191]
    ds_read_b64_tr_b16 v[126:127], v26 offset:6656
    s_waitcnt lgkmcnt(4)
    v_mfma_f32_32x32x16_bf16 v[128:143], v[112:115], a[8:11], v[128:143]
    ds_read_b64_tr_b16 v[96:97], v25 offset:8192
    v_cvt_pk_bf16_f32 v194, v196, v197
    v_cvt_pk_bf16_f32 v195, v198, v199
    buffer_store_dwordx4 v[192:195], v31, s[24:27], s57 offen offset:0 sc1
    v_mfma_f32_32x32x16_bf16 v[160:175], v[112:115], a[136:139], v[160:175]
    ds_read_b64_tr_b16 v[98:99], v25 offset:8704
    v_mfma_f32_32x32x16_bf16 v[144:159], v[116:119], a[8:11], v[144:159]
    s_add_u32 m0, s60, 131072
    s_add_u32 s68, s63, 352256
    buffer_load_dwordx4 v1, s[20:23], s68 offen offset:0 lds
    ds_read_b64_tr_b16 v[100:101], v26 offset:8192
    v_mfma_f32_32x32x16_bf16 v[176:191], v[116:119], a[136:139], v[176:191]
    ds_read_b64_tr_b16 v[102:103], v26 offset:8704
    s_waitcnt lgkmcnt(4)
    v_mfma_f32_32x32x16_bf16 v[128:143], v[120:123], a[12:15], v[128:143]
    ds_read_b64_tr_b16 v[104:105], v25 offset:10240
    buffer_load_dwordx4 v2, s[20:23], s68 offen offset:1024 lds
    v_mfma_f32_32x32x16_bf16 v[160:175], v[120:123], a[140:143], v[160:175]
    ds_read_b64_tr_b16 v[106:107], v25 offset:10752
    v_mfma_f32_32x32x16_bf16 v[144:159], v[124:127], a[12:15], v[144:159]
    ds_read_b64_tr_b16 v[108:109], v26 offset:10240
    v_mfma_f32_32x32x16_bf16 v[176:191], v[124:127], a[140:143], v[176:191]
    ds_read_b64_tr_b16 v[110:111], v26 offset:10752
    s_waitcnt lgkmcnt(4)
    v_mfma_f32_32x32x16_bf16 v[128:143], v[96:99], a[16:19], v[128:143]
    ds_read_b64_tr_b16 v[112:113], v25 offset:12288
    v_cvt_pk_bf16_f32 v200, v200, v201
    v_cvt_pk_bf16_f32 v201, v202, v203
    v_mfma_f32_32x32x16_bf16 v[160:175], v[96:99], a[144:147], v[160:175]
    ds_read_b64_tr_b16 v[114:115], v25 offset:12800
    v_mfma_f32_32x32x16_bf16 v[144:159], v[100:103], a[16:19], v[144:159]
    ds_read_b64_tr_b16 v[116:117], v26 offset:12288
    v_mfma_f32_32x32x16_bf16 v[176:191], v[100:103], a[144:147], v[176:191]
    ds_read_b64_tr_b16 v[118:119], v26 offset:12800
    s_waitcnt lgkmcnt(4)
    v_mfma_f32_32x32x16_bf16 v[128:143], v[104:107], a[20:23], v[128:143]
    ds_read_b64_tr_b16 v[120:121], v25 offset:14336
    buffer_load_dwordx4 v3, s[20:23], s68 offen offset:2048 lds
    v_mfma_f32_32x32x16_bf16 v[160:175], v[104:107], a[148:151], v[160:175]
    ds_read_b64_tr_b16 v[122:123], v25 offset:14848
    v_mfma_f32_32x32x16_bf16 v[144:159], v[108:111], a[20:23], v[144:159]
    ds_read_b64_tr_b16 v[124:125], v26 offset:14336
    v_mfma_f32_32x32x16_bf16 v[176:191], v[108:111], a[148:151], v[176:191]
    ds_read_b64_tr_b16 v[126:127], v26 offset:14848
    s_waitcnt lgkmcnt(4)
    v_mfma_f32_32x32x16_bf16 v[128:143], v[112:115], a[24:27], v[128:143]
    ds_read_b64_tr_b16 v[96:97], v25 offset:16384
    v_cvt_pk_bf16_f32 v202, v204, v205
    v_cvt_pk_bf16_f32 v203, v206, v207
    buffer_store_dwordx4 v[200:203], v31, s[24:27], s57 offen offset:1024 sc1
    v_mfma_f32_32x32x16_bf16 v[160:175], v[112:115], a[152:155], v[160:175]
    ds_read_b64_tr_b16 v[98:99], v25 offset:16896
    v_mfma_f32_32x32x16_bf16 v[144:159], v[116:119], a[24:27], v[144:159]
    s_add_u32 m0, s60, 134144
    s_add_u32 s68, s64, 8192
    buffer_load_dwordx4 v31, s[24:27], s68 offen sc1 lds
    ds_read_b64_tr_b16 v[100:101], v26 offset:16384
    v_mfma_f32_32x32x16_bf16 v[176:191], v[116:119], a[152:155], v[176:191]
    ds_read_b64_tr_b16 v[102:103], v26 offset:16896
    s_waitcnt lgkmcnt(4)
    v_mfma_f32_32x32x16_bf16 v[128:143], v[120:123], a[28:31], v[128:143]
    ds_read_b64_tr_b16 v[104:105], v25 offset:18432
    s_add_u32 m0, s60, 135168
    s_add_u32 s68, s63, 353632
    buffer_load_dwordx4 v1, s[20:23], s68 offen offset:0 lds
    v_mfma_f32_32x32x16_bf16 v[160:175], v[120:123], a[156:159], v[160:175]
    ds_read_b64_tr_b16 v[106:107], v25 offset:18944
    v_mfma_f32_32x32x16_bf16 v[144:159], v[124:127], a[28:31], v[144:159]
    ds_read_b64_tr_b16 v[108:109], v26 offset:18432
    v_mfma_f32_32x32x16_bf16 v[176:191], v[124:127], a[156:159], v[176:191]
    ds_read_b64_tr_b16 v[110:111], v26 offset:18944
    s_waitcnt lgkmcnt(4)
    v_mfma_f32_32x32x16_bf16 v[128:143], v[96:99], a[32:35], v[128:143]
    ds_read_b64_tr_b16 v[112:113], v25 offset:20480
    v_cvt_pk_bf16_f32 v208, v208, v209
    v_cvt_pk_bf16_f32 v209, v210, v211
    v_mfma_f32_32x32x16_bf16 v[160:175], v[96:99], a[160:163], v[160:175]
    ds_read_b64_tr_b16 v[114:115], v25 offset:20992
    v_mfma_f32_32x32x16_bf16 v[144:159], v[100:103], a[32:35], v[144:159]
    buffer_load_dwordx4 v2, s[20:23], s68 offen offset:1024 lds
    ds_read_b64_tr_b16 v[116:117], v26 offset:20480
    v_mfma_f32_32x32x16_bf16 v[176:191], v[100:103], a[160:163], v[176:191]
    ds_read_b64_tr_b16 v[118:119], v26 offset:20992
    s_waitcnt lgkmcnt(4)
    v_mfma_f32_32x32x16_bf16 v[128:143], v[104:107], a[36:39], v[128:143]
    ds_read_b64_tr_b16 v[120:121], v25 offset:22528
    buffer_load_dwordx4 v3, s[20:23], s68 offen offset:2048 lds
    v_mfma_f32_32x32x16_bf16 v[160:175], v[104:107], a[164:167], v[160:175]
    ds_read_b64_tr_b16 v[122:123], v25 offset:23040
    v_mfma_f32_32x32x16_bf16 v[144:159], v[108:111], a[36:39], v[144:159]
    ds_read_b64_tr_b16 v[124:125], v26 offset:22528
    v_mfma_f32_32x32x16_bf16 v[176:191], v[108:111], a[164:167], v[176:191]
    ds_read_b64_tr_b16 v[126:127], v26 offset:23040
    s_waitcnt lgkmcnt(4)
    v_mfma_f32_32x32x16_bf16 v[128:143], v[112:115], a[40:43], v[128:143]
    ds_read_b64_tr_b16 v[96:97], v25 offset:24576
    v_cvt_pk_bf16_f32 v210, v212, v213
    v_cvt_pk_bf16_f32 v211, v214, v215
    buffer_store_dwordx4 v[208:211], v31, s[24:27], s57 offen offset:2048 sc1
    v_mfma_f32_32x32x16_bf16 v[160:175], v[112:115], a[168:171], v[160:175]
    ds_read_b64_tr_b16 v[98:99], v25 offset:25088
    v_mfma_f32_32x32x16_bf16 v[144:159], v[116:119], a[40:43], v[144:159]
    s_add_u32 m0, s60, 138240
    s_add_u32 s68, s64, 40960
    buffer_load_dwordx4 v31, s[24:27], s68 offen sc1 lds
    ds_read_b64_tr_b16 v[100:101], v26 offset:24576
    v_mfma_f32_32x32x16_bf16 v[176:191], v[116:119], a[168:171], v[176:191]
    ds_read_b64_tr_b16 v[102:103], v26 offset:25088
    s_waitcnt lgkmcnt(4)
    v_mfma_f32_32x32x16_bf16 v[128:143], v[120:123], a[44:47], v[128:143]
    ds_read_b64_tr_b16 v[104:105], v25 offset:26624
    v_mfma_f32_32x32x16_bf16 v[160:175], v[120:123], a[172:175], v[160:175]
    ds_read_b64_tr_b16 v[106:107], v25 offset:27136
    v_mfma_f32_32x32x16_bf16 v[144:159], v[124:127], a[44:47], v[144:159]
    ds_read_b64_tr_b16 v[108:109], v26 offset:26624
    v_mfma_f32_32x32x16_bf16 v[176:191], v[124:127], a[172:175], v[176:191]
    ds_read_b64_tr_b16 v[110:111], v26 offset:27136
    s_waitcnt lgkmcnt(4)
    v_mfma_f32_32x32x16_bf16 v[128:143], v[96:99], a[48:51], v[128:143]
    ds_read_b64_tr_b16 v[112:113], v25 offset:28672
    v_cvt_pk_bf16_f32 v216, v216, v217
    v_cvt_pk_bf16_f32 v217, v218, v219
    v_mfma_f32_32x32x16_bf16 v[160:175], v[96:99], a[176:179], v[160:175]
    ds_read_b64_tr_b16 v[114:115], v25 offset:29184
    v_mfma_f32_32x32x16_bf16 v[144:159], v[100:103], a[48:51], v[144:159]
    ds_read_b64_tr_b16 v[116:117], v26 offset:28672
    v_mfma_f32_32x32x16_bf16 v[176:191], v[100:103], a[176:179], v[176:191]
    ds_read_b64_tr_b16 v[118:119], v26 offset:29184
    s_waitcnt lgkmcnt(4)
    v_mfma_f32_32x32x16_bf16 v[128:143], v[104:107], a[52:55], v[128:143]
    ds_read_b64_tr_b16 v[120:121], v25 offset:30720
    v_mfma_f32_32x32x16_bf16 v[160:175], v[104:107], a[180:183], v[160:175]
    ds_read_b64_tr_b16 v[122:123], v25 offset:31232
    v_mfma_f32_32x32x16_bf16 v[144:159], v[108:111], a[52:55], v[144:159]
    ds_read_b64_tr_b16 v[124:125], v26 offset:30720
    v_mfma_f32_32x32x16_bf16 v[176:191], v[108:111], a[180:183], v[176:191]
    ds_read_b64_tr_b16 v[126:127], v26 offset:31232
    s_waitcnt lgkmcnt(0)
    s_waitcnt vmcnt(40)
    s_barrier
    v_mfma_f32_32x32x16_bf16 v[128:143], v[112:115], a[56:59], v[128:143]
    ds_read_b64_tr_b16 v[96:97], v25 offset:32768
    v_cvt_pk_bf16_f32 v218, v220, v221
    v_cvt_pk_bf16_f32 v219, v222, v223
    buffer_store_dwordx4 v[216:219], v31, s[24:27], s57 offen offset:3072 sc1
    v_mfma_f32_32x32x16_bf16 v[160:175], v[112:115], a[184:187], v[160:175]
    ds_read_b64_tr_b16 v[98:99], v25 offset:33280
    v_mfma_f32_32x32x16_bf16 v[144:159], v[116:119], a[56:59], v[144:159]
    s_add_u32 m0, s60, 0
    s_add_u32 s68, s63, 528384
    buffer_load_dwordx4 v1, s[20:23], s68 offen offset:0 lds
    ds_read_b64_tr_b16 v[100:101], v26 offset:32768
    v_mfma_f32_32x32x16_bf16 v[176:191], v[116:119], a[184:187], v[176:191]
    ds_read_b64_tr_b16 v[102:103], v26 offset:33280
    v_mfma_f32_32x32x16_bf16 v[128:143], v[120:123], a[60:63], v[128:143]
    ds_read_b64_tr_b16 v[104:105], v25 offset:34816
    buffer_load_dwordx4 v2, s[20:23], s68 offen offset:1024 lds
    v_mfma_f32_32x32x16_bf16 v[160:175], v[120:123], a[188:191], v[160:175]
    ds_read_b64_tr_b16 v[106:107], v25 offset:35328
    v_mfma_f32_32x32x16_bf16 v[144:159], v[124:127], a[60:63], v[144:159]
    ds_read_b64_tr_b16 v[108:109], v26 offset:34816
    v_mfma_f32_32x32x16_bf16 v[176:191], v[124:127], a[188:191], v[176:191]
    ds_read_b64_tr_b16 v[110:111], v26 offset:35328
    s_waitcnt lgkmcnt(4)
    v_mfma_f32_32x32x16_bf16 v[128:143], v[96:99], a[64:67], v[128:143]
    ds_read_b64_tr_b16 v[112:113], v25 offset:36864
    s_add_u32 s57, s62, 532480
    v_cvt_pk_bf16_f32 v224, v224, v225
    v_cvt_pk_bf16_f32 v225, v226, v227
    v_mfma_f32_32x32x16_bf16 v[160:175], v[96:99], a[192:195], v[160:175]
    ds_read_b64_tr_b16 v[114:115], v25 offset:37376
    v_mfma_f32_32x32x16_bf16 v[144:159], v[100:103], a[64:67], v[144:159]
    ds_read_b64_tr_b16 v[116:117], v26 offset:36864
    v_mfma_f32_32x32x16_bf16 v[176:191], v[100:103], a[192:195], v[176:191]
    ds_read_b64_tr_b16 v[118:119], v26 offset:37376
    s_waitcnt lgkmcnt(4)
    v_mfma_f32_32x32x16_bf16 v[128:143], v[104:107], a[68:71], v[128:143]
    ds_read_b64_tr_b16 v[120:121], v25 offset:38912
    buffer_load_dwordx4 v3, s[20:23], s68 offen offset:2048 lds
    v_mfma_f32_32x32x16_bf16 v[160:175], v[104:107], a[196:199], v[160:175]
    ds_read_b64_tr_b16 v[122:123], v25 offset:39424
    v_mfma_f32_32x32x16_bf16 v[144:159], v[108:111], a[68:71], v[144:159]
    ds_read_b64_tr_b16 v[124:125], v26 offset:38912
    v_mfma_f32_32x32x16_bf16 v[176:191], v[108:111], a[196:199], v[176:191]
    ds_read_b64_tr_b16 v[126:127], v26 offset:39424
    s_waitcnt lgkmcnt(4)
    v_mfma_f32_32x32x16_bf16 v[128:143], v[112:115], a[72:75], v[128:143]
    ds_read_b64_tr_b16 v[96:97], v25 offset:40960
    v_cvt_pk_bf16_f32 v226, v228, v229
    v_cvt_pk_bf16_f32 v227, v230, v231
    buffer_store_dwordx4 v[224:227], v31, s[24:27], s57 offen offset:0 sc1
    v_mfma_f32_32x32x16_bf16 v[160:175], v[112:115], a[200:203], v[160:175]
    ds_read_b64_tr_b16 v[98:99], v25 offset:41472
    v_mfma_f32_32x32x16_bf16 v[144:159], v[116:119], a[72:75], v[144:159]
    ds_read_b64_tr_b16 v[100:101], v26 offset:40960
    v_mfma_f32_32x32x16_bf16 v[176:191], v[116:119], a[200:203], v[176:191]
    ds_read_b64_tr_b16 v[102:103], v26 offset:41472
    s_waitcnt lgkmcnt(4)
    v_mfma_f32_32x32x16_bf16 v[128:143], v[120:123], a[76:79], v[128:143]
    ds_read_b64_tr_b16 v[104:105], v25 offset:43008
    s_add_u32 m0, s60, 3072
    s_add_u32 s68, s64, 12288
    buffer_load_dwordx4 v31, s[24:27], s68 offen sc1 lds
    v_mfma_f32_32x32x16_bf16 v[160:175], v[120:123], a[204:207], v[160:175]
    ds_read_b64_tr_b16 v[106:107], v25 offset:43520
    v_mfma_f32_32x32x16_bf16 v[144:159], v[124:127], a[76:79], v[144:159]
    ds_read_b64_tr_b16 v[108:109], v26 offset:43008
    v_mfma_f32_32x32x16_bf16 v[176:191], v[124:127], a[204:207], v[176:191]
    ds_read_b64_tr_b16 v[110:111], v26 offset:43520
    s_waitcnt lgkmcnt(4)
    v_mfma_f32_32x32x16_bf16 v[128:143], v[96:99], a[80:83], v[128:143]
    ds_read_b64_tr_b16 v[112:113], v25 offset:45056
    v_cvt_pk_bf16_f32 v232, v232, v233
    v_cvt_pk_bf16_f32 v233, v234, v235
    v_mfma_f32_32x32x16_bf16 v[160:175], v[96:99], a[208:211], v[160:175]
    ds_read_b64_tr_b16 v[114:115], v25 offset:45568
    v_mfma_f32_32x32x16_bf16 v[144:159], v[100:103], a[80:83], v[144:159]
    ds_read_b64_tr_b16 v[116:117], v26 offset:45056
    v_mfma_f32_32x32x16_bf16 v[176:191], v[100:103], a[208:211], v[176:191]
    ds_read_b64_tr_b16 v[118:119], v26 offset:45568
    s_waitcnt lgkmcnt(4)
    v_mfma_f32_32x32x16_bf16 v[128:143], v[104:107], a[84:87], v[128:143]
    ds_read_b64_tr_b16 v[120:121], v25 offset:47104
    s_add_u32 m0, s60, 4096
    s_add_u32 s68, s63, 529760
    buffer_load_dwordx4 v1, s[20:23], s68 offen offset:0 lds
    v_mfma_f32_32x32x16_bf16 v[160:175], v[104:107], a[212:215], v[160:175]
    ds_read_b64_tr_b16 v[122:123], v25 offset:47616
    v_mfma_f32_32x32x16_bf16 v[144:159], v[108:111], a[84:87], v[144:159]
    ds_read_b64_tr_b16 v[124:125], v26 offset:47104
    v_mfma_f32_32x32x16_bf16 v[176:191], v[108:111], a[212:215], v[176:191]
    ds_read_b64_tr_b16 v[126:127], v26 offset:47616
    s_waitcnt lgkmcnt(4)
    v_mfma_f32_32x32x16_bf16 v[128:143], v[112:115], a[88:91], v[128:143]
    ds_read_b64_tr_b16 v[96:97], v25 offset:49152
    v_cvt_pk_bf16_f32 v234, v236, v237
    v_cvt_pk_bf16_f32 v235, v238, v239
    buffer_store_dwordx4 v[232:235], v31, s[24:27], s57 offen offset:1024 sc1
    v_mfma_f32_32x32x16_bf16 v[160:175], v[112:115], a[216:219], v[160:175]
    ds_read_b64_tr_b16 v[98:99], v25 offset:49664
    v_mfma_f32_32x32x16_bf16 v[144:159], v[116:119], a[88:91], v[144:159]
    buffer_load_dwordx4 v2, s[20:23], s68 offen offset:1024 lds
    ds_read_b64_tr_b16 v[100:101], v26 offset:49152
    v_mfma_f32_32x32x16_bf16 v[176:191], v[116:119], a[216:219], v[176:191]
    ds_read_b64_tr_b16 v[102:103], v26 offset:49664
    s_waitcnt lgkmcnt(4)
    v_mfma_f32_32x32x16_bf16 v[128:143], v[120:123], a[92:95], v[128:143]
    ds_read_b64_tr_b16 v[104:105], v25 offset:51200
    v_mfma_f32_32x32x16_bf16 v[160:175], v[120:123], a[220:223], v[160:175]
    ds_read_b64_tr_b16 v[106:107], v25 offset:51712
    v_mfma_f32_32x32x16_bf16 v[144:159], v[124:127], a[92:95], v[144:159]
    ds_read_b64_tr_b16 v[108:109], v26 offset:51200
    v_mfma_f32_32x32x16_bf16 v[176:191], v[124:127], a[220:223], v[176:191]
    ds_read_b64_tr_b16 v[110:111], v26 offset:51712
    s_waitcnt lgkmcnt(4)
    v_mfma_f32_32x32x16_bf16 v[128:143], v[96:99], a[96:99], v[128:143]
    ds_read_b64_tr_b16 v[112:113], v25 offset:53248
    v_cvt_pk_bf16_f32 v240, v240, v241
    v_cvt_pk_bf16_f32 v241, v242, v243
    v_mfma_f32_32x32x16_bf16 v[160:175], v[96:99], a[224:227], v[160:175]
    ds_read_b64_tr_b16 v[114:115], v25 offset:53760
    v_mfma_f32_32x32x16_bf16 v[144:159], v[100:103], a[96:99], v[144:159]
    buffer_load_dwordx4 v3, s[20:23], s68 offen offset:2048 lds
    ds_read_b64_tr_b16 v[116:117], v26 offset:53248
    v_mfma_f32_32x32x16_bf16 v[176:191], v[100:103], a[224:227], v[176:191]
    ds_read_b64_tr_b16 v[118:119], v26 offset:53760
    s_waitcnt lgkmcnt(4)
    v_mfma_f32_32x32x16_bf16 v[128:143], v[104:107], a[100:103], v[128:143]
    ds_read_b64_tr_b16 v[120:121], v25 offset:55296
    v_mfma_f32_32x32x16_bf16 v[160:175], v[104:107], a[228:231], v[160:175]
    ds_read_b64_tr_b16 v[122:123], v25 offset:55808
    v_mfma_f32_32x32x16_bf16 v[144:159], v[108:111], a[100:103], v[144:159]
    ds_read_b64_tr_b16 v[124:125], v26 offset:55296
    v_mfma_f32_32x32x16_bf16 v[176:191], v[108:111], a[228:231], v[176:191]
    ds_read_b64_tr_b16 v[126:127], v26 offset:55808
    s_waitcnt lgkmcnt(4)
    v_mfma_f32_32x32x16_bf16 v[128:143], v[112:115], a[104:107], v[128:143]
    ds_read_b64_tr_b16 v[96:97], v25 offset:57344
    v_cvt_pk_bf16_f32 v242, v244, v245
    v_cvt_pk_bf16_f32 v243, v246, v247
    buffer_store_dwordx4 v[240:243], v31, s[24:27], s57 offen offset:2048 sc1
    v_mfma_f32_32x32x16_bf16 v[160:175], v[112:115], a[232:235], v[160:175]
    ds_read_b64_tr_b16 v[98:99], v25 offset:57856
    v_mfma_f32_32x32x16_bf16 v[144:159], v[116:119], a[104:107], v[144:159]
    s_add_u32 m0, s60, 7168
    s_add_u32 s68, s64, 45056
    buffer_load_dwordx4 v31, s[24:27], s68 offen sc1 lds
    ds_read_b64_tr_b16 v[100:101], v26 offset:57344
    v_mfma_f32_32x32x16_bf16 v[176:191], v[116:119], a[232:235], v[176:191]
    ds_read_b64_tr_b16 v[102:103], v26 offset:57856
    s_waitcnt lgkmcnt(4)
    v_mfma_f32_32x32x16_bf16 v[128:143], v[120:123], a[108:111], v[128:143]
    ds_read_b64_tr_b16 v[104:105], v25 offset:59392
    v_mfma_f32_32x32x16_bf16 v[160:175], v[120:123], a[236:239], v[160:175]
    ds_read_b64_tr_b16 v[106:107], v25 offset:59904
    v_mfma_f32_32x32x16_bf16 v[144:159], v[124:127], a[108:111], v[144:159]
    ds_read_b64_tr_b16 v[108:109], v26 offset:59392
    v_mfma_f32_32x32x16_bf16 v[176:191], v[124:127], a[236:239], v[176:191]
    ds_read_b64_tr_b16 v[110:111], v26 offset:59904
    s_waitcnt lgkmcnt(4)
    v_mfma_f32_32x32x16_bf16 v[128:143], v[96:99], a[112:115], v[128:143]
    ds_read_b64_tr_b16 v[112:113], v25 offset:61440
    v_cvt_pk_bf16_f32 v248, v248, v249
    v_cvt_pk_bf16_f32 v249, v250, v251
    v_mfma_f32_32x32x16_bf16 v[160:175], v[96:99], a[240:243], v[160:175]
    ds_read_b64_tr_b16 v[114:115], v25 offset:61952
    v_mfma_f32_32x32x16_bf16 v[144:159], v[100:103], a[112:115], v[144:159]
    ds_read_b64_tr_b16 v[116:117], v26 offset:61440
    v_mfma_f32_32x32x16_bf16 v[176:191], v[100:103], a[240:243], v[176:191]
    ds_read_b64_tr_b16 v[118:119], v26 offset:61952
    s_waitcnt lgkmcnt(4)
    v_mfma_f32_32x32x16_bf16 v[128:143], v[104:107], a[116:119], v[128:143]
    ds_read_b64_tr_b16 v[120:121], v25 offset:63488
    v_mfma_f32_32x32x16_bf16 v[160:175], v[104:107], a[244:247], v[160:175]
    ds_read_b64_tr_b16 v[122:123], v25 offset:64000
    v_mfma_f32_32x32x16_bf16 v[144:159], v[108:111], a[116:119], v[144:159]
    ds_read_b64_tr_b16 v[124:125], v26 offset:63488
    v_mfma_f32_32x32x16_bf16 v[176:191], v[108:111], a[244:247], v[176:191]
    ds_read_b64_tr_b16 v[126:127], v26 offset:64000
    s_waitcnt lgkmcnt(4)
    v_mfma_f32_32x32x16_bf16 v[128:143], v[112:115], a[120:123], v[128:143]
    v_cvt_pk_bf16_f32 v250, v252, v253
    v_cvt_pk_bf16_f32 v251, v254, v255
    buffer_store_dwordx4 v[248:251], v31, s[24:27], s57 offen offset:3072 sc1
    v_mfma_f32_32x32x16_bf16 v[160:175], v[112:115], a[248:251], v[160:175]
    v_mfma_f32_32x32x16_bf16 v[144:159], v[116:119], a[120:123], v[144:159]
    v_mfma_f32_32x32x16_bf16 v[176:191], v[116:119], a[248:251], v[176:191]
    s_waitcnt lgkmcnt(0)
    v_mfma_f32_32x32x16_bf16 v[128:143], v[120:123], a[124:127], v[128:143]
    v_mfma_f32_32x32x16_bf16 v[160:175], v[120:123], a[252:255], v[160:175]
    v_mfma_f32_32x32x16_bf16 v[144:159], v[124:127], a[124:127], v[144:159]
    v_mfma_f32_32x32x16_bf16 v[176:191], v[124:127], a[252:255], v[176:191]
    s_branch K1_Z
K1_V:
    buffer_load_dwordx4 v[76:79], v31, s[12:15], s77 offen offset:0
    buffer_load_dwordx4 v[76:79], v31, s[12:15], s77 offen offset:1024
    s_add_u32 s56, s76, 1048576
    buffer_load_dwordx4 v[76:79], v61, s[72:75], s56 offen
    s_add_u32 s56, s76, 2097152
    buffer_load_dwordx4 v[76:79], v61, s[72:75], s56 offen
    s_waitcnt vmcnt(16)
    s_barrier
    ds_read_b128 a[0:3], v17 offset:0
    ds_read_b128 a[128:131], v17 offset:4096
    ds_read_b64_tr_b16 v[96:97], v68 offset:0
    ds_read_b64_tr_b16 v[98:99], v68 offset:1024
    ds_read_b64_tr_b16 v[100:101], v69 offset:0
    ds_read_b64_tr_b16 v[102:103], v69 offset:1024
    ds_read_b64_tr_b16 v[104:105], v70 offset:0
    ds_read_b64_tr_b16 v[106:107], v70 offset:1024
    ds_read_b64_tr_b16 v[108:109], v71 offset:0
    ds_read_b64_tr_b16 v[110:111], v71 offset:1024
    s_waitcnt lgkmcnt(0)
    v_mfma_f32_32x32x16_bf16 v[192:207], a[0:3], v[96:99], 0
    ds_read_b128 a[4:7], v18 offset:0
    s_add_u32 m0, s60, 98304
    s_add_u32 s68, s58, 256
    buffer_load_dwordx4 v1, s[12:15], s68 offen offset:0 lds
    v_mfma_f32_32x32x16_bf16 v[224:239], a[128:131], v[96:99], 0
    ds_read_b128 a[132:135], v18 offset:4096
    buffer_load_dwordx4 v2, s[12:15], s68 offen offset:1024 lds
    v_mfma_f32_32x32x16_bf16 v[208:223], a[0:3], v[100:103], 0
    ds_read_b64_tr_b16 v[112:113], v68 offset:4096
    buffer_load_dwordx4 v3, s[12:15], s68 offen offset:2048 lds
    v_mfma_f32_32x32x16_bf16 v[240:255], a[128:131], v[100:103], 0
    ds_read_b64_tr_b16 v[114:115], v68 offset:5120
    v_mfma_f32_32x32x16_bf16 v[128:143], a[0:3], v[104:107], 0
    buffer_load_dwordx4 v4, s[12:15], s68 offen offset:3072 lds
    ds_read_b64_tr_b16 v[116:117], v69 offset:4096
    v_mfma_f32_32x32x16_bf16 v[160:175], a[128:131], v[104:107], 0
    ds_read_b64_tr_b16 v[118:119], v69 offset:5120
    ds_read_b64_tr_b16 v[120:121], v70 offset:4096
    v_mfma_f32_32x32x16_bf16 v[144:159], a[0:3], v[108:111], 0
    ds_read_b64_tr_b16 v[122:123], v70 offset:5120
    ds_read_b64_tr_b16 v[124:125], v71 offset:4096
    v_mfma_f32_32x32x16_bf16 v[176:191], a[128:131], v[108:111], 0
    ds_read_b64_tr_b16 v[126:127], v71 offset:5120
    s_waitcnt lgkmcnt(0)
    v_mfma_f32_32x32x16_bf16 v[192:207], a[4:7], v[112:115], v[192:207]
    ds_read_b128 a[8:11], v19 offset:0
    s_add_u32 s56, s76, 3145728
    buffer_load_dwordx4 v[76:79], v61, s[72:75], s56 offen
    v_mfma_f32_32x32x16_bf16 v[224:239], a[132:135], v[112:115], v[224:239]
    ds_read_b128 a[136:139], v19 offset:4096
    s_add_u32 m0, s60, 102400
    s_add_u32 s68, s58, 256
    buffer_load_dwordx4 v5, s[12:15], s68 offen offset:0 lds
    v_mfma_f32_32x32x16_bf16 v[208:223], a[4:7], v[116:119], v[208:223]
    ds_read_b64_tr_b16 v[96:97], v68 offset:8192
    buffer_load_dwordx4 v6, s[12:15], s68 offen offset:1024 lds
    v_mfma_f32_32x32x16_bf16 v[240:255], a[132:135], v[116:119], v[240:255]
    ds_read_b64_tr_b16 v[98:99], v68 offset:9216
    buffer_load_dwordx4 v7, s[12:15], s68 offen offset:2048 lds
    v_mfma_f32_32x32x16_bf16 v[128:143], a[4:7], v[120:123], v[128:143]
    ds_read_b64_tr_b16 v[100:101], v69 offset:8192
    buffer_load_dwordx4 v8, s[12:15], s68 offen offset:3072 lds
    v_mfma_f32_32x32x16_bf16 v[160:175], a[132:135], v[120:123], v[160:175]
    ds_read_b64_tr_b16 v[102:103], v69 offset:9216
    ds_read_b64_tr_b16 v[104:105], v70 offset:8192
    v_mfma_f32_32x32x16_bf16 v[144:159], a[4:7], v[124:127], v[144:159]
    ds_read_b64_tr_b16 v[106:107], v70 offset:9216
    ds_read_b64_tr_b16 v[108:109], v71 offset:8192
    v_mfma_f32_32x32x16_bf16 v[176:191], a[132:135], v[124:127], v[176:191]
    ds_read_b64_tr_b16 v[110:111], v71 offset:9216
    s_waitcnt lgkmcnt(0)
    v_mfma_f32_32x32x16_bf16 v[192:207], a[8:11], v[96:99], v[192:207]
    ds_read_b128 a[12:15], v20 offset:0
    s_add_u32 m0, s61, 131072
    s_add_u32 s68, s67, 1048576
    buffer_load_dwordx4 v64, s[16:19], s68 offen offset:0 lds
    v_mfma_f32_32x32x16_bf16 v[224:239], a[136:139], v[96:99], v[224:239]
    ds_read_b128 a[140:143], v20 offset:4096
    buffer_load_dwordx4 v65, s[16:19], s68 offen offset:1024 lds
    v_mfma_f32_32x32x16_bf16 v[208:223], a[8:11], v[100:103], v[208:223]
    ds_read_b64_tr_b16 v[112:113], v68 offset:12288
    buffer_load_dwordx4 v66, s[16:19], s68 offen offset:2048 lds
    v_mfma_f32_32x32x16_bf16 v[240:255], a[136:139], v[100:103], v[240:255]
    ds_read_b64_tr_b16 v[114:115], v68 offset:13312
    v_mfma_f32_32x32x16_bf16 v[128:143], a[8:11], v[104:107], v[128:143]
    buffer_load_dwordx4 v67, s[16:19], s68 offen offset:3072 lds
    ds_read_b64_tr_b16 v[116:117], v69 offset:12288
    v_mfma_f32_32x32x16_bf16 v[160:175], a[136:139], v[104:107], v[160:175]
    ds_read_b64_tr_b16 v[118:119], v69 offset:13312
    ds_read_b64_tr_b16 v[120:121], v70 offset:12288
    v_mfma_f32_32x32x16_bf16 v[144:159], a[8:11], v[108:111], v[144:159]
    ds_read_b64_tr_b16 v[122:123], v70 offset:13312
    ds_read_b64_tr_b16 v[124:125], v71 offset:12288
    v_mfma_f32_32x32x16_bf16 v[176:191], a[136:139], v[108:111], v[176:191]
    ds_read_b64_tr_b16 v[126:127], v71 offset:13312
    s_waitcnt lgkmcnt(0)
    s_waitcnt vmcnt(17)
    s_barrier
    v_mfma_f32_32x32x16_bf16 v[192:207], a[12:15], v[112:115], v[192:207]
    ds_read_b128 a[16:19], v21 offset:0
    v_mov_b32 v48, 0
    v_mov_b32 v49, 0
    v_mov_b32 v50, 0
    v_mov_b32 v51, 0
    ds_read_b128 a[144:147], v21 offset:4096
    v_mfma_f32_32x32x16_bf16 v[224:239], a[140:143], v[112:115], v[224:239]
    v_dot2_f32_bf16 v48, v40, s66, v48
    v_dot2_f32_bf16 v50, v40, v40, v50
    v_dot2_f32_bf16 v48, v41, s66, v48
    v_dot2_f32_bf16 v50, v41, v41, v50
    ds_read_b64_tr_b16 v[96:97], v72 offset:0
    v_mfma_f32_32x32x16_bf16 v[208:223], a[12:15], v[116:119], v[208:223]
    v_dot2_f32_bf16 v48, v42, s66, v48
    v_dot2_f32_bf16 v50, v42, v42, v50
    v_dot2_f32_bf16 v48, v43, s66, v48
    v_dot2_f32_bf16 v50, v43, v43, v50
    ds_read_b64_tr_b16 v[98:99], v72 offset:1024
    v_mfma_f32_32x32x16_bf16 v[240:255], a[140:143], v[116:119], v[240:255]
    v_dot2_f32_bf16 v49, v44, s66, v49
    v_dot2_f32_bf16 v51, v44, v44, v51
    v_dot2_f32_bf16 v49, v45, s66, v49
    v_dot2_f32_bf16 v51, v45, v45, v51
    ds_read_b64_tr_b16 v[100:101], v73 offset:0
    v_mfma_f32_32x32x16_bf16 v[128:143], a[12:15], v[120:123], v[128:143]
    s_add_u32 m0, s60, 0
    s_add_u32 s68, s58, 384
    buffer_load_dwordx4 v1, s[12:15], s68 offen offset:0 lds
    ds_read_b64_tr_b16 v[102:103], v73 offset:1024
    v_mfma_f32_32x32x16_bf16 v[160:175], a[140:143], v[120:123], v[160:175]
    buffer_load_dwordx4 v2, s[12:15], s68 offen offset:1024 lds
    ds_read_b64_tr_b16 v[104:105], v74 offset:0
    v_mfma_f32_32x32x16_bf16 v[144:159], a[12:15], v[124:127], v[144:159]
    buffer_load_dwordx4 v3, s[12:15], s68 offen offset:2048 lds
    ds_read_b64_tr_b16 v[106:107], v74 offset:1024
    v_mfma_f32_32x32x16_bf16 v[176:191], a[140:143], v[124:127], v[176:191]
    ds_read_b64_tr_b16 v[108:109], v75 offset:0
    ds_read_b64_tr_b16 v[110:111], v75 offset:1024
    s_waitcnt lgkmcnt(0)
    v_mfma_f32_32x32x16_bf16 v[192:207], a[16:19], v[96:99], v[192:207]
    ds_read_b128 a[20:23], v22 offset:0
    v_dot2_f32_bf16 v49, v46, s66, v49
    v_dot2_f32_bf16 v51, v46, v46, v51
    v_dot2_f32_bf16 v49, v47, s66, v49
    v_dot2_f32_bf16 v51, v47, v47, v51
    v_mfma_f32_32x32x16_bf16 v[224:239], a[144:147], v[96:99], v[224:239]
    ds_read_b128 a[148:151], v22 offset:4096
    s_nop 2
    v_permlane32_swap_b32 v48, v49
    v_permlane32_swap_b32 v50, v51
    s_nop 1
    v_mfma_f32_32x32x16_bf16 v[208:223], a[16:19], v[100:103], v[208:223]
    ds_read_b64_tr_b16 v[112:113], v72 offset:4096
    v_add_f32 v48, v48, v49
    v_add_f32 v50, v50, v51
    s_nop 1
    v_permlane16_swap_b32 v48, v50
    v_mfma_f32_32x32x16_bf16 v[240:255], a[144:147], v[100:103], v[240:255]
    ds_read_b64_tr_b16 v[114:115], v72 offset:5120
    buffer_load_dwordx4 v4, s[12:15], s68 offen offset:3072 lds
    v_mfma_f32_32x32x16_bf16 v[128:143], a[16:19], v[104:107], v[128:143]
    ds_read_b64_tr_b16 v[116:117], v73 offset:4096
    s_add_u32 m0, s60, 4096
    s_add_u32 s68, s58, 384
    buffer_load_dwordx4 v5, s[12:15], s68 offen offset:0 lds
    v_mfma_f32_32x32x16_bf16 v[160:175], a[144:147], v[104:107], v[160:175]
    ds_read_b64_tr_b16 v[118:119], v73 offset:5120
    buffer_load_dwordx4 v6, s[12:15], s68 offen offset:1024 lds
    v_mfma_f32_32x32x16_bf16 v[144:159], a[16:19], v[108:111], v[144:159]
    ds_read_b64_tr_b16 v[120:121], v74 offset:4096
    ds_read_b64_tr_b16 v[122:123], v74 offset:5120
    v_mfma_f32_32x32x16_bf16 v[176:191], a[144:147], v[108:111], v[176:191]
    ds_read_b64_tr_b16 v[124:125], v75 offset:4096
    ds_read_b64_tr_b16 v[126:127], v75 offset:5120
    s_waitcnt lgkmcnt(0)
    v_mfma_f32_32x32x16_bf16 v[192:207], a[20:23], v[112:115], v[192:207]
    ds_read_b128 a[24:27], v23 offset:0
    s_nop 1
    v_add_f32 v48, v48, v50
    s_nop 1
    v_add_f32_dpp v48, v48, v48 row_ror:8 row_mask:0xf bank_mask:0xf
    ds_read_b128 a[152:155], v23 offset:4096
    v_mfma_f32_32x32x16_bf16 v[224:239], a[148:151], v[112:115], v[224:239]
    s_nop 1
    v_add_f32_dpp v48, v48, v48 row_ror:4 row_mask:0xf bank_mask:0xf
    s_nop 1
    v_add_f32_dpp v48, v48, v48 row_ror:2 row_mask:0xf bank_mask:0xf
    ds_read_b64_tr_b16 v[96:97], v72 offset:8192
    v_mfma_f32_32x32x16_bf16 v[208:223], a[20:23], v[116:119], v[208:223]
    s_nop 1
    v_add_f32_dpp v48, v48, v48 row_ror:1 row_mask:0xf bank_mask:0xf
    s_nop 1
    v_mul_f32 v48, 0x3b000000, v48
    ds_read_b64_tr_b16 v[98:99], v72 offset:9216
    v_mfma_f32_32x32x16_bf16 v[240:255], a[148:151], v[116:119], v[240:255]
    s_nop 0
    v_readlane_b32 s40, v48, 0
    v_readlane_b32 s41, v48, 16
    v_readlane_b32 s42, v48, 32
    ds_read_b64_tr_b16 v[100:101], v73 offset:8192
    v_mfma_f32_32x32x16_bf16 v[128:143], a[20:23], v[120:123], v[128:143]
    buffer_load_dwordx4 v7, s[12:15], s68 offen offset:2048 lds
    ds_read_b64_tr_b16 v[102:103], v73 offset:9216
    v_mfma_f32_32x32x16_bf16 v[160:175], a[148:151], v[120:123], v[160:175]
    buffer_load_dwordx4 v8, s[12:15], s68 offen offset:3072 lds
    ds_read_b64_tr_b16 v[104:105], v74 offset:8192
    v_mfma_f32_32x32x16_bf16 v[144:159], a[20:23], v[124:127], v[144:159]
    s_add_u32 m0, s61, 32768
    s_add_u32 s68, s67, 1572864
    buffer_load_dwordx4 v64, s[16:19], s68 offen offset:0 lds
    ds_read_b64_tr_b16 v[106:107], v74 offset:9216
    v_mfma_f32_32x32x16_bf16 v[176:191], a[148:151], v[124:127], v[176:191]
    ds_read_b64_tr_b16 v[108:109], v75 offset:8192
    ds_read_b64_tr_b16 v[110:111], v75 offset:9216
    s_waitcnt lgkmcnt(0)
    v_mfma_f32_32x32x16_bf16 v[192:207], a[24:27], v[96:99], v[192:207]
    ds_read_b128 a[28:31], v24 offset:0
    s_cmp_lg_u32 s32, 0
    s_cbranch_scc1 L_W0_7
    v_mov_b32 v60, 0
    s_lshl_b32 s56, s34, 8
    s_add_u32 s56, s56, s33
    s_add_u32 s56, s56, 42532864
    s_mov_b64 exec, 1
    buffer_store_byte v60, v60, s[24:27], s56 offen sc0 sc1
    s_lshl_b32 s56, s2, 4
    s_add_u32 s56, s56, 42598400
    buffer_store_dword v60, v60, s[24:27], s56 offen sc0 sc1
    s_lshl_b32 s56, s2, 4
    s_add_u32 s56, s56, 42606592
    buffer_store_dword v60, v60, s[24:27], s56 offen sc0 sc1
    s_lshl_b32 s56, s2, 4
    s_add_u32 s56, s56, 42614784
    buffer_store_dword v60, v60, s[24:27], s56 offen sc0 sc1
    s_lshl_b32 s56, s2, 4
    s_add_u32 s56, s56, 42622976
    buffer_store_dword v60, v60, s[24:27], s56 offen sc0 sc1
    s_lshl_b32 s56, s2, 5
    s_add_u32 s56, s56, 42467328
    buffer_store_dword v60, v60, s[24:27], s56 offen sc0 sc1
    s_mov_b64 exec, -1
L_W0_7:
    ds_read_b128 a[156:159], v24 offset:4096
    v_mfma_f32_32x32x16_bf16 v[224:239], a[152:155], v[96:99], v[224:239]
    v_readlane_b32 s43, v48, 48
    s_nop 1
    v_mov_b32 v53, s40
    v_mov_b32 v52, s41
    ds_read_b64_tr_b16 v[112:113], v72 offset:12288
    v_mfma_f32_32x32x16_bf16 v[208:223], a[24:27], v[100:103], v[208:223]
    v_fma_f32 v52, -v53, v53, v52
    v_max_f32 v52, 0, v52
    v_add_f32 v52, 0x3727c5ac, v52
    v_rsq_f32 v52, v52
    ds_read_b64_tr_b16 v[114:115], v72 offset:13312
    v_mfma_f32_32x32x16_bf16 v[240:255], a[152:155], v[100:103], v[240:255]
    s_nop 0
    v_mul_f32 v53, v53, v52
    v_sub_f32 v53, 0, v53
    v_mov_b32 v55, s42
    ds_read_b64_tr_b16 v[116:117], v73 offset:12288
    v_mfma_f32_32x32x16_bf16 v[128:143], a[24:27], v[104:107], v[128:143]
    buffer_load_dwordx4 v65, s[16:19], s68 offen offset:1024 lds
    ds_read_b64_tr_b16 v[118:119], v73 offset:13312
    v_mfma_f32_32x32x16_bf16 v[160:175], a[152:155], v[104:107], v[160:175]
    buffer_load_dwordx4 v66, s[16:19], s68 offen offset:2048 lds
    ds_read_b64_tr_b16 v[120:121], v74 offset:12288
    v_mfma_f32_32x32x16_bf16 v[144:159], a[24:27], v[108:111], v[144:159]
    buffer_load_dwordx4 v67, s[16:19], s68 offen offset:3072 lds
    ds_read_b64_tr_b16 v[122:123], v74 offset:13312
    v_mfma_f32_32x32x16_bf16 v[176:191], a[152:155], v[108:111], v[176:191]
    ds_read_b64_tr_b16 v[124:125], v75 offset:12288
    ds_read_b64_tr_b16 v[126:127], v75 offset:13312
    s_waitcnt lgkmcnt(0)
    s_waitcnt vmcnt(12)
    s_barrier
    v_mfma_f32_32x32x16_bf16 v[192:207], a[28:31], v[112:115], v[192:207]
    ds_read_b128 a[32:35], v21 offset:49152
    v_mov_b32 v54, s43
    v_fma_f32 v54, -v55, v55, v54
    v_max_f32 v54, 0, v54
    v_add_f32 v54, 0x3727c5ac, v54
    v_mfma_f32_32x32x16_bf16 v[224:239], a[156:159], v[112:115], v[224:239]
    ds_read_b128 a[160:163], v21 offset:53248
    v_rsq_f32 v54, v54
    s_nop 0
    v_mul_f32 v55, v55, v54
    v_sub_f32 v55, 0, v55
    v_mfma_f32_32x32x16_bf16 v[208:223], a[28:31], v[116:119], v[208:223]
    ds_read_b64_tr_b16 v[96:97], v72 offset:49152
    v_lshlrev_b32 v56, 16, v40
    v_and_b32 v57, 0xffff0000, v40
    v_fma_f32 v56, v56, v52, v53
    v_fma_f32 v57, v57, v52, v53
    v_mfma_f32_32x32x16_bf16 v[240:255], a[156:159], v[116:119], v[240:255]
    ds_read_b64_tr_b16 v[98:99], v72 offset:50176
    s_add_u32 m0, s60, 49152
    s_add_u32 s68, s58, 512
    buffer_load_dwordx4 v1, s[12:15], s68 offen offset:0 lds
    v_mfma_f32_32x32x16_bf16 v[128:143], a[28:31], v[120:123], v[128:143]
    ds_read_b64_tr_b16 v[100:101], v73 offset:49152
    buffer_load_dwordx4 v2, s[12:15], s68 offen offset:1024 lds
    v_mfma_f32_32x32x16_bf16 v[160:175], a[156:159], v[120:123], v[160:175]
    ds_read_b64_tr_b16 v[102:103], v73 offset:50176
    buffer_load_dwordx4 v3, s[12:15], s68 offen offset:2048 lds
    v_mfma_f32_32x32x16_bf16 v[144:159], a[28:31], v[124:127], v[144:159]
    ds_read_b64_tr_b16 v[104:105], v74 offset:49152
    ds_read_b64_tr_b16 v[106:107], v74 offset:50176
    v_mfma_f32_32x32x16_bf16 v[176:191], a[156:159], v[124:127], v[176:191]
    ds_read_b64_tr_b16 v[108:109], v75 offset:49152
    ds_read_b64_tr_b16 v[110:111], v75 offset:50176
    s_waitcnt lgkmcnt(0)
    v_mfma_f32_32x32x16_bf16 v[192:207], a[32:35], v[96:99], v[192:207]
    ds_read_b128 a[36:39], v22 offset:49152
    s_add_u32 s56, s76, 256
    buffer_load_dwordx4 v[76:79], v61, s[72:75], s56 offen
    ds_read_b128 a[164:167], v22 offset:53248
    v_mfma_f32_32x32x16_bf16 v[224:239], a[160:163], v[96:99], v[224:239]
    s_add_u32 s56, s76, 1048832
    buffer_load_dwordx4 v[76:79], v61, s[72:75], s56 offen
    ds_read_b64_tr_b16 v[112:113], v72 offset:53248
    s_add_u32 s56, s76, 2097408
    buffer_load_dwordx4 v[76:79], v61, s[72:75], s56 offen
    v_mfma_f32_32x32x16_bf16 v[208:223], a[32:35], v[100:103], v[208:223]
    ds_read_b64_tr_b16 v[114:115], v72 offset:54272
    s_add_u32 s56, s76, 3145984
    buffer_load_dwordx4 v[76:79], v61, s[72:75], s56 offen
    ds_read_b64_tr_b16 v[116:117], v73 offset:53248
    v_mfma_f32_32x32x16_bf16 v[240:255], a[160:163], v[100:103], v[240:255]
    buffer_load_dwordx4 v[76:79], v31, s[20:23], s77 offen offset:0
    ds_read_b64_tr_b16 v[118:119], v73 offset:54272
    buffer_load_dwordx4 v[76:79], v31, s[20:23], s77 offen offset:1024
    v_mfma_f32_32x32x16_bf16 v[128:143], a[32:35], v[104:107], v[128:143]
    ds_read_b64_tr_b16 v[120:121], v74 offset:53248
    s_mov_b32 s8, s44
    s_mov_b32 s9, s45
    s_mov_b32 s10, 0x400000
    buffer_load_dword v76, v39, s[8:11], s70 offen offset:0
    ds_read_b64_tr_b16 v[122:123], v74 offset:54272
    v_mfma_f32_32x32x16_bf16 v[160:175], a[160:163], v[104:107], v[160:175]
    v_cvt_pk_bf16_f32 v40, v56, v57
    v_lshlrev_b32 v56, 16, v41
    v_and_b32 v57, 0xffff0000, v41
    v_fma_f32 v56, v56, v52, v53
    ds_read_b64_tr_b16 v[124:125], v75 offset:53248
    v_fma_f32 v57, v57, v52, v53
    v_cvt_pk_bf16_f32 v41, v56, v57
    v_lshlrev_b32 v56, 16, v42
    v_and_b32 v57, 0xffff0000, v42
    v_mfma_f32_32x32x16_bf16 v[144:159], a[32:35], v[108:111], v[144:159]
    ds_read_b64_tr_b16 v[126:127], v75 offset:54272
    v_fma_f32 v56, v56, v52, v53
    v_fma_f32 v57, v57, v52, v53
    v_cvt_pk_bf16_f32 v42, v56, v57
    v_lshlrev_b32 v56, 16, v43
    v_and_b32 v57, 0xffff0000, v43
    v_fma_f32 v56, v56, v52, v53
    v_fma_f32 v57, v57, v52, v53
    v_cvt_pk_bf16_f32 v43, v56, v57
    v_mfma_f32_32x32x16_bf16 v[176:191], a[160:163], v[108:111], v[176:191]
    buffer_load_dwordx4 v4, s[12:15], s68 offen offset:3072 lds
    s_add_u32 m0, s60, 53248
    s_add_u32 s68, s58, 512
    buffer_load_dwordx4 v5, s[12:15], s68 offen offset:0 lds
    buffer_load_dwordx4 v6, s[12:15], s68 offen offset:1024 lds
    s_waitcnt lgkmcnt(0)
    v_mfma_f32_32x32x16_bf16 v[192:207], a[36:39], v[112:115], v[192:207]
    ds_read_b128 a[40:43], v23 offset:49152
    v_lshlrev_b32 v56, 16, v44
    v_and_b32 v57, 0xffff0000, v44
    v_fma_f32 v56, v56, v54, v55
    v_fma_f32 v57, v57, v54, v55
    v_mfma_f32_32x32x16_bf16 v[224:239], a[164:167], v[112:115], v[224:239]
    ds_read_b128 a[168:171], v23 offset:53248
    v_cvt_pk_bf16_f32 v44, v56, v57
    v_lshlrev_b32 v56, 16, v45
    v_and_b32 v57, 0xffff0000, v45
    v_fma_f32 v56, v56, v54, v55
    v_mfma_f32_32x32x16_bf16 v[208:223], a[36:39], v[116:119], v[208:223]
    ds_read_b64_tr_b16 v[96:97], v72 offset:57344
    v_fma_f32 v57, v57, v54, v55
    v_cvt_pk_bf16_f32 v45, v56, v57
    v_lshlrev_b32 v56, 16, v46
    v_and_b32 v57, 0xffff0000, v46
    v_mfma_f32_32x32x16_bf16 v[240:255], a[164:167], v[116:119], v[240:255]
    ds_read_b64_tr_b16 v[98:99], v72 offset:58368
    buffer_load_dwordx4 v7, s[12:15], s68 offen offset:2048 lds
    v_mfma_f32_32x32x16_bf16 v[128:143], a[36:39], v[120:123], v[128:143]
    ds_read_b64_tr_b16 v[100:101], v73 offset:57344
    buffer_load_dwordx4 v8, s[12:15], s68 offen offset:3072 lds
    v_mfma_f32_32x32x16_bf16 v[160:175], a[164:167], v[120:123], v[160:175]
    ds_read_b64_tr_b16 v[102:103], v73 offset:58368
    s_add_u32 m0, s61, 81920
    s_add_u32 s68, s67, 2097152
    buffer_load_dwordx4 v64, s[16:19], s68 offen offset:0 lds
    v_mfma_f32_32x32x16_bf16 v[144:159], a[36:39], v[124:127], v[144:159]
    ds_read_b64_tr_b16 v[104:105], v74 offset:57344
    ds_read_b64_tr_b16 v[106:107], v74 offset:58368
    v_mfma_f32_32x32x16_bf16 v[176:191], a[164:167], v[124:127], v[176:191]
    ds_read_b64_tr_b16 v[108:109], v75 offset:57344
    ds_read_b64_tr_b16 v[110:111], v75 offset:58368
    s_waitcnt lgkmcnt(0)
    v_mfma_f32_32x32x16_bf16 v[192:207], a[40:43], v[96:99], v[192:207]
    ds_read_b128 a[44:47], v24 offset:49152
    v_fma_f32 v56, v56, v54, v55
    v_fma_f32 v57, v57, v54, v55
    v_cvt_pk_bf16_f32 v46, v56, v57
    v_lshlrev_b32 v56, 16, v47
    v_mfma_f32_32x32x16_bf16 v[224:239], a[168:171], v[96:99], v[224:239]
    ds_read_b128 a[172:175], v24 offset:53248
    v_and_b32 v57, 0xffff0000, v47
    v_fma_f32 v56, v56, v54, v55
    v_fma_f32 v57, v57, v54, v55
    v_cvt_pk_bf16_f32 v47, v56, v57
    v_mfma_f32_32x32x16_bf16 v[208:223], a[40:43], v[100:103], v[208:223]
    ds_read_b64_tr_b16 v[112:113], v72 offset:61440
    ds_write_b128 v58, v[40:43]
    ds_write_b128 v58, v[44:47] offset:16
    v_mfma_f32_32x32x16_bf16 v[240:255], a[168:171], v[100:103], v[240:255]
    ds_read_b64_tr_b16 v[114:115], v72 offset:62464
    buffer_load_dwordx4 v65, s[16:19], s68 offen offset:1024 lds
    v_mfma_f32_32x32x16_bf16 v[128:143], a[40:43], v[104:107], v[128:143]
    ds_read_b64_tr_b16 v[116:117], v73 offset:61440
    buffer_load_dwordx4 v66, s[16:19], s68 offen offset:2048 lds
    v_mfma_f32_32x32x16_bf16 v[160:175], a[168:171], v[104:107], v[160:175]
    ds_read_b64_tr_b16 v[118:119], v73 offset:62464
    buffer_load_dwordx4 v67, s[16:19], s68 offen offset:3072 lds
    v_mfma_f32_32x32x16_bf16 v[144:159], a[40:43], v[108:111], v[144:159]
    ds_read_b64_tr_b16 v[120:121], v74 offset:61440
    ds_read_b64_tr_b16 v[122:123], v74 offset:62464
    v_mfma_f32_32x32x16_bf16 v[176:191], a[168:171], v[108:111], v[176:191]
    ds_read_b64_tr_b16 v[124:125], v75 offset:61440
    ds_read_b64_tr_b16 v[126:127], v75 offset:62464
    s_waitcnt lgkmcnt(0)
    s_waitcnt vmcnt(19)
    s_waitcnt lgkmcnt(0)
    s_barrier
    v_mfma_f32_32x32x16_bf16 v[192:207], a[44:47], v[112:115], v[192:207]
    ds_read_b128 a[48:51], v17 offset:0
    s_add_u32 m0, s60, 98304
    s_add_u32 s68, s58, 640
    buffer_load_dwordx4 v1, s[12:15], s68 offen offset:0 lds
    v_mfma_f32_32x32x16_bf16 v[224:239], a[172:175], v[112:115], v[224:239]
    ds_read_b128 a[176:179], v17 offset:4096
    buffer_load_dwordx4 v2, s[12:15], s68 offen offset:1024 lds
    v_mfma_f32_32x32x16_bf16 v[208:223], a[44:47], v[116:119], v[208:223]
    ds_read_b64_tr_b16 v[96:97], v68 offset:0
    v_mfma_f32_32x32x16_bf16 v[240:255], a[172:175], v[116:119], v[240:255]
    buffer_load_dwordx4 v3, s[12:15], s68 offen offset:2048 lds
    ds_read_b64_tr_b16 v[98:99], v68 offset:1024
    v_mfma_f32_32x32x16_bf16 v[128:143], a[44:47], v[120:123], v[128:143]
    ds_read_b64_tr_b16 v[100:101], v69 offset:0
    ds_read_b64_tr_b16 v[102:103], v69 offset:1024
    v_mfma_f32_32x32x16_bf16 v[160:175], a[172:175], v[120:123], v[160:175]
    ds_read_b64_tr_b16 v[104:105], v70 offset:0
    v_mfma_f32_32x32x16_bf16 v[144:159], a[44:47], v[124:127], v[144:159]
    ds_read_b64_tr_b16 v[106:107], v70 offset:1024
    ds_read_b64_tr_b16 v[108:109], v71 offset:0
    v_mfma_f32_32x32x16_bf16 v[176:191], a[172:175], v[124:127], v[176:191]
    ds_read_b64_tr_b16 v[110:111], v71 offset:1024
    s_waitcnt lgkmcnt(0)
    v_mfma_f32_32x32x16_bf16 v[192:207], a[48:51], v[96:99], v[192:207]
    ds_read_b128 a[52:55], v18 offset:0
    ds_read_b128 v[40:43], v59
    ds_read_b128 v[44:47], v59 offset:1024
    v_mfma_f32_32x32x16_bf16 v[224:239], a[176:179], v[96:99], v[224:239]
    ds_read_b128 a[180:183], v18 offset:4096
    buffer_load_dwordx4 v4, s[12:15], s68 offen offset:3072 lds
    v_mfma_f32_32x32x16_bf16 v[208:223], a[48:51], v[100:103], v[208:223]
    ds_read_b64_tr_b16 v[112:113], v68 offset:4096
    s_add_u32 m0, s60, 102400
    s_add_u32 s68, s58, 640
    buffer_load_dwordx4 v5, s[12:15], s68 offen offset:0 lds
    v_mfma_f32_32x32x16_bf16 v[240:255], a[176:179], v[100:103], v[240:255]
    ds_read_b64_tr_b16 v[114:115], v68 offset:5120
    v_mfma_f32_32x32x16_bf16 v[128:143], a[48:51], v[104:107], v[128:143]
    buffer_load_dwordx4 v6, s[12:15], s68 offen offset:1024 lds
    ds_read_b64_tr_b16 v[116:117], v69 offset:4096
    v_mfma_f32_32x32x16_bf16 v[160:175], a[176:179], v[104:107], v[160:175]
    ds_read_b64_tr_b16 v[118:119], v69 offset:5120
    ds_read_b64_tr_b16 v[120:121], v70 offset:4096
    v_mfma_f32_32x32x16_bf16 v[144:159], a[48:51], v[108:111], v[144:159]
    ds_read_b64_tr_b16 v[122:123], v70 offset:5120
    ds_read_b64_tr_b16 v[124:125], v71 offset:4096
    v_mfma_f32_32x32x16_bf16 v[176:191], a[176:179], v[108:111], v[176:191]
    ds_read_b64_tr_b16 v[126:127], v71 offset:5120
    s_waitcnt lgkmcnt(0)
    v_mfma_f32_32x32x16_bf16 v[192:207], a[52:55], v[112:115], v[192:207]
    ds_read_b128 a[56:59], v19 offset:0
    buffer_store_dwordx4 v[40:43], v62, s[24:27], s69 offen sc1
    v_mfma_f32_32x32x16_bf16 v[224:239], a[180:183], v[112:115], v[224:239]
    ds_read_b128 a[184:187], v19 offset:4096
    buffer_load_dwordx4 v7, s[12:15], s68 offen offset:2048 lds
    v_mfma_f32_32x32x16_bf16 v[208:223], a[52:55], v[116:119], v[208:223]
    ds_read_b64_tr_b16 v[96:97], v68 offset:8192
    buffer_load_dwordx4 v8, s[12:15], s68 offen offset:3072 lds
    v_mfma_f32_32x32x16_bf16 v[240:255], a[180:183], v[116:119], v[240:255]
    ds_read_b64_tr_b16 v[98:99], v68 offset:9216
    v_mfma_f32_32x32x16_bf16 v[128:143], a[52:55], v[120:123], v[128:143]
    s_add_u32 m0, s61, 131072
    s_add_u32 s68, s67, 2621440
    buffer_load_dwordx4 v64, s[16:19], s68 offen offset:0 lds
    ds_read_b64_tr_b16 v[100:101], v69 offset:8192
    v_mfma_f32_32x32x16_bf16 v[160:175], a[180:183], v[120:123], v[160:175]
    ds_read_b64_tr_b16 v[102:103], v69 offset:9216
    ds_read_b64_tr_b16 v[104:105], v70 offset:8192
    v_mfma_f32_32x32x16_bf16 v[144:159], a[52:55], v[124:127], v[144:159]
    ds_read_b64_tr_b16 v[106:107], v70 offset:9216
    ds_read_b64_tr_b16 v[108:109], v71 offset:8192
    v_mfma_f32_32x32x16_bf16 v[176:191], a[180:183], v[124:127], v[176:191]
    ds_read_b64_tr_b16 v[110:111], v71 offset:9216
    s_waitcnt lgkmcnt(0)
    v_mfma_f32_32x32x16_bf16 v[192:207], a[56:59], v[96:99], v[192:207]
    ds_read_b128 a[60:63], v20 offset:0
    v_add_u32 v62, 4096, v62
    buffer_store_dwordx4 v[44:47], v62, s[24:27], s69 offen sc1
    v_mfma_f32_32x32x16_bf16 v[224:239], a[184:187], v[96:99], v[224:239]
    ds_read_b128 a[188:191], v20 offset:4096
    buffer_load_dwordx4 v65, s[16:19], s68 offen offset:1024 lds
    v_mfma_f32_32x32x16_bf16 v[208:223], a[56:59], v[100:103], v[208:223]
    ds_read_b64_tr_b16 v[112:113], v68 offset:12288
    buffer_load_dwordx4 v66, s[16:19], s68 offen offset:2048 lds
    v_mfma_f32_32x32x16_bf16 v[240:255], a[184:187], v[100:103], v[240:255]
    ds_read_b64_tr_b16 v[114:115], v68 offset:13312
    v_mfma_f32_32x32x16_bf16 v[128:143], a[56:59], v[104:107], v[128:143]
    buffer_load_dwordx4 v67, s[16:19], s68 offen offset:3072 lds
    ds_read_b64_tr_b16 v[116:117], v69 offset:12288
    v_mfma_f32_32x32x16_bf16 v[160:175], a[184:187], v[104:107], v[160:175]
    ds_read_b64_tr_b16 v[118:119], v69 offset:13312
    ds_read_b64_tr_b16 v[120:121], v70 offset:12288
    v_mfma_f32_32x32x16_bf16 v[144:159], a[56:59], v[108:111], v[144:159]
    ds_read_b64_tr_b16 v[122:123], v70 offset:13312
    ds_read_b64_tr_b16 v[124:125], v71 offset:12288
    v_mfma_f32_32x32x16_bf16 v[176:191], a[184:187], v[108:111], v[176:191]
    ds_read_b64_tr_b16 v[126:127], v71 offset:13312
    s_waitcnt lgkmcnt(0)
    s_waitcnt vmcnt(14)
    s_barrier
    v_mfma_f32_32x32x16_bf16 v[192:207], a[60:63], v[112:115], v[192:207]
    ds_read_b128 a[64:67], v21 offset:0
    s_add_u32 m0, s60, 0
    s_add_u32 s68, s58, 768
    buffer_load_dwordx4 v1, s[12:15], s68 offen offset:0 lds
    v_mfma_f32_32x32x16_bf16 v[224:239], a[188:191], v[112:115], v[224:239]
    ds_read_b128 a[192:195], v21 offset:4096
    buffer_load_dwordx4 v2, s[12:15], s68 offen offset:1024 lds
    v_mfma_f32_32x32x16_bf16 v[208:223], a[60:63], v[116:119], v[208:223]
    ds_read_b64_tr_b16 v[96:97], v72 offset:0
    v_mfma_f32_32x32x16_bf16 v[240:255], a[188:191], v[116:119], v[240:255]
    buffer_load_dwordx4 v3, s[12:15], s68 offen offset:2048 lds
    ds_read_b64_tr_b16 v[98:99], v72 offset:1024
    v_mfma_f32_32x32x16_bf16 v[128:143], a[60:63], v[120:123], v[128:143]
    ds_read_b64_tr_b16 v[100:101], v73 offset:0
    ds_read_b64_tr_b16 v[102:103], v73 offset:1024
    v_mfma_f32_32x32x16_bf16 v[160:175], a[188:191], v[120:123], v[160:175]
    ds_read_b64_tr_b16 v[104:105], v74 offset:0
    v_mfma_f32_32x32x16_bf16 v[144:159], a[60:63], v[124:127], v[144:159]
    ds_read_b64_tr_b16 v[106:107], v74 offset:1024
    ds_read_b64_tr_b16 v[108:109], v75 offset:0
    v_mfma_f32_32x32x16_bf16 v[176:191], a[188:191], v[124:127], v[176:191]
    ds_read_b64_tr_b16 v[110:111], v75 offset:1024
    s_waitcnt lgkmcnt(0)
    v_mfma_f32_32x32x16_bf16 v[192:207], a[64:67], v[96:99], v[192:207]
    ds_read_b128 a[68:71], v22 offset:0
    buffer_load_dwordx4 v4, s[12:15], s68 offen offset:3072 lds
    v_mfma_f32_32x32x16_bf16 v[224:239], a[192:195], v[96:99], v[224:239]
    ds_read_b128 a[196:199], v22 offset:4096
    s_add_u32 m0, s60, 4096
    s_add_u32 s68, s58, 768
    buffer_load_dwordx4 v5, s[12:15], s68 offen offset:0 lds
    v_mfma_f32_32x32x16_bf16 v[208:223], a[64:67], v[100:103], v[208:223]
    ds_read_b64_tr_b16 v[112:113], v72 offset:4096
    v_mfma_f32_32x32x16_bf16 v[240:255], a[192:195], v[100:103], v[240:255]
    buffer_load_dwordx4 v6, s[12:15], s68 offen offset:1024 lds
    ds_read_b64_tr_b16 v[114:115], v72 offset:5120
    v_mfma_f32_32x32x16_bf16 v[128:143], a[64:67], v[104:107], v[128:143]
    ds_read_b64_tr_b16 v[116:117], v73 offset:4096
    ds_read_b64_tr_b16 v[118:119], v73 offset:5120
    v_mfma_f32_32x32x16_bf16 v[160:175], a[192:195], v[104:107], v[160:175]
    ds_read_b64_tr_b16 v[120:121], v74 offset:4096
    v_mfma_f32_32x32x16_bf16 v[144:159], a[64:67], v[108:111], v[144:159]
    ds_read_b64_tr_b16 v[122:123], v74 offset:5120
    ds_read_b64_tr_b16 v[124:125], v75 offset:4096
    v_mfma_f32_32x32x16_bf16 v[176:191], a[192:195], v[108:111], v[176:191]
    ds_read_b64_tr_b16 v[126:127], v75 offset:5120
    s_waitcnt lgkmcnt(0)
    v_mfma_f32_32x32x16_bf16 v[192:207], a[68:71], v[112:115], v[192:207]
    ds_read_b128 a[72:75], v23 offset:0
    buffer_load_dwordx4 v7, s[12:15], s68 offen offset:2048 lds
    v_mfma_f32_32x32x16_bf16 v[224:239], a[196:199], v[112:115], v[224:239]
    ds_read_b128 a[200:203], v23 offset:4096
    buffer_load_dwordx4 v8, s[12:15], s68 offen offset:3072 lds
    v_mfma_f32_32x32x16_bf16 v[208:223], a[68:71], v[116:119], v[208:223]
    ds_read_b64_tr_b16 v[96:97], v72 offset:8192
    v_mfma_f32_32x32x16_bf16 v[240:255], a[196:199], v[116:119], v[240:255]
    s_add_u32 m0, s61, 32768
    s_add_u32 s68, s67, 3145728
    buffer_load_dwordx4 v64, s[16:19], s68 offen offset:0 lds
    ds_read_b64_tr_b16 v[98:99], v72 offset:9216
    v_mfma_f32_32x32x16_bf16 v[128:143], a[68:71], v[120:123], v[128:143]
    ds_read_b64_tr_b16 v[100:101], v73 offset:8192
    ds_read_b64_tr_b16 v[102:103], v73 offset:9216
    v_mfma_f32_32x32x16_bf16 v[160:175], a[196:199], v[120:123], v[160:175]
    ds_read_b64_tr_b16 v[104:105], v74 offset:8192
    v_mfma_f32_32x32x16_bf16 v[144:159], a[68:71], v[124:127], v[144:159]
    ds_read_b64_tr_b16 v[106:107], v74 offset:9216
    ds_read_b64_tr_b16 v[108:109], v75 offset:8192
    v_mfma_f32_32x32x16_bf16 v[176:191], a[196:199], v[124:127], v[176:191]
    ds_read_b64_tr_b16 v[110:111], v75 offset:9216
    s_waitcnt lgkmcnt(0)
    v_mfma_f32_32x32x16_bf16 v[192:207], a[72:75], v[96:99], v[192:207]
    ds_read_b128 a[76:79], v24 offset:0
    buffer_load_dwordx4 v65, s[16:19], s68 offen offset:1024 lds
    v_mfma_f32_32x32x16_bf16 v[224:239], a[200:203], v[96:99], v[224:239]
    ds_read_b128 a[204:207], v24 offset:4096
    buffer_load_dwordx4 v66, s[16:19], s68 offen offset:2048 lds
    v_mfma_f32_32x32x16_bf16 v[208:223], a[72:75], v[100:103], v[208:223]
    ds_read_b64_tr_b16 v[112:113], v72 offset:12288
    v_mfma_f32_32x32x16_bf16 v[240:255], a[200:203], v[100:103], v[240:255]
    buffer_load_dwordx4 v67, s[16:19], s68 offen offset:3072 lds
    ds_read_b64_tr_b16 v[114:115], v72 offset:13312
    v_mfma_f32_32x32x16_bf16 v[128:143], a[72:75], v[104:107], v[128:143]
    ds_read_b64_tr_b16 v[116:117], v73 offset:12288
    ds_read_b64_tr_b16 v[118:119], v73 offset:13312
    v_mfma_f32_32x32x16_bf16 v[160:175], a[200:203], v[104:107], v[160:175]
    ds_read_b64_tr_b16 v[120:121], v74 offset:12288
    v_mfma_f32_32x32x16_bf16 v[144:159], a[72:75], v[108:111], v[144:159]
    ds_read_b64_tr_b16 v[122:123], v74 offset:13312
    ds_read_b64_tr_b16 v[124:125], v75 offset:12288
    v_mfma_f32_32x32x16_bf16 v[176:191], a[200:203], v[108:111], v[176:191]
    ds_read_b64_tr_b16 v[126:127], v75 offset:13312
    s_waitcnt lgkmcnt(0)
    s_waitcnt vmcnt(12)
    s_barrier
    v_mfma_f32_32x32x16_bf16 v[192:207], a[76:79], v[112:115], v[192:207]
    ds_read_b128 a[80:83], v21 offset:49152
    s_add_u32 m0, s60, 49152
    s_add_u32 s68, s58, 896
    buffer_load_dwordx4 v1, s[12:15], s68 offen offset:0 lds
    v_mfma_f32_32x32x16_bf16 v[224:239], a[204:207], v[112:115], v[224:239]
    ds_read_b128 a[208:211], v21 offset:53248
    buffer_load_dwordx4 v2, s[12:15], s68 offen offset:1024 lds
    v_mfma_f32_32x32x16_bf16 v[208:223], a[76:79], v[116:119], v[208:223]
    ds_read_b64_tr_b16 v[96:97], v72 offset:49152
    v_mfma_f32_32x32x16_bf16 v[240:255], a[204:207], v[116:119], v[240:255]
    buffer_load_dwordx4 v3, s[12:15], s68 offen offset:2048 lds
    ds_read_b64_tr_b16 v[98:99], v72 offset:50176
    v_mfma_f32_32x32x16_bf16 v[128:143], a[76:79], v[120:123], v[128:143]
    ds_read_b64_tr_b16 v[100:101], v73 offset:49152
    ds_read_b64_tr_b16 v[102:103], v73 offset:50176
    v_mfma_f32_32x32x16_bf16 v[160:175], a[204:207], v[120:123], v[160:175]
    ds_read_b64_tr_b16 v[104:105], v74 offset:49152
    v_mfma_f32_32x32x16_bf16 v[144:159], a[76:79], v[124:127], v[144:159]
    ds_read_b64_tr_b16 v[106:107], v74 offset:50176
    ds_read_b64_tr_b16 v[108:109], v75 offset:49152
    v_mfma_f32_32x32x16_bf16 v[176:191], a[204:207], v[124:127], v[176:191]
    ds_read_b64_tr_b16 v[110:111], v75 offset:50176
    s_waitcnt lgkmcnt(0)
    v_mfma_f32_32x32x16_bf16 v[192:207], a[80:83], v[96:99], v[192:207]
    ds_read_b128 a[84:87], v22 offset:49152
    buffer_load_dwordx4 v4, s[12:15], s68 offen offset:3072 lds
    v_mfma_f32_32x32x16_bf16 v[224:239], a[208:211], v[96:99], v[224:239]
    ds_read_b128 a[212:215], v22 offset:53248
    s_add_u32 m0, s60, 53248
    s_add_u32 s68, s58, 896
    buffer_load_dwordx4 v5, s[12:15], s68 offen offset:0 lds
    v_mfma_f32_32x32x16_bf16 v[208:223], a[80:83], v[100:103], v[208:223]
    ds_read_b64_tr_b16 v[112:113], v72 offset:53248
    v_mfma_f32_32x32x16_bf16 v[240:255], a[208:211], v[100:103], v[240:255]
    buffer_load_dwordx4 v6, s[12:15], s68 offen offset:1024 lds
    ds_read_b64_tr_b16 v[114:115], v72 offset:54272
    v_mfma_f32_32x32x16_bf16 v[128:143], a[80:83], v[104:107], v[128:143]
    ds_read_b64_tr_b16 v[116:117], v73 offset:53248
    ds_read_b64_tr_b16 v[118:119], v73 offset:54272
    v_mfma_f32_32x32x16_bf16 v[160:175], a[208:211], v[104:107], v[160:175]
    ds_read_b64_tr_b16 v[120:121], v74 offset:53248
    v_mfma_f32_32x32x16_bf16 v[144:159], a[80:83], v[108:111], v[144:159]
    ds_read_b64_tr_b16 v[122:123], v74 offset:54272
    ds_read_b64_tr_b16 v[124:125], v75 offset:53248
    v_mfma_f32_32x32x16_bf16 v[176:191], a[208:211], v[108:111], v[176:191]
    ds_read_b64_tr_b16 v[126:127], v75 offset:54272
    s_waitcnt lgkmcnt(0)
    v_mfma_f32_32x32x16_bf16 v[192:207], a[84:87], v[112:115], v[192:207]
    ds_read_b128 a[88:91], v23 offset:49152
    buffer_load_dwordx4 v7, s[12:15], s68 offen offset:2048 lds
    v_mfma_f32_32x32x16_bf16 v[224:239], a[212:215], v[112:115], v[224:239]
    ds_read_b128 a[216:219], v23 offset:53248
    buffer_load_dwordx4 v8, s[12:15], s68 offen offset:3072 lds
    v_mfma_f32_32x32x16_bf16 v[208:223], a[84:87], v[116:119], v[208:223]
    ds_read_b64_tr_b16 v[96:97], v72 offset:57344
    v_mfma_f32_32x32x16_bf16 v[240:255], a[212:215], v[116:119], v[240:255]
    s_add_u32 m0, s61, 81920
    s_add_u32 s68, s67, 3670016
    buffer_load_dwordx4 v64, s[16:19], s68 offen offset:0 lds
    ds_read_b64_tr_b16 v[98:99], v72 offset:58368
    v_mfma_f32_32x32x16_bf16 v[128:143], a[84:87], v[120:123], v[128:143]
    ds_read_b64_tr_b16 v[100:101], v73 offset:57344
    ds_read_b64_tr_b16 v[102:103], v73 offset:58368
    v_mfma_f32_32x32x16_bf16 v[160:175], a[212:215], v[120:123], v[160:175]
    ds_read_b64_tr_b16 v[104:105], v74 offset:57344
    v_mfma_f32_32x32x16_bf16 v[144:159], a[84:87], v[124:127], v[144:159]
    ds_read_b64_tr_b16 v[106:107], v74 offset:58368
    ds_read_b64_tr_b16 v[108:109], v75 offset:57344
    v_mfma_f32_32x32x16_bf16 v[176:191], a[212:215], v[124:127], v[176:191]
    ds_read_b64_tr_b16 v[110:111], v75 offset:58368
    s_waitcnt lgkmcnt(0)
    v_mfma_f32_32x32x16_bf16 v[192:207], a[88:91], v[96:99], v[192:207]
    ds_read_b128 a[92:95], v24 offset:49152
    buffer_load_dwordx4 v65, s[16:19], s68 offen offset:1024 lds
    v_mfma_f32_32x32x16_bf16 v[224:239], a[216:219], v[96:99], v[224:239]
    ds_read_b128 a[220:223], v24 offset:53248
    buffer_load_dwordx4 v66, s[16:19], s68 offen offset:2048 lds
    v_mfma_f32_32x32x16_bf16 v[208:223], a[88:91], v[100:103], v[208:223]
    ds_read_b64_tr_b16 v[112:113], v72 offset:61440
    v_mfma_f32_32x32x16_bf16 v[240:255], a[216:219], v[100:103], v[240:255]
    buffer_load_dwordx4 v67, s[16:19], s68 offen offset:3072 lds
    ds_read_b64_tr_b16 v[114:115], v72 offset:62464
    v_mfma_f32_32x32x16_bf16 v[128:143], a[88:91], v[104:107], v[128:143]
    ds_read_b64_tr_b16 v[116:117], v73 offset:61440
    ds_read_b64_tr_b16 v[118:119], v73 offset:62464
    v_mfma_f32_32x32x16_bf16 v[160:175], a[216:219], v[104:107], v[160:175]
    ds_read_b64_tr_b16 v[120:121], v74 offset:61440
    v_mfma_f32_32x32x16_bf16 v[144:159], a[88:91], v[108:111], v[144:159]
    ds_read_b64_tr_b16 v[122:123], v74 offset:62464
    ds_read_b64_tr_b16 v[124:125], v75 offset:61440
    v_mfma_f32_32x32x16_bf16 v[176:191], a[216:219], v[108:111], v[176:191]
    ds_read_b64_tr_b16 v[126:127], v75 offset:62464
    s_waitcnt lgkmcnt(0)
    s_waitcnt vmcnt(12)
    s_barrier
    v_mfma_f32_32x32x16_bf16 v[192:207], a[92:95], v[112:115], v[192:207]
    ds_read_b128 a[96:99], v17 offset:0
    s_add_u32 m0, s60, 98304
    s_add_u32 s68, s59, 256
    buffer_load_dwordx4 v9, s[16:19], s68 offen offset:0 lds
    v_mfma_f32_32x32x16_bf16 v[224:239], a[220:223], v[112:115], v[224:239]
    ds_read_b128 a[224:227], v17 offset:4096
    buffer_load_dwordx4 v10, s[16:19], s68 offen offset:1024 lds
    v_mfma_f32_32x32x16_bf16 v[208:223], a[92:95], v[116:119], v[208:223]
    ds_read_b64_tr_b16 v[96:97], v68 offset:0
    buffer_load_dwordx4 v11, s[16:19], s68 offen offset:2048 lds
    v_mfma_f32_32x32x16_bf16 v[240:255], a[220:223], v[116:119], v[240:255]
    ds_read_b64_tr_b16 v[98:99], v68 offset:1024
    v_mfma_f32_32x32x16_bf16 v[128:143], a[92:95], v[120:123], v[128:143]
    buffer_load_dwordx4 v12, s[16:19], s68 offen offset:3072 lds
    ds_read_b64_tr_b16 v[100:101], v69 offset:0
    v_mfma_f32_32x32x16_bf16 v[160:175], a[220:223], v[120:123], v[160:175]
    ds_read_b64_tr_b16 v[102:103], v69 offset:1024
    ds_read_b64_tr_b16 v[104:105], v70 offset:0
    v_mfma_f32_32x32x16_bf16 v[144:159], a[92:95], v[124:127], v[144:159]
    ds_read_b64_tr_b16 v[106:107], v70 offset:1024
    ds_read_b64_tr_b16 v[108:109], v71 offset:0
    v_mfma_f32_32x32x16_bf16 v[176:191], a[220:223], v[124:127], v[176:191]
    ds_read_b64_tr_b16 v[110:111], v71 offset:1024
    s_waitcnt lgkmcnt(0)
    v_mfma_f32_32x32x16_bf16 v[192:207], a[96:99], v[96:99], v[192:207]
    ds_read_b128 a[100:103], v18 offset:0
    s_add_u32 m0, s60, 102400
    s_add_u32 s68, s59, 256
    buffer_load_dwordx4 v13, s[16:19], s68 offen offset:0 lds
    v_mfma_f32_32x32x16_bf16 v[224:239], a[224:227], v[96:99], v[224:239]
    ds_read_b128 a[228:231], v18 offset:4096
    buffer_load_dwordx4 v14, s[16:19], s68 offen offset:1024 lds
    v_mfma_f32_32x32x16_bf16 v[208:223], a[96:99], v[100:103], v[208:223]
    ds_read_b64_tr_b16 v[112:113], v68 offset:4096
    v_mfma_f32_32x32x16_bf16 v[240:255], a[224:227], v[100:103], v[240:255]
    buffer_load_dwordx4 v15, s[16:19], s68 offen offset:2048 lds
    ds_read_b64_tr_b16 v[114:115], v68 offset:5120
    v_mfma_f32_32x32x16_bf16 v[128:143], a[96:99], v[104:107], v[128:143]
    ds_read_b64_tr_b16 v[116:117], v69 offset:4096
    ds_read_b64_tr_b16 v[118:119], v69 offset:5120
    v_mfma_f32_32x32x16_bf16 v[160:175], a[224:227], v[104:107], v[160:175]
    ds_read_b64_tr_b16 v[120:121], v70 offset:4096
    v_mfma_f32_32x32x16_bf16 v[144:159], a[96:99], v[108:111], v[144:159]
    ds_read_b64_tr_b16 v[122:123], v70 offset:5120
    ds_read_b64_tr_b16 v[124:125], v71 offset:4096
    v_mfma_f32_32x32x16_bf16 v[176:191], a[224:227], v[108:111], v[176:191]
    ds_read_b64_tr_b16 v[126:127], v71 offset:5120
    s_waitcnt lgkmcnt(0)
    v_mfma_f32_32x32x16_bf16 v[192:207], a[100:103], v[112:115], v[192:207]
    ds_read_b128 a[104:107], v19 offset:0
    buffer_load_dwordx4 v16, s[16:19], s68 offen offset:3072 lds
    v_mfma_f32_32x32x16_bf16 v[224:239], a[228:231], v[112:115], v[224:239]
    ds_read_b128 a[232:235], v19 offset:4096
    s_add_u32 m0, s60, 131072
    s_add_u32 s68, s59, 2097408
    buffer_load_dwordx4 v9, s[16:19], s68 offen offset:0 lds
    v_mfma_f32_32x32x16_bf16 v[208:223], a[100:103], v[116:119], v[208:223]
    ds_read_b64_tr_b16 v[96:97], v68 offset:8192
    buffer_load_dwordx4 v10, s[16:19], s68 offen offset:1024 lds
    v_mfma_f32_32x32x16_bf16 v[240:255], a[228:231], v[116:119], v[240:255]
    ds_read_b64_tr_b16 v[98:99], v68 offset:9216
    v_mfma_f32_32x32x16_bf16 v[128:143], a[100:103], v[120:123], v[128:143]
    buffer_load_dwordx4 v11, s[16:19], s68 offen offset:2048 lds
    ds_read_b64_tr_b16 v[100:101], v69 offset:8192
    v_mfma_f32_32x32x16_bf16 v[160:175], a[228:231], v[120:123], v[160:175]
    ds_read_b64_tr_b16 v[102:103], v69 offset:9216
    ds_read_b64_tr_b16 v[104:105], v70 offset:8192
    v_mfma_f32_32x32x16_bf16 v[144:159], a[100:103], v[124:127], v[144:159]
    ds_read_b64_tr_b16 v[106:107], v70 offset:9216
    ds_read_b64_tr_b16 v[108:109], v71 offset:8192
    v_mfma_f32_32x32x16_bf16 v[176:191], a[228:231], v[124:127], v[176:191]
    ds_read_b64_tr_b16 v[110:111], v71 offset:9216
    s_waitcnt lgkmcnt(0)
    v_mfma_f32_32x32x16_bf16 v[192:207], a[104:107], v[96:99], v[192:207]
    ds_read_b128 a[108:111], v20 offset:0
    buffer_load_dwordx4 v12, s[16:19], s68 offen offset:3072 lds
    v_mfma_f32_32x32x16_bf16 v[224:239], a[232:235], v[96:99], v[224:239]
    ds_read_b128 a[236:239], v20 offset:4096
    s_cmp_lg_u32 s32, 0
    s_cbranch_scc1 L_W0_8
L_W0_8:
    v_mfma_f32_32x32x16_bf16 v[208:223], a[104:107], v[100:103], v[208:223]
    ds_read_b64_tr_b16 v[112:113], v68 offset:12288
    v_mfma_f32_32x32x16_bf16 v[240:255], a[232:235], v[100:103], v[240:255]
    s_cmp_lg_u32 s32, 0
    s_cbranch_scc1 L_W0_9
    v_mov_b32 v46, 1
    v_mov_b32 v47, 0
    s_mov_b64 exec, 1
    buffer_store_byte v46, v47, s[28:31], s2 offen sc0 sc1
    s_mov_b64 exec, -1
L_W0_9:
    ds_read_b64_tr_b16 v[114:115], v68 offset:13312
    v_mfma_f32_32x32x16_bf16 v[128:143], a[104:107], v[104:107], v[128:143]
    ds_read_b64_tr_b16 v[116:117], v69 offset:12288
    ds_read_b64_tr_b16 v[118:119], v69 offset:13312
    v_mfma_f32_32x32x16_bf16 v[160:175], a[232:235], v[104:107], v[160:175]
    ds_read_b64_tr_b16 v[120:121], v70 offset:12288
    v_mfma_f32_32x32x16_bf16 v[144:159], a[104:107], v[108:111], v[144:159]
    ds_read_b64_tr_b16 v[122:123], v70 offset:13312
    ds_read_b64_tr_b16 v[124:125], v71 offset:12288
    v_mfma_f32_32x32x16_bf16 v[176:191], a[232:235], v[108:111], v[176:191]
    ds_read_b64_tr_b16 v[126:127], v71 offset:13312
    s_waitcnt lgkmcnt(0)
    s_waitcnt vmcnt(12)
    s_barrier
    v_mfma_f32_32x32x16_bf16 v[192:207], a[108:111], v[112:115], v[192:207]
    ds_read_b128 a[112:115], v21 offset:0
    s_add_u32 m0, s60, 135168
    s_add_u32 s68, s59, 2097408
    buffer_load_dwordx4 v13, s[16:19], s68 offen offset:0 lds
    v_mfma_f32_32x32x16_bf16 v[224:239], a[236:239], v[112:115], v[224:239]
    ds_read_b128 a[240:243], v21 offset:4096
    buffer_load_dwordx4 v14, s[16:19], s68 offen offset:1024 lds
    v_mfma_f32_32x32x16_bf16 v[208:223], a[108:111], v[116:119], v[208:223]
    ds_read_b64_tr_b16 v[96:97], v72 offset:0
    v_mfma_f32_32x32x16_bf16 v[240:255], a[236:239], v[116:119], v[240:255]
    buffer_load_dwordx4 v15, s[16:19], s68 offen offset:2048 lds
    ds_read_b64_tr_b16 v[98:99], v72 offset:1024
    v_mfma_f32_32x32x16_bf16 v[128:143], a[108:111], v[120:123], v[128:143]
    ds_read_b64_tr_b16 v[100:101], v73 offset:0
    ds_read_b64_tr_b16 v[102:103], v73 offset:1024
    v_mfma_f32_32x32x16_bf16 v[160:175], a[236:239], v[120:123], v[160:175]
    ds_read_b64_tr_b16 v[104:105], v74 offset:0
    v_mfma_f32_32x32x16_bf16 v[144:159], a[108:111], v[124:127], v[144:159]
    ds_read_b64_tr_b16 v[106:107], v74 offset:1024
    ds_read_b64_tr_b16 v[108:109], v75 offset:0
    v_mfma_f32_32x32x16_bf16 v[176:191], a[236:239], v[124:127], v[176:191]
    ds_read_b64_tr_b16 v[110:111], v75 offset:1024
    s_waitcnt lgkmcnt(0)
    v_mfma_f32_32x32x16_bf16 v[192:207], a[112:115], v[96:99], v[192:207]
    ds_read_b128 a[116:119], v22 offset:0
    buffer_load_dwordx4 v16, s[16:19], s68 offen offset:3072 lds
    v_mfma_f32_32x32x16_bf16 v[224:239], a[240:243], v[96:99], v[224:239]
    ds_read_b128 a[244:247], v22 offset:4096
    s_add_u32 m0, s60, 0
    s_add_u32 s68, s59, 384
    buffer_load_dwordx4 v9, s[16:19], s68 offen offset:0 lds
    v_mfma_f32_32x32x16_bf16 v[208:223], a[112:115], v[100:103], v[208:223]
    ds_read_b64_tr_b16 v[112:113], v72 offset:4096
    v_mfma_f32_32x32x16_bf16 v[240:255], a[240:243], v[100:103], v[240:255]
    buffer_load_dwordx4 v10, s[16:19], s68 offen offset:1024 lds
    ds_read_b64_tr_b16 v[114:115], v72 offset:5120
    v_mfma_f32_32x32x16_bf16 v[128:143], a[112:115], v[104:107], v[128:143]
    ds_read_b64_tr_b16 v[116:117], v73 offset:4096
    ds_read_b64_tr_b16 v[118:119], v73 offset:5120
    v_mfma_f32_32x32x16_bf16 v[160:175], a[240:243], v[104:107], v[160:175]
    ds_read_b64_tr_b16 v[120:121], v74 offset:4096
    v_mfma_f32_32x32x16_bf16 v[144:159], a[112:115], v[108:111], v[144:159]
    ds_read_b64_tr_b16 v[122:123], v74 offset:5120
    ds_read_b64_tr_b16 v[124:125], v75 offset:4096
    v_mfma_f32_32x32x16_bf16 v[176:191], a[240:243], v[108:111], v[176:191]
    ds_read_b64_tr_b16 v[126:127], v75 offset:5120
    s_waitcnt lgkmcnt(0)
    v_mfma_f32_32x32x16_bf16 v[192:207], a[116:119], v[112:115], v[192:207]
    ds_read_b128 a[120:123], v23 offset:0
    buffer_load_dwordx4 v11, s[16:19], s68 offen offset:2048 lds
    v_mfma_f32_32x32x16_bf16 v[224:239], a[244:247], v[112:115], v[224:239]
    ds_read_b128 a[248:251], v23 offset:4096
    buffer_load_dwordx4 v12, s[16:19], s68 offen offset:3072 lds
    v_mfma_f32_32x32x16_bf16 v[208:223], a[116:119], v[116:119], v[208:223]
    ds_read_b64_tr_b16 v[96:97], v72 offset:8192
    v_mfma_f32_32x32x16_bf16 v[240:255], a[244:247], v[116:119], v[240:255]
    s_add_u32 m0, s60, 4096
    s_add_u32 s68, s59, 384
    buffer_load_dwordx4 v13, s[16:19], s68 offen offset:0 lds
    ds_read_b64_tr_b16 v[98:99], v72 offset:9216
    v_mfma_f32_32x32x16_bf16 v[128:143], a[116:119], v[120:123], v[128:143]
    ds_read_b64_tr_b16 v[100:101], v73 offset:8192
    ds_read_b64_tr_b16 v[102:103], v73 offset:9216
    v_mfma_f32_32x32x16_bf16 v[160:175], a[244:247], v[120:123], v[160:175]
    ds_read_b64_tr_b16 v[104:105], v74 offset:8192
    v_mfma_f32_32x32x16_bf16 v[144:159], a[116:119], v[124:127], v[144:159]
    ds_read_b64_tr_b16 v[106:107], v74 offset:9216
    ds_read_b64_tr_b16 v[108:109], v75 offset:8192
    v_mfma_f32_32x32x16_bf16 v[176:191], a[244:247], v[124:127], v[176:191]
    ds_read_b64_tr_b16 v[110:111], v75 offset:9216
    s_waitcnt lgkmcnt(0)
    v_mfma_f32_32x32x16_bf16 v[192:207], a[120:123], v[96:99], v[192:207]
    ds_read_b128 a[124:127], v24 offset:0
    buffer_load_dwordx4 v14, s[16:19], s68 offen offset:1024 lds
    v_mfma_f32_32x32x16_bf16 v[224:239], a[248:251], v[96:99], v[224:239]
    ds_read_b128 a[252:255], v24 offset:4096
    buffer_load_dwordx4 v15, s[16:19], s68 offen offset:2048 lds
    v_mfma_f32_32x32x16_bf16 v[208:223], a[120:123], v[100:103], v[208:223]
    ds_read_b64_tr_b16 v[112:113], v72 offset:12288
    v_mfma_f32_32x32x16_bf16 v[240:255], a[248:251], v[100:103], v[240:255]
    buffer_load_dwordx4 v16, s[16:19], s68 offen offset:3072 lds
    ds_read_b64_tr_b16 v[114:115], v72 offset:13312
    v_mfma_f32_32x32x16_bf16 v[128:143], a[120:123], v[104:107], v[128:143]
    ds_read_b64_tr_b16 v[116:117], v73 offset:12288
    ds_read_b64_tr_b16 v[118:119], v73 offset:13312
    v_mfma_f32_32x32x16_bf16 v[160:175], a[248:251], v[104:107], v[160:175]
    ds_read_b64_tr_b16 v[120:121], v74 offset:12288
    v_mfma_f32_32x32x16_bf16 v[144:159], a[120:123], v[108:111], v[144:159]
    ds_read_b64_tr_b16 v[122:123], v74 offset:13312
    ds_read_b64_tr_b16 v[124:125], v75 offset:12288
    v_mfma_f32_32x32x16_bf16 v[176:191], a[248:251], v[108:111], v[176:191]
    ds_read_b64_tr_b16 v[126:127], v75 offset:13312
    s_waitcnt lgkmcnt(0)
    s_waitcnt vmcnt(16)
    s_barrier
    v_mfma_f32_32x32x16_bf16 v[192:207], a[124:127], v[112:115], v[192:207]
    v_mfma_f32_32x32x16_bf16 v[224:239], a[252:255], v[112:115], v[224:239]
    v_mfma_f32_32x32x16_bf16 v[208:223], a[124:127], v[116:119], v[208:223]
    v_mfma_f32_32x32x16_bf16 v[240:255], a[252:255], v[116:119], v[240:255]
    ds_read_b64_tr_b16 v[96:97], v27 offset:32768
    ds_read_b64_tr_b16 v[98:99], v27 offset:33280
    ds_read_b64_tr_b16 v[100:101], v28 offset:32768
    ds_read_b64_tr_b16 v[102:103], v28 offset:33280
    v_mfma_f32_32x32x16_bf16 v[128:143], a[124:127], v[120:123], v[128:143]
    v_mfma_f32_32x32x16_bf16 v[160:175], a[252:255], v[120:123], v[160:175]
    v_cvt_pk_bf16_f32 v64, v192, v193
    v_cvt_pk_bf16_f32 v65, v194, v195
    v_cvt_pk_bf16_f32 v66, v196, v197
    v_cvt_pk_bf16_f32 v67, v198, v199
    v_cvt_pk_bf16_f32 v68, v200, v201
    v_cvt_pk_bf16_f32 v69, v202, v203
    v_cvt_pk_bf16_f32 v70, v204, v205
    v_cvt_pk_bf16_f32 v71, v206, v207
    v_mfma_f32_32x32x16_bf16 v[144:159], a[124:127], v[124:127], v[144:159]
    v_cvt_pk_bf16_f32 v80, v224, v225
    v_cvt_pk_bf16_f32 v81, v226, v227
    v_cvt_pk_bf16_f32 v82, v228, v229
    v_cvt_pk_bf16_f32 v83, v230, v231
    v_cvt_pk_bf16_f32 v84, v232, v233
    v_cvt_pk_bf16_f32 v85, v234, v235
    v_cvt_pk_bf16_f32 v86, v236, v237
    v_cvt_pk_bf16_f32 v87, v238, v239
    v_mfma_f32_32x32x16_bf16 v[176:191], a[252:255], v[124:127], v[176:191]
    ds_read_b64_tr_b16 v[104:105], v27 offset:34816
    ds_read_b64_tr_b16 v[106:107], v27 offset:35328
    ds_read_b64_tr_b16 v[108:109], v28 offset:34816
    ds_read_b64_tr_b16 v[110:111], v28 offset:35328
    v_cvt_pk_bf16_f32 v72, v208, v209
    v_cvt_pk_bf16_f32 v73, v210, v211
    v_cvt_pk_bf16_f32 v74, v212, v213
    v_cvt_pk_bf16_f32 v75, v214, v215
    v_cvt_pk_bf16_f32 v76, v216, v217
    v_cvt_pk_bf16_f32 v77, v218, v219
    v_cvt_pk_bf16_f32 v78, v220, v221
    v_cvt_pk_bf16_f32 v79, v222, v223
    v_cvt_pk_bf16_f32 v88, v240, v241
    v_cvt_pk_bf16_f32 v89, v242, v243
    v_cvt_pk_bf16_f32 v90, v244, v245
    v_cvt_pk_bf16_f32 v91, v246, v247
    v_cvt_pk_bf16_f32 v92, v248, v249
    v_cvt_pk_bf16_f32 v93, v250, v251
    v_cvt_pk_bf16_f32 v94, v252, v253
    v_cvt_pk_bf16_f32 v95, v254, v255
    s_waitcnt lgkmcnt(4)
    v_mfma_f32_32x32x16_bf16 v[192:207], a[0:3], v[96:99], 0
    ds_read_b64_tr_b16 v[112:113], v27 offset:36864
    s_add_u32 m0, s60, 32768
    s_add_u32 s68, s59, 2097536
    buffer_load_dwordx4 v9, s[16:19], s68 offen offset:0 lds
    ds_read_b64_tr_b16 v[114:115], v27 offset:37376
    v_mfma_f32_32x32x16_bf16 v[224:239], a[128:131], v[96:99], 0
    buffer_load_dwordx4 v10, s[16:19], s68 offen offset:1024 lds
    ds_read_b64_tr_b16 v[116:117], v28 offset:36864
    v_mfma_f32_32x32x16_bf16 v[208:223], a[0:3], v[100:103], 0
    v_add_u32 v46, 0, v0
    v_mul_u32_u24 v47, 43691, v46
    v_lshrrev_b32 v47, 19, v47
    v_mul_u32_u24 v48, 12, v47
    ds_read_b64_tr_b16 v[118:119], v28 offset:37376
    v_mfma_f32_32x32x16_bf16 v[240:255], a[128:131], v[100:103], 0
    v_sub_u32 v48, v46, v48
    v_mul_u32_u24 v47, 2752, v47
    v_lshl_add_u32 v1, v48, 4, v47
    v_subrev_u32 v1, 0, v1
    s_add_u32 s57, s62, 0
    buffer_store_dwordx4 v[64:67], v31, s[24:27], s57 offen offset:0 sc1
    s_waitcnt lgkmcnt(4)
    v_mfma_f32_32x32x16_bf16 v[192:207], a[4:7], v[104:107], v[192:207]
    ds_read_b64_tr_b16 v[120:121], v27 offset:38912
    buffer_load_dwordx4 v11, s[16:19], s68 offen offset:2048 lds
    v_mfma_f32_32x32x16_bf16 v[224:239], a[132:135], v[104:107], v[224:239]
    ds_read_b64_tr_b16 v[122:123], v27 offset:39424
    s_cmp_eq_u32 s34, 7
    s_cselect_b32 s56, 2, 12
    v_cmp_le_u32 vcc, s56, v48
    v_mov_b32 v47, 0x40000000
    s_nop 0
    v_cndmask_b32 v1, v1, v47, vcc
    v_mfma_f32_32x32x16_bf16 v[208:223], a[4:7], v[108:111], v[208:223]
    ds_read_b64_tr_b16 v[124:125], v28 offset:38912
    v_add_u32 v46, 64, v0
    v_mul_u32_u24 v47, 43691, v46
    v_lshrrev_b32 v47, 19, v47
    v_mul_u32_u24 v48, 12, v47
    v_mfma_f32_32x32x16_bf16 v[240:255], a[132:135], v[108:111], v[240:255]
    ds_read_b64_tr_b16 v[126:127], v28 offset:39424
    buffer_store_dwordx4 v[68:71], v31, s[24:27], s57 offen offset:1024 sc1
    s_waitcnt lgkmcnt(4)
    v_mfma_f32_32x32x16_bf16 v[192:207], a[8:11], v[112:115], v[192:207]
    ds_read_b64_tr_b16 v[96:97], v27 offset:40960
    buffer_load_dwordx4 v12, s[16:19], s68 offen offset:3072 lds
    v_mfma_f32_32x32x16_bf16 v[224:239], a[136:139], v[112:115], v[224:239]
    ds_read_b64_tr_b16 v[98:99], v27 offset:41472
    v_sub_u32 v48, v46, v48
    v_mul_u32_u24 v47, 2752, v47
    v_lshl_add_u32 v2, v48, 4, v47
    v_subrev_u32 v2, 1024, v2
    v_mfma_f32_32x32x16_bf16 v[208:223], a[8:11], v[116:119], v[208:223]
    ds_read_b64_tr_b16 v[100:101], v28 offset:40960
    s_cmp_eq_u32 s34, 7
    s_cselect_b32 s56, 2, 12
    v_cmp_le_u32 vcc, s56, v48
    v_mov_b32 v47, 0x40000000
    s_nop 0
    v_cndmask_b32 v2, v2, v47, vcc
    v_mfma_f32_32x32x16_bf16 v[240:255], a[136:139], v[116:119], v[240:255]
    ds_read_b64_tr_b16 v[102:103], v28 offset:41472
    s_waitcnt lgkmcnt(4)
    v_mfma_f32_32x32x16_bf16 v[192:207], a[12:15], v[120:123], v[192:207]
    ds_read_b64_tr_b16 v[104:105], v27 offset:43008
    s_add_u32 m0, s60, 36864
    s_add_u32 s68, s59, 2097536
    buffer_load_dwordx4 v13, s[16:19], s68 offen offset:0 lds
    ds_read_b64_tr_b16 v[106:107], v27 offset:43520
    v_mfma_f32_32x32x16_bf16 v[224:239], a[140:143], v[120:123], v[224:239]
    buffer_load_dwordx4 v14, s[16:19], s68 offen offset:1024 lds
    ds_read_b64_tr_b16 v[108:109], v28 offset:43008
    v_mfma_f32_32x32x16_bf16 v[208:223], a[12:15], v[124:127], v[208:223]
    v_add_u32 v46, 128, v0
    v_mul_u32_u24 v47, 43691, v46
    v_lshrrev_b32 v47, 19, v47
    v_mul_u32_u24 v48, 12, v47
    ds_read_b64_tr_b16 v[110:111], v28 offset:43520
    v_mfma_f32_32x32x16_bf16 v[240:255], a[140:143], v[124:127], v[240:255]
    v_sub_u32 v48, v46, v48
    v_mul_u32_u24 v47, 2752, v47
    v_lshl_add_u32 v3, v48, 4, v47
    v_subrev_u32 v3, 2048, v3
    buffer_store_dwordx4 v[72:75], v31, s[24:27], s57 offen offset:2048 sc1
    s_waitcnt lgkmcnt(4)
    v_mfma_f32_32x32x16_bf16 v[192:207], a[16:19], v[96:99], v[192:207]
    ds_read_b64_tr_b16 v[112:113], v27 offset:45056
    buffer_load_dwordx4 v15, s[16:19], s68 offen offset:2048 lds
    v_mfma_f32_32x32x16_bf16 v[224:239], a[144:147], v[96:99], v[224:239]
    ds_read_b64_tr_b16 v[114:115], v27 offset:45568
    s_cmp_eq_u32 s34, 7
    s_cselect_b32 s56, 2, 12
    v_cmp_le_u32 vcc, s56, v48
    v_mov_b32 v47, 0x40000000
    s_nop 0
    v_cndmask_b32 v3, v3, v47, vcc
    v_mfma_f32_32x32x16_bf16 v[208:223], a[16:19], v[100:103], v[208:223]
    ds_read_b64_tr_b16 v[116:117], v28 offset:45056
    v_lshl_add_u32 v46, v33, 3, v35
    v_mul_u32_u24 v46, 192, v46
    v_lshl_add_u32 v46, v37, 5, v46
    v_lshl_add_u32 v46, v36, 3, v46
    v_mfma_f32_32x32x16_bf16 v[240:255], a[144:147], v[100:103], v[240:255]
    ds_read_b64_tr_b16 v[118:119], v28 offset:45568
    s_waitcnt lgkmcnt(4)
    v_mfma_f32_32x32x16_bf16 v[192:207], a[20:23], v[104:107], v[192:207]
    ds_read_b64_tr_b16 v[120:121], v27 offset:47104
    buffer_load_dwordx4 v16, s[16:19], s68 offen offset:3072 lds
    v_mfma_f32_32x32x16_bf16 v[224:239], a[148:151], v[104:107], v[224:239]
    ds_read_b64_tr_b16 v[122:123], v27 offset:47616
    s_lshl_b32 s56, s38, 12
    v_add_u32 v17, s56, v46
    v_add_u32 v18, 0x10000, v17
    v_add_u32 v19, 0x20000, v17
    v_mfma_f32_32x32x16_bf16 v[208:223], a[20:23], v[108:111], v[208:223]
    ds_read_b64_tr_b16 v[124:125], v28 offset:47104
    s_lshl_b32 s56, s37, 12
    s_add_u32 s56, s56, 3072
    v_add_u32 v20, s56, v31
    v_add_u32 v21, 0x10000, v20
    v_add_u32 v22, 0x20000, v20
    v_mfma_f32_32x32x16_bf16 v[240:255], a[148:151], v[108:111], v[240:255]
    ds_read_b64_tr_b16 v[126:127], v28 offset:47616
    buffer_store_dwordx4 v[76:79], v31, s[24:27], s57 offen offset:3072 sc1
    s_waitcnt lgkmcnt(4)
    v_mfma_f32_32x32x16_bf16 v[192:207], a[24:27], v[112:115], v[192:207]
    ds_read_b64_tr_b16 v[96:97], v27 offset:49152
    v_mfma_f32_32x32x16_bf16 v[224:239], a[152:155], v[112:115], v[224:239]
    ds_read_b64_tr_b16 v[98:99], v27 offset:49664
    v_mfma_f32_32x32x16_bf16 v[208:223], a[24:27], v[116:119], v[208:223]
    ds_read_b64_tr_b16 v[100:101], v28 offset:49152
    v_mfma_f32_32x32x16_bf16 v[240:255], a[152:155], v[116:119], v[240:255]
    ds_read_b64_tr_b16 v[102:103], v28 offset:49664
    s_waitcnt lgkmcnt(4)
    v_mfma_f32_32x32x16_bf16 v[192:207], a[28:31], v[120:123], v[192:207]
    ds_read_b64_tr_b16 v[104:105], v27 offset:51200
    s_add_u32 m0, s60, 65536
    s_add_u32 s68, s63, 0
    buffer_load_dwordx4 v1, s[20:23], s68 offen offset:0 lds
    v_mfma_f32_32x32x16_bf16 v[224:239], a[156:159], v[120:123], v[224:239]
    ds_read_b64_tr_b16 v[106:107], v27 offset:51712
    v_mfma_f32_32x32x16_bf16 v[208:223], a[28:31], v[124:127], v[208:223]
    s_add_u32 s57, s62, 8192
    buffer_store_dwordx4 v[80:83], v31, s[24:27], s57 offen offset:0 sc1
    ds_read_b64_tr_b16 v[108:109], v28 offset:51200
    v_mfma_f32_32x32x16_bf16 v[240:255], a[156:159], v[124:127], v[240:255]
    ds_read_b64_tr_b16 v[110:111], v28 offset:51712
    s_waitcnt lgkmcnt(4)
    v_mfma_f32_32x32x16_bf16 v[192:207], a[32:35], v[96:99], v[192:207]
    ds_read_b64_tr_b16 v[112:113], v27 offset:53248
    buffer_load_dwordx4 v2, s[20:23], s68 offen offset:1024 lds
    v_mfma_f32_32x32x16_bf16 v[224:239], a[160:163], v[96:99], v[224:239]
    ds_read_b64_tr_b16 v[114:115], v27 offset:53760
    v_mfma_f32_32x32x16_bf16 v[208:223], a[32:35], v[100:103], v[208:223]
    ds_read_b64_tr_b16 v[116:117], v28 offset:53248
    v_mfma_f32_32x32x16_bf16 v[240:255], a[160:163], v[100:103], v[240:255]
    ds_read_b64_tr_b16 v[118:119], v28 offset:53760
    s_waitcnt lgkmcnt(4)
    v_mfma_f32_32x32x16_bf16 v[192:207], a[36:39], v[104:107], v[192:207]
    ds_read_b64_tr_b16 v[120:121], v27 offset:55296
    buffer_load_dwordx4 v3, s[20:23], s68 offen offset:2048 lds
    v_mfma_f32_32x32x16_bf16 v[224:239], a[164:167], v[104:107], v[224:239]
    ds_read_b64_tr_b16 v[122:123], v27 offset:55808
    v_mfma_f32_32x32x16_bf16 v[208:223], a[36:39], v[108:111], v[208:223]
    buffer_store_dwordx4 v[84:87], v31, s[24:27], s57 offen offset:1024 sc1
    ds_read_b64_tr_b16 v[124:125], v28 offset:55296
    v_mfma_f32_32x32x16_bf16 v[240:255], a[164:167], v[108:111], v[240:255]
    ds_read_b64_tr_b16 v[126:127], v28 offset:55808
    s_waitcnt lgkmcnt(4)
    v_mfma_f32_32x32x16_bf16 v[192:207], a[40:43], v[112:115], v[192:207]
    ds_read_b64_tr_b16 v[96:97], v27 offset:57344
    s_add_u32 m0, s60, 69632
    s_add_u32 s68, s63, 1376
    buffer_load_dwordx4 v1, s[20:23], s68 offen offset:0 lds
    v_mfma_f32_32x32x16_bf16 v[224:239], a[168:171], v[112:115], v[224:239]
    ds_read_b64_tr_b16 v[98:99], v27 offset:57856
    v_mfma_f32_32x32x16_bf16 v[208:223], a[40:43], v[116:119], v[208:223]
    ds_read_b64_tr_b16 v[100:101], v28 offset:57344
    v_mfma_f32_32x32x16_bf16 v[240:255], a[168:171], v[116:119], v[240:255]
    ds_read_b64_tr_b16 v[102:103], v28 offset:57856
    s_waitcnt lgkmcnt(4)
    v_mfma_f32_32x32x16_bf16 v[192:207], a[44:47], v[120:123], v[192:207]
    ds_read_b64_tr_b16 v[104:105], v27 offset:59392
    buffer_load_dwordx4 v2, s[20:23], s68 offen offset:1024 lds
    v_mfma_f32_32x32x16_bf16 v[224:239], a[172:175], v[120:123], v[224:239]
    ds_read_b64_tr_b16 v[106:107], v27 offset:59904
    v_mfma_f32_32x32x16_bf16 v[208:223], a[44:47], v[124:127], v[208:223]
    buffer_store_dwordx4 v[88:91], v31, s[24:27], s57 offen offset:2048 sc1
    ds_read_b64_tr_b16 v[108:109], v28 offset:59392
    v_mfma_f32_32x32x16_bf16 v[240:255], a[172:175], v[124:127], v[240:255]
    ds_read_b64_tr_b16 v[110:111], v28 offset:59904
    s_waitcnt lgkmcnt(4)
    v_mfma_f32_32x32x16_bf16 v[192:207], a[48:51], v[96:99], v[192:207]
    ds_read_b64_tr_b16 v[112:113], v27 offset:61440
    buffer_load_dwordx4 v3, s[20:23], s68 offen offset:2048 lds
    v_mfma_f32_32x32x16_bf16 v[224:239], a[176:179], v[96:99], v[224:239]
    ds_read_b64_tr_b16 v[114:115], v27 offset:61952
    v_mfma_f32_32x32x16_bf16 v[208:223], a[48:51], v[100:103], v[208:223]
    ds_read_b64_tr_b16 v[116:117], v28 offset:61440
    v_mfma_f32_32x32x16_bf16 v[240:255], a[176:179], v[100:103], v[240:255]
    ds_read_b64_tr_b16 v[118:119], v28 offset:61952
    s_waitcnt lgkmcnt(4)
    v_mfma_f32_32x32x16_bf16 v[192:207], a[52:55], v[104:107], v[192:207]
    ds_read_b64_tr_b16 v[120:121], v27 offset:63488
    buffer_store_dwordx4 v[92:95], v31, s[24:27], s57 offen offset:3072 sc1
    v_mfma_f32_32x32x16_bf16 v[224:239], a[180:183], v[104:107], v[224:239]
    ds_read_b64_tr_b16 v[122:123], v27 offset:64000
    v_mfma_f32_32x32x16_bf16 v[208:223], a[52:55], v[108:111], v[208:223]
    s_cmp_lg_u32 s32, 0
    s_cbranch_scc1 L_W0_10
    v_lshlrev_b32 v50, 2, v0
    buffer_load_dword v51, v50, s[28:31], 0 offen offset:0 sc0 sc1
L_W0_10:
    ds_read_b64_tr_b16 v[124:125], v28 offset:63488
    v_mfma_f32_32x32x16_bf16 v[240:255], a[180:183], v[108:111], v[240:255]
    ds_read_b64_tr_b16 v[126:127], v28 offset:64000
    s_waitcnt lgkmcnt(0)
    s_waitcnt vmcnt(30)
    s_barrier
    v_mfma_f32_32x32x16_bf16 v[192:207], a[56:59], v[112:115], v[192:207]
    ds_read_b64_tr_b16 v[96:97], v29 offset:0
    s_add_u32 m0, s60, 98304
    s_add_u32 s68, s63, 176128
    buffer_load_dwordx4 v1, s[20:23], s68 offen offset:0 lds
    v_mfma_f32_32x32x16_bf16 v[224:239], a[184:187], v[112:115], v[224:239]
    ds_read_b64_tr_b16 v[98:99], v29 offset:512
    v_mfma_f32_32x32x16_bf16 v[208:223], a[56:59], v[116:119], v[208:223]
    ds_read_b64_tr_b16 v[100:101], v30 offset:0
    v_mfma_f32_32x32x16_bf16 v[240:255], a[184:187], v[116:119], v[240:255]
    ds_read_b64_tr_b16 v[102:103], v30 offset:512
    v_mfma_f32_32x32x16_bf16 v[192:207], a[60:63], v[120:123], v[192:207]
    ds_read_b64_tr_b16 v[104:105], v29 offset:2048
    s_add_u32 s57, s62, 4096
    v_cvt_pk_bf16_f32 v128, v128, v129
    v_cvt_pk_bf16_f32 v129, v130, v131
    v_mfma_f32_32x32x16_bf16 v[224:239], a[188:191], v[120:123], v[224:239]
    ds_read_b64_tr_b16 v[106:107], v29 offset:2560
    v_mfma_f32_32x32x16_bf16 v[208:223], a[60:63], v[124:127], v[208:223]
    ds_read_b64_tr_b16 v[108:109], v30 offset:2048
    v_mfma_f32_32x32x16_bf16 v[240:255], a[188:191], v[124:127], v[240:255]
    ds_read_b64_tr_b16 v[110:111], v30 offset:2560
    s_waitcnt lgkmcnt(4)
    v_mfma_f32_32x32x16_bf16 v[192:207], a[64:67], v[96:99], v[192:207]
    ds_read_b64_tr_b16 v[112:113], v29 offset:4096
    v_cvt_pk_bf16_f32 v130, v132, v133
    v_cvt_pk_bf16_f32 v131, v134, v135
    buffer_store_dwordx4 v[128:131], v31, s[24:27], s57 offen offset:0 sc1
    v_mfma_f32_32x32x16_bf16 v[224:239], a[192:195], v[96:99], v[224:239]
    ds_read_b64_tr_b16 v[114:115], v29 offset:4608
    v_mfma_f32_32x32x16_bf16 v[208:223], a[64:67], v[100:103], v[208:223]
    buffer_load_dwordx4 v2, s[20:23], s68 offen offset:1024 lds
    ds_read_b64_tr_b16 v[116:117], v30 offset:4096
    v_mfma_f32_32x32x16_bf16 v[240:255], a[192:195], v[100:103], v[240:255]
    ds_read_b64_tr_b16 v[118:119], v30 offset:4608
    s_waitcnt lgkmcnt(4)
    v_mfma_f32_32x32x16_bf16 v[192:207], a[68:71], v[104:107], v[192:207]
    ds_read_b64_tr_b16 v[120:121], v29 offset:6144
    v_cvt_pk_bf16_f32 v136, v136, v137
    v_cvt_pk_bf16_f32 v137, v138, v139
    v_mfma_f32_32x32x16_bf16 v[224:239], a[196:199], v[104:107], v[224:239]
    ds_read_b64_tr_b16 v[122:123], v29 offset:6656
    v_mfma_f32_32x32x16_bf16 v[208:223], a[68:71], v[108:111], v[208:223]
    ds_read_b64_tr_b16 v[124:125], v30 offset:6144
    v_mfma_f32_32x32x16_bf16 v[240:255], a[196:199], v[108:111], v[240:255]
    ds_read_b64_tr_b16 v[126:127], v30 offset:6656
    s_waitcnt lgkmcnt(4)
    v_mfma_f32_32x32x16_bf16 v[192:207], a[72:75], v[112:115], v[192:207]
    ds_read_b64_tr_b16 v[96:97], v29 offset:8192
    v_cvt_pk_bf16_f32 v138, v140, v141
    v_cvt_pk_bf16_f32 v139, v142, v143
    buffer_store_dwordx4 v[136:139], v31, s[24:27], s57 offen offset:1024 sc1
    v_mfma_f32_32x32x16_bf16 v[224:239], a[200:203], v[112:115], v[224:239]
    ds_read_b64_tr_b16 v[98:99], v29 offset:8704
    v_mfma_f32_32x32x16_bf16 v[208:223], a[72:75], v[116:119], v[208:223]
    buffer_load_dwordx4 v3, s[20:23], s68 offen offset:2048 lds
    ds_read_b64_tr_b16 v[100:101], v30 offset:8192
    v_mfma_f32_32x32x16_bf16 v[240:255], a[200:203], v[116:119], v[240:255]
    ds_read_b64_tr_b16 v[102:103], v30 offset:8704
    s_waitcnt lgkmcnt(4)
    v_mfma_f32_32x32x16_bf16 v[192:207], a[76:79], v[120:123], v[192:207]
    ds_read_b64_tr_b16 v[104:105], v29 offset:10240
    v_cvt_pk_bf16_f32 v144, v144, v145
    v_cvt_pk_bf16_f32 v145, v146, v147
    v_mfma_f32_32x32x16_bf16 v[224:239], a[204:207], v[120:123], v[224:239]
    ds_read_b64_tr_b16 v[106:107], v29 offset:10752
    v_mfma_f32_32x32x16_bf16 v[208:223], a[76:79], v[124:127], v[208:223]
    ds_read_b64_tr_b16 v[108:109], v30 offset:10240
    v_mfma_f32_32x32x16_bf16 v[240:255], a[204:207], v[124:127], v[240:255]
    ds_read_b64_tr_b16 v[110:111], v30 offset:10752
    s_waitcnt lgkmcnt(4)
    v_mfma_f32_32x32x16_bf16 v[192:207], a[80:83], v[96:99], v[192:207]
    ds_read_b64_tr_b16 v[112:113], v29 offset:12288
    v_cvt_pk_bf16_f32 v146, v148, v149
    v_cvt_pk_bf16_f32 v147, v150, v151
    buffer_store_dwordx4 v[144:147], v31, s[24:27], s57 offen offset:2048 sc1
    v_mfma_f32_32x32x16_bf16 v[224:239], a[208:211], v[96:99], v[224:239]
    ds_read_b64_tr_b16 v[114:115], v29 offset:12800
    v_mfma_f32_32x32x16_bf16 v[208:223], a[80:83], v[100:103], v[208:223]
    s_add_u32 m0, s60, 102400
    s_add_u32 s68, s63, 177504
    buffer_load_dwordx4 v1, s[20:23], s68 offen offset:0 lds
    ds_read_b64_tr_b16 v[116:117], v30 offset:12288
    v_mfma_f32_32x32x16_bf16 v[240:255], a[208:211], v[100:103], v[240:255]
    ds_read_b64_tr_b16 v[118:119], v30 offset:12800
    s_waitcnt lgkmcnt(4)
    v_mfma_f32_32x32x16_bf16 v[192:207], a[84:87], v[104:107], v[192:207]
    ds_read_b64_tr_b16 v[120:121], v29 offset:14336
    v_cvt_pk_bf16_f32 v152, v152, v153
    v_cvt_pk_bf16_f32 v153, v154, v155
    v_mfma_f32_32x32x16_bf16 v[224:239], a[212:215], v[104:107], v[224:239]
    ds_read_b64_tr_b16 v[122:123], v29 offset:14848
    v_mfma_f32_32x32x16_bf16 v[208:223], a[84:87], v[108:111], v[208:223]
    ds_read_b64_tr_b16 v[124:125], v30 offset:14336
    v_mfma_f32_32x32x16_bf16 v[240:255], a[212:215], v[108:111], v[240:255]
    ds_read_b64_tr_b16 v[126:127], v30 offset:14848
    s_waitcnt lgkmcnt(4)
    v_mfma_f32_32x32x16_bf16 v[192:207], a[88:91], v[112:115], v[192:207]
    ds_read_b64_tr_b16 v[96:97], v29 offset:16384
    v_cvt_pk_bf16_f32 v154, v156, v157
    v_cvt_pk_bf16_f32 v155, v158, v159
    buffer_store_dwordx4 v[152:155], v31, s[24:27], s57 offen offset:3072 sc1
    v_mfma_f32_32x32x16_bf16 v[224:239], a[216:219], v[112:115], v[224:239]
    ds_read_b64_tr_b16 v[98:99], v29 offset:16896
    v_mfma_f32_32x32x16_bf16 v[208:223], a[88:91], v[116:119], v[208:223]
    buffer_load_dwordx4 v2, s[20:23], s68 offen offset:1024 lds
    ds_read_b64_tr_b16 v[100:101], v30 offset:16384
    v_mfma_f32_32x32x16_bf16 v[240:255], a[216:219], v[116:119], v[240:255]
    ds_read_b64_tr_b16 v[102:103], v30 offset:16896
    s_waitcnt lgkmcnt(4)
    v_mfma_f32_32x32x16_bf16 v[192:207], a[92:95], v[120:123], v[192:207]
    ds_read_b64_tr_b16 v[104:105], v29 offset:18432
    s_add_u32 s57, s62, 12288
    v_cvt_pk_bf16_f32 v160, v160, v161
    v_cvt_pk_bf16_f32 v161, v162, v163
    v_mfma_f32_32x32x16_bf16 v[224:239], a[220:223], v[120:123], v[224:239]
    ds_read_b64_tr_b16 v[106:107], v29 offset:18944
    v_mfma_f32_32x32x16_bf16 v[208:223], a[92:95], v[124:127], v[208:223]
    ds_read_b64_tr_b16 v[108:109], v30 offset:18432
    v_mfma_f32_32x32x16_bf16 v[240:255], a[220:223], v[124:127], v[240:255]
    ds_read_b64_tr_b16 v[110:111], v30 offset:18944
    s_waitcnt lgkmcnt(4)
    v_mfma_f32_32x32x16_bf16 v[192:207], a[96:99], v[96:99], v[192:207]
    ds_read_b64_tr_b16 v[112:113], v29 offset:20480
    v_cvt_pk_bf16_f32 v162, v164, v165
    v_cvt_pk_bf16_f32 v163, v166, v167
    buffer_store_dwordx4 v[160:163], v31, s[24:27], s57 offen offset:0 sc1
    v_mfma_f32_32x32x16_bf16 v[224:239], a[224:227], v[96:99], v[224:239]
    ds_read_b64_tr_b16 v[114:115], v29 offset:20992
    v_mfma_f32_32x32x16_bf16 v[208:223], a[96:99], v[100:103], v[208:223]
    buffer_load_dwordx4 v3, s[20:23], s68 offen offset:2048 lds
    ds_read_b64_tr_b16 v[116:117], v30 offset:20480
    v_mfma_f32_32x32x16_bf16 v[240:255], a[224:227], v[100:103], v[240:255]
    ds_read_b64_tr_b16 v[118:119], v30 offset:20992
    s_waitcnt lgkmcnt(4)
    v_mfma_f32_32x32x16_bf16 v[192:207], a[100:103], v[104:107], v[192:207]
    ds_read_b64_tr_b16 v[120:121], v29 offset:22528
    v_cvt_pk_bf16_f32 v168, v168, v169
    v_cvt_pk_bf16_f32 v169, v170, v171
    v_mfma_f32_32x32x16_bf16 v[224:239], a[228:231], v[104:107], v[224:239]
    ds_read_b64_tr_b16 v[122:123], v29 offset:23040
    v_mfma_f32_32x32x16_bf16 v[208:223], a[100:103], v[108:111], v[208:223]
    ds_read_b64_tr_b16 v[124:125], v30 offset:22528
    v_mfma_f32_32x32x16_bf16 v[240:255], a[228:231], v[108:111], v[240:255]
    ds_read_b64_tr_b16 v[126:127], v30 offset:23040
    s_waitcnt lgkmcnt(4)
    v_mfma_f32_32x32x16_bf16 v[192:207], a[104:107], v[112:115], v[192:207]
    ds_read_b64_tr_b16 v[96:97], v29 offset:24576
    v_cvt_pk_bf16_f32 v170, v172, v173
    v_cvt_pk_bf16_f32 v171, v174, v175
    buffer_store_dwordx4 v[168:171], v31, s[24:27], s57 offen offset:1024 sc1
    v_mfma_f32_32x32x16_bf16 v[224:239], a[232:235], v[112:115], v[224:239]
    ds_read_b64_tr_b16 v[98:99], v29 offset:25088
    v_mfma_f32_32x32x16_bf16 v[208:223], a[104:107], v[116:119], v[208:223]
    ds_read_b64_tr_b16 v[100:101], v30 offset:24576
    v_mfma_f32_32x32x16_bf16 v[240:255], a[232:235], v[116:119], v[240:255]
    ds_read_b64_tr_b16 v[102:103], v30 offset:25088
    s_waitcnt lgkmcnt(4)
    v_mfma_f32_32x32x16_bf16 v[192:207], a[108:111], v[120:123], v[192:207]
    ds_read_b64_tr_b16 v[104:105], v29 offset:26624
    v_cvt_pk_bf16_f32 v176, v176, v177
    v_cvt_pk_bf16_f32 v177, v178, v179
    v_mfma_f32_32x32x16_bf16 v[224:239], a[236:239], v[120:123], v[224:239]
    ds_read_b64_tr_b16 v[106:107], v29 offset:27136
    v_mfma_f32_32x32x16_bf16 v[208:223], a[108:111], v[124:127], v[208:223]
    ds_read_b64_tr_b16 v[108:109], v30 offset:26624
    v_mfma_f32_32x32x16_bf16 v[240:255], a[236:239], v[124:127], v[240:255]
    ds_read_b64_tr_b16 v[110:111], v30 offset:27136
    s_waitcnt lgkmcnt(4)
    v_mfma_f32_32x32x16_bf16 v[192:207], a[112:115], v[96:99], v[192:207]
    ds_read_b64_tr_b16 v[112:113], v29 offset:28672
    v_cvt_pk_bf16_f32 v178, v180, v181
    v_cvt_pk_bf16_f32 v179, v182, v183
    buffer_store_dwordx4 v[176:179], v31, s[24:27], s57 offen offset:2048 sc1
    v_mfma_f32_32x32x16_bf16 v[224:239], a[240:243], v[96:99], v[224:239]
    ds_read_b64_tr_b16 v[114:115], v29 offset:29184
    v_mfma_f32_32x32x16_bf16 v[208:223], a[112:115], v[100:103], v[208:223]
    ds_read_b64_tr_b16 v[116:117], v30 offset:28672
    v_mfma_f32_32x32x16_bf16 v[240:255], a[240:243], v[100:103], v[240:255]
    ds_read_b64_tr_b16 v[118:119], v30 offset:29184
    s_waitcnt lgkmcnt(4)
    v_mfma_f32_32x32x16_bf16 v[192:207], a[116:119], v[104:107], v[192:207]
    ds_read_b64_tr_b16 v[120:121], v29 offset:30720
    v_cvt_pk_bf16_f32 v184, v184, v185
    v_cvt_pk_bf16_f32 v185, v186, v187
    v_mfma_f32_32x32x16_bf16 v[224:239], a[244:247], v[104:107], v[224:239]
    ds_read_b64_tr_b16 v[122:123], v29 offset:31232
    v_mfma_f32_32x32x16_bf16 v[208:223], a[116:119], v[108:111], v[208:223]
    s_cmp_lg_u32 s32, 0
    s_cbranch_scc1 L_W0_12
    s_waitcnt vmcnt(13)
    v_cmp_ne_u32 vcc, 0x1010101, v51
    s_nop 1
    s_cbranch_vccz L_POK_11
L_PLP_11:
    s_sleep 4
    buffer_load_dword v51, v50, s[28:31], 0 offen offset:0 sc0 sc1
    s_waitcnt vmcnt(0)
    v_cmp_ne_u32 vcc, 0x1010101, v51
    s_nop 1
    s_cbranch_vccnz L_PLP_11
L_POK_11:
L_W0_12:
    ds_read_b64_tr_b16 v[124:125], v30 offset:30720
    v_mfma_f32_32x32x16_bf16 v[240:255], a[244:247], v[108:111], v[240:255]
    ds_read_b64_tr_b16 v[126:127], v30 offset:31232
    s_waitcnt lgkmcnt(0)
    s_waitcnt vmcnt(35)
    s_barrier
    v_mfma_f32_32x32x16_bf16 v[192:207], a[120:123], v[112:115], v[192:207]
    ds_read_b64_tr_b16 v[96:97], v25 offset:0
    v_cvt_pk_bf16_f32 v186, v188, v189
    v_cvt_pk_bf16_f32 v187, v190, v191
    buffer_store_dwordx4 v[184:187], v31, s[24:27], s57 offen offset:3072 sc1
    v_mfma_f32_32x32x16_bf16 v[224:239], a[248:251], v[112:115], v[224:239]
    ds_read_b64_tr_b16 v[98:99], v25 offset:512
    v_mfma_f32_32x32x16_bf16 v[208:223], a[120:123], v[116:119], v[208:223]
    s_add_u32 m0, s60, 68608
    s_add_u32 s68, s64, 0
    buffer_load_dwordx4 v31, s[24:27], s68 offen sc1 lds
    ds_read_b64_tr_b16 v[100:101], v26 offset:0
    v_mfma_f32_32x32x16_bf16 v[240:255], a[248:251], v[116:119], v[240:255]
    ds_read_b64_tr_b16 v[102:103], v26 offset:512
    v_mfma_f32_32x32x16_bf16 v[192:207], a[124:127], v[120:123], v[192:207]
    ds_read_b64_tr_b16 v[104:105], v25 offset:2048
    s_add_u32 m0, s60, 72704
    s_add_u32 s68, s64, 32768
    buffer_load_dwordx4 v31, s[24:27], s68 offen sc1 lds
    v_mfma_f32_32x32x16_bf16 v[224:239], a[252:255], v[120:123], v[224:239]
    ds_read_b64_tr_b16 v[106:107], v25 offset:2560
    v_mfma_f32_32x32x16_bf16 v[208:223], a[124:127], v[124:127], v[208:223]
    ds_read_b64_tr_b16 v[108:109], v26 offset:2048
    v_mfma_f32_32x32x16_bf16 v[240:255], a[252:255], v[124:127], v[240:255]
    ds_read_b64_tr_b16 v[110:111], v26 offset:2560
    s_waitcnt lgkmcnt(4)
    v_mfma_f32_32x32x16_bf16 v[128:143], a[0:3], v[96:99], 0
    ds_read_b64_tr_b16 v[112:113], v25 offset:4096
    s_add_u32 m0, s60, 101376
    s_add_u32 s68, s64, 4096
    buffer_load_dwordx4 v31, s[24:27], s68 offen sc1 lds
    v_mfma_f32_32x32x16_bf16 v[160:175], a[128:131], v[96:99], 0
    ds_read_b64_tr_b16 v[114:115], v25 offset:4608
    v_mfma_f32_32x32x16_bf16 v[144:159], a[0:3], v[100:103], 0
    ds_read_b64_tr_b16 v[116:117], v26 offset:4096
    v_mfma_f32_32x32x16_bf16 v[176:191], a[128:131], v[100:103], 0
    ds_read_b64_tr_b16 v[118:119], v26 offset:4608
    s_waitcnt lgkmcnt(4)
    v_mfma_f32_32x32x16_bf16 v[128:143], a[4:7], v[104:107], v[128:143]
    ds_read_b64_tr_b16 v[120:121], v25 offset:6144
    s_add_u32 s57, s62, 524288
    v_cvt_pk_bf16_f32 v192, v192, v193
    v_cvt_pk_bf16_f32 v193, v194, v195
    v_mfma_f32_32x32x16_bf16 v[160:175], a[132:135], v[104:107], v[160:175]
    ds_read_b64_tr_b16 v[122:123], v25 offset:6656
    v_mfma_f32_32x32x16_bf16 v[144:159], a[4:7], v[108:111], v[144:159]
    s_add_u32 m0, s60, 105472
    s_add_u32 s68, s64, 36864
    buffer_load_dwordx4 v31, s[24:27], s68 offen sc1 lds
    ds_read_b64_tr_b16 v[124:125], v26 offset:6144
    v_mfma_f32_32x32x16_bf16 v[176:191], a[132:135], v[108:111], v[176:191]
    ds_read_b64_tr_b16 v[126:127], v26 offset:6656
    s_waitcnt lgkmcnt(4)
    v_mfma_f32_32x32x16_bf16 v[128:143], a[8:11], v[112:115], v[128:143]
    ds_read_b64_tr_b16 v[96:97], v25 offset:8192
    v_cvt_pk_bf16_f32 v194, v196, v197
    v_cvt_pk_bf16_f32 v195, v198, v199
    buffer_store_dwordx4 v[192:195], v31, s[24:27], s57 offen offset:0 sc1
    v_mfma_f32_32x32x16_bf16 v[160:175], a[136:139], v[112:115], v[160:175]
    ds_read_b64_tr_b16 v[98:99], v25 offset:8704
    v_mfma_f32_32x32x16_bf16 v[144:159], a[8:11], v[116:119], v[144:159]
    s_add_u32 m0, s60, 131072
    s_add_u32 s68, s63, 352256
    buffer_load_dwordx4 v1, s[20:23], s68 offen offset:0 lds
    ds_read_b64_tr_b16 v[100:101], v26 offset:8192
    v_mfma_f32_32x32x16_bf16 v[176:191], a[136:139], v[116:119], v[176:191]
    ds_read_b64_tr_b16 v[102:103], v26 offset:8704
    s_waitcnt lgkmcnt(4)
    v_mfma_f32_32x32x16_bf16 v[128:143], a[12:15], v[120:123], v[128:143]
    ds_read_b64_tr_b16 v[104:105], v25 offset:10240
    buffer_load_dwordx4 v2, s[20:23], s68 offen offset:1024 lds
    v_mfma_f32_32x32x16_bf16 v[160:175], a[140:143], v[120:123], v[160:175]
    ds_read_b64_tr_b16 v[106:107], v25 offset:10752
    v_mfma_f32_32x32x16_bf16 v[144:159], a[12:15], v[124:127], v[144:159]
    ds_read_b64_tr_b16 v[108:109], v26 offset:10240
    v_mfma_f32_32x32x16_bf16 v[176:191], a[140:143], v[124:127], v[176:191]
    ds_read_b64_tr_b16 v[110:111], v26 offset:10752
    s_waitcnt lgkmcnt(4)
    v_mfma_f32_32x32x16_bf16 v[128:143], a[16:19], v[96:99], v[128:143]
    ds_read_b64_tr_b16 v[112:113], v25 offset:12288
    v_cvt_pk_bf16_f32 v200, v200, v201
    v_cvt_pk_bf16_f32 v201, v202, v203
    v_mfma_f32_32x32x16_bf16 v[160:175], a[144:147], v[96:99], v[160:175]
    ds_read_b64_tr_b16 v[114:115], v25 offset:12800
    v_mfma_f32_32x32x16_bf16 v[144:159], a[16:19], v[100:103], v[144:159]
    ds_read_b64_tr_b16 v[116:117], v26 offset:12288
    v_mfma_f32_32x32x16_bf16 v[176:191], a[144:147], v[100:103], v[176:191]
    ds_read_b64_tr_b16 v[118:119], v26 offset:12800
    s_waitcnt lgkmcnt(4)
    v_mfma_f32_32x32x16_bf16 v[128:143], a[20:23], v[104:107], v[128:143]
    ds_read_b64_tr_b16 v[120:121], v25 offset:14336
    buffer_load_dwordx4 v3, s[20:23], s68 offen offset:2048 lds
    v_mfma_f32_32x32x16_bf16 v[160:175], a[148:151], v[104:107], v[160:175]
    ds_read_b64_tr_b16 v[122:123], v25 offset:14848
    v_mfma_f32_32x32x16_bf16 v[144:159], a[20:23], v[108:111], v[144:159]
    ds_read_b64_tr_b16 v[124:125], v26 offset:14336
    v_mfma_f32_32x32x16_bf16 v[176:191], a[148:151], v[108:111], v[176:191]
    ds_read_b64_tr_b16 v[126:127], v26 offset:14848
    s_waitcnt lgkmcnt(4)
    v_mfma_f32_32x32x16_bf16 v[128:143], a[24:27], v[112:115], v[128:143]
    ds_read_b64_tr_b16 v[96:97], v25 offset:16384
    v_cvt_pk_bf16_f32 v202, v204, v205
    v_cvt_pk_bf16_f32 v203, v206, v207
    buffer_store_dwordx4 v[200:203], v31, s[24:27], s57 offen offset:1024 sc1
    v_mfma_f32_32x32x16_bf16 v[160:175], a[152:155], v[112:115], v[160:175]
    ds_read_b64_tr_b16 v[98:99], v25 offset:16896
    v_mfma_f32_32x32x16_bf16 v[144:159], a[24:27], v[116:119], v[144:159]
    s_add_u32 m0, s60, 134144
    s_add_u32 s68, s64, 8192
    buffer_load_dwordx4 v31, s[24:27], s68 offen sc1 lds
    ds_read_b64_tr_b16 v[100:101], v26 offset:16384
    v_mfma_f32_32x32x16_bf16 v[176:191], a[152:155], v[116:119], v[176:191]
    ds_read_b64_tr_b16 v[102:103], v26 offset:16896
    s_waitcnt lgkmcnt(4)
    v_mfma_f32_32x32x16_bf16 v[128:143], a[28:31], v[120:123], v[128:143]
    ds_read_b64_tr_b16 v[104:105], v25 offset:18432
    s_add_u32 m0, s60, 135168
    s_add_u32 s68, s63, 353632
    buffer_load_dwordx4 v1, s[20:23], s68 offen offset:0 lds
    v_mfma_f32_32x32x16_bf16 v[160:175], a[156:159], v[120:123], v[160:175]
    ds_read_b64_tr_b16 v[106:107], v25 offset:18944
    v_mfma_f32_32x32x16_bf16 v[144:159], a[28:31], v[124:127], v[144:159]
    ds_read_b64_tr_b16 v[108:109], v26 offset:18432
    v_mfma_f32_32x32x16_bf16 v[176:191], a[156:159], v[124:127], v[176:191]
    ds_read_b64_tr_b16 v[110:111], v26 offset:18944
    s_waitcnt lgkmcnt(4)
    v_mfma_f32_32x32x16_bf16 v[128:143], a[32:35], v[96:99], v[128:143]
    ds_read_b64_tr_b16 v[112:113], v25 offset:20480
    v_cvt_pk_bf16_f32 v208, v208, v209
    v_cvt_pk_bf16_f32 v209, v210, v211
    v_mfma_f32_32x32x16_bf16 v[160:175], a[160:163], v[96:99], v[160:175]
    ds_read_b64_tr_b16 v[114:115], v25 offset:20992
    v_mfma_f32_32x32x16_bf16 v[144:159], a[32:35], v[100:103], v[144:159]
    buffer_load_dwordx4 v2, s[20:23], s68 offen offset:1024 lds
    ds_read_b64_tr_b16 v[116:117], v26 offset:20480
    v_mfma_f32_32x32x16_bf16 v[176:191], a[160:163], v[100:103], v[176:191]
    ds_read_b64_tr_b16 v[118:119], v26 offset:20992
    s_waitcnt lgkmcnt(4)
    v_mfma_f32_32x32x16_bf16 v[128:143], a[36:39], v[104:107], v[128:143]
    ds_read_b64_tr_b16 v[120:121], v25 offset:22528
    buffer_load_dwordx4 v3, s[20:23], s68 offen offset:2048 lds
    v_mfma_f32_32x32x16_bf16 v[160:175], a[164:167], v[104:107], v[160:175]
    ds_read_b64_tr_b16 v[122:123], v25 offset:23040
    v_mfma_f32_32x32x16_bf16 v[144:159], a[36:39], v[108:111], v[144:159]
    ds_read_b64_tr_b16 v[124:125], v26 offset:22528
    v_mfma_f32_32x32x16_bf16 v[176:191], a[164:167], v[108:111], v[176:191]
    ds_read_b64_tr_b16 v[126:127], v26 offset:23040
    s_waitcnt lgkmcnt(4)
    v_mfma_f32_32x32x16_bf16 v[128:143], a[40:43], v[112:115], v[128:143]
    ds_read_b64_tr_b16 v[96:97], v25 offset:24576
    v_cvt_pk_bf16_f32 v210, v212, v213
    v_cvt_pk_bf16_f32 v211, v214, v215
    buffer_store_dwordx4 v[208:211], v31, s[24:27], s57 offen offset:2048 sc1
    v_mfma_f32_32x32x16_bf16 v[160:175], a[168:171], v[112:115], v[160:175]
    ds_read_b64_tr_b16 v[98:99], v25 offset:25088
    v_mfma_f32_32x32x16_bf16 v[144:159], a[40:43], v[116:119], v[144:159]
    s_add_u32 m0, s60, 138240
    s_add_u32 s68, s64, 40960
    buffer_load_dwordx4 v31, s[24:27], s68 offen sc1 lds
    ds_read_b64_tr_b16 v[100:101], v26 offset:24576
    v_mfma_f32_32x32x16_bf16 v[176:191], a[168:171], v[116:119], v[176:191]
    ds_read_b64_tr_b16 v[102:103], v26 offset:25088
    s_waitcnt lgkmcnt(4)
    v_mfma_f32_32x32x16_bf16 v[128:143], a[44:47], v[120:123], v[128:143]
    ds_read_b64_tr_b16 v[104:105], v25 offset:26624
    v_mfma_f32_32x32x16_bf16 v[160:175], a[172:175], v[120:123], v[160:175]
    ds_read_b64_tr_b16 v[106:107], v25 offset:27136
    v_mfma_f32_32x32x16_bf16 v[144:159], a[44:47], v[124:127], v[144:159]
    ds_read_b64_tr_b16 v[108:109], v26 offset:26624
    v_mfma_f32_32x32x16_bf16 v[176:191], a[172:175], v[124:127], v[176:191]
    ds_read_b64_tr_b16 v[110:111], v26 offset:27136
    s_waitcnt lgkmcnt(4)
    v_mfma_f32_32x32x16_bf16 v[128:143], a[48:51], v[96:99], v[128:143]
    ds_read_b64_tr_b16 v[112:113], v25 offset:28672
    v_cvt_pk_bf16_f32 v216, v216, v217
    v_cvt_pk_bf16_f32 v217, v218, v219
    v_mfma_f32_32x32x16_bf16 v[160:175], a[176:179], v[96:99], v[160:175]
    ds_read_b64_tr_b16 v[114:115], v25 offset:29184
    v_mfma_f32_32x32x16_bf16 v[144:159], a[48:51], v[100:103], v[144:159]
    ds_read_b64_tr_b16 v[116:117], v26 offset:28672
    v_mfma_f32_32x32x16_bf16 v[176:191], a[176:179], v[100:103], v[176:191]
    ds_read_b64_tr_b16 v[118:119], v26 offset:29184
    s_waitcnt lgkmcnt(4)
    v_mfma_f32_32x32x16_bf16 v[128:143], a[52:55], v[104:107], v[128:143]
    ds_read_b64_tr_b16 v[120:121], v25 offset:30720
    v_mfma_f32_32x32x16_bf16 v[160:175], a[180:183], v[104:107], v[160:175]
    ds_read_b64_tr_b16 v[122:123], v25 offset:31232
    v_mfma_f32_32x32x16_bf16 v[144:159], a[52:55], v[108:111], v[144:159]
    ds_read_b64_tr_b16 v[124:125], v26 offset:30720
    v_mfma_f32_32x32x16_bf16 v[176:191], a[180:183], v[108:111], v[176:191]
    ds_read_b64_tr_b16 v[126:127], v26 offset:31232
    s_waitcnt lgkmcnt(0)
    s_waitcnt vmcnt(40)
    s_barrier
    v_mfma_f32_32x32x16_bf16 v[128:143], a[56:59], v[112:115], v[128:143]
    ds_read_b64_tr_b16 v[96:97], v25 offset:32768
    v_cvt_pk_bf16_f32 v218, v220, v221
    v_cvt_pk_bf16_f32 v219, v222, v223
    buffer_store_dwordx4 v[216:219], v31, s[24:27], s57 offen offset:3072 sc1
    v_mfma_f32_32x32x16_bf16 v[160:175], a[184:187], v[112:115], v[160:175]
    ds_read_b64_tr_b16 v[98:99], v25 offset:33280
    v_mfma_f32_32x32x16_bf16 v[144:159], a[56:59], v[116:119], v[144:159]
    s_add_u32 m0, s60, 0
    s_add_u32 s68, s63, 528384
    buffer_load_dwordx4 v1, s[20:23], s68 offen offset:0 lds
    ds_read_b64_tr_b16 v[100:101], v26 offset:32768
    v_mfma_f32_32x32x16_bf16 v[176:191], a[184:187], v[116:119], v[176:191]
    ds_read_b64_tr_b16 v[102:103], v26 offset:33280
    v_mfma_f32_32x32x16_bf16 v[128:143], a[60:63], v[120:123], v[128:143]
    ds_read_b64_tr_b16 v[104:105], v25 offset:34816
    buffer_load_dwordx4 v2, s[20:23], s68 offen offset:1024 lds
    v_mfma_f32_32x32x16_bf16 v[160:175], a[188:191], v[120:123], v[160:175]
    ds_read_b64_tr_b16 v[106:107], v25 offset:35328
    v_mfma_f32_32x32x16_bf16 v[144:159], a[60:63], v[124:127], v[144:159]
    ds_read_b64_tr_b16 v[108:109], v26 offset:34816
    v_mfma_f32_32x32x16_bf16 v[176:191], a[188:191], v[124:127], v[176:191]
    ds_read_b64_tr_b16 v[110:111], v26 offset:35328
    s_waitcnt lgkmcnt(4)
    v_mfma_f32_32x32x16_bf16 v[128:143], a[64:67], v[96:99], v[128:143]
    ds_read_b64_tr_b16 v[112:113], v25 offset:36864
    s_add_u32 s57, s62, 532480
    v_cvt_pk_bf16_f32 v224, v224, v225
    v_cvt_pk_bf16_f32 v225, v226, v227
    v_mfma_f32_32x32x16_bf16 v[160:175], a[192:195], v[96:99], v[160:175]
    ds_read_b64_tr_b16 v[114:115], v25 offset:37376
    v_mfma_f32_32x32x16_bf16 v[144:159], a[64:67], v[100:103], v[144:159]
    ds_read_b64_tr_b16 v[116:117], v26 offset:36864
    v_mfma_f32_32x32x16_bf16 v[176:191], a[192:195], v[100:103], v[176:191]
    ds_read_b64_tr_b16 v[118:119], v26 offset:37376
    s_waitcnt lgkmcnt(4)
    v_mfma_f32_32x32x16_bf16 v[128:143], a[68:71], v[104:107], v[128:143]
    ds_read_b64_tr_b16 v[120:121], v25 offset:38912
    buffer_load_dwordx4 v3, s[20:23], s68 offen offset:2048 lds
    v_mfma_f32_32x32x16_bf16 v[160:175], a[196:199], v[104:107], v[160:175]
    ds_read_b64_tr_b16 v[122:123], v25 offset:39424
    v_mfma_f32_32x32x16_bf16 v[144:159], a[68:71], v[108:111], v[144:159]
    ds_read_b64_tr_b16 v[124:125], v26 offset:38912
    v_mfma_f32_32x32x16_bf16 v[176:191], a[196:199], v[108:111], v[176:191]
    ds_read_b64_tr_b16 v[126:127], v26 offset:39424
    s_waitcnt lgkmcnt(4)
    v_mfma_f32_32x32x16_bf16 v[128:143], a[72:75], v[112:115], v[128:143]
    ds_read_b64_tr_b16 v[96:97], v25 offset:40960
    v_cvt_pk_bf16_f32 v226, v228, v229
    v_cvt_pk_bf16_f32 v227, v230, v231
    buffer_store_dwordx4 v[224:227], v31, s[24:27], s57 offen offset:0 sc1
    v_mfma_f32_32x32x16_bf16 v[160:175], a[200:203], v[112:115], v[160:175]
    ds_read_b64_tr_b16 v[98:99], v25 offset:41472
    v_mfma_f32_32x32x16_bf16 v[144:159], a[72:75], v[116:119], v[144:159]
    ds_read_b64_tr_b16 v[100:101], v26 offset:40960
    v_mfma_f32_32x32x16_bf16 v[176:191], a[200:203], v[116:119], v[176:191]
    ds_read_b64_tr_b16 v[102:103], v26 offset:41472
    s_waitcnt lgkmcnt(4)
    v_mfma_f32_32x32x16_bf16 v[128:143], a[76:79], v[120:123], v[128:143]
    ds_read_b64_tr_b16 v[104:105], v25 offset:43008
    s_add_u32 m0, s60, 3072
    s_add_u32 s68, s64, 12288
    buffer_load_dwordx4 v31, s[24:27], s68 offen sc1 lds
    v_mfma_f32_32x32x16_bf16 v[160:175], a[204:207], v[120:123], v[160:175]
    ds_read_b64_tr_b16 v[106:107], v25 offset:43520
    v_mfma_f32_32x32x16_bf16 v[144:159], a[76:79], v[124:127], v[144:159]
    ds_read_b64_tr_b16 v[108:109], v26 offset:43008
    v_mfma_f32_32x32x16_bf16 v[176:191], a[204:207], v[124:127], v[176:191]
    ds_read_b64_tr_b16 v[110:111], v26 offset:43520
    s_waitcnt lgkmcnt(4)
    v_mfma_f32_32x32x16_bf16 v[128:143], a[80:83], v[96:99], v[128:143]
    ds_read_b64_tr_b16 v[112:113], v25 offset:45056
    v_cvt_pk_bf16_f32 v232, v232, v233
    v_cvt_pk_bf16_f32 v233, v234, v235
    v_mfma_f32_32x32x16_bf16 v[160:175], a[208:211], v[96:99], v[160:175]
    ds_read_b64_tr_b16 v[114:115], v25 offset:45568
    v_mfma_f32_32x32x16_bf16 v[144:159], a[80:83], v[100:103], v[144:159]
    ds_read_b64_tr_b16 v[116:117], v26 offset:45056
    v_mfma_f32_32x32x16_bf16 v[176:191], a[208:211], v[100:103], v[176:191]
    ds_read_b64_tr_b16 v[118:119], v26 offset:45568
    s_waitcnt lgkmcnt(4)
    v_mfma_f32_32x32x16_bf16 v[128:143], a[84:87], v[104:107], v[128:143]
    ds_read_b64_tr_b16 v[120:121], v25 offset:47104
    s_add_u32 m0, s60, 4096
    s_add_u32 s68, s63, 529760
    buffer_load_dwordx4 v1, s[20:23], s68 offen offset:0 lds
    v_mfma_f32_32x32x16_bf16 v[160:175], a[212:215], v[104:107], v[160:175]
    ds_read_b64_tr_b16 v[122:123], v25 offset:47616
    v_mfma_f32_32x32x16_bf16 v[144:159], a[84:87], v[108:111], v[144:159]
    ds_read_b64_tr_b16 v[124:125], v26 offset:47104
    v_mfma_f32_32x32x16_bf16 v[176:191], a[212:215], v[108:111], v[176:191]
    ds_read_b64_tr_b16 v[126:127], v26 offset:47616
    s_waitcnt lgkmcnt(4)
    v_mfma_f32_32x32x16_bf16 v[128:143], a[88:91], v[112:115], v[128:143]
    ds_read_b64_tr_b16 v[96:97], v25 offset:49152
    v_cvt_pk_bf16_f32 v234, v236, v237
    v_cvt_pk_bf16_f32 v235, v238, v239
    buffer_store_dwordx4 v[232:235], v31, s[24:27], s57 offen offset:1024 sc1
    v_mfma_f32_32x32x16_bf16 v[160:175], a[216:219], v[112:115], v[160:175]
    ds_read_b64_tr_b16 v[98:99], v25 offset:49664
    v_mfma_f32_32x32x16_bf16 v[144:159], a[88:91], v[116:119], v[144:159]
    buffer_load_dwordx4 v2, s[20:23], s68 offen offset:1024 lds
    ds_read_b64_tr_b16 v[100:101], v26 offset:49152
    v_mfma_f32_32x32x16_bf16 v[176:191], a[216:219], v[116:119], v[176:191]
    ds_read_b64_tr_b16 v[102:103], v26 offset:49664
    s_waitcnt lgkmcnt(4)
    v_mfma_f32_32x32x16_bf16 v[128:143], a[92:95], v[120:123], v[128:143]
    ds_read_b64_tr_b16 v[104:105], v25 offset:51200
    v_mfma_f32_32x32x16_bf16 v[160:175], a[220:223], v[120:123], v[160:175]
    ds_read_b64_tr_b16 v[106:107], v25 offset:51712
    v_mfma_f32_32x32x16_bf16 v[144:159], a[92:95], v[124:127], v[144:159]
    ds_read_b64_tr_b16 v[108:109], v26 offset:51200
    v_mfma_f32_32x32x16_bf16 v[176:191], a[220:223], v[124:127], v[176:191]
    ds_read_b64_tr_b16 v[110:111], v26 offset:51712
    s_waitcnt lgkmcnt(4)
    v_mfma_f32_32x32x16_bf16 v[128:143], a[96:99], v[96:99], v[128:143]
    ds_read_b64_tr_b16 v[112:113], v25 offset:53248
    v_cvt_pk_bf16_f32 v240, v240, v241
    v_cvt_pk_bf16_f32 v241, v242, v243
    v_mfma_f32_32x32x16_bf16 v[160:175], a[224:227], v[96:99], v[160:175]
    ds_read_b64_tr_b16 v[114:115], v25 offset:53760
    v_mfma_f32_32x32x16_bf16 v[144:159], a[96:99], v[100:103], v[144:159]
    buffer_load_dwordx4 v3, s[20:23], s68 offen offset:2048 lds
    ds_read_b64_tr_b16 v[116:117], v26 offset:53248
    v_mfma_f32_32x32x16_bf16 v[176:191], a[224:227], v[100:103], v[176:191]
    ds_read_b64_tr_b16 v[118:119], v26 offset:53760
    s_waitcnt lgkmcnt(4)
    v_mfma_f32_32x32x16_bf16 v[128:143], a[100:103], v[104:107], v[128:143]
    ds_read_b64_tr_b16 v[120:121], v25 offset:55296
    v_mfma_f32_32x32x16_bf16 v[160:175], a[228:231], v[104:107], v[160:175]
    ds_read_b64_tr_b16 v[122:123], v25 offset:55808
    v_mfma_f32_32x32x16_bf16 v[144:159], a[100:103], v[108:111], v[144:159]
    ds_read_b64_tr_b16 v[124:125], v26 offset:55296
    v_mfma_f32_32x32x16_bf16 v[176:191], a[228:231], v[108:111], v[176:191]
    ds_read_b64_tr_b16 v[126:127], v26 offset:55808
    s_waitcnt lgkmcnt(4)
    v_mfma_f32_32x32x16_bf16 v[128:143], a[104:107], v[112:115], v[128:143]
    ds_read_b64_tr_b16 v[96:97], v25 offset:57344
    v_cvt_pk_bf16_f32 v242, v244, v245
    v_cvt_pk_bf16_f32 v243, v246, v247
    buffer_store_dwordx4 v[240:243], v31, s[24:27], s57 offen offset:2048 sc1
    v_mfma_f32_32x32x16_bf16 v[160:175], a[232:235], v[112:115], v[160:175]
    ds_read_b64_tr_b16 v[98:99], v25 offset:57856
    v_mfma_f32_32x32x16_bf16 v[144:159], a[104:107], v[116:119], v[144:159]
    s_add_u32 m0, s60, 7168
    s_add_u32 s68, s64, 45056
    buffer_load_dwordx4 v31, s[24:27], s68 offen sc1 lds
    ds_read_b64_tr_b16 v[100:101], v26 offset:57344
    v_mfma_f32_32x32x16_bf16 v[176:191], a[232:235], v[116:119], v[176:191]
    ds_read_b64_tr_b16 v[102:103], v26 offset:57856
    s_waitcnt lgkmcnt(4)
    v_mfma_f32_32x32x16_bf16 v[128:143], a[108:111], v[120:123], v[128:143]
    ds_read_b64_tr_b16 v[104:105], v25 offset:59392
    v_mfma_f32_32x32x16_bf16 v[160:175], a[236:239], v[120:123], v[160:175]
    ds_read_b64_tr_b16 v[106:107], v25 offset:59904
    v_mfma_f32_32x32x16_bf16 v[144:159], a[108:111], v[124:127], v[144:159]
    ds_read_b64_tr_b16 v[108:109], v26 offset:59392
    v_mfma_f32_32x32x16_bf16 v[176:191], a[236:239], v[124:127], v[176:191]
    ds_read_b64_tr_b16 v[110:111], v26 offset:59904
    s_waitcnt lgkmcnt(4)
    v_mfma_f32_32x32x16_bf16 v[128:143], a[112:115], v[96:99], v[128:143]
    ds_read_b64_tr_b16 v[112:113], v25 offset:61440
    v_cvt_pk_bf16_f32 v248, v248, v249
    v_cvt_pk_bf16_f32 v249, v250, v251
    v_mfma_f32_32x32x16_bf16 v[160:175], a[240:243], v[96:99], v[160:175]
    ds_read_b64_tr_b16 v[114:115], v25 offset:61952
    v_mfma_f32_32x32x16_bf16 v[144:159], a[112:115], v[100:103], v[144:159]
    ds_read_b64_tr_b16 v[116:117], v26 offset:61440
    v_mfma_f32_32x32x16_bf16 v[176:191], a[240:243], v[100:103], v[176:191]
    ds_read_b64_tr_b16 v[118:119], v26 offset:61952
    s_waitcnt lgkmcnt(4)
    v_mfma_f32_32x32x16_bf16 v[128:143], a[116:119], v[104:107], v[128:143]
    ds_read_b64_tr_b16 v[120:121], v25 offset:63488
    v_mfma_f32_32x32x16_bf16 v[160:175], a[244:247], v[104:107], v[160:175]
    ds_read_b64_tr_b16 v[122:123], v25 offset:64000
    v_mfma_f32_32x32x16_bf16 v[144:159], a[116:119], v[108:111], v[144:159]
    ds_read_b64_tr_b16 v[124:125], v26 offset:63488
    v_mfma_f32_32x32x16_bf16 v[176:191], a[244:247], v[108:111], v[176:191]
    ds_read_b64_tr_b16 v[126:127], v26 offset:64000
    s_waitcnt lgkmcnt(4)
    v_mfma_f32_32x32x16_bf16 v[128:143], a[120:123], v[112:115], v[128:143]
    v_cvt_pk_bf16_f32 v250, v252, v253
    v_cvt_pk_bf16_f32 v251, v254, v255
    buffer_store_dwordx4 v[248:251], v31, s[24:27], s57 offen offset:3072 sc1
    v_mfma_f32_32x32x16_bf16 v[160:175], a[248:251], v[112:115], v[160:175]
    v_mfma_f32_32x32x16_bf16 v[144:159], a[120:123], v[116:119], v[144:159]
    v_mfma_f32_32x32x16_bf16 v[176:191], a[248:251], v[116:119], v[176:191]
    s_waitcnt lgkmcnt(0)
    v_mfma_f32_32x32x16_bf16 v[128:143], a[124:127], v[120:123], v[128:143]
    v_mfma_f32_32x32x16_bf16 v[160:175], a[252:255], v[120:123], v[160:175]
    v_mfma_f32_32x32x16_bf16 v[144:159], a[124:127], v[124:127], v[144:159]
    v_mfma_f32_32x32x16_bf16 v[176:191], a[252:255], v[124:127], v[176:191]
K1_Z:
    s_cmp_eq_u32 s38, 1
    s_cbranch_scc1 K1_Z2
    s_waitcnt vmcnt(26)
    s_barrier
    ds_read_b128 a[12:15], v21 offset:0
    ds_read_b64_tr_b16 a[0:1], v18 offset:0
    ds_read_b64_tr_b16 a[2:3], v18 offset:768
    ds_read_b64_tr_b16 a[4:5], v18 offset:64
    ds_read_b64_tr_b16 a[6:7], v18 offset:832
    ds_read_b64_tr_b16 a[8:9], v18 offset:128
    ds_read_b64_tr_b16 a[10:11], v18 offset:896
    ds_read_b128 a[28:31], v21 offset:8192
    ds_read_b64_tr_b16 a[16:17], v18 offset:8192
    ds_read_b64_tr_b16 a[18:19], v18 offset:8960
    ds_read_b64_tr_b16 a[20:21], v18 offset:8256
    ds_read_b64_tr_b16 a[22:23], v18 offset:9024
    ds_read_b64_tr_b16 a[24:25], v18 offset:8320
    ds_read_b64_tr_b16 a[26:27], v18 offset:9088
    ds_read_b128 a[44:47], v21 offset:16384
    ds_read_b64_tr_b16 a[32:33], v18 offset:16384
    ds_read_b64_tr_b16 a[34:35], v18 offset:17152
    ds_read_b64_tr_b16 a[36:37], v18 offset:16448
    ds_read_b64_tr_b16 a[38:39], v18 offset:17216
    ds_read_b64_tr_b16 a[40:41], v18 offset:16512
    ds_read_b64_tr_b16 a[42:43], v18 offset:17280
    s_waitcnt lgkmcnt(14)
    v_mfma_f32_32x32x16_bf16 v[192:207], a[0:3], a[12:15], 0
    ds_read_b128 a[60:63], v21 offset:24576
    ds_read_b64_tr_b16 a[48:49], v18 offset:24576
    s_add_u32 m0, s60, 32768
    s_add_u32 s68, s63, 704512
    buffer_load_dwordx4 v1, s[20:23], s68 offen offset:0 lds
    v_mfma_f32_32x32x16_bf16 v[208:223], a[4:7], a[12:15], 0
    ds_read_b64_tr_b16 a[50:51], v18 offset:25344
    ds_read_b64_tr_b16 a[52:53], v18 offset:24640
    buffer_load_dwordx4 v2, s[20:23], s68 offen offset:1024 lds
    v_mfma_f32_32x32x16_bf16 v[224:239], a[8:11], a[12:15], 0
    ds_read_b64_tr_b16 a[54:55], v18 offset:25408
    ds_read_b64_tr_b16 a[56:57], v18 offset:24704
    ds_read_b64_tr_b16 a[58:59], v18 offset:25472
    s_waitcnt lgkmcnt(0)
    s_waitcnt vmcnt(26)
    s_barrier
    v_mfma_f32_32x32x16_bf16 v[192:207], a[16:19], a[28:31], v[192:207]
    ds_read_b128 a[12:15], v21 offset:32768
    ds_read_b64_tr_b16 a[0:1], v18 offset:32768
    buffer_load_dwordx4 v3, s[20:23], s68 offen offset:2048 lds
    v_mfma_f32_32x32x16_bf16 v[208:223], a[20:23], a[28:31], v[208:223]
    ds_read_b64_tr_b16 a[2:3], v18 offset:33536
    ds_read_b64_tr_b16 a[4:5], v18 offset:32832
    s_add_u32 m0, s60, 35840
    s_add_u32 s68, s64, 16384
    buffer_load_dwordx4 v31, s[24:27], s68 offen sc1 lds
    v_mfma_f32_32x32x16_bf16 v[224:239], a[24:27], a[28:31], v[224:239]
    ds_read_b64_tr_b16 a[6:7], v18 offset:33600
    ds_read_b64_tr_b16 a[8:9], v18 offset:32896
    ds_read_b64_tr_b16 a[10:11], v18 offset:33664
    v_mfma_f32_32x32x16_bf16 v[192:207], a[32:35], a[44:47], v[192:207]
    ds_read_b128 a[28:31], v21 offset:40960
    ds_read_b64_tr_b16 a[16:17], v18 offset:40960
    s_add_u32 m0, s60, 36864
    s_add_u32 s68, s63, 705888
    buffer_load_dwordx4 v1, s[20:23], s68 offen offset:0 lds
    v_mfma_f32_32x32x16_bf16 v[208:223], a[36:39], a[44:47], v[208:223]
    ds_read_b64_tr_b16 a[18:19], v18 offset:41728
    ds_read_b64_tr_b16 a[20:21], v18 offset:41024
    buffer_load_dwordx4 v2, s[20:23], s68 offen offset:1024 lds
    v_mfma_f32_32x32x16_bf16 v[224:239], a[40:43], a[44:47], v[224:239]
    ds_read_b64_tr_b16 a[22:23], v18 offset:41792
    ds_read_b64_tr_b16 a[24:25], v18 offset:41088
    ds_read_b64_tr_b16 a[26:27], v18 offset:41856
    v_mfma_f32_32x32x16_bf16 v[192:207], a[48:51], a[60:63], v[192:207]
    ds_read_b128 a[44:47], v21 offset:49152
    ds_read_b64_tr_b16 a[32:33], v18 offset:49152
    buffer_load_dwordx4 v3, s[20:23], s68 offen offset:2048 lds
    v_mfma_f32_32x32x16_bf16 v[208:223], a[52:55], a[60:63], v[208:223]
    ds_read_b64_tr_b16 a[34:35], v18 offset:49920
    ds_read_b64_tr_b16 a[36:37], v18 offset:49216
    s_add_u32 m0, s60, 39936
    s_add_u32 s68, s64, 49152
    buffer_load_dwordx4 v31, s[24:27], s68 offen sc1 lds
    v_mfma_f32_32x32x16_bf16 v[224:239], a[56:59], a[60:63], v[224:239]
    ds_read_b64_tr_b16 a[38:39], v18 offset:49984
    ds_read_b64_tr_b16 a[40:41], v18 offset:49280
    ds_read_b64_tr_b16 a[42:43], v18 offset:50048
    s_waitcnt lgkmcnt(14)
    v_mfma_f32_32x32x16_bf16 v[192:207], a[0:3], a[12:15], v[192:207]
    ds_read_b128 a[60:63], v21 offset:57344
    ds_read_b64_tr_b16 a[48:49], v18 offset:57344
    s_add_u32 m0, s60, 65536
    s_add_u32 s68, s63, 880640
    buffer_load_dwordx4 v1, s[20:23], s68 offen offset:0 lds
    v_mfma_f32_32x32x16_bf16 v[208:223], a[4:7], a[12:15], v[208:223]
    ds_read_b64_tr_b16 a[50:51], v18 offset:58112
    ds_read_b64_tr_b16 a[52:53], v18 offset:57408
    buffer_load_dwordx4 v2, s[20:23], s68 offen offset:1024 lds
    v_mfma_f32_32x32x16_bf16 v[224:239], a[8:11], a[12:15], v[224:239]
    ds_read_b64_tr_b16 a[54:55], v18 offset:58176
    ds_read_b64_tr_b16 a[56:57], v18 offset:57472
    ds_read_b64_tr_b16 a[58:59], v18 offset:58240
    s_waitcnt lgkmcnt(0)
    s_waitcnt vmcnt(23)
    s_barrier
    v_mfma_f32_32x32x16_bf16 v[192:207], a[16:19], a[28:31], v[192:207]
    ds_read_b128 a[12:15], v22 offset:0
    ds_read_b64_tr_b16 a[0:1], v19 offset:0
    buffer_load_dwordx4 v3, s[20:23], s68 offen offset:2048 lds
    v_mfma_f32_32x32x16_bf16 v[208:223], a[20:23], a[28:31], v[208:223]
    ds_read_b64_tr_b16 a[2:3], v19 offset:768
    ds_read_b64_tr_b16 a[4:5], v19 offset:64
    s_add_u32 m0, s60, 68608
    s_add_u32 s68, s64, 20480
    buffer_load_dwordx4 v31, s[24:27], s68 offen sc1 lds
    v_mfma_f32_32x32x16_bf16 v[224:239], a[24:27], a[28:31], v[224:239]
    ds_read_b64_tr_b16 a[6:7], v19 offset:832
    ds_read_b64_tr_b16 a[8:9], v19 offset:128
    ds_read_b64_tr_b16 a[10:11], v19 offset:896
    v_mfma_f32_32x32x16_bf16 v[192:207], a[32:35], a[44:47], v[192:207]
    ds_read_b128 a[28:31], v22 offset:8192
    ds_read_b64_tr_b16 a[16:17], v19 offset:8192
    s_add_u32 m0, s60, 69632
    s_add_u32 s68, s63, 882016
    buffer_load_dwordx4 v1, s[20:23], s68 offen offset:0 lds
    v_mfma_f32_32x32x16_bf16 v[208:223], a[36:39], a[44:47], v[208:223]
    ds_read_b64_tr_b16 a[18:19], v19 offset:8960
    ds_read_b64_tr_b16 a[20:21], v19 offset:8256
    buffer_load_dwordx4 v2, s[20:23], s68 offen offset:1024 lds
    v_mfma_f32_32x32x16_bf16 v[224:239], a[40:43], a[44:47], v[224:239]
    ds_read_b64_tr_b16 a[22:23], v19 offset:9024
    ds_read_b64_tr_b16 a[24:25], v19 offset:8320
    ds_read_b64_tr_b16 a[26:27], v19 offset:9088
    v_mfma_f32_32x32x16_bf16 v[192:207], a[48:51], a[60:63], v[192:207]
    ds_read_b128 a[44:47], v22 offset:16384
    ds_read_b64_tr_b16 a[32:33], v19 offset:16384
    buffer_load_dwordx4 v3, s[20:23], s68 offen offset:2048 lds
    v_mfma_f32_32x32x16_bf16 v[208:223], a[52:55], a[60:63], v[208:223]
    ds_read_b64_tr_b16 a[34:35], v19 offset:17152
    ds_read_b64_tr_b16 a[36:37], v19 offset:16448
    s_add_u32 m0, s60, 72704
    s_add_u32 s68, s64, 53248
    buffer_load_dwordx4 v31, s[24:27], s68 offen sc1 lds
    v_mfma_f32_32x32x16_bf16 v[224:239], a[56:59], a[60:63], v[224:239]
    ds_read_b64_tr_b16 a[38:39], v19 offset:17216
    ds_read_b64_tr_b16 a[40:41], v19 offset:16512
    ds_read_b64_tr_b16 a[42:43], v19 offset:17280
    s_waitcnt lgkmcnt(14)
    v_mfma_f32_32x32x16_bf16 v[192:207], a[0:3], a[12:15], v[192:207]
    ds_read_b128 a[60:63], v22 offset:24576
    ds_read_b64_tr_b16 a[48:49], v19 offset:24576
    s_add_u32 m0, s60, 98304
    s_add_u32 s68, s63, 1056768
    buffer_load_dwordx4 v1, s[20:23], s68 offen offset:0 lds
    v_mfma_f32_32x32x16_bf16 v[208:223], a[4:7], a[12:15], v[208:223]
    ds_read_b64_tr_b16 a[50:51], v19 offset:25344
    ds_read_b64_tr_b16 a[52:53], v19 offset:24640
    buffer_load_dwordx4 v2, s[20:23], s68 offen offset:1024 lds
    v_mfma_f32_32x32x16_bf16 v[224:239], a[8:11], a[12:15], v[224:239]
    ds_read_b64_tr_b16 a[54:55], v19 offset:25408
    ds_read_b64_tr_b16 a[56:57], v19 offset:24704
    ds_read_b64_tr_b16 a[58:59], v19 offset:25472
    s_waitcnt lgkmcnt(0)
    s_waitcnt vmcnt(19)
    s_barrier
    v_mfma_f32_32x32x16_bf16 v[192:207], a[16:19], a[28:31], v[192:207]
    ds_read_b128 a[12:15], v20 offset:0
    ds_read_b64_tr_b16 a[0:1], v17 offset:0
    buffer_load_dwordx4 v3, s[20:23], s68 offen offset:2048 lds
    v_mfma_f32_32x32x16_bf16 v[208:223], a[20:23], a[28:31], v[208:223]
    ds_read_b64_tr_b16 a[2:3], v17 offset:768
    ds_read_b64_tr_b16 a[4:5], v17 offset:64
    s_add_u32 m0, s60, 101376
    s_add_u32 s68, s64, 24576
    buffer_load_dwordx4 v31, s[24:27], s68 offen sc1 lds
    v_mfma_f32_32x32x16_bf16 v[224:239], a[24:27], a[28:31], v[224:239]
    ds_read_b64_tr_b16 a[6:7], v17 offset:832
    ds_read_b64_tr_b16 a[8:9], v17 offset:128
    ds_read_b64_tr_b16 a[10:11], v17 offset:896
    v_mfma_f32_32x32x16_bf16 v[192:207], a[32:35], a[44:47], v[192:207]
    ds_read_b128 a[28:31], v20 offset:8192
    ds_read_b64_tr_b16 a[16:17], v17 offset:8192
    s_add_u32 m0, s60, 102400
    s_add_u32 s68, s63, 1058144
    buffer_load_dwordx4 v1, s[20:23], s68 offen offset:0 lds
    v_mfma_f32_32x32x16_bf16 v[208:223], a[36:39], a[44:47], v[208:223]
    ds_read_b64_tr_b16 a[18:19], v17 offset:8960
    ds_read_b64_tr_b16 a[20:21], v17 offset:8256
    buffer_load_dwordx4 v2, s[20:23], s68 offen offset:1024 lds
    v_mfma_f32_32x32x16_bf16 v[224:239], a[40:43], a[44:47], v[224:239]
    ds_read_b64_tr_b16 a[22:23], v17 offset:9024
    ds_read_b64_tr_b16 a[24:25], v17 offset:8320
    ds_read_b64_tr_b16 a[26:27], v17 offset:9088
    v_mfma_f32_32x32x16_bf16 v[192:207], a[48:51], a[60:63], v[192:207]
    ds_read_b128 a[44:47], v20 offset:16384
    ds_read_b64_tr_b16 a[32:33], v17 offset:16384
    buffer_load_dwordx4 v3, s[20:23], s68 offen offset:2048 lds
    v_mfma_f32_32x32x16_bf16 v[208:223], a[52:55], a[60:63], v[208:223]
    ds_read_b64_tr_b16 a[34:35], v17 offset:17152
    ds_read_b64_tr_b16 a[36:37], v17 offset:16448
    s_add_u32 m0, s60, 105472
    s_add_u32 s68, s64, 57344
    buffer_load_dwordx4 v31, s[24:27], s68 offen sc1 lds
    v_mfma_f32_32x32x16_bf16 v[224:239], a[56:59], a[60:63], v[224:239]
    ds_read_b64_tr_b16 a[38:39], v17 offset:17216
    ds_read_b64_tr_b16 a[40:41], v17 offset:16512
    ds_read_b64_tr_b16 a[42:43], v17 offset:17280
    s_waitcnt lgkmcnt(14)
    v_mfma_f32_32x32x16_bf16 v[192:207], a[0:3], a[12:15], v[192:207]
    ds_read_b128 a[60:63], v20 offset:24576
    ds_read_b64_tr_b16 a[48:49], v17 offset:24576
    s_add_u32 m0, s60, 131072
    s_add_u32 s68, s63, 1232896
    buffer_load_dwordx4 v1, s[20:23], s68 offen offset:0 lds
    v_mfma_f32_32x32x16_bf16 v[208:223], a[4:7], a[12:15], v[208:223]
    ds_read_b64_tr_b16 a[50:51], v17 offset:25344
    ds_read_b64_tr_b16 a[52:53], v17 offset:24640
    buffer_load_dwordx4 v2, s[20:23], s68 offen offset:1024 lds
    v_mfma_f32_32x32x16_bf16 v[224:239], a[8:11], a[12:15], v[224:239]
    ds_read_b64_tr_b16 a[54:55], v17 offset:25408
    ds_read_b64_tr_b16 a[56:57], v17 offset:24704
    ds_read_b64_tr_b16 a[58:59], v17 offset:25472
    s_waitcnt lgkmcnt(0)
    s_waitcnt vmcnt(18)
    s_barrier
    v_mfma_f32_32x32x16_bf16 v[192:207], a[16:19], a[28:31], v[192:207]
    ds_read_b128 a[12:15], v20 offset:32768
    ds_read_b64_tr_b16 a[0:1], v17 offset:32768
    buffer_load_dwordx4 v3, s[20:23], s68 offen offset:2048 lds
    v_mfma_f32_32x32x16_bf16 v[208:223], a[20:23], a[28:31], v[208:223]
    ds_read_b64_tr_b16 a[2:3], v17 offset:33536
    ds_read_b64_tr_b16 a[4:5], v17 offset:32832
    s_add_u32 m0, s60, 134144
    s_add_u32 s68, s64, 28672
    buffer_load_dwordx4 v31, s[24:27], s68 offen sc1 lds
    v_mfma_f32_32x32x16_bf16 v[224:239], a[24:27], a[28:31], v[224:239]
    ds_read_b64_tr_b16 a[6:7], v17 offset:33600
    ds_read_b64_tr_b16 a[8:9], v17 offset:32896
    ds_read_b64_tr_b16 a[10:11], v17 offset:33664
    v_mfma_f32_32x32x16_bf16 v[192:207], a[32:35], a[44:47], v[192:207]
    ds_read_b128 a[28:31], v20 offset:40960
    ds_read_b64_tr_b16 a[16:17], v17 offset:40960
    s_add_u32 m0, s60, 135168
    s_add_u32 s68, s63, 1234272
    buffer_load_dwordx4 v1, s[20:23], s68 offen offset:0 lds
    v_mfma_f32_32x32x16_bf16 v[208:223], a[36:39], a[44:47], v[208:223]
    ds_read_b64_tr_b16 a[18:19], v17 offset:41728
    ds_read_b64_tr_b16 a[20:21], v17 offset:41024
    buffer_load_dwordx4 v2, s[20:23], s68 offen offset:1024 lds
    v_mfma_f32_32x32x16_bf16 v[224:239], a[40:43], a[44:47], v[224:239]
    ds_read_b64_tr_b16 a[22:23], v17 offset:41792
    ds_read_b64_tr_b16 a[24:25], v17 offset:41088
    ds_read_b64_tr_b16 a[26:27], v17 offset:41856
    v_mfma_f32_32x32x16_bf16 v[192:207], a[48:51], a[60:63], v[192:207]
    ds_read_b128 a[44:47], v20 offset:49152
    ds_read_b64_tr_b16 a[32:33], v17 offset:49152
    buffer_load_dwordx4 v3, s[20:23], s68 offen offset:2048 lds
    v_mfma_f32_32x32x16_bf16 v[208:223], a[52:55], a[60:63], v[208:223]
    ds_read_b64_tr_b16 a[34:35], v17 offset:49920
    ds_read_b64_tr_b16 a[36:37], v17 offset:49216
    s_add_u32 m0, s60, 138240
    s_add_u32 s68, s64, 61440
    buffer_load_dwordx4 v31, s[24:27], s68 offen sc1 lds
    v_mfma_f32_32x32x16_bf16 v[224:239], a[56:59], a[60:63], v[224:239]
    ds_read_b64_tr_b16 a[38:39], v17 offset:49984
    ds_read_b64_tr_b16 a[40:41], v17 offset:49280
    ds_read_b64_tr_b16 a[42:43], v17 offset:50048
    s_waitcnt lgkmcnt(14)
    v_mfma_f32_32x32x16_bf16 v[192:207], a[0:3], a[12:15], v[192:207]
    ds_read_b128 a[60:63], v20 offset:57344
    ds_read_b64_tr_b16 a[48:49], v17 offset:57344
    v_mfma_f32_32x32x16_bf16 v[208:223], a[4:7], a[12:15], v[208:223]
    ds_read_b64_tr_b16 a[50:51], v17 offset:58112
    ds_read_b64_tr_b16 a[52:53], v17 offset:57408
    v_mfma_f32_32x32x16_bf16 v[224:239], a[8:11], a[12:15], v[224:239]
    ds_read_b64_tr_b16 a[54:55], v17 offset:58176
    ds_read_b64_tr_b16 a[56:57], v17 offset:57472
    ds_read_b64_tr_b16 a[58:59], v17 offset:58240
    s_add_u32 s57, s62, 528384
    v_cvt_pk_bf16_f32 v128, v128, v129
    v_cvt_pk_bf16_f32 v129, v130, v131
    s_waitcnt lgkmcnt(0)
    s_waitcnt vmcnt(16)
    s_barrier
    v_mfma_f32_32x32x16_bf16 v[192:207], a[16:19], a[28:31], v[192:207]
    ds_read_b128 a[12:15], v21 offset:0
    ds_read_b64_tr_b16 a[0:1], v18 offset:0
    v_mfma_f32_32x32x16_bf16 v[208:223], a[20:23], a[28:31], v[208:223]
    ds_read_b64_tr_b16 a[2:3], v18 offset:768
    ds_read_b64_tr_b16 a[4:5], v18 offset:64
    v_mfma_f32_32x32x16_bf16 v[224:239], a[24:27], a[28:31], v[224:239]
    ds_read_b64_tr_b16 a[6:7], v18 offset:832
    ds_read_b64_tr_b16 a[8:9], v18 offset:128
    ds_read_b64_tr_b16 a[10:11], v18 offset:896
    v_cvt_pk_bf16_f32 v130, v132, v133
    v_cvt_pk_bf16_f32 v131, v134, v135
    buffer_store_dwordx4 v[128:131], v31, s[24:27], s57 offen offset:0 sc1
    v_mfma_f32_32x32x16_bf16 v[192:207], a[32:35], a[44:47], v[192:207]
    ds_read_b128 a[28:31], v21 offset:8192
    ds_read_b64_tr_b16 a[16:17], v18 offset:8192
    v_mfma_f32_32x32x16_bf16 v[208:223], a[36:39], a[44:47], v[208:223]
    ds_read_b64_tr_b16 a[18:19], v18 offset:8960
    ds_read_b64_tr_b16 a[20:21], v18 offset:8256
    v_mfma_f32_32x32x16_bf16 v[224:239], a[40:43], a[44:47], v[224:239]
    ds_read_b64_tr_b16 a[22:23], v18 offset:9024
    ds_read_b64_tr_b16 a[24:25], v18 offset:8320
    ds_read_b64_tr_b16 a[26:27], v18 offset:9088
    v_cvt_pk_bf16_f32 v136, v136, v137
    v_cvt_pk_bf16_f32 v137, v138, v139
    v_mfma_f32_32x32x16_bf16 v[192:207], a[48:51], a[60:63], v[192:207]
    ds_read_b128 a[44:47], v21 offset:16384
    ds_read_b64_tr_b16 a[32:33], v18 offset:16384
    v_mfma_f32_32x32x16_bf16 v[208:223], a[52:55], a[60:63], v[208:223]
    ds_read_b64_tr_b16 a[34:35], v18 offset:17152
    ds_read_b64_tr_b16 a[36:37], v18 offset:16448
    v_mfma_f32_32x32x16_bf16 v[224:239], a[56:59], a[60:63], v[224:239]
    ds_read_b64_tr_b16 a[38:39], v18 offset:17216
    ds_read_b64_tr_b16 a[40:41], v18 offset:16512
    ds_read_b64_tr_b16 a[42:43], v18 offset:17280
    v_cvt_pk_bf16_f32 v138, v140, v141
    v_cvt_pk_bf16_f32 v139, v142, v143
    buffer_store_dwordx4 v[136:139], v31, s[24:27], s57 offen offset:1024 sc1
    s_waitcnt lgkmcnt(14)
    v_mfma_f32_32x32x16_bf16 v[192:207], a[0:3], a[12:15], v[192:207]
    ds_read_b128 a[60:63], v21 offset:24576
    ds_read_b64_tr_b16 a[48:49], v18 offset:24576
    v_mfma_f32_32x32x16_bf16 v[208:223], a[4:7], a[12:15], v[208:223]
    ds_read_b64_tr_b16 a[50:51], v18 offset:25344
    ds_read_b64_tr_b16 a[52:53], v18 offset:24640
    v_mfma_f32_32x32x16_bf16 v[224:239], a[8:11], a[12:15], v[224:239]
    ds_read_b64_tr_b16 a[54:55], v18 offset:25408
    ds_read_b64_tr_b16 a[56:57], v18 offset:24704
    ds_read_b64_tr_b16 a[58:59], v18 offset:25472
    v_cvt_pk_bf16_f32 v144, v144, v145
    v_cvt_pk_bf16_f32 v145, v146, v147
    s_waitcnt lgkmcnt(0)
    s_waitcnt vmcnt(10)
    s_barrier
    v_mfma_f32_32x32x16_bf16 v[192:207], a[16:19], a[28:31], v[192:207]
    ds_read_b128 a[12:15], v21 offset:32768
    ds_read_b64_tr_b16 a[0:1], v18 offset:32768
    v_mfma_f32_32x32x16_bf16 v[208:223], a[20:23], a[28:31], v[208:223]
    ds_read_b64_tr_b16 a[2:3], v18 offset:33536
    ds_read_b64_tr_b16 a[4:5], v18 offset:32832
    v_mfma_f32_32x32x16_bf16 v[224:239], a[24:27], a[28:31], v[224:239]
    ds_read_b64_tr_b16 a[6:7], v18 offset:33600
    ds_read_b64_tr_b16 a[8:9], v18 offset:32896
    ds_read_b64_tr_b16 a[10:11], v18 offset:33664
    v_cvt_pk_bf16_f32 v146, v148, v149
    v_cvt_pk_bf16_f32 v147, v150, v151
    buffer_store_dwordx4 v[144:147], v31, s[24:27], s57 offen offset:2048 sc1
    v_mfma_f32_32x32x16_bf16 v[192:207], a[32:35], a[44:47], v[192:207]
    ds_read_b128 a[28:31], v21 offset:40960
    ds_read_b64_tr_b16 a[16:17], v18 offset:40960
    v_mfma_f32_32x32x16_bf16 v[208:223], a[36:39], a[44:47], v[208:223]
    ds_read_b64_tr_b16 a[18:19], v18 offset:41728
    ds_read_b64_tr_b16 a[20:21], v18 offset:41024
    v_mfma_f32_32x32x16_bf16 v[224:239], a[40:43], a[44:47], v[224:239]
    ds_read_b64_tr_b16 a[22:23], v18 offset:41792
    ds_read_b64_tr_b16 a[24:25], v18 offset:41088
    ds_read_b64_tr_b16 a[26:27], v18 offset:41856
    v_cvt_pk_bf16_f32 v152, v152, v153
    v_cvt_pk_bf16_f32 v153, v154, v155
    v_mfma_f32_32x32x16_bf16 v[192:207], a[48:51], a[60:63], v[192:207]
    ds_read_b128 a[44:47], v21 offset:49152
    ds_read_b64_tr_b16 a[32:33], v18 offset:49152
    v_mfma_f32_32x32x16_bf16 v[208:223], a[52:55], a[60:63], v[208:223]
    ds_read_b64_tr_b16 a[34:35], v18 offset:49920
    ds_read_b64_tr_b16 a[36:37], v18 offset:49216
    v_mfma_f32_32x32x16_bf16 v[224:239], a[56:59], a[60:63], v[224:239]
    ds_read_b64_tr_b16 a[38:39], v18 offset:49984
    ds_read_b64_tr_b16 a[40:41], v18 offset:49280
    ds_read_b64_tr_b16 a[42:43], v18 offset:50048
    v_cvt_pk_bf16_f32 v154, v156, v157
    v_cvt_pk_bf16_f32 v155, v158, v159
    buffer_store_dwordx4 v[152:155], v31, s[24:27], s57 offen offset:3072 sc1
    s_waitcnt lgkmcnt(14)
    v_mfma_f32_32x32x16_bf16 v[192:207], a[0:3], a[12:15], v[192:207]
    ds_read_b128 a[60:63], v21 offset:57344
    ds_read_b64_tr_b16 a[48:49], v18 offset:57344
    v_mfma_f32_32x32x16_bf16 v[208:223], a[4:7], a[12:15], v[208:223]
    ds_read_b64_tr_b16 a[50:51], v18 offset:58112
    ds_read_b64_tr_b16 a[52:53], v18 offset:57408
    v_mfma_f32_32x32x16_bf16 v[224:239], a[8:11], a[12:15], v[224:239]
    ds_read_b64_tr_b16 a[54:55], v18 offset:58176
    ds_read_b64_tr_b16 a[56:57], v18 offset:57472
    ds_read_b64_tr_b16 a[58:59], v18 offset:58240
    s_add_u32 s57, s62, 536576
    v_cvt_pk_bf16_f32 v160, v160, v161
    v_cvt_pk_bf16_f32 v161, v162, v163
    s_waitcnt lgkmcnt(0)
    s_waitcnt vmcnt(4)
    s_barrier
    v_mfma_f32_32x32x16_bf16 v[192:207], a[16:19], a[28:31], v[192:207]
    ds_read_b128 a[12:15], v22 offset:0
    ds_read_b64_tr_b16 a[0:1], v19 offset:0
    v_mfma_f32_32x32x16_bf16 v[208:223], a[20:23], a[28:31], v[208:223]
    ds_read_b64_tr_b16 a[2:3], v19 offset:768
    ds_read_b64_tr_b16 a[4:5], v19 offset:64
    v_mfma_f32_32x32x16_bf16 v[224:239], a[24:27], a[28:31], v[224:239]
    ds_read_b64_tr_b16 a[6:7], v19 offset:832
    ds_read_b64_tr_b16 a[8:9], v19 offset:128
    ds_read_b64_tr_b16 a[10:11], v19 offset:896
    v_cvt_pk_bf16_f32 v162, v164, v165
    v_cvt_pk_bf16_f32 v163, v166, v167
    buffer_store_dwordx4 v[160:163], v31, s[24:27], s57 offen offset:0 sc1
    v_mfma_f32_32x32x16_bf16 v[192:207], a[32:35], a[44:47], v[192:207]
    ds_read_b128 a[28:31], v22 offset:8192
    ds_read_b64_tr_b16 a[16:17], v19 offset:8192
    v_mfma_f32_32x32x16_bf16 v[208:223], a[36:39], a[44:47], v[208:223]
    ds_read_b64_tr_b16 a[18:19], v19 offset:8960
    ds_read_b64_tr_b16 a[20:21], v19 offset:8256
    v_mfma_f32_32x32x16_bf16 v[224:239], a[40:43], a[44:47], v[224:239]
    ds_read_b64_tr_b16 a[22:23], v19 offset:9024
    ds_read_b64_tr_b16 a[24:25], v19 offset:8320
    ds_read_b64_tr_b16 a[26:27], v19 offset:9088
    v_cvt_pk_bf16_f32 v168, v168, v169
    v_cvt_pk_bf16_f32 v169, v170, v171
    v_mfma_f32_32x32x16_bf16 v[192:207], a[48:51], a[60:63], v[192:207]
    ds_read_b128 a[44:47], v22 offset:16384
    ds_read_b64_tr_b16 a[32:33], v19 offset:16384
    v_mfma_f32_32x32x16_bf16 v[208:223], a[52:55], a[60:63], v[208:223]
    ds_read_b64_tr_b16 a[34:35], v19 offset:17152
    ds_read_b64_tr_b16 a[36:37], v19 offset:16448
    v_mfma_f32_32x32x16_bf16 v[224:239], a[56:59], a[60:63], v[224:239]
    ds_read_b64_tr_b16 a[38:39], v19 offset:17216
    ds_read_b64_tr_b16 a[40:41], v19 offset:16512
    ds_read_b64_tr_b16 a[42:43], v19 offset:17280
    v_cvt_pk_bf16_f32 v170, v172, v173
    v_cvt_pk_bf16_f32 v171, v174, v175
    buffer_store_dwordx4 v[168:171], v31, s[24:27], s57 offen offset:1024 sc1
    s_waitcnt lgkmcnt(14)
    v_mfma_f32_32x32x16_bf16 v[192:207], a[0:3], a[12:15], v[192:207]
    ds_read_b128 a[60:63], v22 offset:24576
    ds_read_b64_tr_b16 a[48:49], v19 offset:24576
    v_mfma_f32_32x32x16_bf16 v[208:223], a[4:7], a[12:15], v[208:223]
    ds_read_b64_tr_b16 a[50:51], v19 offset:25344
    ds_read_b64_tr_b16 a[52:53], v19 offset:24640
    v_mfma_f32_32x32x16_bf16 v[224:239], a[8:11], a[12:15], v[224:239]
    ds_read_b64_tr_b16 a[54:55], v19 offset:25408
    ds_read_b64_tr_b16 a[56:57], v19 offset:24704
    ds_read_b64_tr_b16 a[58:59], v19 offset:25472
    v_cvt_pk_bf16_f32 v176, v176, v177
    v_cvt_pk_bf16_f32 v177, v178, v179
    s_waitcnt lgkmcnt(14)
    v_mfma_f32_32x32x16_bf16 v[192:207], a[16:19], a[28:31], v[192:207]
    v_mfma_f32_32x32x16_bf16 v[208:223], a[20:23], a[28:31], v[208:223]
    v_mfma_f32_32x32x16_bf16 v[224:239], a[24:27], a[28:31], v[224:239]
    v_cvt_pk_bf16_f32 v178, v180, v181
    v_cvt_pk_bf16_f32 v179, v182, v183
    buffer_store_dwordx4 v[176:179], v31, s[24:27], s57 offen offset:2048 sc1
    s_waitcnt lgkmcnt(7)
    v_mfma_f32_32x32x16_bf16 v[192:207], a[32:35], a[44:47], v[192:207]
    v_mfma_f32_32x32x16_bf16 v[208:223], a[36:39], a[44:47], v[208:223]
    v_mfma_f32_32x32x16_bf16 v[224:239], a[40:43], a[44:47], v[224:239]
    v_cvt_pk_bf16_f32 v184, v184, v185
    v_cvt_pk_bf16_f32 v185, v186, v187
    s_waitcnt lgkmcnt(0)
    v_mfma_f32_32x32x16_bf16 v[192:207], a[48:51], a[60:63], v[192:207]
    v_mfma_f32_32x32x16_bf16 v[208:223], a[52:55], a[60:63], v[208:223]
    v_mfma_f32_32x32x16_bf16 v[224:239], a[56:59], a[60:63], v[224:239]
    v_cvt_pk_bf16_f32 v186, v188, v189
    v_cvt_pk_bf16_f32 v187, v190, v191
    buffer_store_dwordx4 v[184:187], v31, s[24:27], s57 offen offset:3072 sc1
    s_lshl_b32 s56, s33, 1
    s_add_u32 s56, s56, s37
    s_mul_i32 s56, s56, 48
    s_mul_i32 s57, s34, 6
    s_add_u32 s56, s56, s57
    s_lshl_b32 s56, s56, 10
    s_add_u32 s96, s56, 35651584
    s_add_u32 s97, s96, 4096
    s_nop 7
    s_branch K1_ZJOIN
K1_Z2:
    s_waitcnt vmcnt(26)
    s_barrier
    ds_read_b128 a[12:15], v21 offset:0
    ds_read_b64_tr_b16 a[0:1], v18 offset:0
    ds_read_b64_tr_b16 a[2:3], v18 offset:768
    ds_read_b64_tr_b16 a[4:5], v18 offset:64
    ds_read_b64_tr_b16 a[6:7], v18 offset:832
    ds_read_b64_tr_b16 a[8:9], v18 offset:128
    ds_read_b64_tr_b16 a[10:11], v18 offset:896
    ds_read_b128 a[28:31], v21 offset:8192
    ds_read_b64_tr_b16 a[16:17], v18 offset:8192
    ds_read_b64_tr_b16 a[18:19], v18 offset:8960
    ds_read_b64_tr_b16 a[20:21], v18 offset:8256
    ds_read_b64_tr_b16 a[22:23], v18 offset:9024
    ds_read_b64_tr_b16 a[24:25], v18 offset:8320
    ds_read_b64_tr_b16 a[26:27], v18 offset:9088
    ds_read_b128 a[44:47], v21 offset:16384
    ds_read_b64_tr_b16 a[32:33], v18 offset:16384
    ds_read_b64_tr_b16 a[34:35], v18 offset:17152
    ds_read_b64_tr_b16 a[36:37], v18 offset:16448
    ds_read_b64_tr_b16 a[38:39], v18 offset:17216
    ds_read_b64_tr_b16 a[40:41], v18 offset:16512
    ds_read_b64_tr_b16 a[42:43], v18 offset:17280
    s_waitcnt lgkmcnt(14)
    v_mfma_f32_32x32x16_bf16 v[192:207], a[12:15], a[0:3], 0
    ds_read_b128 a[60:63], v21 offset:24576
    ds_read_b64_tr_b16 a[48:49], v18 offset:24576
    s_add_u32 m0, s60, 32768
    s_add_u32 s68, s63, 704512
    buffer_load_dwordx4 v1, s[20:23], s68 offen offset:0 lds
    v_mfma_f32_32x32x16_bf16 v[208:223], a[12:15], a[4:7], 0
    ds_read_b64_tr_b16 a[50:51], v18 offset:25344
    ds_read_b64_tr_b16 a[52:53], v18 offset:24640
    buffer_load_dwordx4 v2, s[20:23], s68 offen offset:1024 lds
    v_mfma_f32_32x32x16_bf16 v[224:239], a[12:15], a[8:11], 0
    ds_read_b64_tr_b16 a[54:55], v18 offset:25408
    ds_read_b64_tr_b16 a[56:57], v18 offset:24704
    ds_read_b64_tr_b16 a[58:59], v18 offset:25472
    s_waitcnt lgkmcnt(0)
    s_waitcnt vmcnt(26)
    s_barrier
    v_mfma_f32_32x32x16_bf16 v[192:207], a[28:31], a[16:19], v[192:207]
    ds_read_b128 a[12:15], v21 offset:32768
    ds_read_b64_tr_b16 a[0:1], v18 offset:32768
    buffer_load_dwordx4 v3, s[20:23], s68 offen offset:2048 lds
    v_mfma_f32_32x32x16_bf16 v[208:223], a[28:31], a[20:23], v[208:223]
    ds_read_b64_tr_b16 a[2:3], v18 offset:33536
    ds_read_b64_tr_b16 a[4:5], v18 offset:32832
    s_add_u32 m0, s60, 35840
    s_add_u32 s68, s64, 16384
    buffer_load_dwordx4 v31, s[24:27], s68 offen sc1 lds
    v_mfma_f32_32x32x16_bf16 v[224:239], a[28:31], a[24:27], v[224:239]
    ds_read_b64_tr_b16 a[6:7], v18 offset:33600
    ds_read_b64_tr_b16 a[8:9], v18 offset:32896
    ds_read_b64_tr_b16 a[10:11], v18 offset:33664
    v_mfma_f32_32x32x16_bf16 v[192:207], a[44:47], a[32:35], v[192:207]
    ds_read_b128 a[28:31], v21 offset:40960
    ds_read_b64_tr_b16 a[16:17], v18 offset:40960
    s_add_u32 m0, s60, 36864
    s_add_u32 s68, s63, 705888
    buffer_load_dwordx4 v1, s[20:23], s68 offen offset:0 lds
    v_mfma_f32_32x32x16_bf16 v[208:223], a[44:47], a[36:39], v[208:223]
    ds_read_b64_tr_b16 a[18:19], v18 offset:41728
    ds_read_b64_tr_b16 a[20:21], v18 offset:41024
    buffer_load_dwordx4 v2, s[20:23], s68 offen offset:1024 lds
    v_mfma_f32_32x32x16_bf16 v[224:239], a[44:47], a[40:43], v[224:239]
    ds_read_b64_tr_b16 a[22:23], v18 offset:41792
    ds_read_b64_tr_b16 a[24:25], v18 offset:41088
    ds_read_b64_tr_b16 a[26:27], v18 offset:41856
    v_mfma_f32_32x32x16_bf16 v[192:207], a[60:63], a[48:51], v[192:207]
    ds_read_b128 a[44:47], v21 offset:49152
    ds_read_b64_tr_b16 a[32:33], v18 offset:49152
    buffer_load_dwordx4 v3, s[20:23], s68 offen offset:2048 lds
    v_mfma_f32_32x32x16_bf16 v[208:223], a[60:63], a[52:55], v[208:223]
    ds_read_b64_tr_b16 a[34:35], v18 offset:49920
    ds_read_b64_tr_b16 a[36:37], v18 offset:49216
    s_add_u32 m0, s60, 39936
    s_add_u32 s68, s64, 49152
    buffer_load_dwordx4 v31, s[24:27], s68 offen sc1 lds
    v_mfma_f32_32x32x16_bf16 v[224:239], a[60:63], a[56:59], v[224:239]
    ds_read_b64_tr_b16 a[38:39], v18 offset:49984
    ds_read_b64_tr_b16 a[40:41], v18 offset:49280
    ds_read_b64_tr_b16 a[42:43], v18 offset:50048
    s_waitcnt lgkmcnt(14)
    v_mfma_f32_32x32x16_bf16 v[192:207], a[12:15], a[0:3], v[192:207]
    ds_read_b128 a[60:63], v21 offset:57344
    ds_read_b64_tr_b16 a[48:49], v18 offset:57344
    s_add_u32 m0, s60, 65536
    s_add_u32 s68, s63, 880640
    buffer_load_dwordx4 v1, s[20:23], s68 offen offset:0 lds
    v_mfma_f32_32x32x16_bf16 v[208:223], a[12:15], a[4:7], v[208:223]
    ds_read_b64_tr_b16 a[50:51], v18 offset:58112
    ds_read_b64_tr_b16 a[52:53], v18 offset:57408
    buffer_load_dwordx4 v2, s[20:23], s68 offen offset:1024 lds
    v_mfma_f32_32x32x16_bf16 v[224:239], a[12:15], a[8:11], v[224:239]
    ds_read_b64_tr_b16 a[54:55], v18 offset:58176
    ds_read_b64_tr_b16 a[56:57], v18 offset:57472
    ds_read_b64_tr_b16 a[58:59], v18 offset:58240
    s_waitcnt lgkmcnt(0)
    s_waitcnt vmcnt(23)
    s_barrier
    v_mfma_f32_32x32x16_bf16 v[192:207], a[28:31], a[16:19], v[192:207]
    ds_read_b128 a[12:15], v22 offset:0
    ds_read_b64_tr_b16 a[0:1], v19 offset:0
    buffer_load_dwordx4 v3, s[20:23], s68 offen offset:2048 lds
    v_mfma_f32_32x32x16_bf16 v[208:223], a[28:31], a[20:23], v[208:223]
    ds_read_b64_tr_b16 a[2:3], v19 offset:768
    ds_read_b64_tr_b16 a[4:5], v19 offset:64
    s_add_u32 m0, s60, 68608
    s_add_u32 s68, s64, 20480
    buffer_load_dwordx4 v31, s[24:27], s68 offen sc1 lds
    v_mfma_f32_32x32x16_bf16 v[224:239], a[28:31], a[24:27], v[224:239]
    ds_read_b64_tr_b16 a[6:7], v19 offset:832
    ds_read_b64_tr_b16 a[8:9], v19 offset:128
    ds_read_b64_tr_b16 a[10:11], v19 offset:896
    v_mfma_f32_32x32x16_bf16 v[192:207], a[44:47], a[32:35], v[192:207]
    ds_read_b128 a[28:31], v22 offset:8192
    ds_read_b64_tr_b16 a[16:17], v19 offset:8192
    s_add_u32 m0, s60, 69632
    s_add_u32 s68, s63, 882016
    buffer_load_dwordx4 v1, s[20:23], s68 offen offset:0 lds
    v_mfma_f32_32x32x16_bf16 v[208:223], a[44:47], a[36:39], v[208:223]
    ds_read_b64_tr_b16 a[18:19], v19 offset:8960
    ds_read_b64_tr_b16 a[20:21], v19 offset:8256
    buffer_load_dwordx4 v2, s[20:23], s68 offen offset:1024 lds
    v_mfma_f32_32x32x16_bf16 v[224:239], a[44:47], a[40:43], v[224:239]
    ds_read_b64_tr_b16 a[22:23], v19 offset:9024
    ds_read_b64_tr_b16 a[24:25], v19 offset:8320
    ds_read_b64_tr_b16 a[26:27], v19 offset:9088
    v_mfma_f32_32x32x16_bf16 v[192:207], a[60:63], a[48:51], v[192:207]
    ds_read_b128 a[44:47], v22 offset:16384
    ds_read_b64_tr_b16 a[32:33], v19 offset:16384
    buffer_load_dwordx4 v3, s[20:23], s68 offen offset:2048 lds
    v_mfma_f32_32x32x16_bf16 v[208:223], a[60:63], a[52:55], v[208:223]
    ds_read_b64_tr_b16 a[34:35], v19 offset:17152
    ds_read_b64_tr_b16 a[36:37], v19 offset:16448
    s_add_u32 m0, s60, 72704
    s_add_u32 s68, s64, 53248
    buffer_load_dwordx4 v31, s[24:27], s68 offen sc1 lds
    v_mfma_f32_32x32x16_bf16 v[224:239], a[60:63], a[56:59], v[224:239]
    ds_read_b64_tr_b16 a[38:39], v19 offset:17216
    ds_read_b64_tr_b16 a[40:41], v19 offset:16512
    ds_read_b64_tr_b16 a[42:43], v19 offset:17280
    s_waitcnt lgkmcnt(14)
    v_mfma_f32_32x32x16_bf16 v[192:207], a[12:15], a[0:3], v[192:207]
    ds_read_b128 a[60:63], v22 offset:24576
    ds_read_b64_tr_b16 a[48:49], v19 offset:24576
    s_add_u32 m0, s60, 98304
    s_add_u32 s68, s63, 1056768
    buffer_load_dwordx4 v1, s[20:23], s68 offen offset:0 lds
    v_mfma_f32_32x32x16_bf16 v[208:223], a[12:15], a[4:7], v[208:223]
    ds_read_b64_tr_b16 a[50:51], v19 offset:25344
    ds_read_b64_tr_b16 a[52:53], v19 offset:24640
    buffer_load_dwordx4 v2, s[20:23], s68 offen offset:1024 lds
    v_mfma_f32_32x32x16_bf16 v[224:239], a[12:15], a[8:11], v[224:239]
    ds_read_b64_tr_b16 a[54:55], v19 offset:25408
    ds_read_b64_tr_b16 a[56:57], v19 offset:24704
    ds_read_b64_tr_b16 a[58:59], v19 offset:25472
    s_waitcnt lgkmcnt(0)
    s_waitcnt vmcnt(19)
    s_barrier
    v_mfma_f32_32x32x16_bf16 v[192:207], a[28:31], a[16:19], v[192:207]
    ds_read_b128 a[12:15], v20 offset:0
    ds_read_b64_tr_b16 a[0:1], v17 offset:0
    buffer_load_dwordx4 v3, s[20:23], s68 offen offset:2048 lds
    v_mfma_f32_32x32x16_bf16 v[208:223], a[28:31], a[20:23], v[208:223]
    ds_read_b64_tr_b16 a[2:3], v17 offset:768
    ds_read_b64_tr_b16 a[4:5], v17 offset:64
    s_add_u32 m0, s60, 101376
    s_add_u32 s68, s64, 24576
    buffer_load_dwordx4 v31, s[24:27], s68 offen sc1 lds
    v_mfma_f32_32x32x16_bf16 v[224:239], a[28:31], a[24:27], v[224:239]
    ds_read_b64_tr_b16 a[6:7], v17 offset:832
    ds_read_b64_tr_b16 a[8:9], v17 offset:128
    ds_read_b64_tr_b16 a[10:11], v17 offset:896
    v_mfma_f32_32x32x16_bf16 v[192:207], a[44:47], a[32:35], v[192:207]
    ds_read_b128 a[28:31], v20 offset:8192
    ds_read_b64_tr_b16 a[16:17], v17 offset:8192
    s_add_u32 m0, s60, 102400
    s_add_u32 s68, s63, 1058144
    buffer_load_dwordx4 v1, s[20:23], s68 offen offset:0 lds
    v_mfma_f32_32x32x16_bf16 v[208:223], a[44:47], a[36:39], v[208:223]
    ds_read_b64_tr_b16 a[18:19], v17 offset:8960
    ds_read_b64_tr_b16 a[20:21], v17 offset:8256
    buffer_load_dwordx4 v2, s[20:23], s68 offen offset:1024 lds
    v_mfma_f32_32x32x16_bf16 v[224:239], a[44:47], a[40:43], v[224:239]
    ds_read_b64_tr_b16 a[22:23], v17 offset:9024
    ds_read_b64_tr_b16 a[24:25], v17 offset:8320
    ds_read_b64_tr_b16 a[26:27], v17 offset:9088
    v_mfma_f32_32x32x16_bf16 v[192:207], a[60:63], a[48:51], v[192:207]
    ds_read_b128 a[44:47], v20 offset:16384
    ds_read_b64_tr_b16 a[32:33], v17 offset:16384
    buffer_load_dwordx4 v3, s[20:23], s68 offen offset:2048 lds
    v_mfma_f32_32x32x16_bf16 v[208:223], a[60:63], a[52:55], v[208:223]
    ds_read_b64_tr_b16 a[34:35], v17 offset:17152
    ds_read_b64_tr_b16 a[36:37], v17 offset:16448
    s_add_u32 m0, s60, 105472
    s_add_u32 s68, s64, 57344
    buffer_load_dwordx4 v31, s[24:27], s68 offen sc1 lds
    v_mfma_f32_32x32x16_bf16 v[224:239], a[60:63], a[56:59], v[224:239]
    ds_read_b64_tr_b16 a[38:39], v17 offset:17216
    ds_read_b64_tr_b16 a[40:41], v17 offset:16512
    ds_read_b64_tr_b16 a[42:43], v17 offset:17280
    s_waitcnt lgkmcnt(14)
    v_mfma_f32_32x32x16_bf16 v[192:207], a[12:15], a[0:3], v[192:207]
    ds_read_b128 a[60:63], v20 offset:24576
    ds_read_b64_tr_b16 a[48:49], v17 offset:24576
    s_add_u32 m0, s60, 131072
    s_add_u32 s68, s63, 1232896
    buffer_load_dwordx4 v1, s[20:23], s68 offen offset:0 lds
    v_mfma_f32_32x32x16_bf16 v[208:223], a[12:15], a[4:7], v[208:223]
    ds_read_b64_tr_b16 a[50:51], v17 offset:25344
    ds_read_b64_tr_b16 a[52:53], v17 offset:24640
    buffer_load_dwordx4 v2, s[20:23], s68 offen offset:1024 lds
    v_mfma_f32_32x32x16_bf16 v[224:239], a[12:15], a[8:11], v[224:239]
    ds_read_b64_tr_b16 a[54:55], v17 offset:25408
    ds_read_b64_tr_b16 a[56:57], v17 offset:24704
    ds_read_b64_tr_b16 a[58:59], v17 offset:25472
    s_waitcnt lgkmcnt(0)
    s_waitcnt vmcnt(18)
    s_barrier
    v_mfma_f32_32x32x16_bf16 v[192:207], a[28:31], a[16:19], v[192:207]
    ds_read_b128 a[12:15], v20 offset:32768
    ds_read_b64_tr_b16 a[0:1], v17 offset:32768
    buffer_load_dwordx4 v3, s[20:23], s68 offen offset:2048 lds
    v_mfma_f32_32x32x16_bf16 v[208:223], a[28:31], a[20:23], v[208:223]
    ds_read_b64_tr_b16 a[2:3], v17 offset:33536
    ds_read_b64_tr_b16 a[4:5], v17 offset:32832
    s_add_u32 m0, s60, 134144
    s_add_u32 s68, s64, 28672
    buffer_load_dwordx4 v31, s[24:27], s68 offen sc1 lds
    v_mfma_f32_32x32x16_bf16 v[224:239], a[28:31], a[24:27], v[224:239]
    ds_read_b64_tr_b16 a[6:7], v17 offset:33600
    ds_read_b64_tr_b16 a[8:9], v17 offset:32896
    ds_read_b64_tr_b16 a[10:11], v17 offset:33664
    v_mfma_f32_32x32x16_bf16 v[192:207], a[44:47], a[32:35], v[192:207]
    ds_read_b128 a[28:31], v20 offset:40960
    ds_read_b64_tr_b16 a[16:17], v17 offset:40960
    s_add_u32 m0, s60, 135168
    s_add_u32 s68, s63, 1234272
    buffer_load_dwordx4 v1, s[20:23], s68 offen offset:0 lds
    v_mfma_f32_32x32x16_bf16 v[208:223], a[44:47], a[36:39], v[208:223]
    ds_read_b64_tr_b16 a[18:19], v17 offset:41728
    ds_read_b64_tr_b16 a[20:21], v17 offset:41024
    buffer_load_dwordx4 v2, s[20:23], s68 offen offset:1024 lds
    v_mfma_f32_32x32x16_bf16 v[224:239], a[44:47], a[40:43], v[224:239]
    ds_read_b64_tr_b16 a[22:23], v17 offset:41792
    ds_read_b64_tr_b16 a[24:25], v17 offset:41088
    ds_read_b64_tr_b16 a[26:27], v17 offset:41856
    v_mfma_f32_32x32x16_bf16 v[192:207], a[60:63], a[48:51], v[192:207]
    ds_read_b128 a[44:47], v20 offset:49152
    ds_read_b64_tr_b16 a[32:33], v17 offset:49152
    buffer_load_dwordx4 v3, s[20:23], s68 offen offset:2048 lds
    v_mfma_f32_32x32x16_bf16 v[208:223], a[60:63], a[52:55], v[208:223]
    ds_read_b64_tr_b16 a[34:35], v17 offset:49920
    ds_read_b64_tr_b16 a[36:37], v17 offset:49216
    s_add_u32 m0, s60, 138240
    s_add_u32 s68, s64, 61440
    buffer_load_dwordx4 v31, s[24:27], s68 offen sc1 lds
    v_mfma_f32_32x32x16_bf16 v[224:239], a[60:63], a[56:59], v[224:239]
    ds_read_b64_tr_b16 a[38:39], v17 offset:49984
    ds_read_b64_tr_b16 a[40:41], v17 offset:49280
    ds_read_b64_tr_b16 a[42:43], v17 offset:50048
    s_waitcnt lgkmcnt(14)
    v_mfma_f32_32x32x16_bf16 v[192:207], a[12:15], a[0:3], v[192:207]
    ds_read_b128 a[60:63], v20 offset:57344
    ds_read_b64_tr_b16 a[48:49], v17 offset:57344
    v_mfma_f32_32x32x16_bf16 v[208:223], a[12:15], a[4:7], v[208:223]
    ds_read_b64_tr_b16 a[50:51], v17 offset:58112
    ds_read_b64_tr_b16 a[52:53], v17 offset:57408
    v_mfma_f32_32x32x16_bf16 v[224:239], a[12:15], a[8:11], v[224:239]
    ds_read_b64_tr_b16 a[54:55], v17 offset:58176
    ds_read_b64_tr_b16 a[56:57], v17 offset:57472
    ds_read_b64_tr_b16 a[58:59], v17 offset:58240
    s_add_u32 s57, s62, 528384
    v_cvt_pk_bf16_f32 v128, v128, v129
    v_cvt_pk_bf16_f32 v129, v130, v131
    s_waitcnt lgkmcnt(0)
    s_waitcnt vmcnt(16)
    s_barrier
    v_mfma_f32_32x32x16_bf16 v[192:207], a[28:31], a[16:19], v[192:207]
    ds_read_b128 a[12:15], v21 offset:0
    ds_read_b64_tr_b16 a[0:1], v18 offset:0
    v_mfma_f32_32x32x16_bf16 v[208:223], a[28:31], a[20:23], v[208:223]
    ds_read_b64_tr_b16 a[2:3], v18 offset:768
    ds_read_b64_tr_b16 a[4:5], v18 offset:64
    v_mfma_f32_32x32x16_bf16 v[224:239], a[28:31], a[24:27], v[224:239]
    ds_read_b64_tr_b16 a[6:7], v18 offset:832
    ds_read_b64_tr_b16 a[8:9], v18 offset:128
    ds_read_b64_tr_b16 a[10:11], v18 offset:896
    v_cvt_pk_bf16_f32 v130, v132, v133
    v_cvt_pk_bf16_f32 v131, v134, v135
    buffer_store_dwordx4 v[128:131], v31, s[24:27], s57 offen offset:0 sc1
    v_mfma_f32_32x32x16_bf16 v[192:207], a[44:47], a[32:35], v[192:207]
    ds_read_b128 a[28:31], v21 offset:8192
    ds_read_b64_tr_b16 a[16:17], v18 offset:8192
    v_mfma_f32_32x32x16_bf16 v[208:223], a[44:47], a[36:39], v[208:223]
    ds_read_b64_tr_b16 a[18:19], v18 offset:8960
    ds_read_b64_tr_b16 a[20:21], v18 offset:8256
    v_mfma_f32_32x32x16_bf16 v[224:239], a[44:47], a[40:43], v[224:239]
    ds_read_b64_tr_b16 a[22:23], v18 offset:9024
    ds_read_b64_tr_b16 a[24:25], v18 offset:8320
    ds_read_b64_tr_b16 a[26:27], v18 offset:9088
    v_cvt_pk_bf16_f32 v136, v136, v137
    v_cvt_pk_bf16_f32 v137, v138, v139
    v_mfma_f32_32x32x16_bf16 v[192:207], a[60:63], a[48:51], v[192:207]
    ds_read_b128 a[44:47], v21 offset:16384
    ds_read_b64_tr_b16 a[32:33], v18 offset:16384
    v_mfma_f32_32x32x16_bf16 v[208:223], a[60:63], a[52:55], v[208:223]
    ds_read_b64_tr_b16 a[34:35], v18 offset:17152
    ds_read_b64_tr_b16 a[36:37], v18 offset:16448
    v_mfma_f32_32x32x16_bf16 v[224:239], a[60:63], a[56:59], v[224:239]
    ds_read_b64_tr_b16 a[38:39], v18 offset:17216
    ds_read_b64_tr_b16 a[40:41], v18 offset:16512
    ds_read_b64_tr_b16 a[42:43], v18 offset:17280
    v_cvt_pk_bf16_f32 v138, v140, v141
    v_cvt_pk_bf16_f32 v139, v142, v143
    buffer_store_dwordx4 v[136:139], v31, s[24:27], s57 offen offset:1024 sc1
    s_waitcnt lgkmcnt(14)
    v_mfma_f32_32x32x16_bf16 v[192:207], a[12:15], a[0:3], v[192:207]
    ds_read_b128 a[60:63], v21 offset:24576
    ds_read_b64_tr_b16 a[48:49], v18 offset:24576
    v_mfma_f32_32x32x16_bf16 v[208:223], a[12:15], a[4:7], v[208:223]
    ds_read_b64_tr_b16 a[50:51], v18 offset:25344
    ds_read_b64_tr_b16 a[52:53], v18 offset:24640
    v_mfma_f32_32x32x16_bf16 v[224:239], a[12:15], a[8:11], v[224:239]
    ds_read_b64_tr_b16 a[54:55], v18 offset:25408
    ds_read_b64_tr_b16 a[56:57], v18 offset:24704
    ds_read_b64_tr_b16 a[58:59], v18 offset:25472
    v_cvt_pk_bf16_f32 v144, v144, v145
    v_cvt_pk_bf16_f32 v145, v146, v147
    s_waitcnt lgkmcnt(0)
    s_waitcnt vmcnt(10)
    s_barrier
    v_mfma_f32_32x32x16_bf16 v[192:207], a[28:31], a[16:19], v[192:207]
    ds_read_b128 a[12:15], v21 offset:32768
    ds_read_b64_tr_b16 a[0:1], v18 offset:32768
    v_mfma_f32_32x32x16_bf16 v[208:223], a[28:31], a[20:23], v[208:223]
    ds_read_b64_tr_b16 a[2:3], v18 offset:33536
    ds_read_b64_tr_b16 a[4:5], v18 offset:32832
    v_mfma_f32_32x32x16_bf16 v[224:239], a[28:31], a[24:27], v[224:239]
    ds_read_b64_tr_b16 a[6:7], v18 offset:33600
    ds_read_b64_tr_b16 a[8:9], v18 offset:32896
    ds_read_b64_tr_b16 a[10:11], v18 offset:33664
    v_cvt_pk_bf16_f32 v146, v148, v149
    v_cvt_pk_bf16_f32 v147, v150, v151
    buffer_store_dwordx4 v[144:147], v31, s[24:27], s57 offen offset:2048 sc1
    v_mfma_f32_32x32x16_bf16 v[192:207], a[44:47], a[32:35], v[192:207]
    ds_read_b128 a[28:31], v21 offset:40960
    ds_read_b64_tr_b16 a[16:17], v18 offset:40960
    v_mfma_f32_32x32x16_bf16 v[208:223], a[44:47], a[36:39], v[208:223]
    ds_read_b64_tr_b16 a[18:19], v18 offset:41728
    ds_read_b64_tr_b16 a[20:21], v18 offset:41024
    v_mfma_f32_32x32x16_bf16 v[224:239], a[44:47], a[40:43], v[224:239]
    ds_read_b64_tr_b16 a[22:23], v18 offset:41792
    ds_read_b64_tr_b16 a[24:25], v18 offset:41088
    ds_read_b64_tr_b16 a[26:27], v18 offset:41856
    v_cvt_pk_bf16_f32 v152, v152, v153
    v_cvt_pk_bf16_f32 v153, v154, v155
    v_mfma_f32_32x32x16_bf16 v[192:207], a[60:63], a[48:51], v[192:207]
    ds_read_b128 a[44:47], v21 offset:49152
    ds_read_b64_tr_b16 a[32:33], v18 offset:49152
    v_mfma_f32_32x32x16_bf16 v[208:223], a[60:63], a[52:55], v[208:223]
    ds_read_b64_tr_b16 a[34:35], v18 offset:49920
    ds_read_b64_tr_b16 a[36:37], v18 offset:49216
    v_mfma_f32_32x32x16_bf16 v[224:239], a[60:63], a[56:59], v[224:239]
    ds_read_b64_tr_b16 a[38:39], v18 offset:49984
    ds_read_b64_tr_b16 a[40:41], v18 offset:49280
    ds_read_b64_tr_b16 a[42:43], v18 offset:50048
    v_cvt_pk_bf16_f32 v154, v156, v157
    v_cvt_pk_bf16_f32 v155, v158, v159
    buffer_store_dwordx4 v[152:155], v31, s[24:27], s57 offen offset:3072 sc1
    s_waitcnt lgkmcnt(14)
    v_mfma_f32_32x32x16_bf16 v[192:207], a[12:15], a[0:3], v[192:207]
    ds_read_b128 a[60:63], v21 offset:57344
    ds_read_b64_tr_b16 a[48:49], v18 offset:57344
    v_mfma_f32_32x32x16_bf16 v[208:223], a[12:15], a[4:7], v[208:223]
    ds_read_b64_tr_b16 a[50:51], v18 offset:58112
    ds_read_b64_tr_b16 a[52:53], v18 offset:57408
    v_mfma_f32_32x32x16_bf16 v[224:239], a[12:15], a[8:11], v[224:239]
    ds_read_b64_tr_b16 a[54:55], v18 offset:58176
    ds_read_b64_tr_b16 a[56:57], v18 offset:57472
    ds_read_b64_tr_b16 a[58:59], v18 offset:58240
    s_add_u32 s57, s62, 536576
    v_cvt_pk_bf16_f32 v160, v160, v161
    v_cvt_pk_bf16_f32 v161, v162, v163
    s_waitcnt lgkmcnt(0)
    s_waitcnt vmcnt(4)
    s_barrier
    v_mfma_f32_32x32x16_bf16 v[192:207], a[28:31], a[16:19], v[192:207]
    ds_read_b128 a[12:15], v22 offset:0
    ds_read_b64_tr_b16 a[0:1], v19 offset:0
    v_mfma_f32_32x32x16_bf16 v[208:223], a[28:31], a[20:23], v[208:223]
    ds_read_b64_tr_b16 a[2:3], v19 offset:768
    ds_read_b64_tr_b16 a[4:5], v19 offset:64
    v_mfma_f32_32x32x16_bf16 v[224:239], a[28:31], a[24:27], v[224:239]
    ds_read_b64_tr_b16 a[6:7], v19 offset:832
    ds_read_b64_tr_b16 a[8:9], v19 offset:128
    ds_read_b64_tr_b16 a[10:11], v19 offset:896
    v_cvt_pk_bf16_f32 v162, v164, v165
    v_cvt_pk_bf16_f32 v163, v166, v167
    buffer_store_dwordx4 v[160:163], v31, s[24:27], s57 offen offset:0 sc1
    v_mfma_f32_32x32x16_bf16 v[192:207], a[44:47], a[32:35], v[192:207]
    ds_read_b128 a[28:31], v22 offset:8192
    ds_read_b64_tr_b16 a[16:17], v19 offset:8192
    v_mfma_f32_32x32x16_bf16 v[208:223], a[44:47], a[36:39], v[208:223]
    ds_read_b64_tr_b16 a[18:19], v19 offset:8960
    ds_read_b64_tr_b16 a[20:21], v19 offset:8256
    v_mfma_f32_32x32x16_bf16 v[224:239], a[44:47], a[40:43], v[224:239]
    ds_read_b64_tr_b16 a[22:23], v19 offset:9024
    ds_read_b64_tr_b16 a[24:25], v19 offset:8320
    ds_read_b64_tr_b16 a[26:27], v19 offset:9088
    v_cvt_pk_bf16_f32 v168, v168, v169
    v_cvt_pk_bf16_f32 v169, v170, v171
    v_mfma_f32_32x32x16_bf16 v[192:207], a[60:63], a[48:51], v[192:207]
    ds_read_b128 a[44:47], v22 offset:16384
    ds_read_b64_tr_b16 a[32:33], v19 offset:16384
    v_mfma_f32_32x32x16_bf16 v[208:223], a[60:63], a[52:55], v[208:223]
    ds_read_b64_tr_b16 a[34:35], v19 offset:17152
    ds_read_b64_tr_b16 a[36:37], v19 offset:16448
    v_mfma_f32_32x32x16_bf16 v[224:239], a[60:63], a[56:59], v[224:239]
    ds_read_b64_tr_b16 a[38:39], v19 offset:17216
    ds_read_b64_tr_b16 a[40:41], v19 offset:16512
    ds_read_b64_tr_b16 a[42:43], v19 offset:17280
    v_cvt_pk_bf16_f32 v170, v172, v173
    v_cvt_pk_bf16_f32 v171, v174, v175
    buffer_store_dwordx4 v[168:171], v31, s[24:27], s57 offen offset:1024 sc1
    s_waitcnt lgkmcnt(14)
    v_mfma_f32_32x32x16_bf16 v[192:207], a[12:15], a[0:3], v[192:207]
    ds_read_b128 a[60:63], v22 offset:24576
    ds_read_b64_tr_b16 a[48:49], v19 offset:24576
    v_mfma_f32_32x32x16_bf16 v[208:223], a[12:15], a[4:7], v[208:223]
    ds_read_b64_tr_b16 a[50:51], v19 offset:25344
    ds_read_b64_tr_b16 a[52:53], v19 offset:24640
    v_mfma_f32_32x32x16_bf16 v[224:239], a[12:15], a[8:11], v[224:239]
    ds_read_b64_tr_b16 a[54:55], v19 offset:25408
    ds_read_b64_tr_b16 a[56:57], v19 offset:24704
    ds_read_b64_tr_b16 a[58:59], v19 offset:25472
    v_cvt_pk_bf16_f32 v176, v176, v177
    v_cvt_pk_bf16_f32 v177, v178, v179
    s_waitcnt lgkmcnt(14)
    v_mfma_f32_32x32x16_bf16 v[192:207], a[28:31], a[16:19], v[192:207]
    v_mfma_f32_32x32x16_bf16 v[208:223], a[28:31], a[20:23], v[208:223]
    v_mfma_f32_32x32x16_bf16 v[224:239], a[28:31], a[24:27], v[224:239]
    v_cvt_pk_bf16_f32 v178, v180, v181
    v_cvt_pk_bf16_f32 v179, v182, v183
    buffer_store_dwordx4 v[176:179], v31, s[24:27], s57 offen offset:2048 sc1
    s_waitcnt lgkmcnt(7)
    v_mfma_f32_32x32x16_bf16 v[192:207], a[44:47], a[32:35], v[192:207]
    v_mfma_f32_32x32x16_bf16 v[208:223], a[44:47], a[36:39], v[208:223]
    v_mfma_f32_32x32x16_bf16 v[224:239], a[44:47], a[40:43], v[224:239]
    v_cvt_pk_bf16_f32 v184, v184, v185
    v_cvt_pk_bf16_f32 v185, v186, v187
    s_waitcnt lgkmcnt(0)
    v_mfma_f32_32x32x16_bf16 v[192:207], a[60:63], a[48:51], v[192:207]
    v_mfma_f32_32x32x16_bf16 v[208:223], a[60:63], a[52:55], v[208:223]
    v_mfma_f32_32x32x16_bf16 v[224:239], a[60:63], a[56:59], v[224:239]
    v_cvt_pk_bf16_f32 v186, v188, v189
    v_cvt_pk_bf16_f32 v187, v190, v191
    buffer_store_dwordx4 v[184:187], v31, s[24:27], s57 offen offset:3072 sc1
    s_mul_i32 s56, s34, 384
    s_lshl_b32 s57, s33, 2
    s_add_u32 s56, s56, s57
    s_lshl_b32 s57, s37, 1
    s_add_u32 s56, s56, s57
    s_lshl_b32 s56, s56, 10
    s_add_u32 s96, s56, 67108864
    s_lshl_b32 s56, s33, 1
    s_add_u32 s56, s56, s37
    s_lshl_b32 s56, s56, 11
    s_add_u32 s56, s56, 41943040
    s_lshl_b32 s57, s34, 8
    s_add_u32 s97, s56, s57
K1_ZJOIN:
    s_mov_b64 exec, -1
    s_load_dwordx2 s[64:65], s[0:1], 16
    s_load_dwordx4 s[72:75], s[0:1], 96
    s_load_dwordx4 s[68:71], s[0:1], 64
    s_and_b32 s33, s2, 7
    s_lshl_b32 s33, s33, 2
    s_lshr_b32 s37, s2, 3
    s_lshr_b32 s34, s37, 2
    s_and_b32 s37, s37, 3
    s_add_u32 s33, s33, s37
    s_and_b32 s36, s32, 1
    s_lshr_b32 s35, s32, 1
    s_lshl_b32 s59, s32, 13
    v_lshlrev_b32 v1, 4, v0
    v_and_b32 v20, 31, v0
    v_lshrrev_b32 v21, 5, v0
    v_lshrrev_b32 v22, 4, v0
    v_bfe_u32 v23, v0, 2, 2
    v_and_b32 v24, 3, v0
    v_bfe_u32 v25, v0, 4, 1
    v_xor_b32 v26, v23, v22
    v_lshlrev_b32 v27, 13, v22
    v_lshl_add_u32 v27, v26, 6, v27
    v_lshl_add_u32 v27, v24, 4, v27
    v_add_u32 v32, 0, v27
    v_add_u32 v33, 31744, v27
    v_add_u32 v34, 63488, v27
    v_add_u32 v35, 95232, v27
    s_sub_u32 s37, 15, s34
    s_cmp_eq_u32 s35, 0
    s_cselect_b32 s37, s37, s34
    s_lshl_b32 s44, s37, 1
    s_add_u32 s44, s44, s36
    s_lshl_b32 s55, s44, 16
    s_add_u32 s55, s55, 0
    s_lshl_b32 s56, s32, 17
    s_lshl_b32 s37, s33, 8
    s_add_u32 s56, s56, s37
    s_lshl_b32 s57, s32, 12
    s_waitcnt lgkmcnt(0)
    s_mov_b32 s8, s64
    s_mov_b32 s9, s65
    s_mov_b32 s10, 0x400000
    s_mov_b32 s11, 0x20000
    s_mov_b32 s20, s74
    s_mov_b32 s21, s75
    s_mov_b32 s22, 0x10000000
    s_mov_b32 s23, 0x20000
    s_mov_b32 s12, s68
    s_mov_b32 s13, s69
    s_mov_b32 s14, 0x800000
    s_mov_b32 s15, 0x20000
    s_mov_b32 s16, s70
    s_mov_b32 s17, s71
    s_mov_b32 s18, 0x1000
    s_mov_b32 s19, 0x20000
    s_mov_b32 s24, s68
    s_mov_b32 s25, s69
    s_mov_b32 s26, 0x800000
    s_mov_b32 s27, 0x20000
    v_lshl_add_u32 v26, v21, 3, v23
    v_lshlrev_b32 v26, 8, v26
    v_lshl_add_u32 v26, v25, 5, v26
    v_lshl_add_u32 v26, v24, 3, v26
    v_xor_b32 v27, 0, v23
    v_lshl_add_u32 v36, v27, 6, v26
    v_add_u32 v40, 0x10000, v36
    v_xor_b32 v27, 1, v23
    v_lshl_add_u32 v37, v27, 6, v26
    v_add_u32 v41, 0x10000, v37
    v_xor_b32 v27, 2, v23
    v_lshl_add_u32 v38, v27, 6, v26
    v_add_u32 v42, 0x10000, v38
    v_xor_b32 v27, 3, v23
    v_lshl_add_u32 v39, v27, 6, v26
    v_add_u32 v43, 0x10000, v39
    v_mov_b32 v2, v1
    v_add_u32 v3, 32768, v2
    v_add_u32 v5, 65536, v2
    v_mov_b32 v4, v5
    v_lshlrev_b32 v26, 2, v21
    v_sub_u32 v6, v20, v26
    v_mov_b32 v7, 0xf149f2ca
    s_lshl_b32 s45, s33, 19
    s_lshl_b32 s37, s36, 13
    s_add_u32 s45, s45, s37
    s_add_u32 s45, s45, 2097152
    s_lshl_b32 s37, s34, 1
    s_add_u32 s37, s37, 2
    s_sub_u32 s38, 18, s37
    s_lshl_b32 s38, s38, 14
    s_sub_u32 s38, s38, 0x20000000
    s_sub_u32 s41, s37, 2
    s_lshl_b32 s39, s35, 29
    s_add_u32 s45, s45, s39
    s_cmp_eq_u32 s35, 0
    s_cselect_b32 s40, 8, s37
    s_cselect_b32 s42, 0x20000000, s38
    s_cselect_b32 s41, 15, s41
    s_lshl_b32 s63, s34, 8
    s_add_u32 s63, s63, 42532864
    s_lshl_b32 s76, s2, 2
    s_add_u32 s76, s76, s32
    s_lshl_b32 s76, s76, 10
    s_mov_b32 s30, 0x100000
    s_load_dwordx2 s[28:29], s[0:1], 40
    s_load_dwordx2 s[100:101], s[0:1], 80
    s_waitcnt lgkmcnt(0)
    s_getpc_b64 s[64:65]
L_PC2:
    s_add_u32 s64, s64, K2_LOOP-L_PC2
    s_addc_u32 s65, s65, 0
    s_mov_b32 s66, L_CODE_END-K2_LOOP
    s_mov_b32 s67, 0x20000
    s_lshr_b32 s68, s2, 3
    s_lshl_b32 s68, s68, 2
    s_add_u32 s68, s68, s32
    s_lshl_b32 s68, s68, 10
    s_add_u32 m0, s57, 0
    s_add_u32 s58, s56, 0
    buffer_load_dwordx4 v32, s[8:11], s58 offen offset:0 lds
    buffer_load_dwordx4 v33, s[8:11], s58 offen offset:1024 lds
    buffer_load_dwordx4 v34, s[8:11], s58 offen offset:2048 lds
    buffer_load_dwordx4 v35, s[8:11], s58 offen offset:3072 lds
    s_add_u32 s58, s55, 0
    buffer_load_dwordx4 a[0:3], v1, s[20:23], s58 offen offset:0 sc1
    buffer_load_dwordx4 a[4:7], v1, s[20:23], s58 offen offset:1024 sc1
    buffer_load_dwordx4 a[8:11], v1, s[20:23], s58 offen offset:2048 sc1
    buffer_load_dwordx4 a[12:15], v1, s[20:23], s58 offen offset:3072 sc1
    s_add_u32 s58, s55, 32768
    buffer_load_dwordx4 a[16:19], v1, s[20:23], s58 offen offset:0 sc1
    buffer_load_dwordx4 a[20:23], v1, s[20:23], s58 offen offset:1024 sc1
    buffer_load_dwordx4 a[24:27], v1, s[20:23], s58 offen offset:2048 sc1
    buffer_load_dwordx4 a[28:31], v1, s[20:23], s58 offen offset:3072 sc1
    s_add_u32 m0, s57, 16384
    s_add_u32 s58, s56, 524288
    buffer_load_dwordx4 v32, s[8:11], s58 offen offset:0 lds
    buffer_load_dwordx4 v33, s[8:11], s58 offen offset:1024 lds
    buffer_load_dwordx4 v34, s[8:11], s58 offen offset:2048 lds
    buffer_load_dwordx4 v35, s[8:11], s58 offen offset:3072 lds
    s_add_u32 s58, s55, 4096
    buffer_load_dwordx4 a[32:35], v1, s[20:23], s58 offen offset:0 sc1
    buffer_load_dwordx4 a[36:39], v1, s[20:23], s58 offen offset:1024 sc1
    buffer_load_dwordx4 a[40:43], v1, s[20:23], s58 offen offset:2048 sc1
    buffer_load_dwordx4 a[44:47], v1, s[20:23], s58 offen offset:3072 sc1
    s_add_u32 s58, s55, 36864
    buffer_load_dwordx4 a[48:51], v1, s[20:23], s58 offen offset:0 sc1
    buffer_load_dwordx4 a[52:55], v1, s[20:23], s58 offen offset:1024 sc1
    buffer_load_dwordx4 a[56:59], v1, s[20:23], s58 offen offset:2048 sc1
    buffer_load_dwordx4 a[60:63], v1, s[20:23], s58 offen offset:3072 sc1
    s_waitcnt vmcnt(20)
    s_barrier
    ds_read_b64_tr_b16 a[192:193], v36 offset:0
    ds_read_b64_tr_b16 a[194:195], v36 offset:1024
    ds_read_b64_tr_b16 a[196:197], v37 offset:0
    ds_read_b64_tr_b16 a[198:199], v37 offset:1024
    ds_read_b64_tr_b16 a[200:201], v38 offset:0
    ds_read_b64_tr_b16 a[202:203], v38 offset:1024
    ds_read_b64_tr_b16 a[204:205], v39 offset:0
    ds_read_b64_tr_b16 a[206:207], v39 offset:1024
    ds_read_b64_tr_b16 a[208:209], v36 offset:4096
    ds_read_b64_tr_b16 a[210:211], v36 offset:5120
    ds_read_b64_tr_b16 a[212:213], v37 offset:4096
    ds_read_b64_tr_b16 a[214:215], v37 offset:5120
    ds_read_b64_tr_b16 a[216:217], v38 offset:4096
    ds_read_b64_tr_b16 a[218:219], v38 offset:5120
    ds_read_b64_tr_b16 a[220:221], v39 offset:4096
    ds_read_b64_tr_b16 a[222:223], v39 offset:5120
    s_cmp_eq_u32 s35, 1
    s_cbranch_scc1 K2_QP1
    s_waitcnt lgkmcnt(8)
    s_waitcnt vmcnt(12)
    v_mfma_f32_32x32x16_bf16 v[48:63], a[192:195], a[0:3], 0
    ds_read_b64_tr_b16 a[224:225], v36 offset:8192
    s_add_u32 m0, s57, 32768
    s_add_u32 s58, s56, 1048576
    buffer_load_dwordx4 v32, s[8:11], s58 offen offset:0 lds
    v_mov_b32 v180, 0xc0135761
    v_mov_b32 v181, 0xbdd2d3e8
    v_mfma_f32_32x32x16_bf16 v[112:127], a[192:195], a[16:19], 0
    ds_read_b64_tr_b16 a[226:227], v36 offset:9216
    v_mul_f32 v176, v192, v192
    v_mul_f32 v177, v193, v193
    v_mfma_f32_32x32x16_bf16 v[64:79], a[196:199], a[0:3], 0
    ds_read_b64_tr_b16 a[228:229], v37 offset:8192
    buffer_load_dwordx4 v33, s[8:11], s58 offen offset:1024 lds
    v_mul_f32 v178, v194, v194
    v_mul_f32 v179, v195, v195
    v_mfma_f32_32x32x16_bf16 v[128:143], a[196:199], a[16:19], 0
    ds_read_b64_tr_b16 a[230:231], v37 offset:9216
    v_fma_f32 v176, v176, v181, v180
    v_fma_f32 v177, v177, v181, v180
    v_mfma_f32_32x32x16_bf16 v[80:95], a[200:203], a[0:3], 0
    ds_read_b64_tr_b16 a[232:233], v38 offset:8192
    buffer_load_dwordx4 v34, s[8:11], s58 offen offset:2048 lds
    v_fma_f32 v178, v178, v181, v180
    v_fma_f32 v179, v179, v181, v180
    v_mfma_f32_32x32x16_bf16 v[144:159], a[200:203], a[16:19], 0
    ds_read_b64_tr_b16 a[234:235], v38 offset:9216
    v_mul_f32 v176, v176, v192
    v_mul_f32 v177, v177, v193
    v_mfma_f32_32x32x16_bf16 v[96:111], a[204:207], a[0:3], 0
    ds_read_b64_tr_b16 a[236:237], v39 offset:8192
    buffer_load_dwordx4 v35, s[8:11], s58 offen offset:3072 lds
    v_mul_f32 v178, v178, v194
    v_mul_f32 v179, v179, v195
    v_mfma_f32_32x32x16_bf16 v[160:175], a[204:207], a[16:19], 0
    ds_read_b64_tr_b16 a[238:239], v39 offset:9216
    v_exp_f32 v176, v176
    v_exp_f32 v177, v177
    s_waitcnt lgkmcnt(8)
    v_mfma_f32_32x32x16_bf16 v[48:63], a[208:211], a[4:7], v[48:63]
    ds_read_b64_tr_b16 a[240:241], v36 offset:12288
    s_add_u32 s58, s55, 8192
    buffer_load_dwordx4 a[64:67], v1, s[20:23], s58 offen offset:0 sc1
    v_exp_f32 v178, v178
    v_exp_f32 v179, v179
    v_mfma_f32_32x32x16_bf16 v[112:127], a[208:211], a[20:23], v[112:127]
    ds_read_b64_tr_b16 a[242:243], v36 offset:13312
    v_add_f32 v176, 1.0, v176
    v_add_f32 v177, 1.0, v177
    v_mfma_f32_32x32x16_bf16 v[64:79], a[212:215], a[4:7], v[64:79]
    ds_read_b64_tr_b16 a[244:245], v37 offset:12288
    buffer_load_dwordx4 a[68:71], v1, s[20:23], s58 offen offset:1024 sc1
    v_add_f32 v178, 1.0, v178
    v_add_f32 v179, 1.0, v179
    v_mfma_f32_32x32x16_bf16 v[128:143], a[212:215], a[20:23], v[128:143]
    ds_read_b64_tr_b16 a[246:247], v37 offset:13312
    v_rcp_f32 v176, v176
    v_rcp_f32 v177, v177
    v_mfma_f32_32x32x16_bf16 v[80:95], a[216:219], a[4:7], v[80:95]
    ds_read_b64_tr_b16 a[248:249], v38 offset:12288
    buffer_load_dwordx4 a[72:75], v1, s[20:23], s58 offen offset:2048 sc1
    v_rcp_f32 v178, v178
    v_rcp_f32 v179, v179
    v_mfma_f32_32x32x16_bf16 v[144:159], a[216:219], a[20:23], v[144:159]
    ds_read_b64_tr_b16 a[250:251], v38 offset:13312
    v_mul_f32 v192, v192, v176
    v_mul_f32 v193, v193, v177
    v_mfma_f32_32x32x16_bf16 v[96:111], a[220:223], a[4:7], v[96:111]
    ds_read_b64_tr_b16 a[252:253], v39 offset:12288
    buffer_load_dwordx4 a[76:79], v1, s[20:23], s58 offen offset:3072 sc1
    v_mul_f32 v194, v194, v178
    v_mul_f32 v195, v195, v179
    v_mfma_f32_32x32x16_bf16 v[160:175], a[220:223], a[20:23], v[160:175]
    ds_read_b64_tr_b16 a[254:255], v39 offset:13312
    v_mul_f32 v176, v196, v196
    v_mul_f32 v177, v197, v197
    s_waitcnt lgkmcnt(0)
    s_waitcnt vmcnt(16)
    s_barrier
    s_lshl_b32 s37, s2, 4
    s_add_u32 s37, s37, 42614784
    s_cmp_lg_u32 s32, 0
    s_cbranch_scc1 L_W0_13
    v_mov_b32 v246, 1
    v_mov_b32 v247, 0
    s_mov_b64 exec, 1
    buffer_store_byte v246, v247, s[20:23], s37 offen sc0 sc1
    s_mov_b64 exec, -1
L_W0_13:
    v_mfma_f32_32x32x16_bf16 v[48:63], a[224:227], a[8:11], v[48:63]
    ds_read_b64_tr_b16 a[192:193], v36 offset:16384
    s_add_u32 s58, s55, 40960
    buffer_load_dwordx4 a[80:83], v1, s[20:23], s58 offen offset:0 sc1
    v_mul_f32 v178, v198, v198
    v_mul_f32 v179, v199, v199
    v_mfma_f32_32x32x16_bf16 v[112:127], a[224:227], a[24:27], v[112:127]
    ds_read_b64_tr_b16 a[194:195], v36 offset:17408
    v_fma_f32 v176, v176, v181, v180
    v_fma_f32 v177, v177, v181, v180
    v_mfma_f32_32x32x16_bf16 v[64:79], a[228:231], a[8:11], v[64:79]
    ds_read_b64_tr_b16 a[196:197], v37 offset:16384
    buffer_load_dwordx4 a[84:87], v1, s[20:23], s58 offen offset:1024 sc1
    v_fma_f32 v178, v178, v181, v180
    v_fma_f32 v179, v179, v181, v180
    v_mfma_f32_32x32x16_bf16 v[128:143], a[228:231], a[24:27], v[128:143]
    ds_read_b64_tr_b16 a[198:199], v37 offset:17408
    v_mul_f32 v176, v176, v196
    v_mul_f32 v177, v177, v197
    v_mfma_f32_32x32x16_bf16 v[80:95], a[232:235], a[8:11], v[80:95]
    ds_read_b64_tr_b16 a[200:201], v38 offset:16384
    buffer_load_dwordx4 a[88:91], v1, s[20:23], s58 offen offset:2048 sc1
    v_mul_f32 v178, v178, v198
    v_mul_f32 v179, v179, v199
    v_mfma_f32_32x32x16_bf16 v[144:159], a[232:235], a[24:27], v[144:159]
    ds_read_b64_tr_b16 a[202:203], v38 offset:17408
    v_exp_f32 v176, v176
    v_exp_f32 v177, v177
    v_mfma_f32_32x32x16_bf16 v[96:111], a[236:239], a[8:11], v[96:111]
    ds_read_b64_tr_b16 a[204:205], v39 offset:16384
    buffer_load_dwordx4 a[92:95], v1, s[20:23], s58 offen offset:3072 sc1
    v_exp_f32 v178, v178
    v_exp_f32 v179, v179
    v_mfma_f32_32x32x16_bf16 v[160:175], a[236:239], a[24:27], v[160:175]
    ds_read_b64_tr_b16 a[206:207], v39 offset:17408
    v_add_f32 v176, 1.0, v176
    v_add_f32 v177, 1.0, v177
    v_mfma_f32_32x32x16_bf16 v[48:63], a[240:243], a[12:15], v[48:63]
    ds_read_b64_tr_b16 a[208:209], v36 offset:20480
    s_add_u32 m0, s57, 49152
    s_add_u32 s58, s56, 1572864
    buffer_load_dwordx4 v32, s[8:11], s58 offen offset:0 lds
    v_add_f32 v178, 1.0, v178
    v_add_f32 v179, 1.0, v179
    v_mfma_f32_32x32x16_bf16 v[112:127], a[240:243], a[28:31], v[112:127]
    ds_read_b64_tr_b16 a[210:211], v36 offset:21504
    v_rcp_f32 v176, v176
    v_rcp_f32 v177, v177
    v_mfma_f32_32x32x16_bf16 v[64:79], a[244:247], a[12:15], v[64:79]
    ds_read_b64_tr_b16 a[212:213], v37 offset:20480
    buffer_load_dwordx4 v33, s[8:11], s58 offen offset:1024 lds
    v_rcp_f32 v178, v178
    v_rcp_f32 v179, v179
    v_mfma_f32_32x32x16_bf16 v[128:143], a[244:247], a[28:31], v[128:143]
    ds_read_b64_tr_b16 a[214:215], v37 offset:21504
    v_mul_f32 v196, v196, v176
    v_mul_f32 v197, v197, v177
    v_mfma_f32_32x32x16_bf16 v[80:95], a[248:251], a[12:15], v[80:95]
    ds_read_b64_tr_b16 a[216:217], v38 offset:20480
    buffer_load_dwordx4 v34, s[8:11], s58 offen offset:2048 lds
    v_mul_f32 v198, v198, v178
    v_mul_f32 v199, v199, v179
    v_mfma_f32_32x32x16_bf16 v[144:159], a[248:251], a[28:31], v[144:159]
    ds_read_b64_tr_b16 a[218:219], v38 offset:21504
    v_cvt_pk_bf16_f32 v192, v192, v193
    v_cvt_pk_bf16_f32 v193, v194, v195
    v_mfma_f32_32x32x16_bf16 v[96:111], a[252:255], a[12:15], v[96:111]
    ds_read_b64_tr_b16 a[220:221], v39 offset:20480
    buffer_load_dwordx4 v35, s[8:11], s58 offen offset:3072 lds
    v_cvt_pk_bf16_f32 v194, v196, v197
    v_cvt_pk_bf16_f32 v195, v198, v199
    v_mfma_f32_32x32x16_bf16 v[160:175], a[252:255], a[28:31], v[160:175]
    ds_read_b64_tr_b16 a[222:223], v39 offset:21504
    buffer_store_dwordx4 v[192:195], v1, s[20:23], s96 offen offset:0 sc1
    v_mul_f32 v176, v200, v200
    s_waitcnt lgkmcnt(8)
    s_waitcnt vmcnt(17)
    v_mfma_f32_32x32x16_bf16 v[48:63], a[192:195], a[32:35], v[48:63]
    ds_read_b64_tr_b16 a[224:225], v36 offset:24576
    s_add_u32 s58, s55, 12288
    buffer_load_dwordx4 a[96:99], v1, s[20:23], s58 offen offset:0 sc1
    v_mul_f32 v177, v201, v201
    v_mul_f32 v178, v202, v202
    v_mfma_f32_32x32x16_bf16 v[112:127], a[192:195], a[48:51], v[112:127]
    ds_read_b64_tr_b16 a[226:227], v36 offset:25600
    v_mul_f32 v179, v203, v203
    v_fma_f32 v176, v176, v181, v180
    v_mfma_f32_32x32x16_bf16 v[64:79], a[196:199], a[32:35], v[64:79]
    ds_read_b64_tr_b16 a[228:229], v37 offset:24576
    buffer_load_dwordx4 a[100:103], v1, s[20:23], s58 offen offset:1024 sc1
    v_fma_f32 v177, v177, v181, v180
    v_fma_f32 v178, v178, v181, v180
    v_mfma_f32_32x32x16_bf16 v[128:143], a[196:199], a[48:51], v[128:143]
    ds_read_b64_tr_b16 a[230:231], v37 offset:25600
    v_fma_f32 v179, v179, v181, v180
    v_mul_f32 v176, v176, v200
    v_mfma_f32_32x32x16_bf16 v[80:95], a[200:203], a[32:35], v[80:95]
    ds_read_b64_tr_b16 a[232:233], v38 offset:24576
    buffer_load_dwordx4 a[104:107], v1, s[20:23], s58 offen offset:2048 sc1
    v_mul_f32 v177, v177, v201
    v_mul_f32 v178, v178, v202
    v_mfma_f32_32x32x16_bf16 v[144:159], a[200:203], a[48:51], v[144:159]
    ds_read_b64_tr_b16 a[234:235], v38 offset:25600
    v_mul_f32 v179, v179, v203
    v_exp_f32 v176, v176
    v_mfma_f32_32x32x16_bf16 v[96:111], a[204:207], a[32:35], v[96:111]
    ds_read_b64_tr_b16 a[236:237], v39 offset:24576
    buffer_load_dwordx4 a[108:111], v1, s[20:23], s58 offen offset:3072 sc1
    v_exp_f32 v177, v177
    v_exp_f32 v178, v178
    v_mfma_f32_32x32x16_bf16 v[160:175], a[204:207], a[48:51], v[160:175]
    ds_read_b64_tr_b16 a[238:239], v39 offset:25600
    v_exp_f32 v179, v179
    v_add_f32 v176, 1.0, v176
    s_waitcnt lgkmcnt(8)
    v_mfma_f32_32x32x16_bf16 v[48:63], a[208:211], a[36:39], v[48:63]
    ds_read_b64_tr_b16 a[240:241], v36 offset:28672
    s_add_u32 s58, s55, 45056
    buffer_load_dwordx4 a[112:115], v1, s[20:23], s58 offen offset:0 sc1
    v_add_f32 v177, 1.0, v177
    v_add_f32 v178, 1.0, v178
    v_mfma_f32_32x32x16_bf16 v[112:127], a[208:211], a[52:55], v[112:127]
    ds_read_b64_tr_b16 a[242:243], v36 offset:29696
    v_add_f32 v179, 1.0, v179
    v_rcp_f32 v176, v176
    v_mfma_f32_32x32x16_bf16 v[64:79], a[212:215], a[36:39], v[64:79]
    ds_read_b64_tr_b16 a[244:245], v37 offset:28672
    buffer_load_dwordx4 a[116:119], v1, s[20:23], s58 offen offset:1024 sc1
    v_rcp_f32 v177, v177
    v_rcp_f32 v178, v178
    v_mfma_f32_32x32x16_bf16 v[128:143], a[212:215], a[52:55], v[128:143]
    ds_read_b64_tr_b16 a[246:247], v37 offset:29696
    v_rcp_f32 v179, v179
    v_mul_f32 v200, v200, v176
    v_mfma_f32_32x32x16_bf16 v[80:95], a[216:219], a[36:39], v[80:95]
    ds_read_b64_tr_b16 a[248:249], v38 offset:28672
    buffer_load_dwordx4 a[120:123], v1, s[20:23], s58 offen offset:2048 sc1
    v_mul_f32 v201, v201, v177
    v_mul_f32 v202, v202, v178
    v_mfma_f32_32x32x16_bf16 v[144:159], a[216:219], a[52:55], v[144:159]
    ds_read_b64_tr_b16 a[250:251], v38 offset:29696
    v_mul_f32 v203, v203, v179
    v_mul_f32 v176, v204, v204
    v_mfma_f32_32x32x16_bf16 v[96:111], a[220:223], a[36:39], v[96:111]
    ds_read_b64_tr_b16 a[252:253], v39 offset:28672
    buffer_load_dwordx4 a[124:127], v1, s[20:23], s58 offen offset:3072 sc1
    v_mul_f32 v177, v205, v205
    v_mul_f32 v178, v206, v206
    v_mfma_f32_32x32x16_bf16 v[160:175], a[220:223], a[52:55], v[160:175]
    ds_read_b64_tr_b16 a[254:255], v39 offset:29696
    v_mul_f32 v179, v207, v207
    v_fma_f32 v176, v176, v181, v180
    s_waitcnt lgkmcnt(0)
    s_waitcnt vmcnt(21)
    s_barrier
    v_mfma_f32_32x32x16_bf16 v[48:63], a[224:227], a[40:43], v[48:63]
    ds_read_b64_tr_b16 a[192:193], v36 offset:32768
    s_add_u32 m0, s57, 65536
    s_add_u32 s58, s56, 2097152
    buffer_load_dwordx4 v32, s[8:11], s58 offen offset:0 lds
    v_fma_f32 v177, v177, v181, v180
    v_fma_f32 v178, v178, v181, v180
    v_mfma_f32_32x32x16_bf16 v[112:127], a[224:227], a[56:59], v[112:127]
    ds_read_b64_tr_b16 a[194:195], v36 offset:33792
    v_fma_f32 v179, v179, v181, v180
    v_mul_f32 v176, v176, v204
    v_mfma_f32_32x32x16_bf16 v[64:79], a[228:231], a[40:43], v[64:79]
    ds_read_b64_tr_b16 a[196:197], v37 offset:32768
    buffer_load_dwordx4 v33, s[8:11], s58 offen offset:1024 lds
    v_mul_f32 v177, v177, v205
    v_mul_f32 v178, v178, v206
    v_mfma_f32_32x32x16_bf16 v[128:143], a[228:231], a[56:59], v[128:143]
    ds_read_b64_tr_b16 a[198:199], v37 offset:33792
    v_mul_f32 v179, v179, v207
    v_exp_f32 v176, v176
    v_mfma_f32_32x32x16_bf16 v[80:95], a[232:235], a[40:43], v[80:95]
    ds_read_b64_tr_b16 a[200:201], v38 offset:32768
    buffer_load_dwordx4 v34, s[8:11], s58 offen offset:2048 lds
    v_exp_f32 v177, v177
    v_exp_f32 v178, v178
    v_mfma_f32_32x32x16_bf16 v[144:159], a[232:235], a[56:59], v[144:159]
    ds_read_b64_tr_b16 a[202:203], v38 offset:33792
    v_exp_f32 v179, v179
    v_add_f32 v176, 1.0, v176
    v_mfma_f32_32x32x16_bf16 v[96:111], a[236:239], a[40:43], v[96:111]
    ds_read_b64_tr_b16 a[204:205], v39 offset:32768
    buffer_load_dwordx4 v35, s[8:11], s58 offen offset:3072 lds
    v_add_f32 v177, 1.0, v177
    v_add_f32 v178, 1.0, v178
    v_mfma_f32_32x32x16_bf16 v[160:175], a[236:239], a[56:59], v[160:175]
    ds_read_b64_tr_b16 a[206:207], v39 offset:33792
    v_add_f32 v179, 1.0, v179
    v_rcp_f32 v176, v176
    v_mfma_f32_32x32x16_bf16 v[48:63], a[240:243], a[44:47], v[48:63]
    ds_read_b64_tr_b16 a[208:209], v36 offset:36864
    s_add_u32 s58, s55, 16384
    buffer_load_dwordx4 a[0:3], v1, s[20:23], s58 offen offset:0 sc1
    v_rcp_f32 v177, v177
    v_rcp_f32 v178, v178
    v_mfma_f32_32x32x16_bf16 v[112:127], a[240:243], a[60:63], v[112:127]
    ds_read_b64_tr_b16 a[210:211], v36 offset:37888
    v_rcp_f32 v179, v179
    v_mul_f32 v204, v204, v176
    v_mfma_f32_32x32x16_bf16 v[64:79], a[244:247], a[44:47], v[64:79]
    ds_read_b64_tr_b16 a[212:213], v37 offset:36864
    buffer_load_dwordx4 a[4:7], v1, s[20:23], s58 offen offset:1024 sc1
    v_mul_f32 v205, v205, v177
    v_mul_f32 v206, v206, v178
    v_mfma_f32_32x32x16_bf16 v[128:143], a[244:247], a[60:63], v[128:143]
    ds_read_b64_tr_b16 a[214:215], v37 offset:37888
    v_mul_f32 v207, v207, v179
    v_cvt_pk_bf16_f32 v200, v200, v201
    v_mfma_f32_32x32x16_bf16 v[80:95], a[248:251], a[44:47], v[80:95]
    ds_read_b64_tr_b16 a[216:217], v38 offset:36864
    buffer_load_dwordx4 a[8:11], v1, s[20:23], s58 offen offset:2048 sc1
    v_cvt_pk_bf16_f32 v201, v202, v203
    v_cvt_pk_bf16_f32 v202, v204, v205
    v_mfma_f32_32x32x16_bf16 v[144:159], a[248:251], a[60:63], v[144:159]
    ds_read_b64_tr_b16 a[218:219], v38 offset:37888
    v_cvt_pk_bf16_f32 v203, v206, v207
    buffer_store_dwordx4 v[200:203], v1, s[20:23], s96 offen offset:1024 sc1
    v_mfma_f32_32x32x16_bf16 v[96:111], a[252:255], a[44:47], v[96:111]
    ds_read_b64_tr_b16 a[220:221], v39 offset:36864
    buffer_load_dwordx4 a[12:15], v1, s[20:23], s58 offen offset:3072 sc1
    v_mul_f32 v176, v208, v208
    v_mul_f32 v177, v209, v209
    v_mfma_f32_32x32x16_bf16 v[160:175], a[252:255], a[60:63], v[160:175]
    ds_read_b64_tr_b16 a[222:223], v39 offset:37888
    v_mul_f32 v178, v210, v210
    v_mul_f32 v179, v211, v211
    s_waitcnt lgkmcnt(8)
    s_waitcnt vmcnt(22)
    v_mfma_f32_32x32x16_bf16 v[48:63], a[192:195], a[64:67], v[48:63]
    ds_read_b64_tr_b16 a[224:225], v36 offset:40960
    s_add_u32 s58, s55, 49152
    buffer_load_dwordx4 a[16:19], v1, s[20:23], s58 offen offset:0 sc1
    v_fma_f32 v176, v176, v181, v180
    v_fma_f32 v177, v177, v181, v180
    v_mfma_f32_32x32x16_bf16 v[112:127], a[192:195], a[80:83], v[112:127]
    ds_read_b64_tr_b16 a[226:227], v36 offset:41984
    v_fma_f32 v178, v178, v181, v180
    v_fma_f32 v179, v179, v181, v180
    v_mfma_f32_32x32x16_bf16 v[64:79], a[196:199], a[64:67], v[64:79]
    ds_read_b64_tr_b16 a[228:229], v37 offset:40960
    buffer_load_dwordx4 a[20:23], v1, s[20:23], s58 offen offset:1024 sc1
    v_mul_f32 v176, v176, v208
    v_mul_f32 v177, v177, v209
    v_mfma_f32_32x32x16_bf16 v[128:143], a[196:199], a[80:83], v[128:143]
    ds_read_b64_tr_b16 a[230:231], v37 offset:41984
    v_mul_f32 v178, v178, v210
    v_mul_f32 v179, v179, v211
    v_mfma_f32_32x32x16_bf16 v[80:95], a[200:203], a[64:67], v[80:95]
    ds_read_b64_tr_b16 a[232:233], v38 offset:40960
    buffer_load_dwordx4 a[24:27], v1, s[20:23], s58 offen offset:2048 sc1
    v_exp_f32 v176, v176
    v_exp_f32 v177, v177
    v_mfma_f32_32x32x16_bf16 v[144:159], a[200:203], a[80:83], v[144:159]
    ds_read_b64_tr_b16 a[234:235], v38 offset:41984
    v_exp_f32 v178, v178
    v_exp_f32 v179, v179
    v_mfma_f32_32x32x16_bf16 v[96:111], a[204:207], a[64:67], v[96:111]
    ds_read_b64_tr_b16 a[236:237], v39 offset:40960
    buffer_load_dwordx4 a[28:31], v1, s[20:23], s58 offen offset:3072 sc1
    v_add_f32 v176, 1.0, v176
    v_add_f32 v177, 1.0, v177
    v_mfma_f32_32x32x16_bf16 v[160:175], a[204:207], a[80:83], v[160:175]
    ds_read_b64_tr_b16 a[238:239], v39 offset:41984
    v_add_f32 v178, 1.0, v178
    v_add_f32 v179, 1.0, v179
    s_waitcnt lgkmcnt(8)
    v_mfma_f32_32x32x16_bf16 v[48:63], a[208:211], a[68:71], v[48:63]
    ds_read_b64_tr_b16 a[240:241], v36 offset:45056
    s_add_u32 m0, s57, 81920
    s_add_u32 s58, s56, 2621440
    buffer_load_dwordx4 v32, s[8:11], s58 offen offset:0 lds
    v_rcp_f32 v176, v176
    v_rcp_f32 v177, v177
    v_mfma_f32_32x32x16_bf16 v[112:127], a[208:211], a[84:87], v[112:127]
    ds_read_b64_tr_b16 a[242:243], v36 offset:46080
    v_rcp_f32 v178, v178
    v_rcp_f32 v179, v179
    v_mfma_f32_32x32x16_bf16 v[64:79], a[212:215], a[68:71], v[64:79]
    ds_read_b64_tr_b16 a[244:245], v37 offset:45056
    buffer_load_dwordx4 v33, s[8:11], s58 offen offset:1024 lds
    v_mul_f32 v208, v208, v176
    v_mul_f32 v209, v209, v177
    v_mfma_f32_32x32x16_bf16 v[128:143], a[212:215], a[84:87], v[128:143]
    ds_read_b64_tr_b16 a[246:247], v37 offset:46080
    v_mul_f32 v210, v210, v178
    v_mul_f32 v211, v211, v179
    v_mfma_f32_32x32x16_bf16 v[80:95], a[216:219], a[68:71], v[80:95]
    ds_read_b64_tr_b16 a[248:249], v38 offset:45056
    buffer_load_dwordx4 v34, s[8:11], s58 offen offset:2048 lds
    v_mul_f32 v176, v212, v212
    v_mul_f32 v177, v213, v213
    v_mfma_f32_32x32x16_bf16 v[144:159], a[216:219], a[84:87], v[144:159]
    ds_read_b64_tr_b16 a[250:251], v38 offset:46080
    v_mul_f32 v178, v214, v214
    v_mul_f32 v179, v215, v215
    v_mfma_f32_32x32x16_bf16 v[96:111], a[220:223], a[68:71], v[96:111]
    ds_read_b64_tr_b16 a[252:253], v39 offset:45056
    buffer_load_dwordx4 v35, s[8:11], s58 offen offset:3072 lds
    v_fma_f32 v176, v176, v181, v180
    v_fma_f32 v177, v177, v181, v180
    v_mfma_f32_32x32x16_bf16 v[160:175], a[220:223], a[84:87], v[160:175]
    ds_read_b64_tr_b16 a[254:255], v39 offset:46080
    v_fma_f32 v178, v178, v181, v180
    v_fma_f32 v179, v179, v181, v180
    s_waitcnt lgkmcnt(0)
    s_waitcnt vmcnt(26)
    s_barrier
    v_mfma_f32_32x32x16_bf16 v[48:63], a[224:227], a[72:75], v[48:63]
    ds_read_b64_tr_b16 a[192:193], v36 offset:49152
    s_add_u32 s58, s55, 20480
    buffer_load_dwordx4 a[32:35], v1, s[20:23], s58 offen offset:0 sc1
    v_mul_f32 v176, v176, v212
    v_mul_f32 v177, v177, v213
    v_mfma_f32_32x32x16_bf16 v[112:127], a[224:227], a[88:91], v[112:127]
    ds_read_b64_tr_b16 a[194:195], v36 offset:50176
    v_mul_f32 v178, v178, v214
    v_mul_f32 v179, v179, v215
    v_mfma_f32_32x32x16_bf16 v[64:79], a[228:231], a[72:75], v[64:79]
    ds_read_b64_tr_b16 a[196:197], v37 offset:49152
    buffer_load_dwordx4 a[36:39], v1, s[20:23], s58 offen offset:1024 sc1
    v_exp_f32 v176, v176
    v_exp_f32 v177, v177
    v_mfma_f32_32x32x16_bf16 v[128:143], a[228:231], a[88:91], v[128:143]
    ds_read_b64_tr_b16 a[198:199], v37 offset:50176
    v_exp_f32 v178, v178
    v_exp_f32 v179, v179
    v_mfma_f32_32x32x16_bf16 v[80:95], a[232:235], a[72:75], v[80:95]
    ds_read_b64_tr_b16 a[200:201], v38 offset:49152
    buffer_load_dwordx4 a[40:43], v1, s[20:23], s58 offen offset:2048 sc1
    v_add_f32 v176, 1.0, v176
    v_add_f32 v177, 1.0, v177
    v_mfma_f32_32x32x16_bf16 v[144:159], a[232:235], a[88:91], v[144:159]
    ds_read_b64_tr_b16 a[202:203], v38 offset:50176
    v_add_f32 v178, 1.0, v178
    v_add_f32 v179, 1.0, v179
    v_mfma_f32_32x32x16_bf16 v[96:111], a[236:239], a[72:75], v[96:111]
    ds_read_b64_tr_b16 a[204:205], v39 offset:49152
    buffer_load_dwordx4 a[44:47], v1, s[20:23], s58 offen offset:3072 sc1
    v_rcp_f32 v176, v176
    v_rcp_f32 v177, v177
    v_mfma_f32_32x32x16_bf16 v[160:175], a[236:239], a[88:91], v[160:175]
    ds_read_b64_tr_b16 a[206:207], v39 offset:50176
    v_rcp_f32 v178, v178
    v_rcp_f32 v179, v179
    v_mfma_f32_32x32x16_bf16 v[48:63], a[240:243], a[76:79], v[48:63]
    ds_read_b64_tr_b16 a[208:209], v36 offset:53248
    s_add_u32 s58, s55, 53248
    buffer_load_dwordx4 a[48:51], v1, s[20:23], s58 offen offset:0 sc1
    v_mul_f32 v212, v212, v176
    v_mul_f32 v213, v213, v177
    v_mfma_f32_32x32x16_bf16 v[112:127], a[240:243], a[92:95], v[112:127]
    ds_read_b64_tr_b16 a[210:211], v36 offset:54272
    v_mul_f32 v214, v214, v178
    v_mul_f32 v215, v215, v179
    v_mfma_f32_32x32x16_bf16 v[64:79], a[244:247], a[76:79], v[64:79]
    ds_read_b64_tr_b16 a[212:213], v37 offset:53248
    buffer_load_dwordx4 a[52:55], v1, s[20:23], s58 offen offset:1024 sc1
    v_cvt_pk_bf16_f32 v208, v208, v209
    v_cvt_pk_bf16_f32 v209, v210, v211
    v_mfma_f32_32x32x16_bf16 v[128:143], a[244:247], a[92:95], v[128:143]
    ds_read_b64_tr_b16 a[214:215], v37 offset:54272
    v_cvt_pk_bf16_f32 v210, v212, v213
    v_cvt_pk_bf16_f32 v211, v214, v215
    s_mov_b32 s37, 42614784
    s_cmp_lg_u32 s32, 0
    s_cbranch_scc1 L_W0_14
    v_lshlrev_b32 v240, 4, v0
    buffer_load_dword v241, v240, s[20:23], s37 offen offset:0 sc0 sc1
    buffer_load_dword v242, v240, s[20:23], s37 offen offset:1024 sc0 sc1
    buffer_load_dword v243, v240, s[20:23], s37 offen offset:2048 sc0 sc1
    buffer_load_dword v244, v240, s[20:23], s37 offen offset:3072 sc0 sc1
L_W0_14:
    v_mfma_f32_32x32x16_bf16 v[80:95], a[248:251], a[76:79], v[80:95]
    ds_read_b64_tr_b16 a[216:217], v38 offset:53248
    buffer_load_dwordx4 a[56:59], v1, s[20:23], s58 offen offset:2048 sc1
    buffer_store_dwordx4 v[208:211], v1, s[20:23], s96 offen offset:2048 sc1
    v_mul_f32 v176, v216, v216
    v_mfma_f32_32x32x16_bf16 v[144:159], a[248:251], a[92:95], v[144:159]
    ds_read_b64_tr_b16 a[218:219], v38 offset:54272
    v_mul_f32 v177, v217, v217
    v_mul_f32 v178, v218, v218
    v_mfma_f32_32x32x16_bf16 v[96:111], a[252:255], a[76:79], v[96:111]
    ds_read_b64_tr_b16 a[220:221], v39 offset:53248
    buffer_load_dwordx4 a[60:63], v1, s[20:23], s58 offen offset:3072 sc1
    v_mul_f32 v179, v219, v219
    v_fma_f32 v176, v176, v181, v180
    v_mfma_f32_32x32x16_bf16 v[160:175], a[252:255], a[92:95], v[160:175]
    ds_read_b64_tr_b16 a[222:223], v39 offset:54272
    v_fma_f32 v177, v177, v181, v180
    v_fma_f32 v178, v178, v181, v180
    s_waitcnt lgkmcnt(8)
    s_waitcnt vmcnt(26)
    v_mfma_f32_32x32x16_bf16 v[48:63], a[192:195], a[96:99], v[48:63]
    ds_read_b64_tr_b16 a[224:225], v36 offset:57344
    s_add_u32 m0, s57, 98304
    s_add_u32 s58, s56, 3145728
    buffer_load_dwordx4 v32, s[8:11], s58 offen offset:0 lds
    v_fma_f32 v179, v179, v181, v180
    v_mul_f32 v176, v176, v216
    v_mfma_f32_32x32x16_bf16 v[112:127], a[192:195], a[112:115], v[112:127]
    ds_read_b64_tr_b16 a[226:227], v36 offset:58368
    v_mul_f32 v177, v177, v217
    v_mul_f32 v178, v178, v218
    v_mfma_f32_32x32x16_bf16 v[64:79], a[196:199], a[96:99], v[64:79]
    ds_read_b64_tr_b16 a[228:229], v37 offset:57344
    buffer_load_dwordx4 v33, s[8:11], s58 offen offset:1024 lds
    v_mul_f32 v179, v179, v219
    v_exp_f32 v176, v176
    v_mfma_f32_32x32x16_bf16 v[128:143], a[196:199], a[112:115], v[128:143]
    ds_read_b64_tr_b16 a[230:231], v37 offset:58368
    v_exp_f32 v177, v177
    v_exp_f32 v178, v178
    v_mfma_f32_32x32x16_bf16 v[80:95], a[200:203], a[96:99], v[80:95]
    ds_read_b64_tr_b16 a[232:233], v38 offset:57344
    buffer_load_dwordx4 v34, s[8:11], s58 offen offset:2048 lds
    v_exp_f32 v179, v179
    v_add_f32 v176, 1.0, v176
    v_mfma_f32_32x32x16_bf16 v[144:159], a[200:203], a[112:115], v[144:159]
    ds_read_b64_tr_b16 a[234:235], v38 offset:58368
    v_add_f32 v177, 1.0, v177
    v_add_f32 v178, 1.0, v178
    v_mfma_f32_32x32x16_bf16 v[96:111], a[204:207], a[96:99], v[96:111]
    ds_read_b64_tr_b16 a[236:237], v39 offset:57344
    buffer_load_dwordx4 v35, s[8:11], s58 offen offset:3072 lds
    v_add_f32 v179, 1.0, v179
    v_rcp_f32 v176, v176
    v_mfma_f32_32x32x16_bf16 v[160:175], a[204:207], a[112:115], v[160:175]
    ds_read_b64_tr_b16 a[238:239], v39 offset:58368
    v_rcp_f32 v177, v177
    v_rcp_f32 v178, v178
    s_waitcnt lgkmcnt(8)
    v_mfma_f32_32x32x16_bf16 v[48:63], a[208:211], a[100:103], v[48:63]
    ds_read_b64_tr_b16 a[240:241], v36 offset:61440
    buffer_load_dword v252, v1, s[64:67], s68 offen
    v_rcp_f32 v179, v179
    v_mul_f32 v216, v216, v176
    v_mfma_f32_32x32x16_bf16 v[112:127], a[208:211], a[116:119], v[112:127]
    ds_read_b64_tr_b16 a[242:243], v36 offset:62464
    v_mul_f32 v217, v217, v177
    v_mul_f32 v218, v218, v178
    v_mfma_f32_32x32x16_bf16 v[64:79], a[212:215], a[100:103], v[64:79]
    ds_read_b64_tr_b16 a[244:245], v37 offset:61440
    s_add_u32 s58, s55, 24576
    buffer_load_dwordx4 a[64:67], v1, s[20:23], s58 offen offset:0 sc1
    v_mul_f32 v219, v219, v179
    v_mul_f32 v176, v220, v220
    v_mfma_f32_32x32x16_bf16 v[128:143], a[212:215], a[116:119], v[128:143]
    ds_read_b64_tr_b16 a[246:247], v37 offset:62464
    v_mul_f32 v177, v221, v221
    v_mul_f32 v178, v222, v222
    v_mfma_f32_32x32x16_bf16 v[80:95], a[216:219], a[100:103], v[80:95]
    ds_read_b64_tr_b16 a[248:249], v38 offset:61440
    buffer_load_dwordx4 a[68:71], v1, s[20:23], s58 offen offset:1024 sc1
    v_mul_f32 v179, v223, v223
    v_fma_f32 v176, v176, v181, v180
    v_mfma_f32_32x32x16_bf16 v[144:159], a[216:219], a[116:119], v[144:159]
    ds_read_b64_tr_b16 a[250:251], v38 offset:62464
    v_fma_f32 v177, v177, v181, v180
    v_fma_f32 v178, v178, v181, v180
    v_mfma_f32_32x32x16_bf16 v[96:111], a[220:223], a[100:103], v[96:111]
    ds_read_b64_tr_b16 a[252:253], v39 offset:61440
    buffer_load_dwordx4 a[72:75], v1, s[20:23], s58 offen offset:2048 sc1
    v_fma_f32 v179, v179, v181, v180
    v_mul_f32 v176, v176, v220
    v_mfma_f32_32x32x16_bf16 v[160:175], a[220:223], a[116:119], v[160:175]
    ds_read_b64_tr_b16 a[254:255], v39 offset:62464
    v_mul_f32 v177, v177, v221
    v_mul_f32 v178, v178, v222
    s_waitcnt lgkmcnt(0)
    s_waitcnt vmcnt(30)
    s_cmp_lg_u32 s32, 0
    s_cbranch_scc1 L_W0_16
    s_waitcnt vmcnt(11)
    v_and_b32 v241, v241, v242
    v_and_b32 v241, v241, v243
    v_and_b32 v241, v241, v244
    v_cmp_ne_u32 vcc, 0x1, v241
    s_nop 1
    s_cbranch_vccz L_POK_15
L_PLP_15:
    s_sleep 4
    buffer_load_dword v241, v240, s[20:23], s37 offen offset:0 sc0 sc1
    buffer_load_dword v242, v240, s[20:23], s37 offen offset:1024 sc0 sc1
    buffer_load_dword v243, v240, s[20:23], s37 offen offset:2048 sc0 sc1
    buffer_load_dword v244, v240, s[20:23], s37 offen offset:3072 sc0 sc1
    s_waitcnt vmcnt(0)
    v_and_b32 v241, v241, v242
    v_and_b32 v241, v241, v243
    v_and_b32 v241, v241, v244
    v_cmp_ne_u32 vcc, 0x1, v241
    s_nop 1
    s_cbranch_vccnz L_PLP_15
L_POK_15:
L_W0_16:
    s_barrier
    v_mfma_f32_32x32x16_bf16 v[48:63], a[224:227], a[104:107], v[48:63]
    ds_read_b64_tr_b16 a[192:193], v40 offset:0
    buffer_load_dwordx4 a[76:79], v1, s[20:23], s58 offen offset:3072 sc1
    v_mul_f32 v179, v179, v223
    v_exp_f32 v176, v176
    v_mfma_f32_32x32x16_bf16 v[112:127], a[224:227], a[120:123], v[112:127]
    ds_read_b64_tr_b16 a[194:195], v40 offset:1024
    v_exp_f32 v177, v177
    v_exp_f32 v178, v178
    v_mfma_f32_32x32x16_bf16 v[64:79], a[228:231], a[104:107], v[64:79]
    ds_read_b64_tr_b16 a[196:197], v41 offset:0
    s_add_u32 s58, s55, 57344
    buffer_load_dwordx4 a[80:83], v1, s[20:23], s58 offen offset:0 sc1
    v_exp_f32 v179, v179
    v_add_f32 v176, 1.0, v176
    v_mfma_f32_32x32x16_bf16 v[128:143], a[228:231], a[120:123], v[128:143]
    ds_read_b64_tr_b16 a[198:199], v41 offset:1024
    v_add_f32 v177, 1.0, v177
    v_add_f32 v178, 1.0, v178
    v_mfma_f32_32x32x16_bf16 v[80:95], a[232:235], a[104:107], v[80:95]
    ds_read_b64_tr_b16 a[200:201], v42 offset:0
    buffer_load_dwordx4 a[84:87], v1, s[20:23], s58 offen offset:1024 sc1
    v_add_f32 v179, 1.0, v179
    v_rcp_f32 v176, v176
    v_mfma_f32_32x32x16_bf16 v[144:159], a[232:235], a[120:123], v[144:159]
    ds_read_b64_tr_b16 a[202:203], v42 offset:1024
    v_rcp_f32 v177, v177
    v_rcp_f32 v178, v178
    v_mfma_f32_32x32x16_bf16 v[96:111], a[236:239], a[104:107], v[96:111]
    ds_read_b64_tr_b16 a[204:205], v43 offset:0
    buffer_load_dwordx4 a[88:91], v1, s[20:23], s58 offen offset:2048 sc1
    v_rcp_f32 v179, v179
    v_mul_f32 v220, v220, v176
    v_mfma_f32_32x32x16_bf16 v[160:175], a[236:239], a[120:123], v[160:175]
    ds_read_b64_tr_b16 a[206:207], v43 offset:1024
    v_mul_f32 v221, v221, v177
    v_mul_f32 v222, v222, v178
    v_mfma_f32_32x32x16_bf16 v[48:63], a[240:243], a[108:111], v[48:63]
    ds_read_b64_tr_b16 a[208:209], v40 offset:4096
    buffer_load_dwordx4 a[92:95], v1, s[20:23], s58 offen offset:3072 sc1
    v_mul_f32 v223, v223, v179
    v_cvt_pk_bf16_f32 v216, v216, v217
    v_mfma_f32_32x32x16_bf16 v[112:127], a[240:243], a[124:127], v[112:127]
    ds_read_b64_tr_b16 a[210:211], v40 offset:5120
    v_cvt_pk_bf16_f32 v217, v218, v219
    v_cvt_pk_bf16_f32 v218, v220, v221
    v_mfma_f32_32x32x16_bf16 v[64:79], a[244:247], a[108:111], v[64:79]
    ds_read_b64_tr_b16 a[212:213], v41 offset:4096
    s_add_u32 m0, s57, 114688
    s_add_u32 s58, s56, 3670016
    buffer_load_dwordx4 v32, s[8:11], s58 offen offset:0 lds
    v_cvt_pk_bf16_f32 v219, v222, v223
    buffer_store_dwordx4 v[216:219], v1, s[20:23], s96 offen offset:3072 sc1
    v_mfma_f32_32x32x16_bf16 v[128:143], a[244:247], a[124:127], v[128:143]
    ds_read_b64_tr_b16 a[214:215], v41 offset:5120
    v_mul_f32 v176, v224, v224
    v_mul_f32 v177, v225, v225
    v_mfma_f32_32x32x16_bf16 v[80:95], a[248:251], a[108:111], v[80:95]
    ds_read_b64_tr_b16 a[216:217], v42 offset:4096
    buffer_load_dwordx4 v33, s[8:11], s58 offen offset:1024 lds
    v_mul_f32 v178, v226, v226
    v_mul_f32 v179, v227, v227
    v_mfma_f32_32x32x16_bf16 v[144:159], a[248:251], a[124:127], v[144:159]
    ds_read_b64_tr_b16 a[218:219], v42 offset:5120
    v_fma_f32 v176, v176, v181, v180
    v_fma_f32 v177, v177, v181, v180
    v_mfma_f32_32x32x16_bf16 v[96:111], a[252:255], a[108:111], v[96:111]
    ds_read_b64_tr_b16 a[220:221], v43 offset:4096
    buffer_load_dwordx4 v34, s[8:11], s58 offen offset:2048 lds
    v_fma_f32 v178, v178, v181, v180
    v_fma_f32 v179, v179, v181, v180
    v_mfma_f32_32x32x16_bf16 v[160:175], a[252:255], a[124:127], v[160:175]
    ds_read_b64_tr_b16 a[222:223], v43 offset:5120
    v_mul_f32 v176, v176, v224
    v_mul_f32 v177, v177, v225
    s_waitcnt lgkmcnt(8)
    s_waitcnt vmcnt(30)
    v_mfma_f32_32x32x16_bf16 v[48:63], a[192:195], a[0:3], v[48:63]
    ds_read_b64_tr_b16 a[224:225], v40 offset:8192
    buffer_load_dwordx4 v35, s[8:11], s58 offen offset:3072 lds
    v_mul_f32 v178, v178, v226
    v_mul_f32 v179, v179, v227
    v_mfma_f32_32x32x16_bf16 v[112:127], a[192:195], a[16:19], v[112:127]
    ds_read_b64_tr_b16 a[226:227], v40 offset:9216
    v_exp_f32 v176, v176
    v_exp_f32 v177, v177
    v_mfma_f32_32x32x16_bf16 v[64:79], a[196:199], a[0:3], v[64:79]
    ds_read_b64_tr_b16 a[228:229], v41 offset:8192
    s_add_u32 s58, s55, 28672
    buffer_load_dwordx4 a[96:99], v1, s[20:23], s58 offen offset:0 sc1
    v_exp_f32 v178, v178
    v_exp_f32 v179, v179
    v_mfma_f32_32x32x16_bf16 v[128:143], a[196:199], a[16:19], v[128:143]
    ds_read_b64_tr_b16 a[230:231], v41 offset:9216
    v_add_f32 v176, 1.0, v176
    v_add_f32 v177, 1.0, v177
    v_mfma_f32_32x32x16_bf16 v[80:95], a[200:203], a[0:3], v[80:95]
    ds_read_b64_tr_b16 a[232:233], v42 offset:8192
    buffer_load_dwordx4 a[100:103], v1, s[20:23], s58 offen offset:1024 sc1
    v_add_f32 v178, 1.0, v178
    v_add_f32 v179, 1.0, v179
    v_mfma_f32_32x32x16_bf16 v[144:159], a[200:203], a[16:19], v[144:159]
    ds_read_b64_tr_b16 a[234:235], v42 offset:9216
    v_rcp_f32 v176, v176
    v_rcp_f32 v177, v177
    v_mfma_f32_32x32x16_bf16 v[96:111], a[204:207], a[0:3], v[96:111]
    ds_read_b64_tr_b16 a[236:237], v43 offset:8192
    buffer_load_dwordx4 a[104:107], v1, s[20:23], s58 offen offset:2048 sc1
    v_rcp_f32 v178, v178
    v_rcp_f32 v179, v179
    v_mfma_f32_32x32x16_bf16 v[160:175], a[204:207], a[16:19], v[160:175]
    ds_read_b64_tr_b16 a[238:239], v43 offset:9216
    v_mul_f32 v224, v224, v176
    v_mul_f32 v225, v225, v177
    s_waitcnt lgkmcnt(8)
    v_mfma_f32_32x32x16_bf16 v[48:63], a[208:211], a[4:7], v[48:63]
    ds_read_b64_tr_b16 a[240:241], v40 offset:12288
    buffer_load_dwordx4 a[108:111], v1, s[20:23], s58 offen offset:3072 sc1
    v_mul_f32 v226, v226, v178
    v_mul_f32 v227, v227, v179
    v_mfma_f32_32x32x16_bf16 v[112:127], a[208:211], a[20:23], v[112:127]
    ds_read_b64_tr_b16 a[242:243], v40 offset:13312
    v_mul_f32 v176, v228, v228
    v_mul_f32 v177, v229, v229
    v_mfma_f32_32x32x16_bf16 v[64:79], a[212:215], a[4:7], v[64:79]
    ds_read_b64_tr_b16 a[244:245], v41 offset:12288
    s_add_u32 s58, s55, 61440
    buffer_load_dwordx4 a[112:115], v1, s[20:23], s58 offen offset:0 sc1
    v_mul_f32 v178, v230, v230
    v_mul_f32 v179, v231, v231
    v_mfma_f32_32x32x16_bf16 v[128:143], a[212:215], a[20:23], v[128:143]
    ds_read_b64_tr_b16 a[246:247], v41 offset:13312
    v_fma_f32 v176, v176, v181, v180
    v_fma_f32 v177, v177, v181, v180
    v_mfma_f32_32x32x16_bf16 v[80:95], a[216:219], a[4:7], v[80:95]
    ds_read_b64_tr_b16 a[248:249], v42 offset:12288
    buffer_load_dwordx4 a[116:119], v1, s[20:23], s58 offen offset:1024 sc1
    v_fma_f32 v178, v178, v181, v180
    v_fma_f32 v179, v179, v181, v180
    v_mfma_f32_32x32x16_bf16 v[144:159], a[216:219], a[20:23], v[144:159]
    ds_read_b64_tr_b16 a[250:251], v42 offset:13312
    v_mul_f32 v176, v176, v228
    v_mul_f32 v177, v177, v229
    v_mfma_f32_32x32x16_bf16 v[96:111], a[220:223], a[4:7], v[96:111]
    ds_read_b64_tr_b16 a[252:253], v43 offset:12288
    buffer_load_dwordx4 a[120:123], v1, s[20:23], s58 offen offset:2048 sc1
    v_mul_f32 v178, v178, v230
    v_mul_f32 v179, v179, v231
    v_mfma_f32_32x32x16_bf16 v[160:175], a[220:223], a[20:23], v[160:175]
    ds_read_b64_tr_b16 a[254:255], v43 offset:13312
    v_exp_f32 v176, v176
    v_exp_f32 v177, v177
    s_waitcnt lgkmcnt(0)
    s_waitcnt vmcnt(34)
    s_barrier
    v_mfma_f32_32x32x16_bf16 v[48:63], a[224:227], a[8:11], v[48:63]
    ds_read_b64_tr_b16 a[192:193], v40 offset:16384
    buffer_load_dwordx4 a[124:127], v1, s[20:23], s58 offen offset:3072 sc1
    v_exp_f32 v178, v178
    v_exp_f32 v179, v179
    v_mfma_f32_32x32x16_bf16 v[112:127], a[224:227], a[24:27], v[112:127]
    ds_read_b64_tr_b16 a[194:195], v40 offset:17408
    v_add_f32 v176, 1.0, v176
    v_add_f32 v177, 1.0, v177
    v_mfma_f32_32x32x16_bf16 v[64:79], a[228:231], a[8:11], v[64:79]
    ds_read_b64_tr_b16 a[196:197], v41 offset:16384
    s_add_u32 m0, s59, 0
    s_add_u32 s46, s45, 4096
    buffer_load_dwordx4 v1, s[20:23], s45 offen offset:0 sc1 lds
    v_add_f32 v178, 1.0, v178
    v_add_f32 v179, 1.0, v179
    v_mfma_f32_32x32x16_bf16 v[128:143], a[228:231], a[24:27], v[128:143]
    ds_read_b64_tr_b16 a[198:199], v41 offset:17408
    v_rcp_f32 v176, v176
    v_rcp_f32 v177, v177
    v_mfma_f32_32x32x16_bf16 v[80:95], a[232:235], a[8:11], v[80:95]
    ds_read_b64_tr_b16 a[200:201], v42 offset:16384
    buffer_load_dwordx4 v1, s[20:23], s45 offen offset:1024 sc1 lds
    v_rcp_f32 v178, v178
    v_rcp_f32 v179, v179
    v_mfma_f32_32x32x16_bf16 v[144:159], a[232:235], a[24:27], v[144:159]
    ds_read_b64_tr_b16 a[202:203], v42 offset:17408
    v_mul_f32 v228, v228, v176
    v_mul_f32 v229, v229, v177
    v_mfma_f32_32x32x16_bf16 v[96:111], a[236:239], a[8:11], v[96:111]
    ds_read_b64_tr_b16 a[204:205], v43 offset:16384
    buffer_load_dwordx4 v1, s[20:23], s45 offen offset:2048 sc1 lds
    v_mul_f32 v230, v230, v178
    v_mul_f32 v231, v231, v179
    v_mfma_f32_32x32x16_bf16 v[160:175], a[236:239], a[24:27], v[160:175]
    ds_read_b64_tr_b16 a[206:207], v43 offset:17408
    v_cvt_pk_bf16_f32 v224, v224, v225
    v_cvt_pk_bf16_f32 v225, v226, v227
    v_mfma_f32_32x32x16_bf16 v[48:63], a[240:243], a[12:15], v[48:63]
    ds_read_b64_tr_b16 a[208:209], v40 offset:20480
    buffer_load_dwordx4 v1, s[20:23], s45 offen offset:3072 sc1 lds
    v_cvt_pk_bf16_f32 v226, v228, v229
    v_cvt_pk_bf16_f32 v227, v230, v231
    v_mfma_f32_32x32x16_bf16 v[112:127], a[240:243], a[28:31], v[112:127]
    ds_read_b64_tr_b16 a[210:211], v40 offset:21504
    buffer_store_dwordx4 v[224:227], v1, s[20:23], s97 offen offset:0 sc1
    v_mul_f32 v176, v232, v232
    v_mfma_f32_32x32x16_bf16 v[64:79], a[244:247], a[12:15], v[64:79]
    ds_read_b64_tr_b16 a[212:213], v41 offset:20480
    s_add_u32 m0, s59, 4096
    s_nop 0
    buffer_load_dwordx4 v1, s[20:23], s46 offen offset:0 sc1 lds
    v_mul_f32 v177, v233, v233
    v_mul_f32 v178, v234, v234
    v_mfma_f32_32x32x16_bf16 v[128:143], a[244:247], a[28:31], v[128:143]
    ds_read_b64_tr_b16 a[214:215], v41 offset:21504
    v_mul_f32 v179, v235, v235
    v_fma_f32 v176, v176, v181, v180
    v_mfma_f32_32x32x16_bf16 v[80:95], a[248:251], a[12:15], v[80:95]
    ds_read_b64_tr_b16 a[216:217], v42 offset:20480
    buffer_load_dwordx4 v1, s[20:23], s46 offen offset:1024 sc1 lds
    v_fma_f32 v177, v177, v181, v180
    v_fma_f32 v178, v178, v181, v180
    v_mfma_f32_32x32x16_bf16 v[144:159], a[248:251], a[28:31], v[144:159]
    ds_read_b64_tr_b16 a[218:219], v42 offset:21504
    v_fma_f32 v179, v179, v181, v180
    v_mul_f32 v176, v176, v232
    v_mfma_f32_32x32x16_bf16 v[96:111], a[252:255], a[12:15], v[96:111]
    ds_read_b64_tr_b16 a[220:221], v43 offset:20480
    buffer_load_dwordx4 v1, s[20:23], s46 offen offset:2048 sc1 lds
    v_mul_f32 v177, v177, v233
    v_mul_f32 v178, v178, v234
    v_mfma_f32_32x32x16_bf16 v[160:175], a[252:255], a[28:31], v[160:175]
    ds_read_b64_tr_b16 a[222:223], v43 offset:21504
    v_mul_f32 v179, v179, v235
    v_exp_f32 v176, v176
    s_waitcnt lgkmcnt(8)
    s_waitcnt vmcnt(34)
    v_mfma_f32_32x32x16_bf16 v[48:63], a[192:195], a[32:35], v[48:63]
    ds_read_b64_tr_b16 a[224:225], v40 offset:24576
    buffer_load_dwordx4 v1, s[20:23], s46 offen offset:3072 sc1 lds
    v_exp_f32 v177, v177
    v_exp_f32 v178, v178
    v_mfma_f32_32x32x16_bf16 v[112:127], a[192:195], a[48:51], v[112:127]
    ds_read_b64_tr_b16 a[226:227], v40 offset:25600
    v_exp_f32 v179, v179
    v_add_f32 v176, 1.0, v176
    v_mfma_f32_32x32x16_bf16 v[64:79], a[196:199], a[32:35], v[64:79]
    ds_read_b64_tr_b16 a[228:229], v41 offset:24576
    s_add_u32 m0, s59, 32768
    s_add_u32 s47, s45, 16777216
    s_add_u32 s48, s47, 4096
    s_add_u32 s45, s45, 0x4000
    s_add_u32 s46, s45, 4096
    buffer_load_dwordx4 v1, s[20:23], s45 offen offset:0 sc1 lds
    v_add_f32 v177, 1.0, v177
    v_add_f32 v178, 1.0, v178
    v_mfma_f32_32x32x16_bf16 v[128:143], a[196:199], a[48:51], v[128:143]
    ds_read_b64_tr_b16 a[230:231], v41 offset:25600
    v_add_f32 v179, 1.0, v179
    v_rcp_f32 v176, v176
    v_mfma_f32_32x32x16_bf16 v[80:95], a[200:203], a[32:35], v[80:95]
    ds_read_b64_tr_b16 a[232:233], v42 offset:24576
    buffer_load_dwordx4 v1, s[20:23], s45 offen offset:1024 sc1 lds
    v_rcp_f32 v177, v177
    v_rcp_f32 v178, v178
    v_mfma_f32_32x32x16_bf16 v[144:159], a[200:203], a[48:51], v[144:159]
    ds_read_b64_tr_b16 a[234:235], v42 offset:25600
    v_rcp_f32 v179, v179
    v_mul_f32 v232, v232, v176
    v_mfma_f32_32x32x16_bf16 v[96:111], a[204:207], a[32:35], v[96:111]
    ds_read_b64_tr_b16 a[236:237], v43 offset:24576
    buffer_load_dwordx4 v1, s[20:23], s45 offen offset:2048 sc1 lds
    v_mul_f32 v233, v233, v177
    v_mul_f32 v234, v234, v178
    v_mfma_f32_32x32x16_bf16 v[160:175], a[204:207], a[48:51], v[160:175]
    ds_read_b64_tr_b16 a[238:239], v43 offset:25600
    v_mul_f32 v235, v235, v179
    v_mul_f32 v176, v236, v236
    s_waitcnt lgkmcnt(8)
    v_mfma_f32_32x32x16_bf16 v[48:63], a[208:211], a[36:39], v[48:63]
    ds_read_b64_tr_b16 a[240:241], v40 offset:28672
    buffer_load_dwordx4 v1, s[20:23], s45 offen offset:3072 sc1 lds
    v_mul_f32 v177, v237, v237
    v_mul_f32 v178, v238, v238
    v_mfma_f32_32x32x16_bf16 v[112:127], a[208:211], a[52:55], v[112:127]
    ds_read_b64_tr_b16 a[242:243], v40 offset:29696
    v_mul_f32 v179, v239, v239
    v_fma_f32 v176, v176, v181, v180
    v_mfma_f32_32x32x16_bf16 v[64:79], a[212:215], a[36:39], v[64:79]
    ds_read_b64_tr_b16 a[244:245], v41 offset:28672
    s_add_u32 m0, s59, 36864
    s_nop 0
    buffer_load_dwordx4 v1, s[20:23], s46 offen offset:0 sc1 lds
    v_fma_f32 v177, v177, v181, v180
    v_fma_f32 v178, v178, v181, v180
    v_mfma_f32_32x32x16_bf16 v[128:143], a[212:215], a[52:55], v[128:143]
    ds_read_b64_tr_b16 a[246:247], v41 offset:29696
    v_fma_f32 v179, v179, v181, v180
    v_mul_f32 v176, v176, v236
    v_mfma_f32_32x32x16_bf16 v[80:95], a[216:219], a[36:39], v[80:95]
    ds_read_b64_tr_b16 a[248:249], v42 offset:28672
    buffer_load_dwordx4 v1, s[20:23], s46 offen offset:1024 sc1 lds
    v_mul_f32 v177, v177, v237
    v_mul_f32 v178, v178, v238
    v_mfma_f32_32x32x16_bf16 v[144:159], a[216:219], a[52:55], v[144:159]
    ds_read_b64_tr_b16 a[250:251], v42 offset:29696
    v_mul_f32 v179, v179, v239
    v_exp_f32 v176, v176
    v_mfma_f32_32x32x16_bf16 v[96:111], a[220:223], a[36:39], v[96:111]
    ds_read_b64_tr_b16 a[252:253], v43 offset:28672
    buffer_load_dwordx4 v1, s[20:23], s46 offen offset:2048 sc1 lds
    v_exp_f32 v177, v177
    v_exp_f32 v178, v178
    v_mfma_f32_32x32x16_bf16 v[160:175], a[220:223], a[52:55], v[160:175]
    ds_read_b64_tr_b16 a[254:255], v43 offset:29696
    v_exp_f32 v179, v179
    v_add_f32 v176, 1.0, v176
    s_waitcnt lgkmcnt(0)
    s_waitcnt vmcnt(38)
    s_barrier
    v_mfma_f32_32x32x16_bf16 v[48:63], a[224:227], a[40:43], v[48:63]
    ds_read_b64_tr_b16 a[192:193], v40 offset:32768
    buffer_load_dwordx4 v1, s[20:23], s46 offen offset:3072 sc1 lds
    v_add_f32 v177, 1.0, v177
    v_add_f32 v178, 1.0, v178
    v_mfma_f32_32x32x16_bf16 v[112:127], a[224:227], a[56:59], v[112:127]
    ds_read_b64_tr_b16 a[194:195], v40 offset:33792
    v_add_f32 v179, 1.0, v179
    v_rcp_f32 v176, v176
    v_mfma_f32_32x32x16_bf16 v[64:79], a[228:231], a[40:43], v[64:79]
    ds_read_b64_tr_b16 a[196:197], v41 offset:32768
    s_add_u32 m0, s59, 65536
    s_nop 0
    buffer_load_dwordx4 v1, s[20:23], s47 offen offset:0 sc1 lds
    v_rcp_f32 v177, v177
    v_rcp_f32 v178, v178
    v_mfma_f32_32x32x16_bf16 v[128:143], a[228:231], a[56:59], v[128:143]
    ds_read_b64_tr_b16 a[198:199], v41 offset:33792
    v_rcp_f32 v179, v179
    v_mul_f32 v236, v236, v176
    v_mfma_f32_32x32x16_bf16 v[80:95], a[232:235], a[40:43], v[80:95]
    ds_read_b64_tr_b16 a[200:201], v42 offset:32768
    buffer_load_dwordx4 v1, s[20:23], s47 offen offset:1024 sc1 lds
    v_mul_f32 v237, v237, v177
    v_mul_f32 v238, v238, v178
    v_mfma_f32_32x32x16_bf16 v[144:159], a[232:235], a[56:59], v[144:159]
    ds_read_b64_tr_b16 a[202:203], v42 offset:33792
    v_mul_f32 v239, v239, v179
    v_cvt_pk_bf16_f32 v232, v232, v233
    v_mfma_f32_32x32x16_bf16 v[96:111], a[236:239], a[40:43], v[96:111]
    ds_read_b64_tr_b16 a[204:205], v43 offset:32768
    buffer_load_dwordx4 v1, s[20:23], s47 offen offset:2048 sc1 lds
    v_cvt_pk_bf16_f32 v233, v234, v235
    v_cvt_pk_bf16_f32 v234, v236, v237
    v_mfma_f32_32x32x16_bf16 v[160:175], a[236:239], a[56:59], v[160:175]
    ds_read_b64_tr_b16 a[206:207], v43 offset:33792
    v_cvt_pk_bf16_f32 v235, v238, v239
    buffer_store_dwordx4 v[232:235], v1, s[20:23], s97 offen offset:1024 sc1
    v_mfma_f32_32x32x16_bf16 v[48:63], a[240:243], a[44:47], v[48:63]
    ds_read_b64_tr_b16 a[208:209], v40 offset:36864
    buffer_load_dwordx4 v1, s[20:23], s47 offen offset:3072 sc1 lds
    v_mfma_f32_32x32x16_bf16 v[112:127], a[240:243], a[60:63], v[112:127]
    ds_read_b64_tr_b16 a[210:211], v40 offset:37888
    v_mfma_f32_32x32x16_bf16 v[64:79], a[244:247], a[44:47], v[64:79]
    ds_read_b64_tr_b16 a[212:213], v41 offset:36864
    s_add_u32 m0, s59, 69632
    s_nop 0
    buffer_load_dwordx4 v1, s[20:23], s48 offen offset:0 sc1 lds
    v_mfma_f32_32x32x16_bf16 v[128:143], a[244:247], a[60:63], v[128:143]
    ds_read_b64_tr_b16 a[214:215], v41 offset:37888
    v_mfma_f32_32x32x16_bf16 v[80:95], a[248:251], a[44:47], v[80:95]
    ds_read_b64_tr_b16 a[216:217], v42 offset:36864
    buffer_load_dwordx4 v1, s[20:23], s48 offen offset:1024 sc1 lds
    v_mfma_f32_32x32x16_bf16 v[144:159], a[248:251], a[60:63], v[144:159]
    ds_read_b64_tr_b16 a[218:219], v42 offset:37888
    v_mfma_f32_32x32x16_bf16 v[96:111], a[252:255], a[44:47], v[96:111]
    ds_read_b64_tr_b16 a[220:221], v43 offset:36864
    buffer_load_dwordx4 v1, s[20:23], s48 offen offset:2048 sc1 lds
    v_mfma_f32_32x32x16_bf16 v[160:175], a[252:255], a[60:63], v[160:175]
    ds_read_b64_tr_b16 a[222:223], v43 offset:37888
    s_waitcnt lgkmcnt(8)
    s_waitcnt vmcnt(38)
    v_mfma_f32_32x32x16_bf16 v[48:63], a[192:195], a[64:67], v[48:63]
    ds_read_b64_tr_b16 a[224:225], v40 offset:40960
    buffer_load_dwordx4 v1, s[20:23], s48 offen offset:3072 sc1 lds
    v_mfma_f32_32x32x16_bf16 v[112:127], a[192:195], a[80:83], v[112:127]
    ds_read_b64_tr_b16 a[226:227], v40 offset:41984
    v_mfma_f32_32x32x16_bf16 v[64:79], a[196:199], a[64:67], v[64:79]
    ds_read_b64_tr_b16 a[228:229], v41 offset:40960
    v_mfma_f32_32x32x16_bf16 v[128:143], a[196:199], a[80:83], v[128:143]
    ds_read_b64_tr_b16 a[230:231], v41 offset:41984
    v_mfma_f32_32x32x16_bf16 v[80:95], a[200:203], a[64:67], v[80:95]
    ds_read_b64_tr_b16 a[232:233], v42 offset:40960
    v_mfma_f32_32x32x16_bf16 v[144:159], a[200:203], a[80:83], v[144:159]
    ds_read_b64_tr_b16 a[234:235], v42 offset:41984
    v_mfma_f32_32x32x16_bf16 v[96:111], a[204:207], a[64:67], v[96:111]
    ds_read_b64_tr_b16 a[236:237], v43 offset:40960
    v_mfma_f32_32x32x16_bf16 v[160:175], a[204:207], a[80:83], v[160:175]
    ds_read_b64_tr_b16 a[238:239], v43 offset:41984
    s_waitcnt lgkmcnt(8)
    v_mfma_f32_32x32x16_bf16 v[48:63], a[208:211], a[68:71], v[48:63]
    ds_read_b64_tr_b16 a[240:241], v40 offset:45056
    v_mfma_f32_32x32x16_bf16 v[112:127], a[208:211], a[84:87], v[112:127]
    ds_read_b64_tr_b16 a[242:243], v40 offset:46080
    v_mfma_f32_32x32x16_bf16 v[64:79], a[212:215], a[68:71], v[64:79]
    ds_read_b64_tr_b16 a[244:245], v41 offset:45056
    v_mfma_f32_32x32x16_bf16 v[128:143], a[212:215], a[84:87], v[128:143]
    ds_read_b64_tr_b16 a[246:247], v41 offset:46080
    v_mfma_f32_32x32x16_bf16 v[80:95], a[216:219], a[68:71], v[80:95]
    ds_read_b64_tr_b16 a[248:249], v42 offset:45056
    v_mfma_f32_32x32x16_bf16 v[144:159], a[216:219], a[84:87], v[144:159]
    ds_read_b64_tr_b16 a[250:251], v42 offset:46080
    v_mfma_f32_32x32x16_bf16 v[96:111], a[220:223], a[68:71], v[96:111]
    ds_read_b64_tr_b16 a[252:253], v43 offset:45056
    v_mfma_f32_32x32x16_bf16 v[160:175], a[220:223], a[84:87], v[160:175]
    ds_read_b64_tr_b16 a[254:255], v43 offset:46080
    s_waitcnt lgkmcnt(0)
    s_waitcnt vmcnt(34)
    s_waitcnt vmcnt(5)
    s_barrier
    s_lshl_b32 s37, s2, 4
    s_add_u32 s37, s37, 42622976
    s_cmp_lg_u32 s32, 0
    s_cbranch_scc1 L_W0_17
    v_mov_b32 v246, 1
    v_mov_b32 v247, 0
    s_mov_b64 exec, 1
    buffer_store_byte v246, v247, s[20:23], s37 offen sc0 sc1
    s_mov_b64 exec, -1
L_W0_17:
    v_mfma_f32_32x32x16_bf16 v[48:63], a[224:227], a[72:75], v[48:63]
    ds_read_b64_tr_b16 a[192:193], v40 offset:49152
    v_mfma_f32_32x32x16_bf16 v[112:127], a[224:227], a[88:91], v[112:127]
    ds_read_b64_tr_b16 a[194:195], v40 offset:50176
    v_mfma_f32_32x32x16_bf16 v[64:79], a[228:231], a[72:75], v[64:79]
    ds_read_b64_tr_b16 a[196:197], v41 offset:49152
    v_mfma_f32_32x32x16_bf16 v[128:143], a[228:231], a[88:91], v[128:143]
    ds_read_b64_tr_b16 a[198:199], v41 offset:50176
    v_mfma_f32_32x32x16_bf16 v[80:95], a[232:235], a[72:75], v[80:95]
    ds_read_b64_tr_b16 a[200:201], v42 offset:49152
    v_mfma_f32_32x32x16_bf16 v[144:159], a[232:235], a[88:91], v[144:159]
    ds_read_b64_tr_b16 a[202:203], v42 offset:50176
    v_mfma_f32_32x32x16_bf16 v[96:111], a[236:239], a[72:75], v[96:111]
    ds_read_b64_tr_b16 a[204:205], v43 offset:49152
    v_mfma_f32_32x32x16_bf16 v[160:175], a[236:239], a[88:91], v[160:175]
    ds_read_b64_tr_b16 a[206:207], v43 offset:50176
    v_mfma_f32_32x32x16_bf16 v[48:63], a[240:243], a[76:79], v[48:63]
    ds_read_b64_tr_b16 a[208:209], v40 offset:53248
    v_mfma_f32_32x32x16_bf16 v[112:127], a[240:243], a[92:95], v[112:127]
    ds_read_b64_tr_b16 a[210:211], v40 offset:54272
    v_mfma_f32_32x32x16_bf16 v[64:79], a[244:247], a[76:79], v[64:79]
    ds_read_b64_tr_b16 a[212:213], v41 offset:53248
    v_mfma_f32_32x32x16_bf16 v[128:143], a[244:247], a[92:95], v[128:143]
    ds_read_b64_tr_b16 a[214:215], v41 offset:54272
    v_mfma_f32_32x32x16_bf16 v[80:95], a[248:251], a[76:79], v[80:95]
    ds_read_b64_tr_b16 a[216:217], v42 offset:53248
    v_mfma_f32_32x32x16_bf16 v[144:159], a[248:251], a[92:95], v[144:159]
    ds_read_b64_tr_b16 a[218:219], v42 offset:54272
    v_mfma_f32_32x32x16_bf16 v[96:111], a[252:255], a[76:79], v[96:111]
    ds_read_b64_tr_b16 a[220:221], v43 offset:53248
    v_mfma_f32_32x32x16_bf16 v[160:175], a[252:255], a[92:95], v[160:175]
    ds_read_b64_tr_b16 a[222:223], v43 offset:54272
    s_branch K2_QPJ
K2_QP1:
    s_waitcnt lgkmcnt(8)
    s_waitcnt vmcnt(12)
    v_mfma_f32_32x32x16_bf16 v[48:63], a[192:195], a[0:3], 0
    ds_read_b64_tr_b16 a[224:225], v36 offset:8192
    s_add_u32 m0, s57, 32768
    s_add_u32 s58, s56, 1048576
    buffer_load_dwordx4 v32, s[8:11], s58 offen offset:0 lds
    v_mov_b32 v180, 0xc0135761
    v_mov_b32 v181, 0xbdd2d3e8
    v_mul_f32 v176, v192, v192
    v_mfma_f32_32x32x16_bf16 v[112:127], a[192:195], a[16:19], 0
    ds_read_b64_tr_b16 a[226:227], v36 offset:9216
    v_mul_f32 v177, v193, v193
    v_mul_f32 v178, v194, v194
    v_mul_f32 v179, v195, v195
    v_mfma_f32_32x32x16_bf16 v[64:79], a[196:199], a[0:3], 0
    ds_read_b64_tr_b16 a[228:229], v37 offset:8192
    buffer_load_dwordx4 v33, s[8:11], s58 offen offset:1024 lds
    v_fma_f32 v176, v176, v181, v180
    v_fma_f32 v177, v177, v181, v180
    v_fma_f32 v178, v178, v181, v180
    v_mfma_f32_32x32x16_bf16 v[128:143], a[196:199], a[16:19], 0
    ds_read_b64_tr_b16 a[230:231], v37 offset:9216
    v_fma_f32 v179, v179, v181, v180
    v_mul_f32 v176, v176, v192
    v_mul_f32 v177, v177, v193
    v_mfma_f32_32x32x16_bf16 v[80:95], a[200:203], a[0:3], 0
    ds_read_b64_tr_b16 a[232:233], v38 offset:8192
    buffer_load_dwordx4 v34, s[8:11], s58 offen offset:2048 lds
    v_mul_f32 v178, v178, v194
    v_mul_f32 v179, v179, v195
    v_exp_f32 v176, v176
    v_mfma_f32_32x32x16_bf16 v[144:159], a[200:203], a[16:19], 0
    ds_read_b64_tr_b16 a[234:235], v38 offset:9216
    v_exp_f32 v177, v177
    v_exp_f32 v178, v178
    v_exp_f32 v179, v179
    v_mfma_f32_32x32x16_bf16 v[96:111], a[204:207], a[0:3], 0
    ds_read_b64_tr_b16 a[236:237], v39 offset:8192
    buffer_load_dwordx4 v35, s[8:11], s58 offen offset:3072 lds
    v_add_f32 v176, 1.0, v176
    v_add_f32 v177, 1.0, v177
    v_add_f32 v178, 1.0, v178
    v_mfma_f32_32x32x16_bf16 v[160:175], a[204:207], a[16:19], 0
    ds_read_b64_tr_b16 a[238:239], v39 offset:9216
    v_add_f32 v179, 1.0, v179
    v_rcp_f32 v176, v176
    v_rcp_f32 v177, v177
    s_waitcnt lgkmcnt(8)
    v_mfma_f32_32x32x16_bf16 v[48:63], a[208:211], a[4:7], v[48:63]
    ds_read_b64_tr_b16 a[240:241], v36 offset:12288
    s_add_u32 s58, s55, 8192
    buffer_load_dwordx4 a[64:67], v1, s[20:23], s58 offen offset:0 sc1
    v_rcp_f32 v178, v178
    v_rcp_f32 v179, v179
    v_mul_f32 v192, v192, v176
    v_mfma_f32_32x32x16_bf16 v[112:127], a[208:211], a[20:23], v[112:127]
    ds_read_b64_tr_b16 a[242:243], v36 offset:13312
    v_mul_f32 v193, v193, v177
    v_mul_f32 v194, v194, v178
    v_mul_f32 v195, v195, v179
    v_mfma_f32_32x32x16_bf16 v[64:79], a[212:215], a[4:7], v[64:79]
    ds_read_b64_tr_b16 a[244:245], v37 offset:12288
    buffer_load_dwordx4 a[68:71], v1, s[20:23], s58 offen offset:1024 sc1
    v_mul_f32 v176, v196, v196
    v_mul_f32 v177, v197, v197
    v_mul_f32 v178, v198, v198
    v_mfma_f32_32x32x16_bf16 v[128:143], a[212:215], a[20:23], v[128:143]
    ds_read_b64_tr_b16 a[246:247], v37 offset:13312
    v_mul_f32 v179, v199, v199
    v_fma_f32 v176, v176, v181, v180
    v_fma_f32 v177, v177, v181, v180
    v_mfma_f32_32x32x16_bf16 v[80:95], a[216:219], a[4:7], v[80:95]
    ds_read_b64_tr_b16 a[248:249], v38 offset:12288
    buffer_load_dwordx4 a[72:75], v1, s[20:23], s58 offen offset:2048 sc1
    v_fma_f32 v178, v178, v181, v180
    v_fma_f32 v179, v179, v181, v180
    v_mul_f32 v176, v176, v196
    v_mfma_f32_32x32x16_bf16 v[144:159], a[216:219], a[20:23], v[144:159]
    ds_read_b64_tr_b16 a[250:251], v38 offset:13312
    v_mul_f32 v177, v177, v197
    v_mul_f32 v178, v178, v198
    v_mul_f32 v179, v179, v199
    v_mfma_f32_32x32x16_bf16 v[96:111], a[220:223], a[4:7], v[96:111]
    ds_read_b64_tr_b16 a[252:253], v39 offset:12288
    buffer_load_dwordx4 a[76:79], v1, s[20:23], s58 offen offset:3072 sc1
    v_exp_f32 v176, v176
    v_exp_f32 v177, v177
    v_exp_f32 v178, v178
    v_mfma_f32_32x32x16_bf16 v[160:175], a[220:223], a[20:23], v[160:175]
    ds_read_b64_tr_b16 a[254:255], v39 offset:13312
    v_exp_f32 v179, v179
    v_add_f32 v176, 1.0, v176
    v_add_f32 v177, 1.0, v177
    s_waitcnt lgkmcnt(0)
    s_waitcnt vmcnt(16)
    s_barrier
    s_lshl_b32 s37, s2, 4
    s_add_u32 s37, s37, 42614784
    s_cmp_lg_u32 s32, 0
    s_cbranch_scc1 L_W0_18
    v_mov_b32 v246, 1
    v_mov_b32 v247, 0
    s_mov_b64 exec, 1
    buffer_store_byte v246, v247, s[20:23], s37 offen sc0 sc1
    s_mov_b64 exec, -1
L_W0_18:
    v_mfma_f32_32x32x16_bf16 v[48:63], a[224:227], a[8:11], v[48:63]
    ds_read_b64_tr_b16 a[192:193], v36 offset:16384
    s_add_u32 s58, s55, 40960
    buffer_load_dwordx4 a[80:83], v1, s[20:23], s58 offen offset:0 sc1
    v_add_f32 v178, 1.0, v178
    v_add_f32 v179, 1.0, v179
    v_rcp_f32 v176, v176
    v_mfma_f32_32x32x16_bf16 v[112:127], a[224:227], a[24:27], v[112:127]
    ds_read_b64_tr_b16 a[194:195], v36 offset:17408
    v_rcp_f32 v177, v177
    v_rcp_f32 v178, v178
    v_rcp_f32 v179, v179
    v_mfma_f32_32x32x16_bf16 v[64:79], a[228:231], a[8:11], v[64:79]
    ds_read_b64_tr_b16 a[196:197], v37 offset:16384
    buffer_load_dwordx4 a[84:87], v1, s[20:23], s58 offen offset:1024 sc1
    v_mul_f32 v196, v196, v176
    v_mul_f32 v197, v197, v177
    v_mul_f32 v198, v198, v178
    v_mfma_f32_32x32x16_bf16 v[128:143], a[228:231], a[24:27], v[128:143]
    ds_read_b64_tr_b16 a[198:199], v37 offset:17408
    v_mul_f32 v199, v199, v179
    v_mul_f32 v176, v200, v200
    v_mul_f32 v177, v201, v201
    v_mfma_f32_32x32x16_bf16 v[80:95], a[232:235], a[8:11], v[80:95]
    ds_read_b64_tr_b16 a[200:201], v38 offset:16384
    buffer_load_dwordx4 a[88:91], v1, s[20:23], s58 offen offset:2048 sc1
    v_mul_f32 v178, v202, v202
    v_mul_f32 v179, v203, v203
    v_fma_f32 v176, v176, v181, v180
    v_mfma_f32_32x32x16_bf16 v[144:159], a[232:235], a[24:27], v[144:159]
    ds_read_b64_tr_b16 a[202:203], v38 offset:17408
    v_fma_f32 v177, v177, v181, v180
    v_fma_f32 v178, v178, v181, v180
    v_fma_f32 v179, v179, v181, v180
    v_mfma_f32_32x32x16_bf16 v[96:111], a[236:239], a[8:11], v[96:111]
    ds_read_b64_tr_b16 a[204:205], v39 offset:16384
    buffer_load_dwordx4 a[92:95], v1, s[20:23], s58 offen offset:3072 sc1
    v_mul_f32 v176, v176, v200
    v_mul_f32 v177, v177, v201
    v_mul_f32 v178, v178, v202
    v_mfma_f32_32x32x16_bf16 v[160:175], a[236:239], a[24:27], v[160:175]
    ds_read_b64_tr_b16 a[206:207], v39 offset:17408
    v_mul_f32 v179, v179, v203
    v_exp_f32 v176, v176
    v_exp_f32 v177, v177
    v_mfma_f32_32x32x16_bf16 v[48:63], a[240:243], a[12:15], v[48:63]
    ds_read_b64_tr_b16 a[208:209], v36 offset:20480
    s_add_u32 m0, s57, 49152
    s_add_u32 s58, s56, 1572864
    buffer_load_dwordx4 v32, s[8:11], s58 offen offset:0 lds
    v_exp_f32 v178, v178
    v_exp_f32 v179, v179
    v_add_f32 v176, 1.0, v176
    v_mfma_f32_32x32x16_bf16 v[112:127], a[240:243], a[28:31], v[112:127]
    ds_read_b64_tr_b16 a[210:211], v36 offset:21504
    v_add_f32 v177, 1.0, v177
    v_add_f32 v178, 1.0, v178
    v_add_f32 v179, 1.0, v179
    v_mfma_f32_32x32x16_bf16 v[64:79], a[244:247], a[12:15], v[64:79]
    ds_read_b64_tr_b16 a[212:213], v37 offset:20480
    buffer_load_dwordx4 v33, s[8:11], s58 offen offset:1024 lds
    v_rcp_f32 v176, v176
    v_rcp_f32 v177, v177
    v_rcp_f32 v178, v178
    v_mfma_f32_32x32x16_bf16 v[128:143], a[244:247], a[28:31], v[128:143]
    ds_read_b64_tr_b16 a[214:215], v37 offset:21504
    v_rcp_f32 v179, v179
    v_mul_f32 v200, v200, v176
    v_mul_f32 v201, v201, v177
    v_mfma_f32_32x32x16_bf16 v[80:95], a[248:251], a[12:15], v[80:95]
    ds_read_b64_tr_b16 a[216:217], v38 offset:20480
    buffer_load_dwordx4 v34, s[8:11], s58 offen offset:2048 lds
    v_mul_f32 v202, v202, v178
    v_mul_f32 v203, v203, v179
    v_mul_f32 v176, v204, v204
    v_mfma_f32_32x32x16_bf16 v[144:159], a[248:251], a[28:31], v[144:159]
    ds_read_b64_tr_b16 a[218:219], v38 offset:21504
    v_mul_f32 v177, v205, v205
    v_mul_f32 v178, v206, v206
    v_mul_f32 v179, v207, v207
    v_mfma_f32_32x32x16_bf16 v[96:111], a[252:255], a[12:15], v[96:111]
    ds_read_b64_tr_b16 a[220:221], v39 offset:20480
    buffer_load_dwordx4 v35, s[8:11], s58 offen offset:3072 lds
    v_fma_f32 v176, v176, v181, v180
    v_fma_f32 v177, v177, v181, v180
    v_fma_f32 v178, v178, v181, v180
    v_mfma_f32_32x32x16_bf16 v[160:175], a[252:255], a[28:31], v[160:175]
    ds_read_b64_tr_b16 a[222:223], v39 offset:21504
    v_fma_f32 v179, v179, v181, v180
    v_mul_f32 v176, v176, v204
    v_mul_f32 v177, v177, v205
    s_waitcnt lgkmcnt(8)
    s_waitcnt vmcnt(16)
    v_mfma_f32_32x32x16_bf16 v[48:63], a[192:195], a[32:35], v[48:63]
    ds_read_b64_tr_b16 a[224:225], v36 offset:24576
    s_add_u32 s58, s55, 12288
    buffer_load_dwordx4 a[96:99], v1, s[20:23], s58 offen offset:0 sc1
    v_mul_f32 v178, v178, v206
    v_mul_f32 v179, v179, v207
    v_exp_f32 v176, v176
    v_mfma_f32_32x32x16_bf16 v[112:127], a[192:195], a[48:51], v[112:127]
    ds_read_b64_tr_b16 a[226:227], v36 offset:25600
    v_exp_f32 v177, v177
    v_exp_f32 v178, v178
    v_exp_f32 v179, v179
    v_mfma_f32_32x32x16_bf16 v[64:79], a[196:199], a[32:35], v[64:79]
    ds_read_b64_tr_b16 a[228:229], v37 offset:24576
    buffer_load_dwordx4 a[100:103], v1, s[20:23], s58 offen offset:1024 sc1
    v_add_f32 v176, 1.0, v176
    v_add_f32 v177, 1.0, v177
    v_add_f32 v178, 1.0, v178
    v_mfma_f32_32x32x16_bf16 v[128:143], a[196:199], a[48:51], v[128:143]
    ds_read_b64_tr_b16 a[230:231], v37 offset:25600
    v_add_f32 v179, 1.0, v179
    v_rcp_f32 v176, v176
    v_rcp_f32 v177, v177
    v_mfma_f32_32x32x16_bf16 v[80:95], a[200:203], a[32:35], v[80:95]
    ds_read_b64_tr_b16 a[232:233], v38 offset:24576
    buffer_load_dwordx4 a[104:107], v1, s[20:23], s58 offen offset:2048 sc1
    v_rcp_f32 v178, v178
    v_rcp_f32 v179, v179
    v_mul_f32 v204, v204, v176
    v_mfma_f32_32x32x16_bf16 v[144:159], a[200:203], a[48:51], v[144:159]
    ds_read_b64_tr_b16 a[234:235], v38 offset:25600
    v_mul_f32 v205, v205, v177
    v_mul_f32 v206, v206, v178
    v_mul_f32 v207, v207, v179
    v_mfma_f32_32x32x16_bf16 v[96:111], a[204:207], a[32:35], v[96:111]
    ds_read_b64_tr_b16 a[236:237], v39 offset:24576
    buffer_load_dwordx4 a[108:111], v1, s[20:23], s58 offen offset:3072 sc1
    v_mul_f32 v176, v208, v208
    v_mul_f32 v177, v209, v209
    v_mul_f32 v178, v210, v210
    v_mfma_f32_32x32x16_bf16 v[160:175], a[204:207], a[48:51], v[160:175]
    ds_read_b64_tr_b16 a[238:239], v39 offset:25600
    v_mul_f32 v179, v211, v211
    v_fma_f32 v176, v176, v181, v180
    v_fma_f32 v177, v177, v181, v180
    s_waitcnt lgkmcnt(8)
    v_mfma_f32_32x32x16_bf16 v[48:63], a[208:211], a[36:39], v[48:63]
    ds_read_b64_tr_b16 a[240:241], v36 offset:28672
    s_add_u32 s58, s55, 45056
    buffer_load_dwordx4 a[112:115], v1, s[20:23], s58 offen offset:0 sc1
    v_fma_f32 v178, v178, v181, v180
    v_fma_f32 v179, v179, v181, v180
    v_mul_f32 v176, v176, v208
    v_mfma_f32_32x32x16_bf16 v[112:127], a[208:211], a[52:55], v[112:127]
    ds_read_b64_tr_b16 a[242:243], v36 offset:29696
    v_mul_f32 v177, v177, v209
    v_mul_f32 v178, v178, v210
    v_mul_f32 v179, v179, v211
    v_mfma_f32_32x32x16_bf16 v[64:79], a[212:215], a[36:39], v[64:79]
    ds_read_b64_tr_b16 a[244:245], v37 offset:28672
    buffer_load_dwordx4 a[116:119], v1, s[20:23], s58 offen offset:1024 sc1
    v_exp_f32 v176, v176
    v_exp_f32 v177, v177
    v_exp_f32 v178, v178
    v_mfma_f32_32x32x16_bf16 v[128:143], a[212:215], a[52:55], v[128:143]
    ds_read_b64_tr_b16 a[246:247], v37 offset:29696
    v_exp_f32 v179, v179
    v_add_f32 v176, 1.0, v176
    v_add_f32 v177, 1.0, v177
    v_mfma_f32_32x32x16_bf16 v[80:95], a[216:219], a[36:39], v[80:95]
    ds_read_b64_tr_b16 a[248:249], v38 offset:28672
    buffer_load_dwordx4 a[120:123], v1, s[20:23], s58 offen offset:2048 sc1
    v_add_f32 v178, 1.0, v178
    v_add_f32 v179, 1.0, v179
    v_rcp_f32 v176, v176
    v_mfma_f32_32x32x16_bf16 v[144:159], a[216:219], a[52:55], v[144:159]
    ds_read_b64_tr_b16 a[250:251], v38 offset:29696
    v_rcp_f32 v177, v177
    v_rcp_f32 v178, v178
    v_rcp_f32 v179, v179
    v_mul_f32 v208, v208, v176
    v_mfma_f32_32x32x16_bf16 v[96:111], a[220:223], a[36:39], v[96:111]
    ds_read_b64_tr_b16 a[252:253], v39 offset:28672
    buffer_load_dwordx4 a[124:127], v1, s[20:23], s58 offen offset:3072 sc1
    v_mul_f32 v209, v209, v177
    v_mul_f32 v210, v210, v178
    v_mul_f32 v211, v211, v179
    v_mfma_f32_32x32x16_bf16 v[160:175], a[220:223], a[52:55], v[160:175]
    ds_read_b64_tr_b16 a[254:255], v39 offset:29696
    v_mul_f32 v176, v212, v212
    v_mul_f32 v177, v213, v213
    v_mul_f32 v178, v214, v214
    s_waitcnt lgkmcnt(0)
    s_waitcnt vmcnt(20)
    s_barrier
    v_mfma_f32_32x32x16_bf16 v[48:63], a[224:227], a[40:43], v[48:63]
    ds_read_b64_tr_b16 a[192:193], v36 offset:32768
    s_add_u32 m0, s57, 65536
    s_add_u32 s58, s56, 2097152
    buffer_load_dwordx4 v32, s[8:11], s58 offen offset:0 lds
    v_mul_f32 v179, v215, v215
    v_fma_f32 v176, v176, v181, v180
    v_fma_f32 v177, v177, v181, v180
    v_mfma_f32_32x32x16_bf16 v[112:127], a[224:227], a[56:59], v[112:127]
    ds_read_b64_tr_b16 a[194:195], v36 offset:33792
    v_fma_f32 v178, v178, v181, v180
    v_fma_f32 v179, v179, v181, v180
    v_mul_f32 v176, v176, v212
    v_mfma_f32_32x32x16_bf16 v[64:79], a[228:231], a[40:43], v[64:79]
    ds_read_b64_tr_b16 a[196:197], v37 offset:32768
    buffer_load_dwordx4 v33, s[8:11], s58 offen offset:1024 lds
    v_mul_f32 v177, v177, v213
    v_mul_f32 v178, v178, v214
    v_mul_f32 v179, v179, v215
    v_mfma_f32_32x32x16_bf16 v[128:143], a[228:231], a[56:59], v[128:143]
    ds_read_b64_tr_b16 a[198:199], v37 offset:33792
    v_exp_f32 v176, v176
    v_exp_f32 v177, v177
    v_exp_f32 v178, v178
    v_mfma_f32_32x32x16_bf16 v[80:95], a[232:235], a[40:43], v[80:95]
    ds_read_b64_tr_b16 a[200:201], v38 offset:32768
    buffer_load_dwordx4 v34, s[8:11], s58 offen offset:2048 lds
    v_exp_f32 v179, v179
    v_add_f32 v176, 1.0, v176
    v_add_f32 v177, 1.0, v177
    v_mfma_f32_32x32x16_bf16 v[144:159], a[232:235], a[56:59], v[144:159]
    ds_read_b64_tr_b16 a[202:203], v38 offset:33792
    v_add_f32 v178, 1.0, v178
    v_add_f32 v179, 1.0, v179
    v_rcp_f32 v176, v176
    v_mfma_f32_32x32x16_bf16 v[96:111], a[236:239], a[40:43], v[96:111]
    ds_read_b64_tr_b16 a[204:205], v39 offset:32768
    buffer_load_dwordx4 v35, s[8:11], s58 offen offset:3072 lds
    v_rcp_f32 v177, v177
    v_rcp_f32 v178, v178
    v_rcp_f32 v179, v179
    v_mfma_f32_32x32x16_bf16 v[160:175], a[236:239], a[56:59], v[160:175]
    ds_read_b64_tr_b16 a[206:207], v39 offset:33792
    v_mul_f32 v212, v212, v176
    v_mul_f32 v213, v213, v177
    v_mul_f32 v214, v214, v178
    v_mfma_f32_32x32x16_bf16 v[48:63], a[240:243], a[44:47], v[48:63]
    ds_read_b64_tr_b16 a[208:209], v36 offset:36864
    s_add_u32 s58, s55, 16384
    buffer_load_dwordx4 a[0:3], v1, s[20:23], s58 offen offset:0 sc1
    v_mul_f32 v215, v215, v179
    v_mul_f32 v176, v216, v216
    v_mul_f32 v177, v217, v217
    v_mfma_f32_32x32x16_bf16 v[112:127], a[240:243], a[60:63], v[112:127]
    ds_read_b64_tr_b16 a[210:211], v36 offset:37888
    v_mul_f32 v178, v218, v218
    v_mul_f32 v179, v219, v219
    v_fma_f32 v176, v176, v181, v180
    v_mfma_f32_32x32x16_bf16 v[64:79], a[244:247], a[44:47], v[64:79]
    ds_read_b64_tr_b16 a[212:213], v37 offset:36864
    buffer_load_dwordx4 a[4:7], v1, s[20:23], s58 offen offset:1024 sc1
    v_fma_f32 v177, v177, v181, v180
    v_fma_f32 v178, v178, v181, v180
    v_fma_f32 v179, v179, v181, v180
    v_mfma_f32_32x32x16_bf16 v[128:143], a[244:247], a[60:63], v[128:143]
    ds_read_b64_tr_b16 a[214:215], v37 offset:37888
    v_mul_f32 v176, v176, v216
    v_mul_f32 v177, v177, v217
    v_mul_f32 v178, v178, v218
    v_mfma_f32_32x32x16_bf16 v[80:95], a[248:251], a[44:47], v[80:95]
    ds_read_b64_tr_b16 a[216:217], v38 offset:36864
    buffer_load_dwordx4 a[8:11], v1, s[20:23], s58 offen offset:2048 sc1
    v_mul_f32 v179, v179, v219
    v_exp_f32 v176, v176
    v_exp_f32 v177, v177
    v_mfma_f32_32x32x16_bf16 v[144:159], a[248:251], a[60:63], v[144:159]
    ds_read_b64_tr_b16 a[218:219], v38 offset:37888
    v_exp_f32 v178, v178
    v_exp_f32 v179, v179
    v_add_f32 v176, 1.0, v176
    v_mfma_f32_32x32x16_bf16 v[96:111], a[252:255], a[44:47], v[96:111]
    ds_read_b64_tr_b16 a[220:221], v39 offset:36864
    buffer_load_dwordx4 a[12:15], v1, s[20:23], s58 offen offset:3072 sc1
    v_add_f32 v177, 1.0, v177
    v_add_f32 v178, 1.0, v178
    v_add_f32 v179, 1.0, v179
    v_mfma_f32_32x32x16_bf16 v[160:175], a[252:255], a[60:63], v[160:175]
    ds_read_b64_tr_b16 a[222:223], v39 offset:37888
    v_rcp_f32 v176, v176
    v_rcp_f32 v177, v177
    v_rcp_f32 v178, v178
    s_waitcnt lgkmcnt(8)
    s_waitcnt vmcnt(20)
    v_mfma_f32_32x32x16_bf16 v[48:63], a[192:195], a[64:67], v[48:63]
    ds_read_b64_tr_b16 a[224:225], v36 offset:40960
    s_add_u32 s58, s55, 49152
    buffer_load_dwordx4 a[16:19], v1, s[20:23], s58 offen offset:0 sc1
    v_rcp_f32 v179, v179
    v_mul_f32 v216, v216, v176
    v_mul_f32 v217, v217, v177
    v_mfma_f32_32x32x16_bf16 v[112:127], a[192:195], a[80:83], v[112:127]
    ds_read_b64_tr_b16 a[226:227], v36 offset:41984
    v_mul_f32 v218, v218, v178
    v_mul_f32 v219, v219, v179
    v_mul_f32 v176, v220, v220
    v_mfma_f32_32x32x16_bf16 v[64:79], a[196:199], a[64:67], v[64:79]
    ds_read_b64_tr_b16 a[228:229], v37 offset:40960
    buffer_load_dwordx4 a[20:23], v1, s[20:23], s58 offen offset:1024 sc1
    v_mul_f32 v177, v221, v221
    v_mul_f32 v178, v222, v222
    v_mul_f32 v179, v223, v223
    v_mfma_f32_32x32x16_bf16 v[128:143], a[196:199], a[80:83], v[128:143]
    ds_read_b64_tr_b16 a[230:231], v37 offset:41984
    v_fma_f32 v176, v176, v181, v180
    v_fma_f32 v177, v177, v181, v180
    v_fma_f32 v178, v178, v181, v180
    v_mfma_f32_32x32x16_bf16 v[80:95], a[200:203], a[64:67], v[80:95]
    ds_read_b64_tr_b16 a[232:233], v38 offset:40960
    buffer_load_dwordx4 a[24:27], v1, s[20:23], s58 offen offset:2048 sc1
    v_fma_f32 v179, v179, v181, v180
    v_mul_f32 v176, v176, v220
    v_mul_f32 v177, v177, v221
    v_mfma_f32_32x32x16_bf16 v[144:159], a[200:203], a[80:83], v[144:159]
    ds_read_b64_tr_b16 a[234:235], v38 offset:41984
    v_mul_f32 v178, v178, v222
    v_mul_f32 v179, v179, v223
    v_exp_f32 v176, v176
    v_mfma_f32_32x32x16_bf16 v[96:111], a[204:207], a[64:67], v[96:111]
    ds_read_b64_tr_b16 a[236:237], v39 offset:40960
    buffer_load_dwordx4 a[28:31], v1, s[20:23], s58 offen offset:3072 sc1
    v_exp_f32 v177, v177
    v_exp_f32 v178, v178
    v_exp_f32 v179, v179
    v_mfma_f32_32x32x16_bf16 v[160:175], a[204:207], a[80:83], v[160:175]
    ds_read_b64_tr_b16 a[238:239], v39 offset:41984
    v_add_f32 v176, 1.0, v176
    v_add_f32 v177, 1.0, v177
    v_add_f32 v178, 1.0, v178
    s_waitcnt lgkmcnt(8)
    v_mfma_f32_32x32x16_bf16 v[48:63], a[208:211], a[68:71], v[48:63]
    ds_read_b64_tr_b16 a[240:241], v36 offset:45056
    s_add_u32 m0, s57, 81920
    s_add_u32 s58, s56, 2621440
    buffer_load_dwordx4 v32, s[8:11], s58 offen offset:0 lds
    v_add_f32 v179, 1.0, v179
    v_rcp_f32 v176, v176
    v_rcp_f32 v177, v177
    v_mfma_f32_32x32x16_bf16 v[112:127], a[208:211], a[84:87], v[112:127]
    ds_read_b64_tr_b16 a[242:243], v36 offset:46080
    v_rcp_f32 v178, v178
    v_rcp_f32 v179, v179
    v_mul_f32 v220, v220, v176
    v_mfma_f32_32x32x16_bf16 v[64:79], a[212:215], a[68:71], v[64:79]
    ds_read_b64_tr_b16 a[244:245], v37 offset:45056
    buffer_load_dwordx4 v33, s[8:11], s58 offen offset:1024 lds
    v_mul_f32 v221, v221, v177
    v_mul_f32 v222, v222, v178
    v_mul_f32 v223, v223, v179
    v_mfma_f32_32x32x16_bf16 v[128:143], a[212:215], a[84:87], v[128:143]
    ds_read_b64_tr_b16 a[246:247], v37 offset:46080
    v_mul_f32 v176, v224, v224
    v_mul_f32 v177, v225, v225
    v_mul_f32 v178, v226, v226
    v_mfma_f32_32x32x16_bf16 v[80:95], a[216:219], a[68:71], v[80:95]
    ds_read_b64_tr_b16 a[248:249], v38 offset:45056
    buffer_load_dwordx4 v34, s[8:11], s58 offen offset:2048 lds
    v_mul_f32 v179, v227, v227
    v_fma_f32 v176, v176, v181, v180
    v_fma_f32 v177, v177, v181, v180
    v_mfma_f32_32x32x16_bf16 v[144:159], a[216:219], a[84:87], v[144:159]
    ds_read_b64_tr_b16 a[250:251], v38 offset:46080
    v_fma_f32 v178, v178, v181, v180
    v_fma_f32 v179, v179, v181, v180
    v_mul_f32 v176, v176, v224
    v_mfma_f32_32x32x16_bf16 v[96:111], a[220:223], a[68:71], v[96:111]
    ds_read_b64_tr_b16 a[252:253], v39 offset:45056
    buffer_load_dwordx4 v35, s[8:11], s58 offen offset:3072 lds
    v_mul_f32 v177, v177, v225
    v_mul_f32 v178, v178, v226
    v_mul_f32 v179, v179, v227
    v_mfma_f32_32x32x16_bf16 v[160:175], a[220:223], a[84:87], v[160:175]
    ds_read_b64_tr_b16 a[254:255], v39 offset:46080
    v_exp_f32 v176, v176
    v_exp_f32 v177, v177
    v_exp_f32 v178, v178
    s_waitcnt lgkmcnt(0)
    s_waitcnt vmcnt(24)
    s_barrier
    v_mfma_f32_32x32x16_bf16 v[48:63], a[224:227], a[72:75], v[48:63]
    ds_read_b64_tr_b16 a[192:193], v36 offset:49152
    s_add_u32 s58, s55, 20480
    buffer_load_dwordx4 a[32:35], v1, s[20:23], s58 offen offset:0 sc1
    v_exp_f32 v179, v179
    v_add_f32 v176, 1.0, v176
    v_add_f32 v177, 1.0, v177
    v_mfma_f32_32x32x16_bf16 v[112:127], a[224:227], a[88:91], v[112:127]
    ds_read_b64_tr_b16 a[194:195], v36 offset:50176
    v_add_f32 v178, 1.0, v178
    v_add_f32 v179, 1.0, v179
    v_rcp_f32 v176, v176
    v_mfma_f32_32x32x16_bf16 v[64:79], a[228:231], a[72:75], v[64:79]
    ds_read_b64_tr_b16 a[196:197], v37 offset:49152
    buffer_load_dwordx4 a[36:39], v1, s[20:23], s58 offen offset:1024 sc1
    v_rcp_f32 v177, v177
    v_rcp_f32 v178, v178
    v_rcp_f32 v179, v179
    v_mfma_f32_32x32x16_bf16 v[128:143], a[228:231], a[88:91], v[128:143]
    ds_read_b64_tr_b16 a[198:199], v37 offset:50176
    v_mul_f32 v224, v224, v176
    v_mul_f32 v225, v225, v177
    v_mul_f32 v226, v226, v178
    v_mfma_f32_32x32x16_bf16 v[80:95], a[232:235], a[72:75], v[80:95]
    ds_read_b64_tr_b16 a[200:201], v38 offset:49152
    buffer_load_dwordx4 a[40:43], v1, s[20:23], s58 offen offset:2048 sc1
    v_mul_f32 v227, v227, v179
    v_mul_f32 v176, v228, v228
    v_mul_f32 v177, v229, v229
    v_mfma_f32_32x32x16_bf16 v[144:159], a[232:235], a[88:91], v[144:159]
    ds_read_b64_tr_b16 a[202:203], v38 offset:50176
    v_mul_f32 v178, v230, v230
    v_mul_f32 v179, v231, v231
    v_fma_f32 v176, v176, v181, v180
    v_mfma_f32_32x32x16_bf16 v[96:111], a[236:239], a[72:75], v[96:111]
    ds_read_b64_tr_b16 a[204:205], v39 offset:49152
    buffer_load_dwordx4 a[44:47], v1, s[20:23], s58 offen offset:3072 sc1
    v_fma_f32 v177, v177, v181, v180
    v_fma_f32 v178, v178, v181, v180
    v_fma_f32 v179, v179, v181, v180
    v_mfma_f32_32x32x16_bf16 v[160:175], a[236:239], a[88:91], v[160:175]
    ds_read_b64_tr_b16 a[206:207], v39 offset:50176
    v_mul_f32 v176, v176, v228
    v_mul_f32 v177, v177, v229
    v_mul_f32 v178, v178, v230
    v_mfma_f32_32x32x16_bf16 v[48:63], a[240:243], a[76:79], v[48:63]
    ds_read_b64_tr_b16 a[208:209], v36 offset:53248
    s_add_u32 s58, s55, 53248
    buffer_load_dwordx4 a[48:51], v1, s[20:23], s58 offen offset:0 sc1
    v_mul_f32 v179, v179, v231
    v_exp_f32 v176, v176
    v_exp_f32 v177, v177
    v_mfma_f32_32x32x16_bf16 v[112:127], a[240:243], a[92:95], v[112:127]
    ds_read_b64_tr_b16 a[210:211], v36 offset:54272
    v_exp_f32 v178, v178
    v_exp_f32 v179, v179
    v_add_f32 v176, 1.0, v176
    v_mfma_f32_32x32x16_bf16 v[64:79], a[244:247], a[76:79], v[64:79]
    ds_read_b64_tr_b16 a[212:213], v37 offset:53248
    buffer_load_dwordx4 a[52:55], v1, s[20:23], s58 offen offset:1024 sc1
    v_add_f32 v177, 1.0, v177
    v_add_f32 v178, 1.0, v178
    v_add_f32 v179, 1.0, v179
    v_mfma_f32_32x32x16_bf16 v[128:143], a[244:247], a[92:95], v[128:143]
    ds_read_b64_tr_b16 a[214:215], v37 offset:54272
    v_rcp_f32 v176, v176
    v_rcp_f32 v177, v177
    v_rcp_f32 v178, v178
    v_rcp_f32 v179, v179
    s_mov_b32 s37, 42614784
    s_cmp_lg_u32 s32, 0
    s_cbranch_scc1 L_W0_19
    v_lshlrev_b32 v240, 4, v0
    buffer_load_dword v241, v240, s[20:23], s37 offen offset:0 sc0 sc1
    buffer_load_dword v242, v240, s[20:23], s37 offen offset:1024 sc0 sc1
    buffer_load_dword v243, v240, s[20:23], s37 offen offset:2048 sc0 sc1
    buffer_load_dword v244, v240, s[20:23], s37 offen offset:3072 sc0 sc1
L_W0_19:
    v_mfma_f32_32x32x16_bf16 v[80:95], a[248:251], a[76:79], v[80:95]
    ds_read_b64_tr_b16 a[216:217], v38 offset:53248
    buffer_load_dwordx4 a[56:59], v1, s[20:23], s58 offen offset:2048 sc1
    v_mul_f32 v228, v228, v176
    v_mul_f32 v229, v229, v177
    v_mul_f32 v230, v230, v178
    v_mfma_f32_32x32x16_bf16 v[144:159], a[248:251], a[92:95], v[144:159]
    ds_read_b64_tr_b16 a[218:219], v38 offset:54272
    v_mul_f32 v231, v231, v179
    v_mul_f32 v176, v232, v232
    v_mul_f32 v177, v233, v233
    v_mfma_f32_32x32x16_bf16 v[96:111], a[252:255], a[76:79], v[96:111]
    ds_read_b64_tr_b16 a[220:221], v39 offset:53248
    buffer_load_dwordx4 a[60:63], v1, s[20:23], s58 offen offset:3072 sc1
    v_mul_f32 v178, v234, v234
    v_mul_f32 v179, v235, v235
    v_fma_f32 v176, v176, v181, v180
    v_mfma_f32_32x32x16_bf16 v[160:175], a[252:255], a[92:95], v[160:175]
    ds_read_b64_tr_b16 a[222:223], v39 offset:54272
    v_fma_f32 v177, v177, v181, v180
    v_fma_f32 v178, v178, v181, v180
    v_fma_f32 v179, v179, v181, v180
    s_waitcnt lgkmcnt(8)
    s_waitcnt vmcnt(24)
    v_mfma_f32_32x32x16_bf16 v[48:63], a[192:195], a[96:99], v[48:63]
    ds_read_b64_tr_b16 a[224:225], v36 offset:57344
    s_add_u32 m0, s57, 98304
    s_add_u32 s58, s56, 3145728
    buffer_load_dwordx4 v32, s[8:11], s58 offen offset:0 lds
    v_mul_f32 v176, v176, v232
    v_mul_f32 v177, v177, v233
    v_mul_f32 v178, v178, v234
    v_mfma_f32_32x32x16_bf16 v[112:127], a[192:195], a[112:115], v[112:127]
    ds_read_b64_tr_b16 a[226:227], v36 offset:58368
    v_mul_f32 v179, v179, v235
    v_exp_f32 v176, v176
    v_exp_f32 v177, v177
    v_mfma_f32_32x32x16_bf16 v[64:79], a[196:199], a[96:99], v[64:79]
    ds_read_b64_tr_b16 a[228:229], v37 offset:57344
    buffer_load_dwordx4 v33, s[8:11], s58 offen offset:1024 lds
    v_exp_f32 v178, v178
    v_exp_f32 v179, v179
    v_add_f32 v176, 1.0, v176
    v_mfma_f32_32x32x16_bf16 v[128:143], a[196:199], a[112:115], v[128:143]
    ds_read_b64_tr_b16 a[230:231], v37 offset:58368
    v_add_f32 v177, 1.0, v177
    v_add_f32 v178, 1.0, v178
    v_add_f32 v179, 1.0, v179
    v_mfma_f32_32x32x16_bf16 v[80:95], a[200:203], a[96:99], v[80:95]
    ds_read_b64_tr_b16 a[232:233], v38 offset:57344
    buffer_load_dwordx4 v34, s[8:11], s58 offen offset:2048 lds
    v_rcp_f32 v176, v176
    v_rcp_f32 v177, v177
    v_rcp_f32 v178, v178
    v_mfma_f32_32x32x16_bf16 v[144:159], a[200:203], a[112:115], v[144:159]
    ds_read_b64_tr_b16 a[234:235], v38 offset:58368
    v_rcp_f32 v179, v179
    v_mul_f32 v232, v232, v176
    v_mul_f32 v233, v233, v177
    v_mfma_f32_32x32x16_bf16 v[96:111], a[204:207], a[96:99], v[96:111]
    ds_read_b64_tr_b16 a[236:237], v39 offset:57344
    buffer_load_dwordx4 v35, s[8:11], s58 offen offset:3072 lds
    v_mul_f32 v234, v234, v178
    v_mul_f32 v235, v235, v179
    v_mul_f32 v176, v236, v236
    v_mfma_f32_32x32x16_bf16 v[160:175], a[204:207], a[112:115], v[160:175]
    ds_read_b64_tr_b16 a[238:239], v39 offset:58368
    v_mul_f32 v177, v237, v237
    v_mul_f32 v178, v238, v238
    v_mul_f32 v179, v239, v239
    s_waitcnt lgkmcnt(8)
    v_mfma_f32_32x32x16_bf16 v[48:63], a[208:211], a[100:103], v[48:63]
    ds_read_b64_tr_b16 a[240:241], v36 offset:61440
    buffer_load_dword v252, v1, s[64:67], s68 offen
    v_fma_f32 v176, v176, v181, v180
    v_fma_f32 v177, v177, v181, v180
    v_fma_f32 v178, v178, v181, v180
    v_mfma_f32_32x32x16_bf16 v[112:127], a[208:211], a[116:119], v[112:127]
    ds_read_b64_tr_b16 a[242:243], v36 offset:62464
    v_fma_f32 v179, v179, v181, v180
    v_mul_f32 v176, v176, v236
    v_mul_f32 v177, v177, v237
    v_mfma_f32_32x32x16_bf16 v[64:79], a[212:215], a[100:103], v[64:79]
    ds_read_b64_tr_b16 a[244:245], v37 offset:61440
    s_add_u32 s58, s55, 24576
    buffer_load_dwordx4 a[64:67], v1, s[20:23], s58 offen offset:0 sc1
    v_mul_f32 v178, v178, v238
    v_mul_f32 v179, v179, v239
    v_exp_f32 v176, v176
    v_mfma_f32_32x32x16_bf16 v[128:143], a[212:215], a[116:119], v[128:143]
    ds_read_b64_tr_b16 a[246:247], v37 offset:62464
    v_exp_f32 v177, v177
    v_exp_f32 v178, v178
    v_exp_f32 v179, v179
    v_mfma_f32_32x32x16_bf16 v[80:95], a[216:219], a[100:103], v[80:95]
    ds_read_b64_tr_b16 a[248:249], v38 offset:61440
    buffer_load_dwordx4 a[68:71], v1, s[20:23], s58 offen offset:1024 sc1
    v_add_f32 v176, 1.0, v176
    v_add_f32 v177, 1.0, v177
    v_add_f32 v178, 1.0, v178
    v_mfma_f32_32x32x16_bf16 v[144:159], a[216:219], a[116:119], v[144:159]
    ds_read_b64_tr_b16 a[250:251], v38 offset:62464
    v_add_f32 v179, 1.0, v179
    v_rcp_f32 v176, v176
    v_rcp_f32 v177, v177
    v_mfma_f32_32x32x16_bf16 v[96:111], a[220:223], a[100:103], v[96:111]
    ds_read_b64_tr_b16 a[252:253], v39 offset:61440
    buffer_load_dwordx4 a[72:75], v1, s[20:23], s58 offen offset:2048 sc1
    v_rcp_f32 v178, v178
    v_rcp_f32 v179, v179
    v_mul_f32 v236, v236, v176
    v_mfma_f32_32x32x16_bf16 v[160:175], a[220:223], a[116:119], v[160:175]
    ds_read_b64_tr_b16 a[254:255], v39 offset:62464
    v_mul_f32 v237, v237, v177
    v_mul_f32 v238, v238, v178
    v_mul_f32 v239, v239, v179
    s_waitcnt lgkmcnt(0)
    s_waitcnt vmcnt(28)
    s_cmp_lg_u32 s32, 0
    s_cbranch_scc1 L_W0_21
    s_waitcnt vmcnt(10)
    v_and_b32 v241, v241, v242
    v_and_b32 v241, v241, v243
    v_and_b32 v241, v241, v244
    v_cmp_ne_u32 vcc, 0x1, v241
    s_nop 1
    s_cbranch_vccz L_POK_20
L_PLP_20:
    s_sleep 4
    buffer_load_dword v241, v240, s[20:23], s37 offen offset:0 sc0 sc1
    buffer_load_dword v242, v240, s[20:23], s37 offen offset:1024 sc0 sc1
    buffer_load_dword v243, v240, s[20:23], s37 offen offset:2048 sc0 sc1
    buffer_load_dword v244, v240, s[20:23], s37 offen offset:3072 sc0 sc1
    s_waitcnt vmcnt(0)
    v_and_b32 v241, v241, v242
    v_and_b32 v241, v241, v243
    v_and_b32 v241, v241, v244
    v_cmp_ne_u32 vcc, 0x1, v241
    s_nop 1
    s_cbranch_vccnz L_PLP_20
L_POK_20:
L_W0_21:
    s_barrier
    v_mfma_f32_32x32x16_bf16 v[48:63], a[224:227], a[104:107], v[48:63]
    ds_read_b64_tr_b16 a[192:193], v40 offset:0
    buffer_load_dwordx4 a[76:79], v1, s[20:23], s58 offen offset:3072 sc1
    s_mul_i32 s98, s36, 9216
    s_add_u32 s98, s98, 131072
    v_mul_u32_u24 v182, 576, v21
    v_mfma_f32_32x32x16_bf16 v[112:127], a[224:227], a[120:123], v[112:127]
    ds_read_b64_tr_b16 a[194:195], v40 offset:1024
    v_lshl_add_u32 v182, v20, 2, v182
    v_add_u32 v182, s98, v182
    v_mul_u32_u24 v183, 144, v0
    v_mfma_f32_32x32x16_bf16 v[64:79], a[228:231], a[104:107], v[64:79]
    ds_read_b64_tr_b16 a[196:197], v41 offset:0
    s_add_u32 s58, s55, 57344
    buffer_load_dwordx4 a[80:83], v1, s[20:23], s58 offen offset:0 sc1
    v_add_u32 v183, s98, v183
    v_add_f32 v184, v192, v208
    v_mul_f32 v185, v192, v192
    v_mfma_f32_32x32x16_bf16 v[128:143], a[228:231], a[120:123], v[128:143]
    ds_read_b64_tr_b16 a[198:199], v41 offset:1024
    v_add_f32 v184, v184, v224
    v_fmac_f32 v185, v208, v208
    v_fmac_f32 v185, v224, v224
    v_mfma_f32_32x32x16_bf16 v[80:95], a[232:235], a[104:107], v[80:95]
    ds_read_b64_tr_b16 a[200:201], v42 offset:0
    buffer_load_dwordx4 a[84:87], v1, s[20:23], s58 offen offset:1024 sc1
    ds_write_b32 v182, v184 offset:0
    ds_write_b32 v182, v185 offset:4608
    v_add_f32 v186, v193, v209
    v_mfma_f32_32x32x16_bf16 v[144:159], a[232:235], a[120:123], v[144:159]
    ds_read_b64_tr_b16 a[202:203], v42 offset:1024
    v_mul_f32 v187, v193, v193
    v_add_f32 v186, v186, v225
    v_fmac_f32 v187, v209, v209
    v_mfma_f32_32x32x16_bf16 v[96:111], a[236:239], a[104:107], v[96:111]
    ds_read_b64_tr_b16 a[204:205], v43 offset:0
    buffer_load_dwordx4 a[88:91], v1, s[20:23], s58 offen offset:2048 sc1
    v_fmac_f32 v187, v225, v225
    ds_write_b32 v182, v186 offset:144
    ds_write_b32 v182, v187 offset:4752
    v_mfma_f32_32x32x16_bf16 v[160:175], a[236:239], a[120:123], v[160:175]
    ds_read_b64_tr_b16 a[206:207], v43 offset:1024
    v_add_f32 v188, v194, v210
    v_mul_f32 v189, v194, v194
    v_add_f32 v188, v188, v226
    v_mfma_f32_32x32x16_bf16 v[48:63], a[240:243], a[108:111], v[48:63]
    ds_read_b64_tr_b16 a[208:209], v40 offset:4096
    buffer_load_dwordx4 a[92:95], v1, s[20:23], s58 offen offset:3072 sc1
    v_fmac_f32 v189, v210, v210
    v_fmac_f32 v189, v226, v226
    ds_write_b32 v182, v188 offset:288
    v_mfma_f32_32x32x16_bf16 v[112:127], a[240:243], a[124:127], v[112:127]
    ds_read_b64_tr_b16 a[210:211], v40 offset:5120
    ds_write_b32 v182, v189 offset:4896
    v_add_f32 v190, v195, v211
    v_mul_f32 v191, v195, v195
    v_mfma_f32_32x32x16_bf16 v[64:79], a[244:247], a[108:111], v[64:79]
    ds_read_b64_tr_b16 a[212:213], v41 offset:4096
    s_add_u32 m0, s57, 114688
    s_add_u32 s58, s56, 3670016
    buffer_load_dwordx4 v32, s[8:11], s58 offen offset:0 lds
    v_add_f32 v190, v190, v227
    v_fmac_f32 v191, v211, v211
    v_fmac_f32 v191, v227, v227
    v_mfma_f32_32x32x16_bf16 v[128:143], a[244:247], a[124:127], v[128:143]
    ds_read_b64_tr_b16 a[214:215], v41 offset:5120
    ds_write_b32 v182, v190 offset:432
    ds_write_b32 v182, v191 offset:5040
    v_add_f32 v184, v196, v212
    v_mfma_f32_32x32x16_bf16 v[80:95], a[248:251], a[108:111], v[80:95]
    ds_read_b64_tr_b16 a[216:217], v42 offset:4096
    buffer_load_dwordx4 v33, s[8:11], s58 offen offset:1024 lds
    v_mul_f32 v185, v196, v196
    v_add_f32 v184, v184, v228
    v_fmac_f32 v185, v212, v212
    v_mfma_f32_32x32x16_bf16 v[144:159], a[248:251], a[124:127], v[144:159]
    ds_read_b64_tr_b16 a[218:219], v42 offset:5120
    v_fmac_f32 v185, v228, v228
    ds_write_b32 v182, v184 offset:1152
    ds_write_b32 v182, v185 offset:5760
    v_mfma_f32_32x32x16_bf16 v[96:111], a[252:255], a[108:111], v[96:111]
    ds_read_b64_tr_b16 a[220:221], v43 offset:4096
    buffer_load_dwordx4 v34, s[8:11], s58 offen offset:2048 lds
    v_add_f32 v186, v197, v213
    v_mul_f32 v187, v197, v197
    v_add_f32 v186, v186, v229
    v_mfma_f32_32x32x16_bf16 v[160:175], a[252:255], a[124:127], v[160:175]
    ds_read_b64_tr_b16 a[222:223], v43 offset:5120
    v_fmac_f32 v187, v213, v213
    v_fmac_f32 v187, v229, v229
    ds_write_b32 v182, v186 offset:1296
    s_waitcnt lgkmcnt(15)
    s_waitcnt vmcnt(28)
    v_mfma_f32_32x32x16_bf16 v[48:63], a[192:195], a[0:3], v[48:63]
    ds_read_b64_tr_b16 a[224:225], v40 offset:8192
    buffer_load_dwordx4 v35, s[8:11], s58 offen offset:3072 lds
    ds_write_b32 v182, v187 offset:5904
    v_add_f32 v188, v198, v214
    v_mul_f32 v189, v198, v198
    v_mfma_f32_32x32x16_bf16 v[112:127], a[192:195], a[16:19], v[112:127]
    ds_read_b64_tr_b16 a[226:227], v40 offset:9216
    v_add_f32 v188, v188, v230
    v_fmac_f32 v189, v214, v214
    v_fmac_f32 v189, v230, v230
    v_mfma_f32_32x32x16_bf16 v[64:79], a[196:199], a[0:3], v[64:79]
    ds_read_b64_tr_b16 a[228:229], v41 offset:8192
    s_add_u32 s58, s55, 28672
    buffer_load_dwordx4 a[96:99], v1, s[20:23], s58 offen offset:0 sc1
    ds_write_b32 v182, v188 offset:1440
    ds_write_b32 v182, v189 offset:6048
    v_add_f32 v190, v199, v215
    v_mfma_f32_32x32x16_bf16 v[128:143], a[196:199], a[16:19], v[128:143]
    ds_read_b64_tr_b16 a[230:231], v41 offset:9216
    v_mul_f32 v191, v199, v199
    v_add_f32 v190, v190, v231
    v_fmac_f32 v191, v215, v215
    v_mfma_f32_32x32x16_bf16 v[80:95], a[200:203], a[0:3], v[80:95]
    ds_read_b64_tr_b16 a[232:233], v42 offset:8192
    buffer_load_dwordx4 a[100:103], v1, s[20:23], s58 offen offset:1024 sc1
    v_fmac_f32 v191, v231, v231
    ds_write_b32 v182, v190 offset:1584
    ds_write_b32 v182, v191 offset:6192
    v_mfma_f32_32x32x16_bf16 v[144:159], a[200:203], a[16:19], v[144:159]
    ds_read_b64_tr_b16 a[234:235], v42 offset:9216
    v_add_f32 v184, v200, v216
    v_mul_f32 v185, v200, v200
    v_add_f32 v184, v184, v232
    v_mfma_f32_32x32x16_bf16 v[96:111], a[204:207], a[0:3], v[96:111]
    ds_read_b64_tr_b16 a[236:237], v43 offset:8192
    buffer_load_dwordx4 a[104:107], v1, s[20:23], s58 offen offset:2048 sc1
    v_fmac_f32 v185, v216, v216
    v_fmac_f32 v185, v232, v232
    ds_write_b32 v182, v184 offset:2304
    v_mfma_f32_32x32x16_bf16 v[160:175], a[204:207], a[16:19], v[160:175]
    ds_read_b64_tr_b16 a[238:239], v43 offset:9216
    ds_write_b32 v182, v185 offset:6912
    v_add_f32 v186, v201, v217
    v_mul_f32 v187, v201, v201
    s_waitcnt lgkmcnt(15)
    v_mfma_f32_32x32x16_bf16 v[48:63], a[208:211], a[4:7], v[48:63]
    ds_read_b64_tr_b16 a[240:241], v40 offset:12288
    buffer_load_dwordx4 a[108:111], v1, s[20:23], s58 offen offset:3072 sc1
    v_add_f32 v186, v186, v233
    v_fmac_f32 v187, v217, v217
    v_fmac_f32 v187, v233, v233
    v_mfma_f32_32x32x16_bf16 v[112:127], a[208:211], a[20:23], v[112:127]
    ds_read_b64_tr_b16 a[242:243], v40 offset:13312
    ds_write_b32 v182, v186 offset:2448
    ds_write_b32 v182, v187 offset:7056
    v_add_f32 v188, v202, v218
    v_mul_f32 v189, v202, v202
    v_mfma_f32_32x32x16_bf16 v[64:79], a[212:215], a[4:7], v[64:79]
    ds_read_b64_tr_b16 a[244:245], v41 offset:12288
    s_add_u32 s58, s55, 61440
    buffer_load_dwordx4 a[112:115], v1, s[20:23], s58 offen offset:0 sc1
    v_add_f32 v188, v188, v234
    v_fmac_f32 v189, v218, v218
    v_fmac_f32 v189, v234, v234
    v_mfma_f32_32x32x16_bf16 v[128:143], a[212:215], a[20:23], v[128:143]
    ds_read_b64_tr_b16 a[246:247], v41 offset:13312
    ds_write_b32 v182, v188 offset:2592
    ds_write_b32 v182, v189 offset:7200
    v_add_f32 v190, v203, v219
    v_mfma_f32_32x32x16_bf16 v[80:95], a[216:219], a[4:7], v[80:95]
    ds_read_b64_tr_b16 a[248:249], v42 offset:12288
    buffer_load_dwordx4 a[116:119], v1, s[20:23], s58 offen offset:1024 sc1
    v_mul_f32 v191, v203, v203
    v_add_f32 v190, v190, v235
    v_fmac_f32 v191, v219, v219
    v_mfma_f32_32x32x16_bf16 v[144:159], a[216:219], a[20:23], v[144:159]
    ds_read_b64_tr_b16 a[250:251], v42 offset:13312
    v_fmac_f32 v191, v235, v235
    ds_write_b32 v182, v190 offset:2736
    ds_write_b32 v182, v191 offset:7344
    v_mfma_f32_32x32x16_bf16 v[96:111], a[220:223], a[4:7], v[96:111]
    ds_read_b64_tr_b16 a[252:253], v43 offset:12288
    buffer_load_dwordx4 a[120:123], v1, s[20:23], s58 offen offset:2048 sc1
    v_add_f32 v184, v204, v220
    v_mul_f32 v185, v204, v204
    v_add_f32 v184, v184, v236
    v_mfma_f32_32x32x16_bf16 v[160:175], a[220:223], a[20:23], v[160:175]
    ds_read_b64_tr_b16 a[254:255], v43 offset:13312
    v_fmac_f32 v185, v220, v220
    v_fmac_f32 v185, v236, v236
    ds_write_b32 v182, v184 offset:3456
    s_waitcnt lgkmcnt(1)
    s_waitcnt vmcnt(32)
    s_barrier
    v_mfma_f32_32x32x16_bf16 v[48:63], a[224:227], a[8:11], v[48:63]
    ds_read_b64_tr_b16 a[192:193], v40 offset:16384
    buffer_load_dwordx4 a[124:127], v1, s[20:23], s58 offen offset:3072 sc1
    ds_write_b32 v182, v185 offset:8064
    v_add_f32 v186, v205, v221
    v_mul_f32 v187, v205, v205
    v_mfma_f32_32x32x16_bf16 v[112:127], a[224:227], a[24:27], v[112:127]
    ds_read_b64_tr_b16 a[194:195], v40 offset:17408
    v_add_f32 v186, v186, v237
    v_fmac_f32 v187, v221, v221
    v_fmac_f32 v187, v237, v237
    v_mfma_f32_32x32x16_bf16 v[64:79], a[228:231], a[8:11], v[64:79]
    ds_read_b64_tr_b16 a[196:197], v41 offset:16384
    s_add_u32 m0, s59, 0
    s_add_u32 s46, s45, 4096
    buffer_load_dwordx4 v1, s[20:23], s45 offen offset:0 sc1 lds
    ds_write_b32 v182, v186 offset:3600
    ds_write_b32 v182, v187 offset:8208
    v_add_f32 v188, v206, v222
    v_mfma_f32_32x32x16_bf16 v[128:143], a[228:231], a[24:27], v[128:143]
    ds_read_b64_tr_b16 a[198:199], v41 offset:17408
    v_mul_f32 v189, v206, v206
    v_add_f32 v188, v188, v238
    v_fmac_f32 v189, v222, v222
    v_mfma_f32_32x32x16_bf16 v[80:95], a[232:235], a[8:11], v[80:95]
    ds_read_b64_tr_b16 a[200:201], v42 offset:16384
    buffer_load_dwordx4 v1, s[20:23], s45 offen offset:1024 sc1 lds
    v_fmac_f32 v189, v238, v238
    ds_write_b32 v182, v188 offset:3744
    ds_write_b32 v182, v189 offset:8352
    v_mfma_f32_32x32x16_bf16 v[144:159], a[232:235], a[24:27], v[144:159]
    ds_read_b64_tr_b16 a[202:203], v42 offset:17408
    v_add_f32 v190, v207, v223
    v_mul_f32 v191, v207, v207
    v_add_f32 v190, v190, v239
    v_mfma_f32_32x32x16_bf16 v[96:111], a[236:239], a[8:11], v[96:111]
    ds_read_b64_tr_b16 a[204:205], v43 offset:16384
    buffer_load_dwordx4 v1, s[20:23], s45 offen offset:2048 sc1 lds
    v_fmac_f32 v191, v223, v223
    v_fmac_f32 v191, v239, v239
    ds_write_b32 v182, v190 offset:3888
    v_mfma_f32_32x32x16_bf16 v[160:175], a[236:239], a[24:27], v[160:175]
    ds_read_b64_tr_b16 a[206:207], v43 offset:17408
    ds_write_b32 v182, v191 offset:8496
    v_cvt_pk_bf16_f32 v192, v192, v193
    v_cvt_pk_bf16_f32 v193, v194, v195
    v_mfma_f32_32x32x16_bf16 v[48:63], a[240:243], a[12:15], v[48:63]
    ds_read_b64_tr_b16 a[208:209], v40 offset:20480
    buffer_load_dwordx4 v1, s[20:23], s45 offen offset:3072 sc1 lds
    v_cvt_pk_bf16_f32 v194, v196, v197
    v_cvt_pk_bf16_f32 v195, v198, v199
    s_nop 1
    v_mfma_f32_32x32x16_bf16 v[112:127], a[240:243], a[28:31], v[112:127]
    ds_read_b64_tr_b16 a[210:211], v40 offset:21504
    v_permlane32_swap_b32 v192, v194
    v_permlane32_swap_b32 v193, v195
    s_nop 1
    v_mfma_f32_32x32x16_bf16 v[64:79], a[244:247], a[12:15], v[64:79]
    ds_read_b64_tr_b16 a[212:213], v41 offset:20480
    s_add_u32 m0, s59, 4096
    s_nop 0
    buffer_load_dwordx4 v1, s[20:23], s46 offen offset:0 sc1 lds
    buffer_store_dwordx4 v[192:195], v1, s[20:23], s96 offen offset:0 sc1
    v_cvt_pk_bf16_f32 v200, v200, v201
    v_cvt_pk_bf16_f32 v201, v202, v203
    v_mfma_f32_32x32x16_bf16 v[128:143], a[244:247], a[28:31], v[128:143]
    ds_read_b64_tr_b16 a[214:215], v41 offset:21504
    v_cvt_pk_bf16_f32 v202, v204, v205
    v_cvt_pk_bf16_f32 v203, v206, v207
    s_nop 1
    v_mfma_f32_32x32x16_bf16 v[80:95], a[248:251], a[12:15], v[80:95]
    ds_read_b64_tr_b16 a[216:217], v42 offset:20480
    buffer_load_dwordx4 v1, s[20:23], s46 offen offset:1024 sc1 lds
    v_permlane32_swap_b32 v200, v202
    v_permlane32_swap_b32 v201, v203
    s_nop 1
    v_mfma_f32_32x32x16_bf16 v[144:159], a[248:251], a[28:31], v[144:159]
    ds_read_b64_tr_b16 a[218:219], v42 offset:21504
    buffer_store_dwordx4 v[200:203], v1, s[20:23], s96 offen offset:1024 sc1
    s_add_u32 s96, s96, 131072
    v_cvt_pk_bf16_f32 v208, v208, v209
    v_mfma_f32_32x32x16_bf16 v[96:111], a[252:255], a[12:15], v[96:111]
    ds_read_b64_tr_b16 a[220:221], v43 offset:20480
    buffer_load_dwordx4 v1, s[20:23], s46 offen offset:2048 sc1 lds
    v_cvt_pk_bf16_f32 v209, v210, v211
    v_cvt_pk_bf16_f32 v210, v212, v213
    v_cvt_pk_bf16_f32 v211, v214, v215
    v_mfma_f32_32x32x16_bf16 v[160:175], a[252:255], a[28:31], v[160:175]
    ds_read_b64_tr_b16 a[222:223], v43 offset:21504
    s_nop 1
    v_permlane32_swap_b32 v208, v210
    v_permlane32_swap_b32 v209, v211
    s_waitcnt lgkmcnt(9)
    s_waitcnt vmcnt(34)
    v_mfma_f32_32x32x16_bf16 v[48:63], a[192:195], a[32:35], v[48:63]
    ds_read_b64_tr_b16 a[224:225], v40 offset:24576
    buffer_load_dwordx4 v1, s[20:23], s46 offen offset:3072 sc1 lds
    s_nop 1
    buffer_store_dwordx4 v[208:211], v1, s[20:23], s96 offen offset:0 sc1
    v_cvt_pk_bf16_f32 v216, v216, v217
    v_mfma_f32_32x32x16_bf16 v[112:127], a[192:195], a[48:51], v[112:127]
    ds_read_b64_tr_b16 a[226:227], v40 offset:25600
    v_cvt_pk_bf16_f32 v217, v218, v219
    v_cvt_pk_bf16_f32 v218, v220, v221
    v_cvt_pk_bf16_f32 v219, v222, v223
    v_mfma_f32_32x32x16_bf16 v[64:79], a[196:199], a[32:35], v[64:79]
    ds_read_b64_tr_b16 a[228:229], v41 offset:24576
    s_add_u32 m0, s59, 32768
    s_add_u32 s47, s45, 16777216
    s_add_u32 s48, s47, 4096
    s_add_u32 s45, s45, 0x4000
    s_add_u32 s46, s45, 4096
    buffer_load_dwordx4 v1, s[20:23], s45 offen offset:0 sc1 lds
    s_nop 1
    v_permlane32_swap_b32 v216, v218
    v_permlane32_swap_b32 v217, v219
    v_mfma_f32_32x32x16_bf16 v[128:143], a[196:199], a[48:51], v[128:143]
    ds_read_b64_tr_b16 a[230:231], v41 offset:25600
    s_nop 1
    buffer_store_dwordx4 v[216:219], v1, s[20:23], s96 offen offset:1024 sc1
    s_add_u32 s96, s96, 131072
    v_mfma_f32_32x32x16_bf16 v[80:95], a[200:203], a[32:35], v[80:95]
    ds_read_b64_tr_b16 a[232:233], v42 offset:24576
    buffer_load_dwordx4 v1, s[20:23], s45 offen offset:1024 sc1 lds
    v_cvt_pk_bf16_f32 v224, v224, v225
    v_cvt_pk_bf16_f32 v225, v226, v227
    v_cvt_pk_bf16_f32 v226, v228, v229
    v_mfma_f32_32x32x16_bf16 v[144:159], a[200:203], a[48:51], v[144:159]
    ds_read_b64_tr_b16 a[234:235], v42 offset:25600
    v_cvt_pk_bf16_f32 v227, v230, v231
    s_nop 1
    v_permlane32_swap_b32 v224, v226
    v_mfma_f32_32x32x16_bf16 v[96:111], a[204:207], a[32:35], v[96:111]
    ds_read_b64_tr_b16 a[236:237], v43 offset:24576
    buffer_load_dwordx4 v1, s[20:23], s45 offen offset:2048 sc1 lds
    v_permlane32_swap_b32 v225, v227
    s_nop 1
    buffer_store_dwordx4 v[224:227], v1, s[20:23], s96 offen offset:0 sc1
    v_mfma_f32_32x32x16_bf16 v[160:175], a[204:207], a[48:51], v[160:175]
    ds_read_b64_tr_b16 a[238:239], v43 offset:25600
    v_cvt_pk_bf16_f32 v232, v232, v233
    v_cvt_pk_bf16_f32 v233, v234, v235
    v_cvt_pk_bf16_f32 v234, v236, v237
    s_waitcnt lgkmcnt(8)
    v_mfma_f32_32x32x16_bf16 v[48:63], a[208:211], a[36:39], v[48:63]
    ds_read_b64_tr_b16 a[240:241], v40 offset:28672
    buffer_load_dwordx4 v1, s[20:23], s45 offen offset:3072 sc1 lds
    v_cvt_pk_bf16_f32 v235, v238, v239
    s_nop 1
    v_permlane32_swap_b32 v232, v234
    v_mfma_f32_32x32x16_bf16 v[112:127], a[208:211], a[52:55], v[112:127]
    ds_read_b64_tr_b16 a[242:243], v40 offset:29696
    v_permlane32_swap_b32 v233, v235
    s_nop 1
    buffer_store_dwordx4 v[232:235], v1, s[20:23], s96 offen offset:1024 sc1
    v_mfma_f32_32x32x16_bf16 v[64:79], a[212:215], a[36:39], v[64:79]
    ds_read_b64_tr_b16 a[244:245], v41 offset:28672
    s_add_u32 m0, s59, 36864
    s_nop 0
    buffer_load_dwordx4 v1, s[20:23], s46 offen offset:0 sc1 lds
    v_lshlrev_b32 v182, 2, v0
    s_nop 0
    ds_read_b128 v[192:195], v183 offset:0
    v_mfma_f32_32x32x16_bf16 v[128:143], a[212:215], a[52:55], v[128:143]
    ds_read_b64_tr_b16 a[246:247], v41 offset:29696
    ds_read_b128 v[196:199], v183 offset:16
    ds_read_b128 v[200:203], v183 offset:32
    ds_read_b128 v[204:207], v183 offset:48
    v_mfma_f32_32x32x16_bf16 v[80:95], a[216:219], a[36:39], v[80:95]
    ds_read_b64_tr_b16 a[248:249], v42 offset:28672
    buffer_load_dwordx4 v1, s[20:23], s46 offen offset:1024 sc1 lds
    ds_read_b128 v[208:211], v183 offset:64
    ds_read_b128 v[212:215], v183 offset:80
    ds_read_b128 v[216:219], v183 offset:96
    v_mfma_f32_32x32x16_bf16 v[144:159], a[216:219], a[52:55], v[144:159]
    ds_read_b64_tr_b16 a[250:251], v42 offset:29696
    ds_read_b128 v[220:223], v183 offset:112
    s_waitcnt lgkmcnt(0)
    v_add_f32 v192, v192, v208
    v_mfma_f32_32x32x16_bf16 v[96:111], a[220:223], a[36:39], v[96:111]
    ds_read_b64_tr_b16 a[252:253], v43 offset:28672
    buffer_load_dwordx4 v1, s[20:23], s46 offen offset:2048 sc1 lds
    v_add_f32 v193, v193, v209
    v_add_f32 v194, v194, v210
    v_add_f32 v195, v195, v211
    v_mfma_f32_32x32x16_bf16 v[160:175], a[220:223], a[52:55], v[160:175]
    ds_read_b64_tr_b16 a[254:255], v43 offset:29696
    v_add_f32 v196, v196, v212
    v_add_f32 v197, v197, v213
    v_add_f32 v198, v198, v214
    s_waitcnt lgkmcnt(0)
    s_waitcnt vmcnt(42)
    s_barrier
    v_mfma_f32_32x32x16_bf16 v[48:63], a[224:227], a[40:43], v[48:63]
    ds_read_b64_tr_b16 a[192:193], v40 offset:32768
    buffer_load_dwordx4 v1, s[20:23], s46 offen offset:3072 sc1 lds
    v_add_f32 v199, v199, v215
    v_add_f32 v200, v200, v216
    v_add_f32 v201, v201, v217
    v_mfma_f32_32x32x16_bf16 v[112:127], a[224:227], a[56:59], v[112:127]
    ds_read_b64_tr_b16 a[194:195], v40 offset:33792
    v_add_f32 v202, v202, v218
    v_add_f32 v203, v203, v219
    v_add_f32 v204, v204, v220
    v_mfma_f32_32x32x16_bf16 v[64:79], a[228:231], a[40:43], v[64:79]
    ds_read_b64_tr_b16 a[196:197], v41 offset:32768
    s_add_u32 m0, s59, 65536
    s_nop 0
    buffer_load_dwordx4 v1, s[20:23], s47 offen offset:0 sc1 lds
    v_add_f32 v205, v205, v221
    v_add_f32 v206, v206, v222
    v_add_f32 v207, v207, v223
    v_mfma_f32_32x32x16_bf16 v[128:143], a[228:231], a[56:59], v[128:143]
    ds_read_b64_tr_b16 a[198:199], v41 offset:33792
    v_add_f32 v192, v192, v200
    v_add_f32 v193, v193, v201
    v_add_f32 v194, v194, v202
    v_mfma_f32_32x32x16_bf16 v[80:95], a[232:235], a[40:43], v[80:95]
    ds_read_b64_tr_b16 a[200:201], v42 offset:32768
    buffer_load_dwordx4 v1, s[20:23], s47 offen offset:1024 sc1 lds
    v_add_f32 v195, v195, v203
    v_add_f32 v196, v196, v204
    v_add_f32 v197, v197, v205
    v_mfma_f32_32x32x16_bf16 v[144:159], a[232:235], a[56:59], v[144:159]
    ds_read_b64_tr_b16 a[202:203], v42 offset:33792
    v_add_f32 v198, v198, v206
    v_add_f32 v199, v199, v207
    v_add_f32 v192, v192, v196
    v_mfma_f32_32x32x16_bf16 v[96:111], a[236:239], a[40:43], v[96:111]
    ds_read_b64_tr_b16 a[204:205], v43 offset:32768
    buffer_load_dwordx4 v1, s[20:23], s47 offen offset:2048 sc1 lds
    v_add_f32 v193, v193, v197
    v_add_f32 v194, v194, v198
    v_add_f32 v195, v195, v199
    v_mfma_f32_32x32x16_bf16 v[160:175], a[236:239], a[56:59], v[160:175]
    ds_read_b64_tr_b16 a[206:207], v43 offset:33792
    v_add_f32 v192, v192, v194
    v_add_f32 v193, v193, v195
    v_add_f32 v192, v192, v193
    buffer_store_dword v192, v182, s[20:23], s97 offen sc1
    v_mfma_f32_32x32x16_bf16 v[48:63], a[240:243], a[44:47], v[48:63]
    ds_read_b64_tr_b16 a[208:209], v40 offset:36864
    buffer_load_dwordx4 v1, s[20:23], s47 offen offset:3072 sc1 lds
    v_mfma_f32_32x32x16_bf16 v[112:127], a[240:243], a[60:63], v[112:127]
    ds_read_b64_tr_b16 a[210:211], v40 offset:37888
    v_mfma_f32_32x32x16_bf16 v[64:79], a[244:247], a[44:47], v[64:79]
    ds_read_b64_tr_b16 a[212:213], v41 offset:36864
    s_add_u32 m0, s59, 69632
    s_nop 0
    buffer_load_dwordx4 v1, s[20:23], s48 offen offset:0 sc1 lds
    v_mfma_f32_32x32x16_bf16 v[128:143], a[244:247], a[60:63], v[128:143]
    ds_read_b64_tr_b16 a[214:215], v41 offset:37888
    v_mfma_f32_32x32x16_bf16 v[80:95], a[248:251], a[44:47], v[80:95]
    ds_read_b64_tr_b16 a[216:217], v42 offset:36864
    buffer_load_dwordx4 v1, s[20:23], s48 offen offset:1024 sc1 lds
    v_mfma_f32_32x32x16_bf16 v[144:159], a[248:251], a[60:63], v[144:159]
    ds_read_b64_tr_b16 a[218:219], v42 offset:37888
    v_mfma_f32_32x32x16_bf16 v[96:111], a[252:255], a[44:47], v[96:111]
    ds_read_b64_tr_b16 a[220:221], v43 offset:36864
    buffer_load_dwordx4 v1, s[20:23], s48 offen offset:2048 sc1 lds
    v_mfma_f32_32x32x16_bf16 v[160:175], a[252:255], a[60:63], v[160:175]
    ds_read_b64_tr_b16 a[222:223], v43 offset:37888
    s_waitcnt lgkmcnt(8)
    s_waitcnt vmcnt(42)
    v_mfma_f32_32x32x16_bf16 v[48:63], a[192:195], a[64:67], v[48:63]
    ds_read_b64_tr_b16 a[224:225], v40 offset:40960
    buffer_load_dwordx4 v1, s[20:23], s48 offen offset:3072 sc1 lds
    v_mfma_f32_32x32x16_bf16 v[112:127], a[192:195], a[80:83], v[112:127]
    ds_read_b64_tr_b16 a[226:227], v40 offset:41984
    v_mfma_f32_32x32x16_bf16 v[64:79], a[196:199], a[64:67], v[64:79]
    ds_read_b64_tr_b16 a[228:229], v41 offset:40960
    v_mfma_f32_32x32x16_bf16 v[128:143], a[196:199], a[80:83], v[128:143]
    ds_read_b64_tr_b16 a[230:231], v41 offset:41984
    v_mfma_f32_32x32x16_bf16 v[80:95], a[200:203], a[64:67], v[80:95]
    ds_read_b64_tr_b16 a[232:233], v42 offset:40960
    v_mfma_f32_32x32x16_bf16 v[144:159], a[200:203], a[80:83], v[144:159]
    ds_read_b64_tr_b16 a[234:235], v42 offset:41984
    v_mfma_f32_32x32x16_bf16 v[96:111], a[204:207], a[64:67], v[96:111]
    ds_read_b64_tr_b16 a[236:237], v43 offset:40960
    v_mfma_f32_32x32x16_bf16 v[160:175], a[204:207], a[80:83], v[160:175]
    ds_read_b64_tr_b16 a[238:239], v43 offset:41984
    s_waitcnt lgkmcnt(8)
    v_mfma_f32_32x32x16_bf16 v[48:63], a[208:211], a[68:71], v[48:63]
    ds_read_b64_tr_b16 a[240:241], v40 offset:45056
    v_mfma_f32_32x32x16_bf16 v[112:127], a[208:211], a[84:87], v[112:127]
    ds_read_b64_tr_b16 a[242:243], v40 offset:46080
    v_mfma_f32_32x32x16_bf16 v[64:79], a[212:215], a[68:71], v[64:79]
    ds_read_b64_tr_b16 a[244:245], v41 offset:45056
    v_mfma_f32_32x32x16_bf16 v[128:143], a[212:215], a[84:87], v[128:143]
    ds_read_b64_tr_b16 a[246:247], v41 offset:46080
    v_mfma_f32_32x32x16_bf16 v[80:95], a[216:219], a[68:71], v[80:95]
    ds_read_b64_tr_b16 a[248:249], v42 offset:45056
    v_mfma_f32_32x32x16_bf16 v[144:159], a[216:219], a[84:87], v[144:159]
    ds_read_b64_tr_b16 a[250:251], v42 offset:46080
    v_mfma_f32_32x32x16_bf16 v[96:111], a[220:223], a[68:71], v[96:111]
    ds_read_b64_tr_b16 a[252:253], v43 offset:45056
    v_mfma_f32_32x32x16_bf16 v[160:175], a[220:223], a[84:87], v[160:175]
    ds_read_b64_tr_b16 a[254:255], v43 offset:46080
    s_waitcnt lgkmcnt(0)
    s_waitcnt vmcnt(39)
    s_waitcnt vmcnt(5)
    s_barrier
    s_lshl_b32 s37, s2, 4
    s_add_u32 s37, s37, 42622976
    s_cmp_lg_u32 s32, 0
    s_cbranch_scc1 L_W0_22
    v_mov_b32 v246, 1
    v_mov_b32 v247, 0
    s_mov_b64 exec, 1
    buffer_store_byte v246, v247, s[20:23], s37 offen sc0 sc1
    s_mov_b64 exec, -1
L_W0_22:
    v_mfma_f32_32x32x16_bf16 v[48:63], a[224:227], a[72:75], v[48:63]
    ds_read_b64_tr_b16 a[192:193], v40 offset:49152
    v_mfma_f32_32x32x16_bf16 v[112:127], a[224:227], a[88:91], v[112:127]
    ds_read_b64_tr_b16 a[194:195], v40 offset:50176
    v_mfma_f32_32x32x16_bf16 v[64:79], a[228:231], a[72:75], v[64:79]
    ds_read_b64_tr_b16 a[196:197], v41 offset:49152
    v_mfma_f32_32x32x16_bf16 v[128:143], a[228:231], a[88:91], v[128:143]
    ds_read_b64_tr_b16 a[198:199], v41 offset:50176
    v_mfma_f32_32x32x16_bf16 v[80:95], a[232:235], a[72:75], v[80:95]
    ds_read_b64_tr_b16 a[200:201], v42 offset:49152
    v_mfma_f32_32x32x16_bf16 v[144:159], a[232:235], a[88:91], v[144:159]
    ds_read_b64_tr_b16 a[202:203], v42 offset:50176
    v_mfma_f32_32x32x16_bf16 v[96:111], a[236:239], a[72:75], v[96:111]
    ds_read_b64_tr_b16 a[204:205], v43 offset:49152
    v_mfma_f32_32x32x16_bf16 v[160:175], a[236:239], a[88:91], v[160:175]
    ds_read_b64_tr_b16 a[206:207], v43 offset:50176
    v_mfma_f32_32x32x16_bf16 v[48:63], a[240:243], a[76:79], v[48:63]
    ds_read_b64_tr_b16 a[208:209], v40 offset:53248
    v_mfma_f32_32x32x16_bf16 v[112:127], a[240:243], a[92:95], v[112:127]
    ds_read_b64_tr_b16 a[210:211], v40 offset:54272
    v_mfma_f32_32x32x16_bf16 v[64:79], a[244:247], a[76:79], v[64:79]
    ds_read_b64_tr_b16 a[212:213], v41 offset:53248
    v_mfma_f32_32x32x16_bf16 v[128:143], a[244:247], a[92:95], v[128:143]
    ds_read_b64_tr_b16 a[214:215], v41 offset:54272
    v_mfma_f32_32x32x16_bf16 v[80:95], a[248:251], a[76:79], v[80:95]
    ds_read_b64_tr_b16 a[216:217], v42 offset:53248
    v_mfma_f32_32x32x16_bf16 v[144:159], a[248:251], a[92:95], v[144:159]
    ds_read_b64_tr_b16 a[218:219], v42 offset:54272
    v_mfma_f32_32x32x16_bf16 v[96:111], a[252:255], a[76:79], v[96:111]
    ds_read_b64_tr_b16 a[220:221], v43 offset:53248
    v_mfma_f32_32x32x16_bf16 v[160:175], a[252:255], a[92:95], v[160:175]
    ds_read_b64_tr_b16 a[222:223], v43 offset:54272
K2_QPJ:
    ds_read_b64_tr_b16 a[224:225], v40 offset:57344
    ds_read_b64_tr_b16 a[226:227], v40 offset:58368
    ds_read_b64_tr_b16 a[228:229], v41 offset:57344
    ds_read_b64_tr_b16 a[230:231], v41 offset:58368
    ds_read_b64_tr_b16 a[232:233], v42 offset:57344
    ds_read_b64_tr_b16 a[234:235], v42 offset:58368
    ds_read_b64_tr_b16 a[236:237], v43 offset:57344
    ds_read_b64_tr_b16 a[238:239], v43 offset:58368
    ds_read_b64_tr_b16 a[240:241], v40 offset:61440
    ds_read_b64_tr_b16 a[242:243], v40 offset:62464
    ds_read_b64_tr_b16 a[244:245], v41 offset:61440
    ds_read_b64_tr_b16 a[246:247], v41 offset:62464
    ds_read_b64_tr_b16 a[248:249], v42 offset:61440
    ds_read_b64_tr_b16 a[250:251], v42 offset:62464
    ds_read_b64_tr_b16 a[252:253], v43 offset:61440
    ds_read_b64_tr_b16 a[254:255], v43 offset:62464
    v_mov_b32 v20, 0x3e0293ee
    v_mov_b32 v21, 0x3e0293ee
    v_add_u32 v22, s59, v1
    v_add_u32 v23, 131072, v22
    v_add_u32 v22, 98304, v22
    s_waitcnt lgkmcnt(0)
    s_barrier
    v_mfma_f32_32x32x16_bf16 v[48:63], a[192:195], a[96:99], v[48:63]
    v_mfma_f32_32x32x16_bf16 v[48:63], a[208:211], a[100:103], v[48:63]
    v_mfma_f32_32x32x16_bf16 v[48:63], a[224:227], a[104:107], v[48:63]
    v_mfma_f32_32x32x16_bf16 v[48:63], a[240:243], a[108:111], v[48:63]
    v_mfma_f32_32x32x16_bf16 v[64:79], a[196:199], a[96:99], v[64:79]
    v_mfma_f32_32x32x16_bf16 v[64:79], a[212:215], a[100:103], v[64:79]
    v_mul_f32 v48, v20, v48
    v_mul_f32 v49, v20, v49
    v_mul_f32 v50, v20, v50
    v_mul_f32 v51, v20, v51
    v_mul_f32 v52, v20, v52
    v_mul_f32 v53, v20, v53
    v_mul_f32 v54, v20, v54
    v_mul_f32 v55, v20, v55
    v_cvt_pk_bf16_f32 v48, v48, v49
    v_cvt_pk_bf16_f32 v49, v50, v51
    v_cvt_pk_bf16_f32 v50, v52, v53
    v_cvt_pk_bf16_f32 v51, v54, v55
    ds_write_b128 v23, v[48:51] offset:0
    v_mfma_f32_32x32x16_bf16 v[64:79], a[228:231], a[104:107], v[64:79]
    v_mul_f32 v56, v20, v56
    v_mul_f32 v57, v20, v57
    v_mul_f32 v58, v20, v58
    v_mul_f32 v59, v20, v59
    v_mul_f32 v60, v20, v60
    v_mul_f32 v61, v20, v61
    v_mul_f32 v62, v20, v62
    v_mul_f32 v63, v20, v63
    v_mfma_f32_32x32x16_bf16 v[64:79], a[244:247], a[108:111], v[64:79]
    v_cvt_pk_bf16_f32 v56, v56, v57
    v_cvt_pk_bf16_f32 v57, v58, v59
    v_cvt_pk_bf16_f32 v58, v60, v61
    v_cvt_pk_bf16_f32 v59, v62, v63
    ds_write_b128 v23, v[56:59] offset:1024
    v_mfma_f32_32x32x16_bf16 v[80:95], a[200:203], a[96:99], v[80:95]
    v_mfma_f32_32x32x16_bf16 v[80:95], a[216:219], a[100:103], v[80:95]
    v_mul_f32 v64, v20, v64
    v_mul_f32 v65, v20, v65
    v_mul_f32 v66, v20, v66
    v_mul_f32 v67, v20, v67
    v_mul_f32 v68, v20, v68
    v_mul_f32 v69, v20, v69
    v_mul_f32 v70, v20, v70
    v_mul_f32 v71, v20, v71
    v_cvt_pk_bf16_f32 v64, v64, v65
    v_cvt_pk_bf16_f32 v65, v66, v67
    v_cvt_pk_bf16_f32 v66, v68, v69
    v_cvt_pk_bf16_f32 v67, v70, v71
    ds_write_b128 v23, v[64:67] offset:2048
    v_mfma_f32_32x32x16_bf16 v[80:95], a[232:235], a[104:107], v[80:95]
    v_mul_f32 v72, v20, v72
    v_mul_f32 v73, v20, v73
    v_mul_f32 v74, v20, v74
    v_mul_f32 v75, v20, v75
    v_mul_f32 v76, v20, v76
    v_mul_f32 v77, v20, v77
    v_mul_f32 v78, v20, v78
    v_mul_f32 v79, v20, v79
    v_mfma_f32_32x32x16_bf16 v[80:95], a[248:251], a[108:111], v[80:95]
    v_cvt_pk_bf16_f32 v72, v72, v73
    v_cvt_pk_bf16_f32 v73, v74, v75
    v_cvt_pk_bf16_f32 v74, v76, v77
    v_cvt_pk_bf16_f32 v75, v78, v79
    ds_write_b128 v23, v[72:75] offset:3072
    v_mfma_f32_32x32x16_bf16 v[96:111], a[204:207], a[96:99], v[96:111]
    v_mfma_f32_32x32x16_bf16 v[96:111], a[220:223], a[100:103], v[96:111]
    v_mul_f32 v80, v20, v80
    v_mul_f32 v81, v20, v81
    v_mul_f32 v82, v20, v82
    v_mul_f32 v83, v20, v83
    v_mul_f32 v84, v20, v84
    v_mul_f32 v85, v20, v85
    v_mul_f32 v86, v20, v86
    v_mul_f32 v87, v20, v87
    v_cvt_pk_bf16_f32 v80, v80, v81
    v_cvt_pk_bf16_f32 v81, v82, v83
    v_cvt_pk_bf16_f32 v82, v84, v85
    v_cvt_pk_bf16_f32 v83, v86, v87
    ds_write_b128 v23, v[80:83] offset:4096
    v_mfma_f32_32x32x16_bf16 v[96:111], a[236:239], a[104:107], v[96:111]
    v_mul_f32 v88, v20, v88
    v_mul_f32 v89, v20, v89
    v_mul_f32 v90, v20, v90
    v_mul_f32 v91, v20, v91
    v_mul_f32 v92, v20, v92
    v_mul_f32 v93, v20, v93
    v_mul_f32 v94, v20, v94
    v_mul_f32 v95, v20, v95
    v_mfma_f32_32x32x16_bf16 v[96:111], a[252:255], a[108:111], v[96:111]
    v_cvt_pk_bf16_f32 v88, v88, v89
    v_cvt_pk_bf16_f32 v89, v90, v91
    v_cvt_pk_bf16_f32 v90, v92, v93
    v_cvt_pk_bf16_f32 v91, v94, v95
    ds_write_b128 v23, v[88:91] offset:5120
    v_mfma_f32_32x32x16_bf16 v[112:127], a[192:195], a[112:115], v[112:127]
    v_mfma_f32_32x32x16_bf16 v[112:127], a[208:211], a[116:119], v[112:127]
    v_mul_f32 v96, v20, v96
    v_mul_f32 v97, v20, v97
    v_mul_f32 v98, v20, v98
    v_mul_f32 v99, v20, v99
    v_mul_f32 v100, v20, v100
    v_mul_f32 v101, v20, v101
    v_mul_f32 v102, v20, v102
    v_mul_f32 v103, v20, v103
    v_cvt_pk_bf16_f32 v96, v96, v97
    v_cvt_pk_bf16_f32 v97, v98, v99
    v_cvt_pk_bf16_f32 v98, v100, v101
    v_cvt_pk_bf16_f32 v99, v102, v103
    ds_write_b128 v23, v[96:99] offset:6144
    v_mfma_f32_32x32x16_bf16 v[112:127], a[224:227], a[120:123], v[112:127]
    v_mul_f32 v104, v20, v104
    v_mul_f32 v105, v20, v105
    v_mul_f32 v106, v20, v106
    v_mul_f32 v107, v20, v107
    v_mul_f32 v108, v20, v108
    v_mul_f32 v109, v20, v109
    v_mul_f32 v110, v20, v110
    v_mul_f32 v111, v20, v111
    v_mfma_f32_32x32x16_bf16 v[112:127], a[240:243], a[124:127], v[112:127]
    v_cvt_pk_bf16_f32 v104, v104, v105
    v_cvt_pk_bf16_f32 v105, v106, v107
    v_cvt_pk_bf16_f32 v106, v108, v109
    v_cvt_pk_bf16_f32 v107, v110, v111
    ds_write_b128 v23, v[104:107] offset:7168
    v_mfma_f32_32x32x16_bf16 v[128:143], a[196:199], a[112:115], v[128:143]
    v_mfma_f32_32x32x16_bf16 v[128:143], a[212:215], a[116:119], v[128:143]
    v_mul_f32 v112, v20, v112
    v_mul_f32 v113, v20, v113
    v_mul_f32 v114, v20, v114
    v_mul_f32 v115, v20, v115
    v_mul_f32 v116, v20, v116
    v_mul_f32 v117, v20, v117
    v_mul_f32 v118, v20, v118
    v_mul_f32 v119, v20, v119
    v_cvt_pk_bf16_f32 v112, v112, v113
    v_cvt_pk_bf16_f32 v113, v114, v115
    v_cvt_pk_bf16_f32 v114, v116, v117
    v_cvt_pk_bf16_f32 v115, v118, v119
    ds_write_b128 v22, v[112:115] offset:0
    v_mfma_f32_32x32x16_bf16 v[128:143], a[228:231], a[120:123], v[128:143]
    v_mul_f32 v120, v20, v120
    v_mul_f32 v121, v20, v121
    v_mul_f32 v122, v20, v122
    v_mul_f32 v123, v20, v123
    v_mul_f32 v124, v20, v124
    v_mul_f32 v125, v20, v125
    v_mul_f32 v126, v20, v126
    v_mul_f32 v127, v20, v127
    v_mfma_f32_32x32x16_bf16 v[128:143], a[244:247], a[124:127], v[128:143]
    v_cvt_pk_bf16_f32 v120, v120, v121
    v_cvt_pk_bf16_f32 v121, v122, v123
    v_cvt_pk_bf16_f32 v122, v124, v125
    v_cvt_pk_bf16_f32 v123, v126, v127
    ds_write_b128 v22, v[120:123] offset:1024
    v_mfma_f32_32x32x16_bf16 v[144:159], a[200:203], a[112:115], v[144:159]
    v_mfma_f32_32x32x16_bf16 v[144:159], a[216:219], a[116:119], v[144:159]
    v_mul_f32 v128, v20, v128
    v_mul_f32 v129, v20, v129
    v_mul_f32 v130, v20, v130
    v_mul_f32 v131, v20, v131
    v_mul_f32 v132, v20, v132
    v_mul_f32 v133, v20, v133
    v_mul_f32 v134, v20, v134
    v_mul_f32 v135, v20, v135
    v_cvt_pk_bf16_f32 v128, v128, v129
    v_cvt_pk_bf16_f32 v129, v130, v131
    v_cvt_pk_bf16_f32 v130, v132, v133
    v_cvt_pk_bf16_f32 v131, v134, v135
    ds_write_b128 v22, v[128:131] offset:2048
    v_mfma_f32_32x32x16_bf16 v[144:159], a[232:235], a[120:123], v[144:159]
    v_mul_f32 v136, v20, v136
    v_mul_f32 v137, v20, v137
    v_mul_f32 v138, v20, v138
    v_mul_f32 v139, v20, v139
    v_mul_f32 v140, v20, v140
    v_mul_f32 v141, v20, v141
    v_mul_f32 v142, v20, v142
    v_mul_f32 v143, v20, v143
    v_mfma_f32_32x32x16_bf16 v[144:159], a[248:251], a[124:127], v[144:159]
    v_cvt_pk_bf16_f32 v136, v136, v137
    v_cvt_pk_bf16_f32 v137, v138, v139
    v_cvt_pk_bf16_f32 v138, v140, v141
    v_cvt_pk_bf16_f32 v139, v142, v143
    ds_write_b128 v22, v[136:139] offset:3072
    v_mfma_f32_32x32x16_bf16 v[160:175], a[204:207], a[112:115], v[160:175]
    v_mfma_f32_32x32x16_bf16 v[160:175], a[220:223], a[116:119], v[160:175]
    v_mul_f32 v144, v20, v144
    v_mul_f32 v145, v20, v145
    v_mul_f32 v146, v20, v146
    v_mul_f32 v147, v20, v147
    v_mul_f32 v148, v20, v148
    v_mul_f32 v149, v20, v149
    v_mul_f32 v150, v20, v150
    v_mul_f32 v151, v20, v151
    v_cvt_pk_bf16_f32 v144, v144, v145
    v_cvt_pk_bf16_f32 v145, v146, v147
    v_cvt_pk_bf16_f32 v146, v148, v149
    v_cvt_pk_bf16_f32 v147, v150, v151
    ds_write_b128 v22, v[144:147] offset:4096
    v_mfma_f32_32x32x16_bf16 v[160:175], a[236:239], a[120:123], v[160:175]
    v_mul_f32 v152, v20, v152
    v_mul_f32 v153, v20, v153
    v_mul_f32 v154, v20, v154
    v_mul_f32 v155, v20, v155
    v_mul_f32 v156, v20, v156
    v_mul_f32 v157, v20, v157
    v_mul_f32 v158, v20, v158
    v_mul_f32 v159, v20, v159
    v_mfma_f32_32x32x16_bf16 v[160:175], a[252:255], a[124:127], v[160:175]
    v_cvt_pk_bf16_f32 v152, v152, v153
    v_cvt_pk_bf16_f32 v153, v154, v155
    v_cvt_pk_bf16_f32 v154, v156, v157
    v_cvt_pk_bf16_f32 v155, v158, v159
    ds_write_b128 v22, v[152:155] offset:5120
    s_nop 15
    v_mul_f32 v160, v20, v160
    v_mul_f32 v161, v20, v161
    v_mul_f32 v162, v20, v162
    v_mul_f32 v163, v20, v163
    v_mul_f32 v164, v20, v164
    v_mul_f32 v165, v20, v165
    v_mul_f32 v166, v20, v166
    v_mul_f32 v167, v20, v167
    v_cvt_pk_bf16_f32 v160, v160, v161
    v_cvt_pk_bf16_f32 v161, v162, v163
    v_cvt_pk_bf16_f32 v162, v164, v165
    v_cvt_pk_bf16_f32 v163, v166, v167
    ds_write_b128 v22, v[160:163] offset:6144
    v_mul_f32 v168, v20, v168
    v_mul_f32 v169, v20, v169
    v_mul_f32 v170, v20, v170
    v_mul_f32 v171, v20, v171
    v_mul_f32 v172, v20, v172
    v_mul_f32 v173, v20, v173
    v_mul_f32 v174, v20, v174
    v_mul_f32 v175, v20, v175
    v_cvt_pk_bf16_f32 v168, v168, v169
    v_cvt_pk_bf16_f32 v169, v170, v171
    v_cvt_pk_bf16_f32 v170, v172, v173
    v_cvt_pk_bf16_f32 v171, v174, v175
    ds_write_b128 v22, v[168:171] offset:7168
    s_waitcnt lgkmcnt(0)
    s_barrier
    s_lshl_b32 s37, s36, 13
    v_add_u32 v24, s37, v1
    v_add_u32 v25, 131072, v24
    v_add_u32 v24, 98304, v24
    ds_read_b128 a[192:195], v2 offset:0
    ds_read_b128 a[196:199], v2 offset:1024
    ds_read_b128 a[200:203], v2 offset:2048
    ds_read_b128 a[204:207], v2 offset:3072
    ds_read_b128 a[208:211], v2 offset:4096
    ds_read_b128 a[212:215], v2 offset:5120
    ds_read_b128 a[216:219], v2 offset:6144
    ds_read_b128 a[220:223], v2 offset:7168
    ds_read_b128 a[128:131], v23 offset:0
    ds_read_b128 a[132:135], v23 offset:1024
    ds_read_b128 a[136:139], v23 offset:2048
    ds_read_b128 a[140:143], v23 offset:3072
    ds_read_b128 a[144:147], v23 offset:4096
    ds_read_b128 a[148:151], v23 offset:5120
    ds_read_b128 a[152:155], v23 offset:6144
    ds_read_b128 a[156:159], v23 offset:7168
    ds_read_b128 a[160:163], v22 offset:0
    ds_read_b128 a[164:167], v22 offset:1024
    ds_read_b128 a[168:171], v22 offset:2048
    ds_read_b128 a[172:175], v22 offset:3072
    ds_read_b128 a[176:179], v22 offset:4096
    ds_read_b128 a[180:183], v22 offset:5120
    ds_read_b128 a[184:187], v22 offset:6144
    ds_read_b128 a[188:191], v22 offset:7168
    ds_read_b128 v[144:147], v25 offset:0
    ds_read_b128 v[148:151], v25 offset:1024
    ds_read_b128 v[152:155], v25 offset:2048
    ds_read_b128 v[156:159], v25 offset:3072
    ds_read_b128 v[160:163], v25 offset:4096
    ds_read_b128 v[164:167], v25 offset:5120
    ds_read_b128 v[168:171], v25 offset:6144
    ds_read_b128 v[172:175], v25 offset:7168
    ds_read_b128 v[176:179], v24 offset:0
    ds_read_b128 v[180:183], v24 offset:1024
    ds_read_b128 v[184:187], v24 offset:2048
    ds_read_b128 v[188:191], v24 offset:3072
    ds_read_b128 v[192:195], v24 offset:4096
    ds_read_b128 v[196:199], v24 offset:5120
    ds_read_b128 v[200:203], v24 offset:6144
    ds_read_b128 v[204:207], v24 offset:7168
    buffer_load_dword v248, v1, s[24:27], s76 offen
    s_add_u32 s76, s76, s30
    v_mov_b32 v128, 0
    v_mov_b32 v80, 0
    v_mov_b32 v96, 0
    v_mov_b32 v64, 0
    v_mov_b32 v129, 0
    v_mov_b32 v81, 0
    v_mov_b32 v97, 0
    v_mov_b32 v65, 0
    v_mov_b32 v130, 0
    v_mov_b32 v82, 0
    v_mov_b32 v98, 0
    v_mov_b32 v66, 0
    v_mov_b32 v131, 0
    v_mov_b32 v83, 0
    v_mov_b32 v99, 0
    v_mov_b32 v67, 0
    v_mov_b32 v132, 0
    v_mov_b32 v84, 0
    v_mov_b32 v100, 0
    v_mov_b32 v68, v7
    v_mov_b32 v133, 0
    v_mov_b32 v85, 0
    v_mov_b32 v101, 0
    v_mov_b32 v69, v7
    v_mov_b32 v134, 0
    v_mov_b32 v86, 0
    v_mov_b32 v102, 0
    v_mov_b32 v70, v7
    v_mov_b32 v135, 0
    v_mov_b32 v87, 0
    v_mov_b32 v103, 0
    v_mov_b32 v71, v7
    v_mov_b32 v136, 0
    v_mov_b32 v88, 0
    v_mov_b32 v104, 0
    v_mov_b32 v72, v7
    v_mov_b32 v137, 0
    v_mov_b32 v89, 0
    v_mov_b32 v105, 0
    v_mov_b32 v73, v7
    v_mov_b32 v138, 0
    v_mov_b32 v90, 0
    v_mov_b32 v106, 0
    v_mov_b32 v74, v7
    v_mov_b32 v139, 0
    v_mov_b32 v91, 0
    v_mov_b32 v107, 0
    v_mov_b32 v75, v7
    v_mov_b32 v140, 0
    v_mov_b32 v92, 0
    v_mov_b32 v108, 0
    v_mov_b32 v76, v7
    v_mov_b32 v141, 0
    v_mov_b32 v93, 0
    v_mov_b32 v109, 0
    v_mov_b32 v77, v7
    v_mov_b32 v142, 0
    v_mov_b32 v94, 0
    v_mov_b32 v110, 0
    v_mov_b32 v78, v7
    v_mov_b32 v143, 0
    v_mov_b32 v95, 0
    v_mov_b32 v111, 0
    v_mov_b32 v79, v7
    v_mov_b32 v8, 0
    v_mov_b32 v9, 0
    v_mov_b32 v10, 0
    v_mov_b32 v11, 0
    v_mov_b32 v12, 0
    v_mov_b32 v13, 0
    v_mov_b32 v20, 0x7f800000
    v_cmp_gt_i32 s[64:65], 0, v6
    v_cmp_gt_i32 s[66:67], 1, v6
    v_cmp_gt_i32 s[68:69], 2, v6
    v_cmp_gt_i32 s[70:71], 3, v6
    v_cndmask_b32 v224, v20, v7, s[64:65]
    v_cndmask_b32 v225, v20, v7, s[66:67]
    v_cndmask_b32 v226, v20, v7, s[68:69]
    v_cndmask_b32 v227, v20, v7, s[70:71]
    v_cmp_gt_i32 s[64:65], 8, v6
    v_cmp_gt_i32 s[66:67], 9, v6
    v_cmp_gt_i32 s[68:69], 10, v6
    v_cmp_gt_i32 s[70:71], 11, v6
    v_cndmask_b32 v228, v20, v7, s[64:65]
    v_cndmask_b32 v229, v20, v7, s[66:67]
    v_cndmask_b32 v230, v20, v7, s[68:69]
    v_cndmask_b32 v231, v20, v7, s[70:71]
    v_cmp_gt_i32 s[64:65], 16, v6
    v_cmp_gt_i32 s[66:67], 17, v6
    v_cmp_gt_i32 s[68:69], 18, v6
    v_cmp_gt_i32 s[70:71], 19, v6
    v_cndmask_b32 v232, v20, v7, s[64:65]
    v_cndmask_b32 v233, v20, v7, s[66:67]
    v_cndmask_b32 v234, v20, v7, s[68:69]
    v_cndmask_b32 v235, v20, v7, s[70:71]
    v_cmp_gt_i32 s[64:65], 24, v6
    v_cmp_gt_i32 s[66:67], 25, v6
    v_cmp_gt_i32 s[68:69], 26, v6
    v_cmp_gt_i32 s[70:71], 27, v6
    v_cndmask_b32 v236, v20, v7, s[64:65]
    v_cndmask_b32 v237, v20, v7, s[66:67]
    v_cndmask_b32 v238, v20, v7, s[68:69]
    v_cndmask_b32 v239, v20, v7, s[70:71]
    s_mov_b32 s77, 0
    s_mov_b32 s31, 0
    s_cmp_eq_u32 s35, 0
    s_cselect_b32 s99, 99, s40
    s_mov_b32 s51, 0xff800000
    s_mov_b32 s53, 0xff800000
    s_mov_b32 s52, 0xff800000
    s_mov_b32 s54, 0xff800000
    v_mfma_f32_32x32x16_bf16 a[0:15], v[128:131], v[128:131], 0
    v_mfma_f32_32x32x16_bf16 a[16:31], v[128:131], v[128:131], 0
    v_mfma_f32_32x32x16_bf16 a[32:47], v[128:131], v[128:131], 0
    v_mfma_f32_32x32x16_bf16 a[48:63], v[128:131], v[128:131], 0
    v_mfma_f32_32x32x16_bf16 a[64:79], v[128:131], v[128:131], 0
    v_mfma_f32_32x32x16_bf16 a[80:95], v[128:131], v[128:131], 0
    v_mfma_f32_32x32x16_bf16 a[96:111], v[128:131], v[128:131], 0
    v_mfma_f32_32x32x16_bf16 a[112:127], v[128:131], v[128:131], 0
    s_mov_b32 s39, 0
    s_mov_b32 s43, 0
    s_mov_b32 s49, s59
    s_add_u32 s50, s59, 98304
    s_waitcnt lgkmcnt(0)
    .p2align 6
K2_LOOP:
    s_cmp_eq_u32 s39, s77
    s_cbranch_scc1 K2_EVENT
K2_SWRET:
    s_waitcnt lgkmcnt(0)
    v_mfma_f32_32x32x16_bf16 v[48:63], a[192:195], a[128:131], v[80:95]
    ds_read_b128 a[224:227], v4 offset:8192
    v_exp_f32 v68, v68
    v_exp_f32 v69, v69
    v_add_f32 v10, v10, v64
    v_mfma_f32_32x32x16_bf16 v[48:63], a[196:199], a[132:135], v[48:63]
    ds_read_b128 a[232:235], v4 offset:10240
    v_exp_f32 v70, v70
    v_exp_f32 v71, v71
    v_add_f32 v11, v11, v65
    v_mfma_f32_32x32x16_bf16 v[48:63], a[200:203], a[136:139], v[48:63]
    v_exp_f32 v72, v72
    v_exp_f32 v73, v73
    v_exp_f32 v74, v74
    v_mfma_f32_32x32x16_bf16 v[48:63], a[204:207], a[140:143], v[48:63]
    ds_read_b128 a[240:243], v4 offset:12288
    v_exp_f32 v75, v75
    v_exp_f32 v76, v76
    v_cvt_pk_bf16_f32 v136, v64, v65
    v_mfma_f32_32x32x16_bf16 v[48:63], a[208:211], a[144:147], v[48:63]
    ds_read_b128 a[248:251], v4 offset:14336
    v_exp_f32 v77, v77
    v_exp_f32 v78, v78
    v_add_f32 v10, v10, v66
    v_mfma_f32_32x32x16_bf16 v[48:63], a[212:215], a[148:151], v[48:63]
    v_exp_f32 v79, v79
    v_add_f32 v11, v11, v67
    v_cvt_pk_bf16_f32 v137, v66, v67
    v_add_f32 v10, v10, v68
    v_add_f32 v11, v11, v69
    v_mfma_f32_32x32x16_bf16 v[48:63], a[216:219], a[152:155], v[48:63]
    ds_read_b128 a[228:231], v4 offset:9216
    v_cvt_pk_bf16_f32 v138, v68, v69
    v_add_f32 v10, v10, v70
    v_add_f32 v11, v11, v71
    v_cvt_pk_bf16_f32 v139, v70, v71
    v_add_f32 v10, v10, v72
    v_mfma_f32_32x32x16_bf16 v[48:63], a[220:223], a[156:159], v[48:63]
    v_add_f32 v11, v11, v73
    v_cvt_pk_bf16_f32 v140, v72, v73
    v_add_f32 v10, v10, v74
    v_add_f32 v11, v11, v75
    v_cvt_pk_bf16_f32 v141, v74, v75
    v_add_f32 v10, v10, v76
    v_add_f32 v11, v11, v77
    v_cvt_pk_bf16_f32 v142, v76, v77
    v_add_f32 v10, v10, v78
    v_add_f32 v11, v11, v79
    v_cvt_pk_bf16_f32 v143, v78, v79
    v_mfma_f32_32x32x16_bf16 v[64:79], a[192:195], a[160:163], v[96:111]
    ds_read_b128 a[236:239], v4 offset:11264
    v_mfma_f32_32x32x16_bf16 v[64:79], a[196:199], a[164:167], v[64:79]
    ds_read_b128 a[244:247], v4 offset:13312
    v_max3_f32 v14, v48, v49, v50
    v_max3_f32 v15, v51, v52, v53
    v_max3_f32 v16, v54, v55, v56
    v_max3_f32 v17, v57, v58, v59
    v_max3_f32 v18, v60, v61, v62
    v_mfma_f32_32x32x16_bf16 v[64:79], a[200:203], a[168:171], v[64:79]
    v_max3_f32 v14, v14, v15, v63
    v_max3_f32 v16, v16, v17, v18
    v_max_f32 v14, v14, v16
    v_cmp_lt_f32 vcc, s51, v14
    s_add_u32 s47, s45, 16777216
    s_add_u32 s48, s45, 16781312
    v_mfma_f32_32x32x16_bf16 v[64:79], a[204:207], a[172:175], v[64:79]
    ds_read_b128 a[252:255], v4 offset:15360
    s_cbranch_vccnz K2_RARE_0_0
K2_RET_0_0:
    s_mov_b32 m0, s49
    v_mfma_f32_32x32x16_bf16 v[64:79], a[208:211], a[176:179], v[64:79]
    s_cmp_eq_u32 s39, s41
    s_cselect_b32 s46, s42, 0x4000
    s_add_u32 s45, s45, s46
    s_add_u32 s46, s45, 4096
    v_exp_f32 v48, v48
    v_mfma_f32_32x32x16_bf16 v[64:79], a[212:215], a[180:183], v[64:79]
    v_exp_f32 v49, v49
    v_exp_f32 v50, v50
    v_exp_f32 v51, v51
    v_mfma_f32_32x32x16_bf16 v[64:79], a[216:219], a[184:187], v[64:79]
    v_exp_f32 v52, v52
    v_exp_f32 v53, v53
    v_exp_f32 v54, v54
    v_mfma_f32_32x32x16_bf16 v[64:79], a[220:223], a[188:191], v[64:79]
    v_exp_f32 v55, v55
    v_exp_f32 v56, v56
    v_add_f32 v8, v8, v48
    s_waitcnt lgkmcnt(0)
    v_mfma_f32_32x32x16_bf16 a[0:15], a[224:227], v[128:131], a[0:15]
    ds_read_b128 a[192:195], v2 offset:8192
    v_exp_f32 v57, v57
    v_exp_f32 v58, v58
    v_add_f32 v9, v9, v49
    v_mfma_f32_32x32x16_bf16 a[16:31], a[232:235], v[128:131], a[16:31]
    ds_read_b128 a[196:199], v2 offset:9216
    v_max3_f32 v14, v64, v65, v66
    v_max3_f32 v15, v67, v68, v69
    v_max3_f32 v16, v70, v71, v72
    v_max3_f32 v17, v73, v74, v75
    v_max3_f32 v18, v76, v77, v78
    v_mfma_f32_32x32x16_bf16 a[32:47], a[240:243], v[128:131], a[32:47]
    ds_read_b128 a[200:203], v2 offset:10240
    v_max3_f32 v14, v14, v15, v79
    v_max3_f32 v16, v16, v17, v18
    v_max_f32 v14, v14, v16
    v_cmp_lt_f32 vcc, s52, v14
    v_cvt_pk_bf16_f32 v112, v48, v49
    v_mfma_f32_32x32x16_bf16 a[48:63], a[248:251], v[128:131], a[48:63]
    ds_read_b128 a[204:207], v2 offset:11264
    s_cbranch_vccnz K2_RARE_1_0
K2_RET_1_0:
    v_exp_f32 v59, v59
    v_mfma_f32_32x32x16_bf16 a[0:15], a[228:231], v[132:135], a[0:15]
    v_exp_f32 v60, v60
    v_exp_f32 v61, v61
    v_exp_f32 v62, v62
    v_mfma_f32_32x32x16_bf16 a[16:31], a[236:239], v[132:135], a[16:31]
    ds_read_b128 a[208:211], v2 offset:12288
    v_exp_f32 v63, v63
    v_add_f32 v8, v8, v50
    v_add_f32 v9, v9, v51
    v_cvt_pk_bf16_f32 v113, v50, v51
    v_mfma_f32_32x32x16_bf16 a[32:47], a[244:247], v[132:135], a[32:47]
    ds_read_b128 a[212:215], v2 offset:13312
    v_add_f32 v8, v8, v52
    v_add_f32 v9, v9, v53
    v_cvt_pk_bf16_f32 v114, v52, v53
    v_add_f32 v8, v8, v54
    v_add_f32 v9, v9, v55
    v_mfma_f32_32x32x16_bf16 a[48:63], a[252:255], v[132:135], a[48:63]
    ds_read_b128 a[216:219], v2 offset:14336
    v_cvt_pk_bf16_f32 v115, v54, v55
    v_add_f32 v8, v8, v56
    v_add_f32 v9, v9, v57
    v_cvt_pk_bf16_f32 v116, v56, v57
    v_add_f32 v8, v8, v58
    v_mfma_f32_32x32x16_bf16 a[64:79], a[224:227], v[136:139], a[64:79]
    ds_read_b128 a[220:223], v2 offset:15360
    v_add_f32 v9, v9, v59
    v_cvt_pk_bf16_f32 v117, v58, v59
    v_add_f32 v8, v8, v60
    v_add_f32 v9, v9, v61
    v_cvt_pk_bf16_f32 v118, v60, v61
    v_mfma_f32_32x32x16_bf16 a[80:95], a[232:235], v[136:139], a[80:95]
    v_add_f32 v8, v8, v62
    v_add_f32 v9, v9, v63
    v_cvt_pk_bf16_f32 v119, v62, v63
    v_exp_f32 v64, v64
    v_mov_b32 v4, v5
    v_mfma_f32_32x32x16_bf16 a[96:111], a[240:243], v[136:139], a[96:111]
    v_exp_f32 v65, v65
    v_exp_f32 v66, v66
    v_exp_f32 v67, v67
    v_mfma_f32_32x32x16_bf16 a[112:127], a[248:251], v[136:139], a[112:127]
    s_waitcnt vmcnt(1) lgkmcnt(0)
    s_barrier
    v_exp_f32 v68, v68
    v_exp_f32 v69, v69
    v_mfma_f32_32x32x16_bf16 a[64:79], a[228:231], v[140:143], a[64:79]
    buffer_load_dwordx4 v1, s[20:23], s45 offen offset:0 sc1 lds
    v_exp_f32 v70, v70
    v_exp_f32 v71, v71
    v_mfma_f32_32x32x16_bf16 a[80:95], a[236:239], v[140:143], a[80:95]
    v_exp_f32 v72, v72
    v_exp_f32 v73, v73
    v_exp_f32 v74, v74
    v_mfma_f32_32x32x16_bf16 a[96:111], a[244:247], v[140:143], a[96:111]
    buffer_load_dwordx4 v1, s[20:23], s45 offen offset:1024 sc1 lds
    v_exp_f32 v75, v75
    v_exp_f32 v76, v76
    v_mfma_f32_32x32x16_bf16 a[112:127], a[252:255], v[140:143], a[112:127]
    v_exp_f32 v77, v77
    v_exp_f32 v78, v78
    v_exp_f32 v79, v79
    v_mfma_f32_32x32x16_bf16 v[48:63], a[192:195], a[128:131], v[80:95]
    ds_read_b128 a[224:227], v5 offset:0
    buffer_load_dwordx4 v1, s[20:23], s45 offen offset:2048 sc1 lds
    v_add_f32 v10, v10, v64
    v_add_f32 v11, v11, v65
    v_cvt_pk_bf16_f32 v120, v64, v65
    v_mfma_f32_32x32x16_bf16 v[48:63], a[196:199], a[132:135], v[48:63]
    ds_read_b128 a[232:235], v5 offset:2048
    v_add_f32 v10, v10, v66
    v_add_f32 v11, v11, v67
    v_cvt_pk_bf16_f32 v121, v66, v67
    v_add_f32 v10, v10, v68
    v_add_f32 v11, v11, v69
    v_mfma_f32_32x32x16_bf16 v[48:63], a[200:203], a[136:139], v[48:63]
    buffer_load_dwordx4 v1, s[20:23], s45 offen offset:3072 sc1 lds
    s_add_u32 m0, s49, 4096
    v_cvt_pk_bf16_f32 v122, v68, v69
    v_add_f32 v10, v10, v70
    v_add_f32 v11, v11, v71
    v_mfma_f32_32x32x16_bf16 v[48:63], a[204:207], a[140:143], v[48:63]
    ds_read_b128 a[240:243], v5 offset:4096
    v_cvt_pk_bf16_f32 v123, v70, v71
    v_add_f32 v10, v10, v72
    v_add_f32 v11, v11, v73
    v_cvt_pk_bf16_f32 v124, v72, v73
    v_add_f32 v10, v10, v74
    v_mfma_f32_32x32x16_bf16 v[48:63], a[208:211], a[144:147], v[48:63]
    ds_read_b128 a[248:251], v5 offset:6144
    buffer_load_dwordx4 v1, s[20:23], s46 offen offset:0 sc1 lds
    v_add_f32 v11, v11, v75
    v_cvt_pk_bf16_f32 v125, v74, v75
    v_add_f32 v10, v10, v76
    v_mfma_f32_32x32x16_bf16 v[48:63], a[212:215], a[148:151], v[48:63]
    v_add_f32 v11, v11, v77
    v_cvt_pk_bf16_f32 v126, v76, v77
    v_add_f32 v10, v10, v78
    v_add_f32 v11, v11, v79
    v_cvt_pk_bf16_f32 v127, v78, v79
    s_xor_b32 s49, s49, 0x8000
    v_mfma_f32_32x32x16_bf16 v[48:63], a[216:219], a[152:155], v[48:63]
    ds_read_b128 a[228:231], v5 offset:1024
    buffer_load_dwordx4 v1, s[20:23], s46 offen offset:1024 sc1 lds
    v_xor_b32 v2, 0x8000, v2
    s_add_u32 s39, s39, 1
    v_mfma_f32_32x32x16_bf16 v[48:63], a[220:223], a[156:159], v[48:63]
    v_mfma_f32_32x32x16_bf16 v[64:79], a[192:195], a[160:163], v[96:111]
    ds_read_b128 a[236:239], v5 offset:3072
    buffer_load_dwordx4 v1, s[20:23], s46 offen offset:2048 sc1 lds
    v_mfma_f32_32x32x16_bf16 v[64:79], a[196:199], a[164:167], v[64:79]
    ds_read_b128 a[244:247], v5 offset:5120
    v_max3_f32 v14, v48, v49, v50
    v_max3_f32 v15, v51, v52, v53
    v_max3_f32 v16, v54, v55, v56
    v_max3_f32 v17, v57, v58, v59
    v_max3_f32 v18, v60, v61, v62
    v_mfma_f32_32x32x16_bf16 v[64:79], a[200:203], a[168:171], v[64:79]
    buffer_load_dwordx4 v1, s[20:23], s46 offen offset:3072 sc1 lds
    s_mov_b32 m0, s50
    v_max3_f32 v14, v14, v15, v63
    v_max3_f32 v16, v16, v17, v18
    v_max_f32 v14, v14, v16
    v_mfma_f32_32x32x16_bf16 v[64:79], a[204:207], a[172:175], v[64:79]
    ds_read_b128 a[252:255], v5 offset:7168
    v_cmp_lt_f32 vcc, s51, v14
    v_mfma_f32_32x32x16_bf16 v[64:79], a[208:211], a[176:179], v[64:79]
    buffer_load_dwordx4 v1, s[20:23], s47 offen offset:0 sc1 lds
    s_cbranch_vccnz K2_RARE_0_1
K2_RET_0_1:
    v_mfma_f32_32x32x16_bf16 v[64:79], a[212:215], a[180:183], v[64:79]
    v_exp_f32 v48, v48
    v_exp_f32 v49, v49
    v_exp_f32 v50, v50
    v_mfma_f32_32x32x16_bf16 v[64:79], a[216:219], a[184:187], v[64:79]
    buffer_load_dwordx4 v1, s[20:23], s47 offen offset:1024 sc1 lds
    v_exp_f32 v51, v51
    v_exp_f32 v52, v52
    v_mfma_f32_32x32x16_bf16 v[64:79], a[220:223], a[188:191], v[64:79]
    v_exp_f32 v53, v53
    v_exp_f32 v54, v54
    v_xor_b32 v5, 0x8000, v5
    s_waitcnt lgkmcnt(0)
    v_mfma_f32_32x32x16_bf16 a[0:15], a[224:227], v[112:115], a[0:15]
    ds_read_b128 a[192:195], v3 offset:0
    buffer_load_dwordx4 v1, s[20:23], s47 offen offset:2048 sc1 lds
    v_exp_f32 v55, v55
    v_add_f32 v8, v8, v48
    v_mfma_f32_32x32x16_bf16 a[16:31], a[232:235], v[112:115], a[16:31]
    ds_read_b128 a[196:199], v3 offset:1024
    v_max3_f32 v14, v64, v65, v66
    v_max3_f32 v15, v67, v68, v69
    v_max3_f32 v16, v70, v71, v72
    v_max3_f32 v17, v73, v74, v75
    v_max3_f32 v18, v76, v77, v78
    v_mfma_f32_32x32x16_bf16 a[32:47], a[240:243], v[112:115], a[32:47]
    buffer_load_dwordx4 v1, s[20:23], s47 offen offset:3072 sc1 lds
    s_add_u32 m0, s50, 4096
    v_max3_f32 v14, v14, v15, v79
    v_max3_f32 v16, v16, v17, v18
    v_max_f32 v14, v14, v16
    v_mfma_f32_32x32x16_bf16 a[48:63], a[248:251], v[112:115], a[48:63]
    ds_read_b128 a[200:203], v3 offset:2048
    v_cmp_lt_f32 vcc, s52, v14
    v_exp_f32 v56, v56
    v_exp_f32 v57, v57
    v_mfma_f32_32x32x16_bf16 a[0:15], a[228:231], v[116:119], a[0:15]
    ds_read_b128 a[204:207], v3 offset:3072
    buffer_load_dwordx4 v1, s[20:23], s48 offen offset:0 sc1 lds
    s_cbranch_vccnz K2_RARE_1_1
K2_RET_1_1:
    v_mfma_f32_32x32x16_bf16 a[16:31], a[236:239], v[116:119], a[16:31]
    v_exp_f32 v58, v58
    v_exp_f32 v59, v59
    v_exp_f32 v60, v60
    v_mfma_f32_32x32x16_bf16 a[32:47], a[244:247], v[116:119], a[32:47]
    ds_read_b128 a[208:211], v3 offset:4096
    buffer_load_dwordx4 v1, s[20:23], s48 offen offset:1024 sc1 lds
    v_exp_f32 v61, v61
    s_xor_b32 s50, s50, 0x8000
    v_mfma_f32_32x32x16_bf16 a[48:63], a[252:255], v[116:119], a[48:63]
    v_exp_f32 v62, v62
    v_exp_f32 v63, v63
    v_add_f32 v9, v9, v49
    v_cvt_pk_bf16_f32 v128, v48, v49
    v_mfma_f32_32x32x16_bf16 a[64:79], a[224:227], v[120:123], a[64:79]
    ds_read_b128 a[212:215], v3 offset:5120
    buffer_load_dwordx4 v1, s[20:23], s48 offen offset:2048 sc1 lds
    s_add_u32 s43, s43, 1
    v_add_f32 v8, v8, v50
    v_add_f32 v9, v9, v51
    v_mfma_f32_32x32x16_bf16 a[80:95], a[232:235], v[120:123], a[80:95]
    ds_read_b128 a[216:219], v3 offset:6144
    v_cvt_pk_bf16_f32 v129, v50, v51
    v_add_f32 v8, v8, v52
    v_add_f32 v9, v9, v53
    v_cvt_pk_bf16_f32 v130, v52, v53
    v_add_f32 v8, v8, v54
    v_mfma_f32_32x32x16_bf16 a[96:111], a[240:243], v[120:123], a[96:111]
    buffer_load_dwordx4 v1, s[20:23], s48 offen offset:3072 sc1 lds
    v_add_f32 v9, v9, v55
    v_cvt_pk_bf16_f32 v131, v54, v55
    v_add_f32 v8, v8, v56
    v_add_f32 v9, v9, v57
    v_mfma_f32_32x32x16_bf16 a[112:127], a[248:251], v[120:123], a[112:127]
    ds_read_b128 a[220:223], v3 offset:7168
    v_cvt_pk_bf16_f32 v132, v56, v57
    v_add_f32 v8, v8, v58
    v_add_f32 v9, v9, v59
    v_cvt_pk_bf16_f32 v133, v58, v59
    v_add_f32 v8, v8, v60
    v_mfma_f32_32x32x16_bf16 a[64:79], a[228:231], v[124:127], a[64:79]
    buffer_load_dword v248, v1, s[24:27], s76 offen
    s_add_u32 s76, s76, s30
    v_add_f32 v9, v9, v61
    v_cvt_pk_bf16_f32 v134, v60, v61
    v_add_f32 v8, v8, v62
    v_mfma_f32_32x32x16_bf16 a[80:95], a[236:239], v[124:127], a[80:95]
    v_xor_b32 v3, 0x8000, v3
    v_add_f32 v9, v9, v63
    v_cvt_pk_bf16_f32 v135, v62, v63
    v_exp_f32 v64, v64
    v_mfma_f32_32x32x16_bf16 a[96:111], a[244:247], v[124:127], a[96:111]
    v_exp_f32 v65, v65
    v_exp_f32 v66, v66
    v_exp_f32 v67, v67
    v_mfma_f32_32x32x16_bf16 a[112:127], a[252:255], v[124:127], a[112:127]
    s_cmp_lt_u32 s39, 17
    s_cbranch_scc1 K2_LOOP
K2_TAIL:
    ds_read_b128 a[224:227], v4 offset:8192
    ds_read_b128 a[232:235], v4 offset:10240
    ds_read_b128 a[240:243], v4 offset:12288
    ds_read_b128 a[248:251], v4 offset:14336
    ds_read_b128 a[228:231], v4 offset:9216
    ds_read_b128 a[236:239], v4 offset:11264
    ds_read_b128 a[244:247], v4 offset:13312
    ds_read_b128 a[252:255], v4 offset:15360
    s_mul_i32 s61, s34, 384
    s_lshl_b32 s62, s32, 5
    s_add_u32 s61, s61, s62
    s_lshl_b32 s61, s61, 10
    s_add_u32 s61, s61, 38797312
    s_cmp_eq_u32 s34, 7
    s_cselect_b32 s98, 0x20000000, s61
    s_add_u32 s62, s61, 0
    buffer_load_dwordx4 v[144:147], v1, s[20:23], s62 offen offset:0 sc1
    v_exp_f32 v68, v68
    v_exp_f32 v69, v69
    v_add_f32 v10, v10, v64
    v_exp_f32 v70, v70
    v_exp_f32 v71, v71
    v_add_f32 v11, v11, v65
    v_exp_f32 v72, v72
    v_exp_f32 v73, v73
    v_exp_f32 v74, v74
    buffer_load_dwordx4 v[148:151], v1, s[20:23], s62 offen offset:1024 sc1
    v_exp_f32 v75, v75
    v_exp_f32 v76, v76
    v_cvt_pk_bf16_f32 v136, v64, v65
    v_exp_f32 v77, v77
    v_exp_f32 v78, v78
    v_add_f32 v10, v10, v66
    v_exp_f32 v79, v79
    v_add_f32 v11, v11, v67
    buffer_load_dwordx4 v[152:155], v1, s[20:23], s62 offen offset:2048 sc1
    v_cvt_pk_bf16_f32 v137, v66, v67
    v_add_f32 v10, v10, v68
    v_add_f32 v11, v11, v69
    v_cvt_pk_bf16_f32 v138, v68, v69
    v_add_f32 v10, v10, v70
    v_add_f32 v11, v11, v71
    v_cvt_pk_bf16_f32 v139, v70, v71
    v_add_f32 v10, v10, v72
    v_add_f32 v11, v11, v73
    buffer_load_dwordx4 v[156:159], v1, s[20:23], s62 offen offset:3072 sc1
    v_cvt_pk_bf16_f32 v140, v72, v73
    v_add_f32 v10, v10, v74
    v_add_f32 v11, v11, v75
    v_cvt_pk_bf16_f32 v141, v74, v75
    v_add_f32 v10, v10, v76
    v_add_f32 v11, v11, v77
    v_cvt_pk_bf16_f32 v142, v76, v77
    v_add_f32 v10, v10, v78
    s_add_u32 s62, s98, 131072
    buffer_load_dwordx4 v[160:163], v1, s[20:23], s62 offen offset:0 sc1
    v_add_f32 v11, v11, v79
    v_cvt_pk_bf16_f32 v143, v78, v79
    v_add_f32 v8, v8, v9
    v_add_f32 v10, v10, v11
    v_mov_b32 v9, v8
    v_mov_b32 v11, v10
    v_add_u32 v24, s59, v1
    v_and_b32 v25, 0x18000, v4
    v_permlane32_swap_b32 v8, v9
    buffer_load_dwordx4 v[164:167], v1, s[20:23], s62 offen offset:1024 sc1
    v_permlane32_swap_b32 v10, v11
    v_add_u32 v25, v25, v24
    v_add_u32 v24, 131072, v24
    v_add_f32 v8, v8, v9
    v_add_f32 v10, v10, v11
    s_cmp_eq_u32 s35, 0
    s_cselect_b64 vcc, -1, 0
    v_xor_b32 v26, 0x4000, v24
    v_xor_b32 v27, 0x4000, v25
    buffer_load_dwordx4 v[168:171], v1, s[20:23], s62 offen offset:2048 sc1
    v_cndmask_b32 v28, v12, v13, vcc
    v_cndmask_b32 v29, v8, v10, vcc
    ds_write_b64 v26, v[28:29]
    v_lshrrev_b32 v240, 4, v0
    v_lshrrev_b32 v241, 3, v0
    v_lshlrev_b32 v241, 12, v241
    v_and_b32 v242, 7, v0
    v_xor_b32 v242, v242, v240
    v_lshl_add_u32 v243, v242, 4, v241
    buffer_load_dwordx4 v[172:175], v1, s[20:23], s62 offen offset:3072 sc1
    v_xor_b32 v242, 4, v242
    v_lshl_add_u32 v244, v242, 4, v241
    v_add_u32 v32, 0, v243
    v_add_u32 v33, 31744, v244
    v_add_u32 v34, 63488, v243
    v_add_u32 v35, 95232, v244
    v_add_u32 v36, 131072, v243
    v_add_u32 v37, 162816, v244
    s_add_u32 s62, s98, 262144
    buffer_load_dwordx4 v[176:179], v1, s[20:23], s62 offen offset:0 sc1
    v_add_u32 v38, 194560, v243
    v_add_u32 v39, 226304, v244
    v_lshrrev_b32 v240, 5, v0
    v_bfe_u32 v241, v0, 1, 3
    v_xor_b32 v241, v241, v240
    v_and_b32 v242, 31, v0
    v_lshlrev_b32 v242, 7, v242
    v_add_u32 v242, s59, v242
    v_xor_b32 v243, 0, v241
    buffer_load_dwordx4 v[180:183], v1, s[20:23], s62 offen offset:1024 sc1
    v_lshl_add_u32 v40, v243, 4, v242
    v_add_u32 v44, 0x10000, v40
    v_xor_b32 v243, 2, v241
    v_lshl_add_u32 v41, v243, 4, v242
    v_add_u32 v45, 0x10000, v41
    v_xor_b32 v243, 4, v241
    v_lshl_add_u32 v42, v243, 4, v242
    v_add_u32 v46, 0x10000, v42
    buffer_load_dwordx4 v[184:187], v1, s[20:23], s62 offen offset:2048 sc1
    v_xor_b32 v243, 6, v241
    v_lshl_add_u32 v43, v243, 4, v242
    v_add_u32 v47, 0x10000, v43
    s_lshl_b32 s60, s33, 18
    s_lshl_b32 s58, s32, 10
    s_add_u32 s60, s60, s58
    s_sub_u32 s37, 15, s34
    s_lshl_b32 s37, s37, 2
    s_lshl_b32 s38, s36, 1
    buffer_load_dwordx4 v[188:191], v1, s[20:23], s62 offen offset:3072 sc1
    s_add_u32 s37, s37, s38
    s_add_u32 s37, s37, s35
    s_mul_i32 s37, s37, 304
    s_lshl_b32 s38, s33, 3
    s_add_u32 s37, s37, s38
    s_lshl_b32 s37, s37, 10
    s_add_u32 s37, s37, 42991616
    s_add_u32 s38, s37, 4096
    s_waitcnt vmcnt(12)
    s_waitcnt lgkmcnt(0)
    s_barrier
    s_cmp_eq_u32 s35, 1
    s_cbranch_scc1 K2_MERGE1
    ds_read_b64 v[28:29], v24
    v_mfma_f32_32x32x16_bf16 a[64:79], a[224:227], v[136:139], a[64:79]
    s_add_u32 m0, s59, 0
    s_add_u32 s58, s60, 0
    buffer_load_dwordx4 v32, s[12:15], s58 offen offset:0 lds
    v_mfma_f32_32x32x16_bf16 a[80:95], a[232:235], v[136:139], a[80:95]
    buffer_load_dwordx4 v33, s[12:15], s58 offen offset:1024 lds
    v_mfma_f32_32x32x16_bf16 a[96:111], a[240:243], v[136:139], a[96:111]
    buffer_load_dwordx4 v34, s[12:15], s58 offen offset:2048 lds
    v_mfma_f32_32x32x16_bf16 a[112:127], a[248:251], v[136:139], a[112:127]
    buffer_load_dwordx4 v35, s[12:15], s58 offen offset:3072 lds
    v_mfma_f32_32x32x16_bf16 a[64:79], a[228:231], v[140:143], a[64:79]
    s_add_u32 m0, s59, 4096
    s_add_u32 s58, s60, 0
    buffer_load_dwordx4 v36, s[12:15], s58 offen offset:0 lds
    v_mfma_f32_32x32x16_bf16 a[80:95], a[236:239], v[140:143], a[80:95]
    buffer_load_dwordx4 v37, s[12:15], s58 offen offset:1024 lds
    v_mfma_f32_32x32x16_bf16 a[96:111], a[244:247], v[140:143], a[96:111]
    buffer_load_dwordx4 v38, s[12:15], s58 offen offset:2048 lds
    v_mfma_f32_32x32x16_bf16 a[112:127], a[252:255], v[140:143], a[112:127]
    buffer_load_dwordx4 v39, s[12:15], s58 offen offset:3072 lds
    s_waitcnt lgkmcnt(0)
    v_mfma_f32_32x32x16_bf16 a[0:15], a[224:227], v[128:131], a[0:15]
    s_add_u32 m0, s59, 32768
    s_add_u32 s58, s60, 128
    buffer_load_dwordx4 v32, s[12:15], s58 offen offset:0 lds
    v_min_f32 v20, v12, v28
    v_sub_f32 v22, v20, v12
    v_sub_f32 v28, v20, v28
    v_exp_f32 v22, v22
    v_exp_f32 v28, v28
    s_nop 0
    v_mfma_f32_32x32x16_bf16 a[16:31], a[232:235], v[128:131], a[16:31]
    buffer_load_dwordx4 v33, s[12:15], s58 offen offset:1024 lds
    v_mul_f32 v20, v8, v22
    v_fmac_f32 v20, v29, v28
    v_rcp_f32 v20, v20
    s_nop 0
    v_mul_f32 v22, v22, v20
    v_mul_f32 v28, v28, v20
    v_mov_b32 v23, v22
    v_mov_b32 v29, v28
    v_mfma_f32_32x32x16_bf16 a[32:47], a[240:243], v[128:131], a[32:47]
    ds_write_b128 v24, a[64:67] offset:0
    ds_write_b128 v24, a[68:71] offset:1024
    ds_write_b128 v24, a[72:75] offset:2048
    buffer_load_dwordx4 v34, s[12:15], s58 offen offset:2048 lds
    v_mfma_f32_32x32x16_bf16 a[48:63], a[248:251], v[128:131], a[48:63]
    ds_write_b128 v24, a[76:79] offset:3072
    ds_write_b128 v24, a[80:83] offset:4096
    ds_write_b128 v24, a[84:87] offset:5120
    buffer_load_dwordx4 v35, s[12:15], s58 offen offset:3072 lds
    v_mfma_f32_32x32x16_bf16 a[0:15], a[228:231], v[132:135], a[0:15]
    ds_write_b128 v24, a[88:91] offset:6144
    ds_write_b128 v24, a[92:95] offset:7168
    s_add_u32 m0, s59, 36864
    s_add_u32 s58, s60, 128
    buffer_load_dwordx4 v36, s[12:15], s58 offen offset:0 lds
    v_mfma_f32_32x32x16_bf16 a[16:31], a[236:239], v[132:135], a[16:31]
    ds_write_b128 v25, a[96:99] offset:0
    ds_write_b128 v25, a[100:103] offset:1024
    ds_write_b128 v25, a[104:107] offset:2048
    buffer_load_dwordx4 v37, s[12:15], s58 offen offset:1024 lds
    v_mfma_f32_32x32x16_bf16 a[32:47], a[244:247], v[132:135], a[32:47]
    ds_write_b128 v25, a[108:111] offset:3072
    ds_write_b128 v25, a[112:115] offset:4096
    ds_write_b128 v25, a[116:119] offset:5120
    buffer_load_dwordx4 v38, s[12:15], s58 offen offset:2048 lds
    v_mfma_f32_32x32x16_bf16 a[48:63], a[252:255], v[132:135], a[48:63]
    ds_write_b128 v25, a[120:123] offset:6144
    ds_write_b128 v25, a[124:127] offset:7168
    buffer_load_dwordx4 v39, s[12:15], s58 offen offset:3072 lds
    s_waitcnt lgkmcnt(0)
    s_barrier
    ds_read_b128 v[48:51], v26 offset:0
    ds_read_b128 v[52:55], v26 offset:1024
    ds_read_b128 v[56:59], v26 offset:2048
    ds_read_b128 v[60:63], v26 offset:3072
    ds_read_b128 v[64:67], v26 offset:4096
    ds_read_b128 v[68:71], v26 offset:5120
    ds_read_b128 v[72:75], v26 offset:6144
    ds_read_b128 v[76:79], v26 offset:7168
    ds_read_b128 v[80:83], v27 offset:0
    ds_read_b128 v[84:87], v27 offset:1024
    ds_read_b128 v[88:91], v27 offset:2048
    ds_read_b128 v[92:95], v27 offset:3072
    ds_read_b128 v[96:99], v27 offset:4096
    ds_read_b128 v[100:103], v27 offset:5120
    ds_read_b128 v[104:107], v27 offset:6144
    ds_read_b128 v[108:111], v27 offset:7168
    s_add_u32 s62, s61, 4096
    buffer_load_dwordx4 v[192:195], v1, s[20:23], s62 offen offset:0 sc1
    v_accvgpr_read_b32 v112, a0
    v_accvgpr_read_b32 v113, a1
    v_accvgpr_read_b32 v114, a2
    v_accvgpr_read_b32 v115, a3
    v_accvgpr_read_b32 v116, a4
    v_accvgpr_read_b32 v117, a5
    v_accvgpr_read_b32 v118, a6
    v_accvgpr_read_b32 v119, a7
    s_waitcnt lgkmcnt(14)
    v_pk_mul_f32 v[48:49], v[48:49], v[28:29]
    v_pk_mul_f32 v[50:51], v[50:51], v[28:29]
    v_pk_mul_f32 v[52:53], v[52:53], v[28:29]
    v_pk_mul_f32 v[54:55], v[54:55], v[28:29]
    v_pk_fma_f32 v[48:49], v[112:113], v[22:23], v[48:49]
    v_pk_fma_f32 v[50:51], v[114:115], v[22:23], v[50:51]
    buffer_load_dwordx4 v[196:199], v1, s[20:23], s62 offen offset:1024 sc1
    v_pk_fma_f32 v[52:53], v[116:117], v[22:23], v[52:53]
    v_pk_fma_f32 v[54:55], v[118:119], v[22:23], v[54:55]
    v_cvt_pk_bf16_f32 v120, v48, v49
    v_cvt_pk_bf16_f32 v121, v50, v51
    v_cvt_pk_bf16_f32 v122, v52, v53
    v_cvt_pk_bf16_f32 v123, v54, v55
    buffer_store_dwordx4 v[120:123], v1, s[20:23], s37 offen offset:0 sc1
    v_accvgpr_read_b32 v112, a8
    v_accvgpr_read_b32 v113, a9
    v_accvgpr_read_b32 v114, a10
    v_accvgpr_read_b32 v115, a11
    v_accvgpr_read_b32 v116, a12
    v_accvgpr_read_b32 v117, a13
    v_accvgpr_read_b32 v118, a14
    v_accvgpr_read_b32 v119, a15
    buffer_load_dwordx4 v[200:203], v1, s[20:23], s62 offen offset:2048 sc1
    s_waitcnt lgkmcnt(12)
    v_pk_mul_f32 v[56:57], v[56:57], v[28:29]
    v_pk_mul_f32 v[58:59], v[58:59], v[28:29]
    v_pk_mul_f32 v[60:61], v[60:61], v[28:29]
    v_pk_mul_f32 v[62:63], v[62:63], v[28:29]
    v_pk_fma_f32 v[56:57], v[112:113], v[22:23], v[56:57]
    v_pk_fma_f32 v[58:59], v[114:115], v[22:23], v[58:59]
    v_pk_fma_f32 v[60:61], v[116:117], v[22:23], v[60:61]
    v_pk_fma_f32 v[62:63], v[118:119], v[22:23], v[62:63]
    v_cvt_pk_bf16_f32 v124, v56, v57
    v_cvt_pk_bf16_f32 v125, v58, v59
    v_cvt_pk_bf16_f32 v126, v60, v61
    v_cvt_pk_bf16_f32 v127, v62, v63
    buffer_store_dwordx4 v[124:127], v1, s[20:23], s37 offen offset:1024 sc1
    buffer_load_dwordx4 v[204:207], v1, s[20:23], s62 offen offset:3072 sc1
    v_accvgpr_read_b32 v112, a16
    v_accvgpr_read_b32 v113, a17
    v_accvgpr_read_b32 v114, a18
    v_accvgpr_read_b32 v115, a19
    v_accvgpr_read_b32 v116, a20
    v_accvgpr_read_b32 v117, a21
    v_accvgpr_read_b32 v118, a22
    v_accvgpr_read_b32 v119, a23
    s_waitcnt lgkmcnt(10)
    v_pk_mul_f32 v[64:65], v[64:65], v[28:29]
    v_pk_mul_f32 v[66:67], v[66:67], v[28:29]
    v_pk_mul_f32 v[68:69], v[68:69], v[28:29]
    v_pk_mul_f32 v[70:71], v[70:71], v[28:29]
    v_pk_fma_f32 v[64:65], v[112:113], v[22:23], v[64:65]
    v_pk_fma_f32 v[66:67], v[114:115], v[22:23], v[66:67]
    s_add_u32 s62, s98, 135168
    buffer_load_dwordx4 v[208:211], v1, s[20:23], s62 offen offset:0 sc1
    v_pk_fma_f32 v[68:69], v[116:117], v[22:23], v[68:69]
    v_pk_fma_f32 v[70:71], v[118:119], v[22:23], v[70:71]
    v_cvt_pk_bf16_f32 v128, v64, v65
    v_cvt_pk_bf16_f32 v129, v66, v67
    v_cvt_pk_bf16_f32 v130, v68, v69
    v_cvt_pk_bf16_f32 v131, v70, v71
    buffer_store_dwordx4 v[128:131], v1, s[20:23], s37 offen offset:2048 sc1
    v_accvgpr_read_b32 v112, a24
    v_accvgpr_read_b32 v113, a25
    v_accvgpr_read_b32 v114, a26
    v_accvgpr_read_b32 v115, a27
    v_accvgpr_read_b32 v116, a28
    v_accvgpr_read_b32 v117, a29
    v_accvgpr_read_b32 v118, a30
    v_accvgpr_read_b32 v119, a31
    buffer_load_dwordx4 v[212:215], v1, s[20:23], s62 offen offset:1024 sc1
    s_waitcnt lgkmcnt(8)
    v_pk_mul_f32 v[72:73], v[72:73], v[28:29]
    v_pk_mul_f32 v[74:75], v[74:75], v[28:29]
    v_pk_mul_f32 v[76:77], v[76:77], v[28:29]
    v_pk_mul_f32 v[78:79], v[78:79], v[28:29]
    v_pk_fma_f32 v[72:73], v[112:113], v[22:23], v[72:73]
    v_pk_fma_f32 v[74:75], v[114:115], v[22:23], v[74:75]
    v_pk_fma_f32 v[76:77], v[116:117], v[22:23], v[76:77]
    v_pk_fma_f32 v[78:79], v[118:119], v[22:23], v[78:79]
    v_cvt_pk_bf16_f32 v132, v72, v73
    v_cvt_pk_bf16_f32 v133, v74, v75
    v_cvt_pk_bf16_f32 v134, v76, v77
    v_cvt_pk_bf16_f32 v135, v78, v79
    buffer_store_dwordx4 v[132:135], v1, s[20:23], s37 offen offset:3072 sc1
    buffer_load_dwordx4 v[216:219], v1, s[20:23], s62 offen offset:2048 sc1
    v_accvgpr_read_b32 v112, a32
    v_accvgpr_read_b32 v113, a33
    v_accvgpr_read_b32 v114, a34
    v_accvgpr_read_b32 v115, a35
    v_accvgpr_read_b32 v116, a36
    v_accvgpr_read_b32 v117, a37
    v_accvgpr_read_b32 v118, a38
    v_accvgpr_read_b32 v119, a39
    s_waitcnt lgkmcnt(6)
    v_pk_mul_f32 v[80:81], v[80:81], v[28:29]
    v_pk_mul_f32 v[82:83], v[82:83], v[28:29]
    v_pk_mul_f32 v[84:85], v[84:85], v[28:29]
    v_pk_mul_f32 v[86:87], v[86:87], v[28:29]
    v_pk_fma_f32 v[80:81], v[112:113], v[22:23], v[80:81]
    v_pk_fma_f32 v[82:83], v[114:115], v[22:23], v[82:83]
    buffer_load_dwordx4 v[220:223], v1, s[20:23], s62 offen offset:3072 sc1
    v_pk_fma_f32 v[84:85], v[116:117], v[22:23], v[84:85]
    v_pk_fma_f32 v[86:87], v[118:119], v[22:23], v[86:87]
    v_cvt_pk_bf16_f32 v120, v80, v81
    v_cvt_pk_bf16_f32 v121, v82, v83
    v_cvt_pk_bf16_f32 v122, v84, v85
    v_cvt_pk_bf16_f32 v123, v86, v87
    buffer_store_dwordx4 v[120:123], v1, s[20:23], s38 offen offset:0 sc1
    v_accvgpr_read_b32 v112, a40
    v_accvgpr_read_b32 v113, a41
    v_accvgpr_read_b32 v114, a42
    v_accvgpr_read_b32 v115, a43
    v_accvgpr_read_b32 v116, a44
    v_accvgpr_read_b32 v117, a45
    v_accvgpr_read_b32 v118, a46
    v_accvgpr_read_b32 v119, a47
    s_add_u32 s62, s98, 266240
    buffer_load_dwordx4 v[224:227], v1, s[20:23], s62 offen offset:0 sc1
    s_waitcnt lgkmcnt(4)
    v_pk_mul_f32 v[88:89], v[88:89], v[28:29]
    v_pk_mul_f32 v[90:91], v[90:91], v[28:29]
    v_pk_mul_f32 v[92:93], v[92:93], v[28:29]
    v_pk_mul_f32 v[94:95], v[94:95], v[28:29]
    v_pk_fma_f32 v[88:89], v[112:113], v[22:23], v[88:89]
    v_pk_fma_f32 v[90:91], v[114:115], v[22:23], v[90:91]
    v_pk_fma_f32 v[92:93], v[116:117], v[22:23], v[92:93]
    v_pk_fma_f32 v[94:95], v[118:119], v[22:23], v[94:95]
    v_cvt_pk_bf16_f32 v124, v88, v89
    v_cvt_pk_bf16_f32 v125, v90, v91
    v_cvt_pk_bf16_f32 v126, v92, v93
    v_cvt_pk_bf16_f32 v127, v94, v95
    buffer_store_dwordx4 v[124:127], v1, s[20:23], s38 offen offset:1024 sc1
    buffer_load_dwordx4 v[228:231], v1, s[20:23], s62 offen offset:1024 sc1
    v_accvgpr_read_b32 v112, a48
    v_accvgpr_read_b32 v113, a49
    v_accvgpr_read_b32 v114, a50
    v_accvgpr_read_b32 v115, a51
    v_accvgpr_read_b32 v116, a52
    v_accvgpr_read_b32 v117, a53
    v_accvgpr_read_b32 v118, a54
    v_accvgpr_read_b32 v119, a55
    s_waitcnt lgkmcnt(2)
    v_pk_mul_f32 v[96:97], v[96:97], v[28:29]
    v_pk_mul_f32 v[98:99], v[98:99], v[28:29]
    v_pk_mul_f32 v[100:101], v[100:101], v[28:29]
    v_pk_mul_f32 v[102:103], v[102:103], v[28:29]
    v_pk_fma_f32 v[96:97], v[112:113], v[22:23], v[96:97]
    v_pk_fma_f32 v[98:99], v[114:115], v[22:23], v[98:99]
    buffer_load_dwordx4 v[232:235], v1, s[20:23], s62 offen offset:2048 sc1
    v_pk_fma_f32 v[100:101], v[116:117], v[22:23], v[100:101]
    v_pk_fma_f32 v[102:103], v[118:119], v[22:23], v[102:103]
    v_cvt_pk_bf16_f32 v128, v96, v97
    v_cvt_pk_bf16_f32 v129, v98, v99
    v_cvt_pk_bf16_f32 v130, v100, v101
    v_cvt_pk_bf16_f32 v131, v102, v103
    buffer_store_dwordx4 v[128:131], v1, s[20:23], s38 offen offset:2048 sc1
    v_accvgpr_read_b32 v112, a56
    v_accvgpr_read_b32 v113, a57
    v_accvgpr_read_b32 v114, a58
    v_accvgpr_read_b32 v115, a59
    v_accvgpr_read_b32 v116, a60
    v_accvgpr_read_b32 v117, a61
    v_accvgpr_read_b32 v118, a62
    v_accvgpr_read_b32 v119, a63
    buffer_load_dwordx4 v[236:239], v1, s[20:23], s62 offen offset:3072 sc1
    s_waitcnt lgkmcnt(0)
    v_pk_mul_f32 v[104:105], v[104:105], v[28:29]
    v_pk_mul_f32 v[106:107], v[106:107], v[28:29]
    v_pk_mul_f32 v[108:109], v[108:109], v[28:29]
    v_pk_mul_f32 v[110:111], v[110:111], v[28:29]
    v_pk_fma_f32 v[104:105], v[112:113], v[22:23], v[104:105]
    v_pk_fma_f32 v[106:107], v[114:115], v[22:23], v[106:107]
    v_pk_fma_f32 v[108:109], v[116:117], v[22:23], v[108:109]
    v_pk_fma_f32 v[110:111], v[118:119], v[22:23], v[110:111]
    v_cvt_pk_bf16_f32 v132, v104, v105
    v_cvt_pk_bf16_f32 v133, v106, v107
    v_cvt_pk_bf16_f32 v134, v108, v109
    v_cvt_pk_bf16_f32 v135, v110, v111
    buffer_store_dwordx4 v[132:135], v1, s[20:23], s38 offen offset:3072 sc1
    s_branch K2_G
K2_MERGE1:
    ds_read_b64 v[28:29], v24
    v_mfma_f32_32x32x16_bf16 a[0:15], a[224:227], v[128:131], a[0:15]
    s_add_u32 m0, s59, 0
    s_add_u32 s58, s60, 0
    buffer_load_dwordx4 v32, s[12:15], s58 offen offset:0 lds
    v_mfma_f32_32x32x16_bf16 a[16:31], a[232:235], v[128:131], a[16:31]
    buffer_load_dwordx4 v33, s[12:15], s58 offen offset:1024 lds
    v_mfma_f32_32x32x16_bf16 a[32:47], a[240:243], v[128:131], a[32:47]
    buffer_load_dwordx4 v34, s[12:15], s58 offen offset:2048 lds
    v_mfma_f32_32x32x16_bf16 a[48:63], a[248:251], v[128:131], a[48:63]
    buffer_load_dwordx4 v35, s[12:15], s58 offen offset:3072 lds
    v_mfma_f32_32x32x16_bf16 a[0:15], a[228:231], v[132:135], a[0:15]
    s_add_u32 m0, s59, 4096
    s_add_u32 s58, s60, 0
    buffer_load_dwordx4 v36, s[12:15], s58 offen offset:0 lds
    v_mfma_f32_32x32x16_bf16 a[16:31], a[236:239], v[132:135], a[16:31]
    buffer_load_dwordx4 v37, s[12:15], s58 offen offset:1024 lds
    v_mfma_f32_32x32x16_bf16 a[32:47], a[244:247], v[132:135], a[32:47]
    buffer_load_dwordx4 v38, s[12:15], s58 offen offset:2048 lds
    v_mfma_f32_32x32x16_bf16 a[48:63], a[252:255], v[132:135], a[48:63]
    buffer_load_dwordx4 v39, s[12:15], s58 offen offset:3072 lds
    s_waitcnt lgkmcnt(0)
    v_mfma_f32_32x32x16_bf16 a[64:79], a[224:227], v[136:139], a[64:79]
    s_add_u32 m0, s59, 32768
    s_add_u32 s58, s60, 128
    buffer_load_dwordx4 v32, s[12:15], s58 offen offset:0 lds
    v_min_f32 v20, v13, v28
    v_sub_f32 v22, v20, v13
    v_sub_f32 v28, v20, v28
    v_exp_f32 v22, v22
    v_exp_f32 v28, v28
    s_nop 0
    v_mfma_f32_32x32x16_bf16 a[80:95], a[232:235], v[136:139], a[80:95]
    buffer_load_dwordx4 v33, s[12:15], s58 offen offset:1024 lds
    v_mul_f32 v20, v10, v22
    v_fmac_f32 v20, v29, v28
    v_rcp_f32 v20, v20
    s_nop 0
    v_mul_f32 v22, v22, v20
    v_mul_f32 v28, v28, v20
    v_mov_b32 v23, v22
    v_mov_b32 v29, v28
    v_mfma_f32_32x32x16_bf16 a[96:111], a[240:243], v[136:139], a[96:111]
    ds_write_b128 v24, a[0:3] offset:0
    ds_write_b128 v24, a[4:7] offset:1024
    ds_write_b128 v24, a[8:11] offset:2048
    buffer_load_dwordx4 v34, s[12:15], s58 offen offset:2048 lds
    v_mfma_f32_32x32x16_bf16 a[112:127], a[248:251], v[136:139], a[112:127]
    ds_write_b128 v24, a[12:15] offset:3072
    ds_write_b128 v24, a[16:19] offset:4096
    ds_write_b128 v24, a[20:23] offset:5120
    buffer_load_dwordx4 v35, s[12:15], s58 offen offset:3072 lds
    v_mfma_f32_32x32x16_bf16 a[64:79], a[228:231], v[140:143], a[64:79]
    ds_write_b128 v24, a[24:27] offset:6144
    ds_write_b128 v24, a[28:31] offset:7168
    s_add_u32 m0, s59, 36864
    s_add_u32 s58, s60, 128
    buffer_load_dwordx4 v36, s[12:15], s58 offen offset:0 lds
    v_mfma_f32_32x32x16_bf16 a[80:95], a[236:239], v[140:143], a[80:95]
    ds_write_b128 v25, a[32:35] offset:0
    ds_write_b128 v25, a[36:39] offset:1024
    ds_write_b128 v25, a[40:43] offset:2048
    buffer_load_dwordx4 v37, s[12:15], s58 offen offset:1024 lds
    v_mfma_f32_32x32x16_bf16 a[96:111], a[244:247], v[140:143], a[96:111]
    ds_write_b128 v25, a[44:47] offset:3072
    ds_write_b128 v25, a[48:51] offset:4096
    ds_write_b128 v25, a[52:55] offset:5120
    buffer_load_dwordx4 v38, s[12:15], s58 offen offset:2048 lds
    v_mfma_f32_32x32x16_bf16 a[112:127], a[252:255], v[140:143], a[112:127]
    ds_write_b128 v25, a[56:59] offset:6144
    ds_write_b128 v25, a[60:63] offset:7168
    buffer_load_dwordx4 v39, s[12:15], s58 offen offset:3072 lds
    s_waitcnt lgkmcnt(0)
    s_barrier
    ds_read_b128 v[48:51], v26 offset:0
    ds_read_b128 v[52:55], v26 offset:1024
    ds_read_b128 v[56:59], v26 offset:2048
    ds_read_b128 v[60:63], v26 offset:3072
    ds_read_b128 v[64:67], v26 offset:4096
    ds_read_b128 v[68:71], v26 offset:5120
    ds_read_b128 v[72:75], v26 offset:6144
    ds_read_b128 v[76:79], v26 offset:7168
    ds_read_b128 v[80:83], v27 offset:0
    ds_read_b128 v[84:87], v27 offset:1024
    ds_read_b128 v[88:91], v27 offset:2048
    ds_read_b128 v[92:95], v27 offset:3072
    ds_read_b128 v[96:99], v27 offset:4096
    ds_read_b128 v[100:103], v27 offset:5120
    ds_read_b128 v[104:107], v27 offset:6144
    ds_read_b128 v[108:111], v27 offset:7168
    s_add_u32 s62, s61, 4096
    buffer_load_dwordx4 v[192:195], v1, s[20:23], s62 offen offset:0 sc1
    v_accvgpr_read_b32 v112, a64
    v_accvgpr_read_b32 v113, a65
    v_accvgpr_read_b32 v114, a66
    v_accvgpr_read_b32 v115, a67
    v_accvgpr_read_b32 v116, a68
    v_accvgpr_read_b32 v117, a69
    v_accvgpr_read_b32 v118, a70
    v_accvgpr_read_b32 v119, a71
    s_waitcnt lgkmcnt(14)
    v_pk_mul_f32 v[48:49], v[48:49], v[28:29]
    v_pk_mul_f32 v[50:51], v[50:51], v[28:29]
    v_pk_mul_f32 v[52:53], v[52:53], v[28:29]
    v_pk_mul_f32 v[54:55], v[54:55], v[28:29]
    v_pk_fma_f32 v[48:49], v[112:113], v[22:23], v[48:49]
    v_pk_fma_f32 v[50:51], v[114:115], v[22:23], v[50:51]
    buffer_load_dwordx4 v[196:199], v1, s[20:23], s62 offen offset:1024 sc1
    v_pk_fma_f32 v[52:53], v[116:117], v[22:23], v[52:53]
    v_pk_fma_f32 v[54:55], v[118:119], v[22:23], v[54:55]
    v_cvt_pk_bf16_f32 v120, v48, v49
    v_cvt_pk_bf16_f32 v121, v50, v51
    v_cvt_pk_bf16_f32 v122, v52, v53
    v_cvt_pk_bf16_f32 v123, v54, v55
    buffer_store_dwordx4 v[120:123], v1, s[20:23], s37 offen offset:0 sc1
    v_accvgpr_read_b32 v112, a72
    v_accvgpr_read_b32 v113, a73
    v_accvgpr_read_b32 v114, a74
    v_accvgpr_read_b32 v115, a75
    v_accvgpr_read_b32 v116, a76
    v_accvgpr_read_b32 v117, a77
    v_accvgpr_read_b32 v118, a78
    v_accvgpr_read_b32 v119, a79
    buffer_load_dwordx4 v[200:203], v1, s[20:23], s62 offen offset:2048 sc1
    s_waitcnt lgkmcnt(12)
    v_pk_mul_f32 v[56:57], v[56:57], v[28:29]
    v_pk_mul_f32 v[58:59], v[58:59], v[28:29]
    v_pk_mul_f32 v[60:61], v[60:61], v[28:29]
    v_pk_mul_f32 v[62:63], v[62:63], v[28:29]
    v_pk_fma_f32 v[56:57], v[112:113], v[22:23], v[56:57]
    v_pk_fma_f32 v[58:59], v[114:115], v[22:23], v[58:59]
    v_pk_fma_f32 v[60:61], v[116:117], v[22:23], v[60:61]
    v_pk_fma_f32 v[62:63], v[118:119], v[22:23], v[62:63]
    v_cvt_pk_bf16_f32 v124, v56, v57
    v_cvt_pk_bf16_f32 v125, v58, v59
    v_cvt_pk_bf16_f32 v126, v60, v61
    v_cvt_pk_bf16_f32 v127, v62, v63
    buffer_store_dwordx4 v[124:127], v1, s[20:23], s37 offen offset:1024 sc1
    buffer_load_dwordx4 v[204:207], v1, s[20:23], s62 offen offset:3072 sc1
    v_accvgpr_read_b32 v112, a80
    v_accvgpr_read_b32 v113, a81
    v_accvgpr_read_b32 v114, a82
    v_accvgpr_read_b32 v115, a83
    v_accvgpr_read_b32 v116, a84
    v_accvgpr_read_b32 v117, a85
    v_accvgpr_read_b32 v118, a86
    v_accvgpr_read_b32 v119, a87
    s_waitcnt lgkmcnt(10)
    v_pk_mul_f32 v[64:65], v[64:65], v[28:29]
    v_pk_mul_f32 v[66:67], v[66:67], v[28:29]
    v_pk_mul_f32 v[68:69], v[68:69], v[28:29]
    v_pk_mul_f32 v[70:71], v[70:71], v[28:29]
    v_pk_fma_f32 v[64:65], v[112:113], v[22:23], v[64:65]
    v_pk_fma_f32 v[66:67], v[114:115], v[22:23], v[66:67]
    s_add_u32 s62, s98, 135168
    buffer_load_dwordx4 v[208:211], v1, s[20:23], s62 offen offset:0 sc1
    v_pk_fma_f32 v[68:69], v[116:117], v[22:23], v[68:69]
    v_pk_fma_f32 v[70:71], v[118:119], v[22:23], v[70:71]
    v_cvt_pk_bf16_f32 v128, v64, v65
    v_cvt_pk_bf16_f32 v129, v66, v67
    v_cvt_pk_bf16_f32 v130, v68, v69
    v_cvt_pk_bf16_f32 v131, v70, v71
    buffer_store_dwordx4 v[128:131], v1, s[20:23], s37 offen offset:2048 sc1
    v_accvgpr_read_b32 v112, a88
    v_accvgpr_read_b32 v113, a89
    v_accvgpr_read_b32 v114, a90
    v_accvgpr_read_b32 v115, a91
    v_accvgpr_read_b32 v116, a92
    v_accvgpr_read_b32 v117, a93
    v_accvgpr_read_b32 v118, a94
    v_accvgpr_read_b32 v119, a95
    buffer_load_dwordx4 v[212:215], v1, s[20:23], s62 offen offset:1024 sc1
    s_waitcnt lgkmcnt(8)
    v_pk_mul_f32 v[72:73], v[72:73], v[28:29]
    v_pk_mul_f32 v[74:75], v[74:75], v[28:29]
    v_pk_mul_f32 v[76:77], v[76:77], v[28:29]
    v_pk_mul_f32 v[78:79], v[78:79], v[28:29]
    v_pk_fma_f32 v[72:73], v[112:113], v[22:23], v[72:73]
    v_pk_fma_f32 v[74:75], v[114:115], v[22:23], v[74:75]
    v_pk_fma_f32 v[76:77], v[116:117], v[22:23], v[76:77]
    v_pk_fma_f32 v[78:79], v[118:119], v[22:23], v[78:79]
    v_cvt_pk_bf16_f32 v132, v72, v73
    v_cvt_pk_bf16_f32 v133, v74, v75
    v_cvt_pk_bf16_f32 v134, v76, v77
    v_cvt_pk_bf16_f32 v135, v78, v79
    buffer_store_dwordx4 v[132:135], v1, s[20:23], s37 offen offset:3072 sc1
    buffer_load_dwordx4 v[216:219], v1, s[20:23], s62 offen offset:2048 sc1
    v_accvgpr_read_b32 v112, a96
    v_accvgpr_read_b32 v113, a97
    v_accvgpr_read_b32 v114, a98
    v_accvgpr_read_b32 v115, a99
    v_accvgpr_read_b32 v116, a100
    v_accvgpr_read_b32 v117, a101
    v_accvgpr_read_b32 v118, a102
    v_accvgpr_read_b32 v119, a103
    s_waitcnt lgkmcnt(6)
    v_pk_mul_f32 v[80:81], v[80:81], v[28:29]
    v_pk_mul_f32 v[82:83], v[82:83], v[28:29]
    v_pk_mul_f32 v[84:85], v[84:85], v[28:29]
    v_pk_mul_f32 v[86:87], v[86:87], v[28:29]
    v_pk_fma_f32 v[80:81], v[112:113], v[22:23], v[80:81]
    v_pk_fma_f32 v[82:83], v[114:115], v[22:23], v[82:83]
    buffer_load_dwordx4 v[220:223], v1, s[20:23], s62 offen offset:3072 sc1
    v_pk_fma_f32 v[84:85], v[116:117], v[22:23], v[84:85]
    v_pk_fma_f32 v[86:87], v[118:119], v[22:23], v[86:87]
    v_cvt_pk_bf16_f32 v120, v80, v81
    v_cvt_pk_bf16_f32 v121, v82, v83
    v_cvt_pk_bf16_f32 v122, v84, v85
    v_cvt_pk_bf16_f32 v123, v86, v87
    buffer_store_dwordx4 v[120:123], v1, s[20:23], s38 offen offset:0 sc1
    v_accvgpr_read_b32 v112, a104
    v_accvgpr_read_b32 v113, a105
    v_accvgpr_read_b32 v114, a106
    v_accvgpr_read_b32 v115, a107
    v_accvgpr_read_b32 v116, a108
    v_accvgpr_read_b32 v117, a109
    v_accvgpr_read_b32 v118, a110
    v_accvgpr_read_b32 v119, a111
    s_add_u32 s62, s98, 266240
    buffer_load_dwordx4 v[224:227], v1, s[20:23], s62 offen offset:0 sc1
    s_waitcnt lgkmcnt(4)
    v_pk_mul_f32 v[88:89], v[88:89], v[28:29]
    v_pk_mul_f32 v[90:91], v[90:91], v[28:29]
    v_pk_mul_f32 v[92:93], v[92:93], v[28:29]
    v_pk_mul_f32 v[94:95], v[94:95], v[28:29]
    v_pk_fma_f32 v[88:89], v[112:113], v[22:23], v[88:89]
    v_pk_fma_f32 v[90:91], v[114:115], v[22:23], v[90:91]
    v_pk_fma_f32 v[92:93], v[116:117], v[22:23], v[92:93]
    v_pk_fma_f32 v[94:95], v[118:119], v[22:23], v[94:95]
    v_cvt_pk_bf16_f32 v124, v88, v89
    v_cvt_pk_bf16_f32 v125, v90, v91
    v_cvt_pk_bf16_f32 v126, v92, v93
    v_cvt_pk_bf16_f32 v127, v94, v95
    buffer_store_dwordx4 v[124:127], v1, s[20:23], s38 offen offset:1024 sc1
    buffer_load_dwordx4 v[228:231], v1, s[20:23], s62 offen offset:1024 sc1
    v_accvgpr_read_b32 v112, a112
    v_accvgpr_read_b32 v113, a113
    v_accvgpr_read_b32 v114, a114
    v_accvgpr_read_b32 v115, a115
    v_accvgpr_read_b32 v116, a116
    v_accvgpr_read_b32 v117, a117
    v_accvgpr_read_b32 v118, a118
    v_accvgpr_read_b32 v119, a119
    s_waitcnt lgkmcnt(2)
    v_pk_mul_f32 v[96:97], v[96:97], v[28:29]
    v_pk_mul_f32 v[98:99], v[98:99], v[28:29]
    v_pk_mul_f32 v[100:101], v[100:101], v[28:29]
    v_pk_mul_f32 v[102:103], v[102:103], v[28:29]
    v_pk_fma_f32 v[96:97], v[112:113], v[22:23], v[96:97]
    v_pk_fma_f32 v[98:99], v[114:115], v[22:23], v[98:99]
    buffer_load_dwordx4 v[232:235], v1, s[20:23], s62 offen offset:2048 sc1
    v_pk_fma_f32 v[100:101], v[116:117], v[22:23], v[100:101]
    v_pk_fma_f32 v[102:103], v[118:119], v[22:23], v[102:103]
    v_cvt_pk_bf16_f32 v128, v96, v97
    v_cvt_pk_bf16_f32 v129, v98, v99
    v_cvt_pk_bf16_f32 v130, v100, v101
    v_cvt_pk_bf16_f32 v131, v102, v103
    buffer_store_dwordx4 v[128:131], v1, s[20:23], s38 offen offset:2048 sc1
    v_accvgpr_read_b32 v112, a120
    v_accvgpr_read_b32 v113, a121
    v_accvgpr_read_b32 v114, a122
    v_accvgpr_read_b32 v115, a123
    v_accvgpr_read_b32 v116, a124
    v_accvgpr_read_b32 v117, a125
    v_accvgpr_read_b32 v118, a126
    v_accvgpr_read_b32 v119, a127
    buffer_load_dwordx4 v[236:239], v1, s[20:23], s62 offen offset:3072 sc1
    s_waitcnt lgkmcnt(0)
    v_pk_mul_f32 v[104:105], v[104:105], v[28:29]
    v_pk_mul_f32 v[106:107], v[106:107], v[28:29]
    v_pk_mul_f32 v[108:109], v[108:109], v[28:29]
    v_pk_mul_f32 v[110:111], v[110:111], v[28:29]
    v_pk_fma_f32 v[104:105], v[112:113], v[22:23], v[104:105]
    v_pk_fma_f32 v[106:107], v[114:115], v[22:23], v[106:107]
    v_pk_fma_f32 v[108:109], v[116:117], v[22:23], v[108:109]
    v_pk_fma_f32 v[110:111], v[118:119], v[22:23], v[110:111]
    v_cvt_pk_bf16_f32 v132, v104, v105
    v_cvt_pk_bf16_f32 v133, v106, v107
    v_cvt_pk_bf16_f32 v134, v108, v109
    v_cvt_pk_bf16_f32 v135, v110, v111
    buffer_store_dwordx4 v[132:135], v1, s[20:23], s38 offen offset:3072 sc1
K2_G:
    v_add_u32 v248, 0x20000, v40
    v_add_u32 v249, 0x20000, v41
    v_add_u32 v250, 0x20000, v42
    v_add_u32 v251, 0x20000, v43
    s_barrier
    s_waitcnt vmcnt(28)
    ds_read_b128 v[48:51], v40 offset:0
    ds_read_b128 v[64:67], v40 offset:4096
    ds_read_b128 v[52:55], v41 offset:0
    ds_read_b128 v[68:71], v41 offset:4096
    ds_read_b128 v[56:59], v42 offset:0
    ds_read_b128 v[72:75], v42 offset:4096
    ds_read_b128 v[60:63], v43 offset:0
    ds_read_b128 v[76:79], v43 offset:4096
    s_waitcnt lgkmcnt(0)
    v_mfma_f32_32x32x16_bf16 a[0:15], v[144:147], v[48:51], 0
    s_add_u32 m0, s59, 65536
    s_add_u32 s58, s60, 256
    buffer_load_dwordx4 v32, s[12:15], s58 offen offset:0 lds
    v_mfma_f32_32x32x16_bf16 a[48:63], v[144:147], v[64:67], 0
    buffer_load_dwordx4 v33, s[12:15], s58 offen offset:1024 lds
    v_mfma_f32_32x32x16_bf16 a[16:31], v[160:163], v[48:51], 0
    buffer_load_dwordx4 v34, s[12:15], s58 offen offset:2048 lds
    v_mfma_f32_32x32x16_bf16 a[64:79], v[160:163], v[64:67], 0
    buffer_load_dwordx4 v35, s[12:15], s58 offen offset:3072 lds
    v_mfma_f32_32x32x16_bf16 a[32:47], v[176:179], v[48:51], 0
    v_mfma_f32_32x32x16_bf16 a[80:95], v[176:179], v[64:67], 0
    s_add_u32 m0, s59, 69632
    s_add_u32 s58, s60, 256
    buffer_load_dwordx4 v36, s[12:15], s58 offen offset:0 lds
    v_mfma_f32_32x32x16_bf16 a[0:15], v[148:151], v[52:55], a[0:15]
    buffer_load_dwordx4 v37, s[12:15], s58 offen offset:1024 lds
    v_mfma_f32_32x32x16_bf16 a[48:63], v[148:151], v[68:71], a[48:63]
    buffer_load_dwordx4 v38, s[12:15], s58 offen offset:2048 lds
    v_mfma_f32_32x32x16_bf16 a[16:31], v[164:167], v[52:55], a[16:31]
    buffer_load_dwordx4 v39, s[12:15], s58 offen offset:3072 lds
    v_mfma_f32_32x32x16_bf16 a[64:79], v[164:167], v[68:71], a[64:79]
    v_mfma_f32_32x32x16_bf16 a[32:47], v[180:183], v[52:55], a[32:47]
    s_add_u32 s62, s61, 8192
    buffer_load_dwordx4 a[128:131], v1, s[20:23], s62 offen offset:0 sc1
    v_mfma_f32_32x32x16_bf16 a[80:95], v[180:183], v[68:71], a[80:95]
    buffer_load_dwordx4 a[132:135], v1, s[20:23], s62 offen offset:1024 sc1
    v_mfma_f32_32x32x16_bf16 a[0:15], v[152:155], v[56:59], a[0:15]
    buffer_load_dwordx4 a[136:139], v1, s[20:23], s62 offen offset:2048 sc1
    v_mfma_f32_32x32x16_bf16 a[48:63], v[152:155], v[72:75], a[48:63]
    s_waitcnt vmcnt(12)
    v_mfma_f32_32x32x16_bf16 a[16:31], v[168:171], v[56:59], a[16:31]
    buffer_load_dwordx4 a[140:143], v1, s[20:23], s62 offen offset:3072 sc1
    ds_read_b128 v[80:83], v40 offset:32768
    v_mfma_f32_32x32x16_bf16 a[64:79], v[168:171], v[72:75], a[64:79]
    s_add_u32 s62, s98, 139264
    buffer_load_dwordx4 a[144:147], v1, s[20:23], s62 offen offset:0 sc1
    ds_read_b128 v[96:99], v40 offset:36864
    v_mfma_f32_32x32x16_bf16 a[32:47], v[184:187], v[56:59], a[32:47]
    buffer_load_dwordx4 a[148:151], v1, s[20:23], s62 offen offset:1024 sc1
    ds_read_b128 v[84:87], v41 offset:32768
    v_mfma_f32_32x32x16_bf16 a[80:95], v[184:187], v[72:75], a[80:95]
    buffer_load_dwordx4 a[152:155], v1, s[20:23], s62 offen offset:2048 sc1
    ds_read_b128 v[100:103], v41 offset:36864
    v_mfma_f32_32x32x16_bf16 a[0:15], v[156:159], v[60:63], a[0:15]
    buffer_load_dwordx4 a[156:159], v1, s[20:23], s62 offen offset:3072 sc1
    ds_read_b128 v[88:91], v42 offset:32768
    v_mfma_f32_32x32x16_bf16 a[48:63], v[156:159], v[76:79], a[48:63]
    s_add_u32 s62, s98, 270336
    buffer_load_dwordx4 a[160:163], v1, s[20:23], s62 offen offset:0 sc1
    ds_read_b128 v[104:107], v42 offset:36864
    v_mfma_f32_32x32x16_bf16 a[16:31], v[172:175], v[60:63], a[16:31]
    buffer_load_dwordx4 a[164:167], v1, s[20:23], s62 offen offset:1024 sc1
    ds_read_b128 v[92:95], v43 offset:32768
    v_mfma_f32_32x32x16_bf16 a[64:79], v[172:175], v[76:79], a[64:79]
    buffer_load_dwordx4 a[168:171], v1, s[20:23], s62 offen offset:2048 sc1
    ds_read_b128 v[108:111], v43 offset:36864
    v_mfma_f32_32x32x16_bf16 a[32:47], v[188:191], v[60:63], a[32:47]
    buffer_load_dwordx4 a[172:175], v1, s[20:23], s62 offen offset:3072 sc1
    v_mfma_f32_32x32x16_bf16 a[80:95], v[188:191], v[76:79], a[80:95]
    s_waitcnt lgkmcnt(0)
    v_mfma_f32_32x32x16_bf16 a[0:15], v[192:195], v[80:83], a[0:15]
    s_add_u32 m0, s59, 0
    s_add_u32 s58, s60, 384
    buffer_load_dwordx4 v32, s[12:15], s58 offen offset:0 lds
    v_mfma_f32_32x32x16_bf16 a[48:63], v[192:195], v[96:99], a[48:63]
    buffer_load_dwordx4 v33, s[12:15], s58 offen offset:1024 lds
    v_mfma_f32_32x32x16_bf16 a[16:31], v[208:211], v[80:83], a[16:31]
    buffer_load_dwordx4 v34, s[12:15], s58 offen offset:2048 lds
    v_mfma_f32_32x32x16_bf16 a[64:79], v[208:211], v[96:99], a[64:79]
    buffer_load_dwordx4 v35, s[12:15], s58 offen offset:3072 lds
    v_mfma_f32_32x32x16_bf16 a[32:47], v[224:227], v[80:83], a[32:47]
    v_mfma_f32_32x32x16_bf16 a[80:95], v[224:227], v[96:99], a[80:95]
    s_add_u32 m0, s59, 4096
    s_add_u32 s58, s60, 384
    buffer_load_dwordx4 v36, s[12:15], s58 offen offset:0 lds
    v_mfma_f32_32x32x16_bf16 a[0:15], v[196:199], v[84:87], a[0:15]
    buffer_load_dwordx4 v37, s[12:15], s58 offen offset:1024 lds
    v_mfma_f32_32x32x16_bf16 a[48:63], v[196:199], v[100:103], a[48:63]
    buffer_load_dwordx4 v38, s[12:15], s58 offen offset:2048 lds
    v_mfma_f32_32x32x16_bf16 a[16:31], v[212:215], v[84:87], a[16:31]
    buffer_load_dwordx4 v39, s[12:15], s58 offen offset:3072 lds
    v_mfma_f32_32x32x16_bf16 a[64:79], v[212:215], v[100:103], a[64:79]
    v_mfma_f32_32x32x16_bf16 a[32:47], v[228:231], v[84:87], a[32:47]
    s_add_u32 s62, s61, 12288
    buffer_load_dwordx4 a[176:179], v1, s[20:23], s62 offen offset:0 sc1
    v_mfma_f32_32x32x16_bf16 a[80:95], v[228:231], v[100:103], a[80:95]
    buffer_load_dwordx4 a[180:183], v1, s[20:23], s62 offen offset:1024 sc1
    v_mfma_f32_32x32x16_bf16 a[0:15], v[200:203], v[88:91], a[0:15]
    buffer_load_dwordx4 a[184:187], v1, s[20:23], s62 offen offset:2048 sc1
    v_mfma_f32_32x32x16_bf16 a[48:63], v[200:203], v[104:107], a[48:63]
    s_waitcnt vmcnt(11)
    v_mfma_f32_32x32x16_bf16 a[16:31], v[216:219], v[88:91], a[16:31]
    buffer_load_dwordx4 a[188:191], v1, s[20:23], s62 offen offset:3072 sc1
    ds_read_b128 v[48:51], v44 offset:0
    v_mfma_f32_32x32x16_bf16 a[64:79], v[216:219], v[104:107], a[64:79]
    s_add_u32 s62, s98, 143360
    buffer_load_dwordx4 a[192:195], v1, s[20:23], s62 offen offset:0 sc1
    ds_read_b128 v[64:67], v44 offset:4096
    v_mfma_f32_32x32x16_bf16 a[32:47], v[232:235], v[88:91], a[32:47]
    buffer_load_dwordx4 a[196:199], v1, s[20:23], s62 offen offset:1024 sc1
    ds_read_b128 v[52:55], v45 offset:0
    v_mfma_f32_32x32x16_bf16 a[80:95], v[232:235], v[104:107], a[80:95]
    buffer_load_dwordx4 a[200:203], v1, s[20:23], s62 offen offset:2048 sc1
    ds_read_b128 v[68:71], v45 offset:4096
    v_mfma_f32_32x32x16_bf16 a[0:15], v[204:207], v[92:95], a[0:15]
    buffer_load_dwordx4 a[204:207], v1, s[20:23], s62 offen offset:3072 sc1
    ds_read_b128 v[56:59], v46 offset:0
    v_mfma_f32_32x32x16_bf16 a[48:63], v[204:207], v[108:111], a[48:63]
    s_add_u32 s62, s98, 274432
    buffer_load_dwordx4 a[208:211], v1, s[20:23], s62 offen offset:0 sc1
    ds_read_b128 v[72:75], v46 offset:4096
    v_mfma_f32_32x32x16_bf16 a[16:31], v[220:223], v[92:95], a[16:31]
    buffer_load_dwordx4 a[212:215], v1, s[20:23], s62 offen offset:1024 sc1
    ds_read_b128 v[60:63], v47 offset:0
    v_mfma_f32_32x32x16_bf16 a[64:79], v[220:223], v[108:111], a[64:79]
    buffer_load_dwordx4 a[216:219], v1, s[20:23], s62 offen offset:2048 sc1
    ds_read_b128 v[76:79], v47 offset:4096
    v_mfma_f32_32x32x16_bf16 a[32:47], v[236:239], v[92:95], a[32:47]
    buffer_load_dwordx4 a[220:223], v1, s[20:23], s62 offen offset:3072 sc1
    v_mfma_f32_32x32x16_bf16 a[80:95], v[236:239], v[108:111], a[80:95]
    s_waitcnt lgkmcnt(0)
    s_barrier
    s_lshl_b32 s37, s34, 5
    s_add_u32 s37, s37, s33
    s_lshl_b32 s37, s37, 4
    s_add_u32 s37, s37, 42598400
    s_cmp_lg_u32 s32, 0
    s_cbranch_scc1 L_W0_23
    v_mov_b32 v17, 1
    v_mov_b32 v18, 0
    s_mov_b64 exec, 1
    buffer_store_byte v17, v18, s[20:23], s37 offen sc0 sc1
    s_mov_b64 exec, -1
L_W0_23:
    v_mfma_f32_32x32x16_bf16 a[0:15], a[128:131], v[48:51], a[0:15]
    s_add_u32 m0, s59, 32768
    s_add_u32 s58, s60, 512
    buffer_load_dwordx4 v32, s[12:15], s58 offen offset:0 lds
    v_mfma_f32_32x32x16_bf16 a[48:63], a[128:131], v[64:67], a[48:63]
    buffer_load_dwordx4 v33, s[12:15], s58 offen offset:1024 lds
    v_mfma_f32_32x32x16_bf16 a[16:31], a[144:147], v[48:51], a[16:31]
    buffer_load_dwordx4 v34, s[12:15], s58 offen offset:2048 lds
    v_mfma_f32_32x32x16_bf16 a[64:79], a[144:147], v[64:67], a[64:79]
    buffer_load_dwordx4 v35, s[12:15], s58 offen offset:3072 lds
    v_mfma_f32_32x32x16_bf16 a[32:47], a[160:163], v[48:51], a[32:47]
    v_mfma_f32_32x32x16_bf16 a[80:95], a[160:163], v[64:67], a[80:95]
    s_add_u32 m0, s59, 36864
    s_add_u32 s58, s60, 512
    buffer_load_dwordx4 v36, s[12:15], s58 offen offset:0 lds
    v_mfma_f32_32x32x16_bf16 a[0:15], a[132:135], v[52:55], a[0:15]
    buffer_load_dwordx4 v37, s[12:15], s58 offen offset:1024 lds
    v_mfma_f32_32x32x16_bf16 a[48:63], a[132:135], v[68:71], a[48:63]
    buffer_load_dwordx4 v38, s[12:15], s58 offen offset:2048 lds
    v_mfma_f32_32x32x16_bf16 a[16:31], a[148:151], v[52:55], a[16:31]
    buffer_load_dwordx4 v39, s[12:15], s58 offen offset:3072 lds
    v_mfma_f32_32x32x16_bf16 a[64:79], a[148:151], v[68:71], a[64:79]
    v_mfma_f32_32x32x16_bf16 a[32:47], a[164:167], v[52:55], a[32:47]
    s_add_u32 s62, s61, 16384
    buffer_load_dwordx4 v[144:147], v1, s[20:23], s62 offen offset:0 sc1
    v_mfma_f32_32x32x16_bf16 a[80:95], a[164:167], v[68:71], a[80:95]
    buffer_load_dwordx4 v[148:151], v1, s[20:23], s62 offen offset:1024 sc1
    v_mfma_f32_32x32x16_bf16 a[0:15], a[136:139], v[56:59], a[0:15]
    buffer_load_dwordx4 v[152:155], v1, s[20:23], s62 offen offset:2048 sc1
    v_mfma_f32_32x32x16_bf16 a[48:63], a[136:139], v[72:75], a[48:63]
    s_waitcnt vmcnt(11)
    v_mfma_f32_32x32x16_bf16 a[16:31], a[152:155], v[56:59], a[16:31]
    buffer_load_dwordx4 v[156:159], v1, s[20:23], s62 offen offset:3072 sc1
    ds_read_b128 v[80:83], v40 offset:0
    v_mfma_f32_32x32x16_bf16 a[64:79], a[152:155], v[72:75], a[64:79]
    s_add_u32 s62, s98, 147456
    buffer_load_dwordx4 v[160:163], v1, s[20:23], s62 offen offset:0 sc1
    ds_read_b128 v[96:99], v40 offset:4096
    v_mfma_f32_32x32x16_bf16 a[32:47], a[168:171], v[56:59], a[32:47]
    buffer_load_dwordx4 v[164:167], v1, s[20:23], s62 offen offset:1024 sc1
    ds_read_b128 v[84:87], v41 offset:0
    v_mfma_f32_32x32x16_bf16 a[80:95], a[168:171], v[72:75], a[80:95]
    buffer_load_dwordx4 v[168:171], v1, s[20:23], s62 offen offset:2048 sc1
    ds_read_b128 v[100:103], v41 offset:4096
    v_mfma_f32_32x32x16_bf16 a[0:15], a[140:143], v[60:63], a[0:15]
    buffer_load_dwordx4 v[172:175], v1, s[20:23], s62 offen offset:3072 sc1
    ds_read_b128 v[88:91], v42 offset:0
    v_mfma_f32_32x32x16_bf16 a[48:63], a[140:143], v[76:79], a[48:63]
    s_add_u32 s62, s98, 278528
    buffer_load_dwordx4 v[176:179], v1, s[20:23], s62 offen offset:0 sc1
    ds_read_b128 v[104:107], v42 offset:4096
    v_mfma_f32_32x32x16_bf16 a[16:31], a[156:159], v[60:63], a[16:31]
    buffer_load_dwordx4 v[180:183], v1, s[20:23], s62 offen offset:1024 sc1
    ds_read_b128 v[92:95], v43 offset:0
    v_mfma_f32_32x32x16_bf16 a[64:79], a[156:159], v[76:79], a[64:79]
    buffer_load_dwordx4 v[184:187], v1, s[20:23], s62 offen offset:2048 sc1
    ds_read_b128 v[108:111], v43 offset:4096
    v_mfma_f32_32x32x16_bf16 a[32:47], a[172:175], v[60:63], a[32:47]
    buffer_load_dwordx4 v[188:191], v1, s[20:23], s62 offen offset:3072 sc1
    v_mfma_f32_32x32x16_bf16 a[80:95], a[172:175], v[76:79], a[80:95]
    s_waitcnt lgkmcnt(0)
    v_mfma_f32_32x32x16_bf16 a[0:15], a[176:179], v[80:83], a[0:15]
    s_add_u32 m0, s59, 65536
    s_add_u32 s58, s60, 640
    buffer_load_dwordx4 v32, s[12:15], s58 offen offset:0 lds
    v_mfma_f32_32x32x16_bf16 a[48:63], a[176:179], v[96:99], a[48:63]
    buffer_load_dwordx4 v33, s[12:15], s58 offen offset:1024 lds
    v_mfma_f32_32x32x16_bf16 a[16:31], a[192:195], v[80:83], a[16:31]
    buffer_load_dwordx4 v34, s[12:15], s58 offen offset:2048 lds
    v_mfma_f32_32x32x16_bf16 a[64:79], a[192:195], v[96:99], a[64:79]
    buffer_load_dwordx4 v35, s[12:15], s58 offen offset:3072 lds
    v_mfma_f32_32x32x16_bf16 a[32:47], a[208:211], v[80:83], a[32:47]
    v_mfma_f32_32x32x16_bf16 a[80:95], a[208:211], v[96:99], a[80:95]
    s_add_u32 m0, s59, 69632
    s_add_u32 s58, s60, 640
    buffer_load_dwordx4 v36, s[12:15], s58 offen offset:0 lds
    v_mfma_f32_32x32x16_bf16 a[0:15], a[180:183], v[84:87], a[0:15]
    buffer_load_dwordx4 v37, s[12:15], s58 offen offset:1024 lds
    v_mfma_f32_32x32x16_bf16 a[48:63], a[180:183], v[100:103], a[48:63]
    buffer_load_dwordx4 v38, s[12:15], s58 offen offset:2048 lds
    v_mfma_f32_32x32x16_bf16 a[16:31], a[196:199], v[84:87], a[16:31]
    buffer_load_dwordx4 v39, s[12:15], s58 offen offset:3072 lds
    v_mfma_f32_32x32x16_bf16 a[64:79], a[196:199], v[100:103], a[64:79]
    v_mfma_f32_32x32x16_bf16 a[32:47], a[212:215], v[84:87], a[32:47]
    s_add_u32 s62, s61, 20480
    buffer_load_dwordx4 v[192:195], v1, s[20:23], s62 offen offset:0 sc1
    v_mfma_f32_32x32x16_bf16 a[80:95], a[212:215], v[100:103], a[80:95]
    buffer_load_dwordx4 v[196:199], v1, s[20:23], s62 offen offset:1024 sc1
    v_mfma_f32_32x32x16_bf16 a[0:15], a[184:187], v[88:91], a[0:15]
    buffer_load_dwordx4 v[200:203], v1, s[20:23], s62 offen offset:2048 sc1
    v_mfma_f32_32x32x16_bf16 a[48:63], a[184:187], v[104:107], a[48:63]
    s_waitcnt vmcnt(11)
    v_mfma_f32_32x32x16_bf16 a[16:31], a[200:203], v[88:91], a[16:31]
    buffer_load_dwordx4 v[204:207], v1, s[20:23], s62 offen offset:3072 sc1
    ds_read_b128 v[48:51], v40 offset:32768
    v_mfma_f32_32x32x16_bf16 a[64:79], a[200:203], v[104:107], a[64:79]
    s_add_u32 s62, s98, 151552
    buffer_load_dwordx4 v[208:211], v1, s[20:23], s62 offen offset:0 sc1
    ds_read_b128 v[64:67], v40 offset:36864
    v_mfma_f32_32x32x16_bf16 a[32:47], a[216:219], v[88:91], a[32:47]
    buffer_load_dwordx4 v[212:215], v1, s[20:23], s62 offen offset:1024 sc1
    ds_read_b128 v[52:55], v41 offset:32768
    v_mfma_f32_32x32x16_bf16 a[80:95], a[216:219], v[104:107], a[80:95]
    buffer_load_dwordx4 v[216:219], v1, s[20:23], s62 offen offset:2048 sc1
    ds_read_b128 v[68:71], v41 offset:36864
    v_mfma_f32_32x32x16_bf16 a[0:15], a[188:191], v[92:95], a[0:15]
    buffer_load_dwordx4 v[220:223], v1, s[20:23], s62 offen offset:3072 sc1
    ds_read_b128 v[56:59], v42 offset:32768
    v_mfma_f32_32x32x16_bf16 a[48:63], a[188:191], v[108:111], a[48:63]
    s_add_u32 s62, s98, 282624
    buffer_load_dwordx4 v[224:227], v1, s[20:23], s62 offen offset:0 sc1
    ds_read_b128 v[72:75], v42 offset:36864
    v_mfma_f32_32x32x16_bf16 a[16:31], a[204:207], v[92:95], a[16:31]
    buffer_load_dwordx4 v[228:231], v1, s[20:23], s62 offen offset:1024 sc1
    ds_read_b128 v[60:63], v43 offset:32768
    v_mfma_f32_32x32x16_bf16 a[64:79], a[204:207], v[108:111], a[64:79]
    buffer_load_dwordx4 v[232:235], v1, s[20:23], s62 offen offset:2048 sc1
    ds_read_b128 v[76:79], v43 offset:36864
    v_mfma_f32_32x32x16_bf16 a[32:47], a[220:223], v[92:95], a[32:47]
    buffer_load_dwordx4 v[236:239], v1, s[20:23], s62 offen offset:3072 sc1
    v_mfma_f32_32x32x16_bf16 a[80:95], a[220:223], v[108:111], a[80:95]
    s_waitcnt lgkmcnt(0)
    s_bfe_u32 s37, s2, 0x10002
    s_lshl_b32 s37, s37, 3
    s_bfe_u32 s38, s2, 0x30003
    s_add_u32 s37, s37, s38
    s_sub_u32 s38, 15, s37
    s_min_u32 s37, s37, s38
    s_lshl_b32 s37, s37, 9
    s_and_b32 s38, s2, 3
    s_lshl_b32 s38, s38, 7
    s_add_u32 s37, s37, s38
    s_add_u32 s63, s37, 42598400
    s_cmp_lg_u32 s32, 0
    s_cbranch_scc1 L_W0_24
    v_and_b32 v17, 7, v0
    v_lshlrev_b32 v17, 4, v17
    buffer_load_ubyte v18, v17, s[20:23], s63 offen sc0 sc1
L_W0_24:
    v_mfma_f32_32x32x16_bf16 a[0:15], v[144:147], v[48:51], a[0:15]
    s_add_u32 m0, s59, 0
    s_add_u32 s58, s60, 768
    buffer_load_dwordx4 v32, s[12:15], s58 offen offset:0 lds
    v_mfma_f32_32x32x16_bf16 a[48:63], v[144:147], v[64:67], a[48:63]
    buffer_load_dwordx4 v33, s[12:15], s58 offen offset:1024 lds
    v_mfma_f32_32x32x16_bf16 a[16:31], v[160:163], v[48:51], a[16:31]
    buffer_load_dwordx4 v34, s[12:15], s58 offen offset:2048 lds
    v_mfma_f32_32x32x16_bf16 a[64:79], v[160:163], v[64:67], a[64:79]
    buffer_load_dwordx4 v35, s[12:15], s58 offen offset:3072 lds
    v_mfma_f32_32x32x16_bf16 a[32:47], v[176:179], v[48:51], a[32:47]
    v_mfma_f32_32x32x16_bf16 a[80:95], v[176:179], v[64:67], a[80:95]
    s_add_u32 m0, s59, 4096
    s_add_u32 s58, s60, 768
    buffer_load_dwordx4 v36, s[12:15], s58 offen offset:0 lds
    v_mfma_f32_32x32x16_bf16 a[0:15], v[148:151], v[52:55], a[0:15]
    buffer_load_dwordx4 v37, s[12:15], s58 offen offset:1024 lds
    v_mfma_f32_32x32x16_bf16 a[48:63], v[148:151], v[68:71], a[48:63]
    buffer_load_dwordx4 v38, s[12:15], s58 offen offset:2048 lds
    v_mfma_f32_32x32x16_bf16 a[16:31], v[164:167], v[52:55], a[16:31]
    buffer_load_dwordx4 v39, s[12:15], s58 offen offset:3072 lds
    v_mfma_f32_32x32x16_bf16 a[64:79], v[164:167], v[68:71], a[64:79]
    v_mfma_f32_32x32x16_bf16 a[32:47], v[180:183], v[52:55], a[32:47]
    s_add_u32 s62, s61, 24576
    buffer_load_dwordx4 a[128:131], v1, s[20:23], s62 offen offset:0 sc1
    v_mfma_f32_32x32x16_bf16 a[80:95], v[180:183], v[68:71], a[80:95]
    buffer_load_dwordx4 a[132:135], v1, s[20:23], s62 offen offset:1024 sc1
    v_mfma_f32_32x32x16_bf16 a[0:15], v[152:155], v[56:59], a[0:15]
    buffer_load_dwordx4 a[136:139], v1, s[20:23], s62 offen offset:2048 sc1
    v_mfma_f32_32x32x16_bf16 a[48:63], v[152:155], v[72:75], a[48:63]
    s_waitcnt vmcnt(11)
    v_mfma_f32_32x32x16_bf16 a[16:31], v[168:171], v[56:59], a[16:31]
    buffer_load_dwordx4 a[140:143], v1, s[20:23], s62 offen offset:3072 sc1
    ds_read_b128 v[80:83], v44 offset:0
    v_mfma_f32_32x32x16_bf16 a[64:79], v[168:171], v[72:75], a[64:79]
    s_add_u32 s62, s98, 155648
    buffer_load_dwordx4 a[144:147], v1, s[20:23], s62 offen offset:0 sc1
    ds_read_b128 v[96:99], v44 offset:4096
    v_mfma_f32_32x32x16_bf16 a[32:47], v[184:187], v[56:59], a[32:47]
    buffer_load_dwordx4 a[148:151], v1, s[20:23], s62 offen offset:1024 sc1
    ds_read_b128 v[84:87], v45 offset:0
    v_mfma_f32_32x32x16_bf16 a[80:95], v[184:187], v[72:75], a[80:95]
    buffer_load_dwordx4 a[152:155], v1, s[20:23], s62 offen offset:2048 sc1
    ds_read_b128 v[100:103], v45 offset:4096
    v_mfma_f32_32x32x16_bf16 a[0:15], v[156:159], v[60:63], a[0:15]
    buffer_load_dwordx4 a[156:159], v1, s[20:23], s62 offen offset:3072 sc1
    ds_read_b128 v[88:91], v46 offset:0
    v_mfma_f32_32x32x16_bf16 a[48:63], v[156:159], v[76:79], a[48:63]
    s_add_u32 s62, s98, 286720
    buffer_load_dwordx4 a[160:163], v1, s[20:23], s62 offen offset:0 sc1
    ds_read_b128 v[104:107], v46 offset:4096
    v_mfma_f32_32x32x16_bf16 a[16:31], v[172:175], v[60:63], a[16:31]
    buffer_load_dwordx4 a[164:167], v1, s[20:23], s62 offen offset:1024 sc1
    ds_read_b128 v[92:95], v47 offset:0
    v_mfma_f32_32x32x16_bf16 a[64:79], v[172:175], v[76:79], a[64:79]
    buffer_load_dwordx4 a[168:171], v1, s[20:23], s62 offen offset:2048 sc1
    ds_read_b128 v[108:111], v47 offset:4096
    v_mfma_f32_32x32x16_bf16 a[32:47], v[188:191], v[60:63], a[32:47]
    buffer_load_dwordx4 a[172:175], v1, s[20:23], s62 offen offset:3072 sc1
    v_mfma_f32_32x32x16_bf16 a[80:95], v[188:191], v[76:79], a[80:95]
    s_waitcnt lgkmcnt(0)
    v_mfma_f32_32x32x16_bf16 a[0:15], v[192:195], v[80:83], a[0:15]
    s_add_u32 m0, s59, 32768
    s_add_u32 s58, s60, 896
    buffer_load_dwordx4 v32, s[12:15], s58 offen offset:0 lds
    v_mfma_f32_32x32x16_bf16 a[48:63], v[192:195], v[96:99], a[48:63]
    buffer_load_dwordx4 v33, s[12:15], s58 offen offset:1024 lds
    v_mfma_f32_32x32x16_bf16 a[16:31], v[208:211], v[80:83], a[16:31]
    buffer_load_dwordx4 v34, s[12:15], s58 offen offset:2048 lds
    v_mfma_f32_32x32x16_bf16 a[64:79], v[208:211], v[96:99], a[64:79]
    buffer_load_dwordx4 v35, s[12:15], s58 offen offset:3072 lds
    v_mfma_f32_32x32x16_bf16 a[32:47], v[224:227], v[80:83], a[32:47]
    v_mfma_f32_32x32x16_bf16 a[80:95], v[224:227], v[96:99], a[80:95]
    s_add_u32 m0, s59, 36864
    s_add_u32 s58, s60, 896
    buffer_load_dwordx4 v36, s[12:15], s58 offen offset:0 lds
    v_mfma_f32_32x32x16_bf16 a[0:15], v[196:199], v[84:87], a[0:15]
    buffer_load_dwordx4 v37, s[12:15], s58 offen offset:1024 lds
    v_mfma_f32_32x32x16_bf16 a[48:63], v[196:199], v[100:103], a[48:63]
    buffer_load_dwordx4 v38, s[12:15], s58 offen offset:2048 lds
    v_mfma_f32_32x32x16_bf16 a[16:31], v[212:215], v[84:87], a[16:31]
    buffer_load_dwordx4 v39, s[12:15], s58 offen offset:3072 lds
    v_mfma_f32_32x32x16_bf16 a[64:79], v[212:215], v[100:103], a[64:79]
    v_mfma_f32_32x32x16_bf16 a[32:47], v[228:231], v[84:87], a[32:47]
    s_add_u32 s62, s61, 28672
    buffer_load_dwordx4 a[176:179], v1, s[20:23], s62 offen offset:0 sc1
    v_mfma_f32_32x32x16_bf16 a[80:95], v[228:231], v[100:103], a[80:95]
    buffer_load_dwordx4 a[180:183], v1, s[20:23], s62 offen offset:1024 sc1
    v_mfma_f32_32x32x16_bf16 a[0:15], v[200:203], v[88:91], a[0:15]
    buffer_load_dwordx4 a[184:187], v1, s[20:23], s62 offen offset:2048 sc1
    v_mfma_f32_32x32x16_bf16 a[48:63], v[200:203], v[104:107], a[48:63]
    s_waitcnt vmcnt(11)
    v_mfma_f32_32x32x16_bf16 a[16:31], v[216:219], v[88:91], a[16:31]
    buffer_load_dwordx4 a[188:191], v1, s[20:23], s62 offen offset:3072 sc1
    ds_read_b128 v[48:51], v40 offset:0
    v_mfma_f32_32x32x16_bf16 a[64:79], v[216:219], v[104:107], a[64:79]
    s_add_u32 s62, s98, 159744
    buffer_load_dwordx4 a[192:195], v1, s[20:23], s62 offen offset:0 sc1
    ds_read_b128 v[64:67], v40 offset:4096
    v_mfma_f32_32x32x16_bf16 a[32:47], v[232:235], v[88:91], a[32:47]
    buffer_load_dwordx4 a[196:199], v1, s[20:23], s62 offen offset:1024 sc1
    ds_read_b128 v[52:55], v41 offset:0
    v_mfma_f32_32x32x16_bf16 a[80:95], v[232:235], v[104:107], a[80:95]
    buffer_load_dwordx4 a[200:203], v1, s[20:23], s62 offen offset:2048 sc1
    ds_read_b128 v[68:71], v41 offset:4096
    v_mfma_f32_32x32x16_bf16 a[0:15], v[204:207], v[92:95], a[0:15]
    buffer_load_dwordx4 a[204:207], v1, s[20:23], s62 offen offset:3072 sc1
    ds_read_b128 v[56:59], v42 offset:0
    v_mfma_f32_32x32x16_bf16 a[48:63], v[204:207], v[108:111], a[48:63]
    s_add_u32 s62, s98, 290816
    buffer_load_dwordx4 a[208:211], v1, s[20:23], s62 offen offset:0 sc1
    ds_read_b128 v[72:75], v42 offset:4096
    v_mfma_f32_32x32x16_bf16 a[16:31], v[220:223], v[92:95], a[16:31]
    buffer_load_dwordx4 a[212:215], v1, s[20:23], s62 offen offset:1024 sc1
    ds_read_b128 v[60:63], v43 offset:0
    v_mfma_f32_32x32x16_bf16 a[64:79], v[220:223], v[108:111], a[64:79]
    buffer_load_dwordx4 a[216:219], v1, s[20:23], s62 offen offset:2048 sc1
    ds_read_b128 v[76:79], v43 offset:4096
    v_mfma_f32_32x32x16_bf16 a[32:47], v[236:239], v[92:95], a[32:47]
    buffer_load_dwordx4 a[220:223], v1, s[20:23], s62 offen offset:3072 sc1
    v_mfma_f32_32x32x16_bf16 a[80:95], v[236:239], v[108:111], a[80:95]
    s_waitcnt lgkmcnt(0)
    v_mfma_f32_32x32x16_bf16 a[0:15], a[128:131], v[48:51], a[0:15]
    s_lshl_b32 s37, s33, 1
    s_add_u32 s37, s37, s35
    s_mul_i32 s38, s34, 6
    s_mul_i32 s60, s36, 3
    s_add_u32 s38, s38, s60
    s_mul_i32 s60, s37, 48
    s_add_u32 s60, s60, s38
    s_lshl_b32 s60, s60, 10
    s_add_u32 s60, s60, 35651584
    s_mul_i32 s61, s37, 304
    v_mfma_f32_32x32x16_bf16 a[48:63], a[128:131], v[64:67], a[48:63]
    s_add_u32 s61, s61, s38
    s_add_u32 s61, s61, 256
    s_lshl_b32 s61, s61, 10
    s_add_u32 s61, s61, 42991616
    s_lshl_b32 s37, s37, 6
    v_and_b32 v21, 31, v0
    v_lshlrev_b32 v21, 1, v21
    buffer_load_dwordx4 v[4:7], v1, s[20:23], s60 offen offset:0 sc1
    buffer_load_dwordx4 v[8:11], v1, s[20:23], s60 offen offset:1024 sc1
    buffer_load_dwordx4 v[12:15], v1, s[20:23], s60 offen offset:2048 sc1
    v_mfma_f32_32x32x16_bf16 a[16:31], a[144:147], v[48:51], a[16:31]
    buffer_load_ushort v16, v21, s[16:19], s37 offen
    s_mov_b32 s24, s100
    s_mov_b32 s25, s101
    s_mov_b32 s26, 0xac000
    s_lshl_b32 s76, s2, 2
    v_mfma_f32_32x32x16_bf16 a[64:79], a[144:147], v[64:67], a[64:79]
    s_add_u32 s76, s76, s32
    s_lshl_b32 s76, s76, 10
    buffer_load_dword v240, v1, s[24:27], s76 offen
    s_sub_u32 s37, 3, s32
    s_and_b32 s37, s37, 3
    s_lshl_b32 s37, s37, 15
    s_add_u32 s37, s37, s59
    v_add_u32 v28, s37, v1
    s_sub_u32 s37, 4, s32
    s_and_b32 s37, s37, 3
    v_mfma_f32_32x32x16_bf16 a[32:47], a[160:163], v[48:51], a[32:47]
    s_lshl_b32 s37, s37, 15
    s_add_u32 s37, s37, s59
    v_add_u32 v29, s37, v1
    s_sub_u32 s37, 5, s32
    s_and_b32 s37, s37, 3
    s_lshl_b32 s37, s37, 15
    s_add_u32 s37, s37, s59
    v_add_u32 v30, s37, v1
    s_sub_u32 s37, 6, s32
    s_and_b32 s37, s37, 3
    v_mfma_f32_32x32x16_bf16 a[80:95], a[160:163], v[64:67], a[80:95]
    s_lshl_b32 s37, s37, 15
    s_add_u32 s37, s37, s59
    v_add_u32 v31, s37, v1
    s_add_u32 s37, s32, 1
    s_and_b32 s37, s37, 3
    v_mfma_f32_32x32x16_bf16 a[0:15], a[132:135], v[52:55], a[0:15]
    s_lshl_b32 s37, s37, 13
    s_add_u32 s37, s37, 65536
    v_add_u32 v22, s37, v1
    s_add_u32 s37, s32, 2
    s_and_b32 s37, s37, 3
    s_lshl_b32 s37, s37, 13
    s_add_u32 s37, s37, 32768
    v_add_u32 v23, s37, v1
    s_add_u32 s37, s32, 3
    s_and_b32 s37, s37, 3
    v_mfma_f32_32x32x16_bf16 a[48:63], a[132:135], v[68:71], a[48:63]
    s_lshl_b32 s37, s37, 13
    s_add_u32 s37, s37, 0
    v_add_u32 v24, s37, v1
    s_lshl_b32 s37, s33, 3
    s_add_u32 s37, s37, s34
    s_lshl_b32 s37, s37, 4
    s_add_u32 s50, s37, 42606592
    s_mov_b32 s53, s34
    s_load_dwordx2 s[64:65], s[0:1], 40
    s_load_dwordx4 s[68:71], s[0:1], 80
    v_mfma_f32_32x32x16_bf16 a[16:31], a[148:151], v[52:55], a[16:31]
    s_load_dwordx4 s[72:75], s[0:1], 96
    s_load_dwordx2 s[66:67], s[0:1], 0
    s_and_b32 s37, s2, 3
    s_bfe_u32 s35, s2, 0x10002
    s_lshl_b32 s35, s35, 3
    v_mfma_f32_32x32x16_bf16 a[64:79], a[148:151], v[68:71], a[64:79]
    s_bfe_u32 s33, s2, 0x30003
    s_add_u32 s35, s35, s33
    s_lshr_b32 s36, s2, 6
    v_lshrrev_b32 v152, 4, v0
    v_bfe_u32 v153, v0, 2, 2
    v_and_b32 v154, 3, v0
    v_xor_b32 v156, v153, v152
    v_lshlrev_b32 v157, 10, v152
    v_lshl_add_u32 v157, v156, 6, v157
    v_lshl_add_u32 v157, v154, 4, v157
    v_mfma_f32_32x32x16_bf16 a[32:47], a[164:167], v[52:55], a[32:47]
    v_add_u32 v160, 0, v157
    v_add_u32 v161, 3072, v157
    v_add_u32 v162, 6144, v157
    v_add_u32 v163, 9216, v157
    s_lshl_b32 s42, s32, 12
    s_and_b32 s43, s32, 1
    s_lshr_b32 s44, s32, 1
    s_lshl_b32 s38, s35, 2
    s_add_u32 s38, s38, s32
    s_mul_i32 s38, s38, 304
    v_mfma_f32_32x32x16_bf16 a[80:95], a[164:167], v[68:71], a[80:95]
    s_mul_i32 s33, s37, 12
    s_add_u32 s39, s38, s33
    s_add_u32 s39, s39, 256
    s_lshl_b32 s33, s37, 6
    s_add_u32 s38, s38, s33
    v_mfma_f32_32x32x16_bf16 a[0:15], a[136:139], v[56:59], a[0:15]
    s_lshl_b32 s38, s38, 10
    s_add_u32 s38, s38, 42991616
    s_lshl_b32 s39, s39, 10
    s_add_u32 s39, s39, 42991616
    s_lshl_b32 s33, s36, 8
    s_lshl_b32 s34, s32, 14
    s_add_u32 s33, s33, s34
    s_lshl_b32 s40, s37, 20
    s_add_u32 s40, s40, s33
    s_mul_i32 s41, s37, 196608
    v_mfma_f32_32x32x16_bf16 a[48:63], a[136:139], v[72:75], a[48:63]
    s_add_u32 s41, s41, s33
    s_cmp_lg_u32 s32, 0
    s_cbranch_scc1 L_W0_26
    v_cmp_ne_u32 vcc, 1, v18
    s_nop 1
    s_cbranch_vccz L_POK_25
L_PLP_25:
    s_sleep 2
    buffer_load_ubyte v18, v17, s[20:23], s63 offen sc0 sc1
    s_waitcnt vmcnt(0)
    v_cmp_ne_u32 vcc, 1, v18
    s_nop 1
    s_cbranch_vccnz L_PLP_25
L_POK_25:
L_W0_26:
    s_waitcnt lgkmcnt(0)
    s_mov_b32 s8, s64
    s_mov_b32 s9, s65
    s_mov_b32 s10, 0x400000
    s_mov_b32 s11, 0x20000
    s_mov_b32 s24, s74
    s_mov_b32 s25, s75
    s_mov_b32 s26, 0x10000000
    s_mov_b32 s27, 0x20000
    s_barrier
    s_waitcnt vmcnt(5)
    v_mfma_f32_32x32x16_bf16 a[16:31], a[152:155], v[56:59], a[16:31]
    ds_read_b128 v[80:83], v40 offset:32768
    ds_read_b128 v[96:99], v40 offset:36864
    v_mfma_f32_32x32x16_bf16 a[64:79], a[152:155], v[72:75], a[64:79]
    s_add_u32 m0, s42, 98304
    s_add_u32 s33, s38, 0
    buffer_load_dwordx4 v1, s[24:27], s33 offen offset:0 sc1 lds
    v_mfma_f32_32x32x16_bf16 a[32:47], a[168:171], v[56:59], a[32:47]
    ds_read_b128 v[84:87], v41 offset:32768
    ds_read_b128 v[100:103], v41 offset:36864
    v_mfma_f32_32x32x16_bf16 a[80:95], a[168:171], v[72:75], a[80:95]
    buffer_load_dwordx4 v1, s[24:27], s33 offen offset:1024 sc1 lds
    v_mfma_f32_32x32x16_bf16 a[0:15], a[140:143], v[60:63], a[0:15]
    ds_read_b128 v[88:91], v42 offset:32768
    buffer_load_dwordx4 v1, s[24:27], s33 offen offset:2048 sc1 lds
    v_mfma_f32_32x32x16_bf16 a[48:63], a[140:143], v[76:79], a[48:63]
    ds_read_b128 v[104:107], v42 offset:36864
    v_mfma_f32_32x32x16_bf16 a[16:31], a[156:159], v[60:63], a[16:31]
    ds_read_b128 v[92:95], v43 offset:32768
    buffer_load_dwordx4 v1, s[24:27], s33 offen offset:3072 sc1 lds
    v_mfma_f32_32x32x16_bf16 a[64:79], a[156:159], v[76:79], a[64:79]
    ds_read_b128 v[108:111], v43 offset:36864
    v_mfma_f32_32x32x16_bf16 a[32:47], a[172:175], v[60:63], a[32:47]
    s_add_u32 m0, s42, 114688
    s_add_u32 s33, s40, 0
    buffer_load_dwordx4 v160, s[8:11], s33 offen offset:0 lds
    v_mfma_f32_32x32x16_bf16 a[80:95], a[172:175], v[76:79], a[80:95]
    s_waitcnt lgkmcnt(0)
    v_mfma_f32_32x32x16_bf16 a[0:15], a[176:179], v[80:83], a[0:15]
    buffer_load_dwordx4 v161, s[8:11], s33 offen offset:1024 lds
    v_mfma_f32_32x32x16_bf16 a[48:63], a[176:179], v[96:99], a[48:63]
    v_mfma_f32_32x32x16_bf16 a[16:31], a[192:195], v[80:83], a[16:31]
    buffer_load_dwordx4 v162, s[8:11], s33 offen offset:2048 lds
    v_mfma_f32_32x32x16_bf16 a[64:79], a[192:195], v[96:99], a[64:79]
    v_mfma_f32_32x32x16_bf16 a[32:47], a[208:211], v[80:83], a[32:47]
    buffer_load_dwordx4 v163, s[8:11], s33 offen offset:3072 lds
    v_mfma_f32_32x32x16_bf16 a[80:95], a[208:211], v[96:99], a[80:95]
    v_mfma_f32_32x32x16_bf16 a[0:15], a[180:183], v[84:87], a[0:15]
    s_add_u32 m0, s42, 131072
    s_add_u32 s33, s38, 4096
    buffer_load_dwordx4 v1, s[24:27], s33 offen offset:0 sc1 lds
    v_mfma_f32_32x32x16_bf16 a[48:63], a[180:183], v[100:103], a[48:63]
    v_mfma_f32_32x32x16_bf16 a[16:31], a[196:199], v[84:87], a[16:31]
    buffer_load_dwordx4 v1, s[24:27], s33 offen offset:1024 sc1 lds
    v_mfma_f32_32x32x16_bf16 a[64:79], a[196:199], v[100:103], a[64:79]
    v_mfma_f32_32x32x16_bf16 a[32:47], a[212:215], v[84:87], a[32:47]
    buffer_load_dwordx4 v1, s[24:27], s33 offen offset:2048 sc1 lds
    v_mfma_f32_32x32x16_bf16 a[80:95], a[212:215], v[100:103], a[80:95]
    v_mfma_f32_32x32x16_bf16 a[0:15], a[184:187], v[88:91], a[0:15]
    buffer_load_dwordx4 v1, s[24:27], s33 offen offset:3072 sc1 lds
    v_mfma_f32_32x32x16_bf16 a[48:63], a[184:187], v[104:107], a[48:63]
    v_mfma_f32_32x32x16_bf16 a[16:31], a[200:203], v[88:91], a[16:31]
    s_add_u32 m0, s42, 147456
    s_add_u32 s33, s40, 65536
    buffer_load_dwordx4 v160, s[8:11], s33 offen offset:0 lds
    v_mfma_f32_32x32x16_bf16 a[64:79], a[200:203], v[104:107], a[64:79]
    v_mfma_f32_32x32x16_bf16 a[32:47], a[216:219], v[88:91], a[32:47]
    buffer_load_dwordx4 v161, s[8:11], s33 offen offset:1024 lds
    v_mfma_f32_32x32x16_bf16 a[80:95], a[216:219], v[104:107], a[80:95]
    v_mfma_f32_32x32x16_bf16 a[0:15], a[188:191], v[92:95], a[0:15]
    buffer_load_dwordx4 v162, s[8:11], s33 offen offset:2048 lds
    v_mfma_f32_32x32x16_bf16 a[48:63], a[188:191], v[108:111], a[48:63]
    v_mfma_f32_32x32x16_bf16 a[16:31], a[204:207], v[92:95], a[16:31]
    buffer_load_dwordx4 v163, s[8:11], s33 offen offset:3072 lds
    v_mfma_f32_32x32x16_bf16 a[64:79], a[204:207], v[108:111], a[64:79]
    v_mfma_f32_32x32x16_bf16 a[32:47], a[220:223], v[92:95], a[32:47]
    v_mfma_f32_32x32x16_bf16 a[80:95], a[220:223], v[108:111], a[80:95]
    s_nop 7
    s_cmp_eq_u32 s32, 0
    s_cbranch_scc1 K2_GO0
    ds_write_b128 v28, a[0:3] offset:0
    ds_write_b128 v28, a[4:7] offset:1024
    ds_write_b128 v28, a[8:11] offset:2048
    ds_write_b128 v28, a[12:15] offset:3072
    ds_write_b128 v28, a[16:19] offset:4096
    ds_write_b128 v28, a[20:23] offset:5120
    s_branch K2_GN0
K2_GO0:
    v_accvgpr_read_b32 v48, a0
    v_accvgpr_read_b32 v49, a1
    v_accvgpr_read_b32 v50, a2
    v_accvgpr_read_b32 v51, a3
    v_accvgpr_read_b32 v52, a4
    v_accvgpr_read_b32 v53, a5
    v_accvgpr_read_b32 v54, a6
    v_accvgpr_read_b32 v55, a7
    v_accvgpr_read_b32 v80, a8
    v_accvgpr_read_b32 v81, a9
    v_accvgpr_read_b32 v82, a10
    v_accvgpr_read_b32 v83, a11
    v_accvgpr_read_b32 v84, a12
    v_accvgpr_read_b32 v85, a13
    v_accvgpr_read_b32 v86, a14
    v_accvgpr_read_b32 v87, a15
    v_accvgpr_read_b32 v112, a16
    v_accvgpr_read_b32 v113, a17
    v_accvgpr_read_b32 v114, a18
    v_accvgpr_read_b32 v115, a19
    v_accvgpr_read_b32 v116, a20
    v_accvgpr_read_b32 v117, a21
    v_accvgpr_read_b32 v118, a22
    v_accvgpr_read_b32 v119, a23
K2_GN0:
    s_cmp_eq_u32 s32, 1
    s_cbranch_scc1 K2_GO1
    ds_write_b128 v29, a[24:27] offset:0
    ds_write_b128 v29, a[28:31] offset:1024
    ds_write_b128 v29, a[32:35] offset:2048
    ds_write_b128 v29, a[36:39] offset:3072
    ds_write_b128 v29, a[40:43] offset:4096
    ds_write_b128 v29, a[44:47] offset:5120
    s_branch K2_GN1
K2_GO1:
    v_accvgpr_read_b32 v48, a24
    v_accvgpr_read_b32 v49, a25
    v_accvgpr_read_b32 v50, a26
    v_accvgpr_read_b32 v51, a27
    v_accvgpr_read_b32 v52, a28
    v_accvgpr_read_b32 v53, a29
    v_accvgpr_read_b32 v54, a30
    v_accvgpr_read_b32 v55, a31
    v_accvgpr_read_b32 v80, a32
    v_accvgpr_read_b32 v81, a33
    v_accvgpr_read_b32 v82, a34
    v_accvgpr_read_b32 v83, a35
    v_accvgpr_read_b32 v84, a36
    v_accvgpr_read_b32 v85, a37
    v_accvgpr_read_b32 v86, a38
    v_accvgpr_read_b32 v87, a39
    v_accvgpr_read_b32 v112, a40
    v_accvgpr_read_b32 v113, a41
    v_accvgpr_read_b32 v114, a42
    v_accvgpr_read_b32 v115, a43
    v_accvgpr_read_b32 v116, a44
    v_accvgpr_read_b32 v117, a45
    v_accvgpr_read_b32 v118, a46
    v_accvgpr_read_b32 v119, a47
K2_GN1:
    s_cmp_eq_u32 s32, 2
    s_cbranch_scc1 K2_GO2
    ds_write_b128 v30, a[48:51] offset:0
    ds_write_b128 v30, a[52:55] offset:1024
    ds_write_b128 v30, a[56:59] offset:2048
    ds_write_b128 v30, a[60:63] offset:3072
    ds_write_b128 v30, a[64:67] offset:4096
    ds_write_b128 v30, a[68:71] offset:5120
    s_branch K2_GN2
K2_GO2:
    v_accvgpr_read_b32 v48, a48
    v_accvgpr_read_b32 v49, a49
    v_accvgpr_read_b32 v50, a50
    v_accvgpr_read_b32 v51, a51
    v_accvgpr_read_b32 v52, a52
    v_accvgpr_read_b32 v53, a53
    v_accvgpr_read_b32 v54, a54
    v_accvgpr_read_b32 v55, a55
    v_accvgpr_read_b32 v80, a56
    v_accvgpr_read_b32 v81, a57
    v_accvgpr_read_b32 v82, a58
    v_accvgpr_read_b32 v83, a59
    v_accvgpr_read_b32 v84, a60
    v_accvgpr_read_b32 v85, a61
    v_accvgpr_read_b32 v86, a62
    v_accvgpr_read_b32 v87, a63
    v_accvgpr_read_b32 v112, a64
    v_accvgpr_read_b32 v113, a65
    v_accvgpr_read_b32 v114, a66
    v_accvgpr_read_b32 v115, a67
    v_accvgpr_read_b32 v116, a68
    v_accvgpr_read_b32 v117, a69
    v_accvgpr_read_b32 v118, a70
    v_accvgpr_read_b32 v119, a71
K2_GN2:
    s_cmp_eq_u32 s32, 3
    s_cbranch_scc1 K2_GO3
    ds_write_b128 v31, a[72:75] offset:0
    ds_write_b128 v31, a[76:79] offset:1024
    ds_write_b128 v31, a[80:83] offset:2048
    ds_write_b128 v31, a[84:87] offset:3072
    ds_write_b128 v31, a[88:91] offset:4096
    ds_write_b128 v31, a[92:95] offset:5120
    s_branch K2_GN3
K2_GO3:
    v_accvgpr_read_b32 v48, a72
    v_accvgpr_read_b32 v49, a73
    v_accvgpr_read_b32 v50, a74
    v_accvgpr_read_b32 v51, a75
    v_accvgpr_read_b32 v52, a76
    v_accvgpr_read_b32 v53, a77
    v_accvgpr_read_b32 v54, a78
    v_accvgpr_read_b32 v55, a79
    v_accvgpr_read_b32 v80, a80
    v_accvgpr_read_b32 v81, a81
    v_accvgpr_read_b32 v82, a82
    v_accvgpr_read_b32 v83, a83
    v_accvgpr_read_b32 v84, a84
    v_accvgpr_read_b32 v85, a85
    v_accvgpr_read_b32 v86, a86
    v_accvgpr_read_b32 v87, a87
    v_accvgpr_read_b32 v112, a88
    v_accvgpr_read_b32 v113, a89
    v_accvgpr_read_b32 v114, a90
    v_accvgpr_read_b32 v115, a91
    v_accvgpr_read_b32 v116, a92
    v_accvgpr_read_b32 v117, a93
    v_accvgpr_read_b32 v118, a94
    v_accvgpr_read_b32 v119, a95
K2_GN3:
    s_waitcnt lgkmcnt(0)
    s_barrier
    ds_read_b128 v[56:59], v22 offset:0
    ds_read_b128 v[60:63], v22 offset:1024
    ds_read_b128 v[64:67], v23 offset:0
    ds_read_b128 v[68:71], v23 offset:1024
    ds_read_b128 v[72:75], v24 offset:0
    ds_read_b128 v[76:79], v24 offset:1024
    ds_read_b128 v[88:91], v22 offset:2048
    ds_read_b128 v[92:95], v22 offset:3072
    ds_read_b128 v[96:99], v23 offset:2048
    ds_read_b128 v[100:103], v23 offset:3072
    ds_read_b128 v[104:107], v24 offset:2048
    ds_read_b128 v[108:111], v24 offset:3072
    ds_read_b128 v[120:123], v22 offset:4096
    ds_read_b128 v[124:127], v22 offset:5120
    ds_read_b128 v[128:131], v23 offset:4096
    ds_read_b128 v[132:135], v23 offset:5120
    ds_read_b128 v[136:139], v24 offset:4096
    ds_read_b128 v[140:143], v24 offset:5120
    s_waitcnt vmcnt(17)
    v_lshlrev_b32 v16, 16, v16
    s_waitcnt lgkmcnt(12)
    v_add_f32 v48, v48, v56
    v_add_f32 v64, v64, v72
    v_add_f32 v49, v49, v57
    v_add_f32 v65, v65, v73
    v_add_f32 v50, v50, v58
    v_add_f32 v66, v66, v74
    v_add_f32 v51, v51, v59
    v_add_f32 v67, v67, v75
    v_add_f32 v52, v52, v60
    v_add_f32 v68, v68, v76
    v_add_f32 v53, v53, v61
    v_add_f32 v69, v69, v77
    v_add_f32 v54, v54, v62
    v_add_f32 v70, v70, v78
    v_add_f32 v55, v55, v63
    v_add_f32 v71, v71, v79
    v_add_f32 v48, v48, v16
    v_add_f32 v49, v49, v16
    v_add_f32 v50, v50, v16
    v_add_f32 v51, v51, v16
    v_add_f32 v52, v52, v16
    v_add_f32 v53, v53, v16
    v_add_f32 v54, v54, v16
    v_add_f32 v55, v55, v16
    v_add_f32 v48, v48, v64
    v_add_f32 v49, v49, v65
    v_add_f32 v50, v50, v66
    v_add_f32 v51, v51, v67
    v_add_f32 v52, v52, v68
    v_add_f32 v53, v53, v69
    v_add_f32 v54, v54, v70
    v_add_f32 v55, v55, v71
    v_lshlrev_b32 v26, 16, v4
    v_and_b32 v27, 0xffff0000, v4
    v_mul_f32 v48, v48, v26
    v_mul_f32 v49, v49, v27
    v_lshlrev_b32 v26, 16, v5
    v_and_b32 v27, 0xffff0000, v5
    v_mul_f32 v50, v50, v26
    v_mul_f32 v51, v51, v27
    v_lshlrev_b32 v26, 16, v6
    v_and_b32 v27, 0xffff0000, v6
    v_mul_f32 v52, v52, v26
    v_mul_f32 v53, v53, v27
    v_lshlrev_b32 v26, 16, v7
    v_and_b32 v27, 0xffff0000, v7
    v_mul_f32 v54, v54, v26
    v_mul_f32 v55, v55, v27
    v_cvt_pk_bf16_f32 v48, v48, v49
    v_cvt_pk_bf16_f32 v49, v50, v51
    v_cvt_pk_bf16_f32 v50, v52, v53
    v_cvt_pk_bf16_f32 v51, v54, v55
    buffer_store_dwordx4 v[48:51], v1, s[20:23], s61 offen offset:0 sc1
    s_waitcnt lgkmcnt(6)
    v_add_f32 v80, v80, v88
    v_add_f32 v96, v96, v104
    v_add_f32 v81, v81, v89
    v_add_f32 v97, v97, v105
    v_add_f32 v82, v82, v90
    v_add_f32 v98, v98, v106
    v_add_f32 v83, v83, v91
    v_add_f32 v99, v99, v107
    v_add_f32 v84, v84, v92
    v_add_f32 v100, v100, v108
    v_add_f32 v85, v85, v93
    v_add_f32 v101, v101, v109
    v_add_f32 v86, v86, v94
    v_add_f32 v102, v102, v110
    v_add_f32 v87, v87, v95
    v_add_f32 v103, v103, v111
    v_add_f32 v80, v80, v16
    v_add_f32 v81, v81, v16
    v_add_f32 v82, v82, v16
    v_add_f32 v83, v83, v16
    v_add_f32 v84, v84, v16
    v_add_f32 v85, v85, v16
    v_add_f32 v86, v86, v16
    v_add_f32 v87, v87, v16
    v_add_f32 v80, v80, v96
    v_add_f32 v81, v81, v97
    v_add_f32 v82, v82, v98
    v_add_f32 v83, v83, v99
    v_add_f32 v84, v84, v100
    v_add_f32 v85, v85, v101
    v_add_f32 v86, v86, v102
    v_add_f32 v87, v87, v103
    v_lshlrev_b32 v26, 16, v8
    v_and_b32 v27, 0xffff0000, v8
    v_mul_f32 v80, v80, v26
    v_mul_f32 v81, v81, v27
    v_lshlrev_b32 v26, 16, v9
    v_and_b32 v27, 0xffff0000, v9
    v_mul_f32 v82, v82, v26
    v_mul_f32 v83, v83, v27
    v_lshlrev_b32 v26, 16, v10
    v_and_b32 v27, 0xffff0000, v10
    v_mul_f32 v84, v84, v26
    v_mul_f32 v85, v85, v27
    v_lshlrev_b32 v26, 16, v11
    v_and_b32 v27, 0xffff0000, v11
    v_mul_f32 v86, v86, v26
    v_mul_f32 v87, v87, v27
    v_cvt_pk_bf16_f32 v80, v80, v81
    v_cvt_pk_bf16_f32 v81, v82, v83
    v_cvt_pk_bf16_f32 v82, v84, v85
    v_cvt_pk_bf16_f32 v83, v86, v87
    buffer_store_dwordx4 v[80:83], v1, s[20:23], s61 offen offset:1024 sc1
    s_waitcnt lgkmcnt(0)
    v_add_f32 v112, v112, v120
    v_add_f32 v128, v128, v136
    v_add_f32 v113, v113, v121
    v_add_f32 v129, v129, v137
    v_add_f32 v114, v114, v122
    v_add_f32 v130, v130, v138
    v_add_f32 v115, v115, v123
    v_add_f32 v131, v131, v139
    v_add_f32 v116, v116, v124
    v_add_f32 v132, v132, v140
    v_add_f32 v117, v117, v125
    v_add_f32 v133, v133, v141
    v_add_f32 v118, v118, v126
    v_add_f32 v134, v134, v142
    v_add_f32 v119, v119, v127
    v_add_f32 v135, v135, v143
    v_add_f32 v112, v112, v16
    v_add_f32 v113, v113, v16
    v_add_f32 v114, v114, v16
    v_add_f32 v115, v115, v16
    v_add_f32 v116, v116, v16
    v_add_f32 v117, v117, v16
    v_add_f32 v118, v118, v16
    v_add_f32 v119, v119, v16
    v_add_f32 v112, v112, v128
    v_add_f32 v113, v113, v129
    v_add_f32 v114, v114, v130
    v_add_f32 v115, v115, v131
    v_add_f32 v116, v116, v132
    v_add_f32 v117, v117, v133
    v_add_f32 v118, v118, v134
    v_add_f32 v119, v119, v135
    v_lshlrev_b32 v26, 16, v12
    v_and_b32 v27, 0xffff0000, v12
    v_mul_f32 v112, v112, v26
    v_mul_f32 v113, v113, v27
    v_lshlrev_b32 v26, 16, v13
    v_and_b32 v27, 0xffff0000, v13
    v_mul_f32 v114, v114, v26
    v_mul_f32 v115, v115, v27
    v_lshlrev_b32 v26, 16, v14
    v_and_b32 v27, 0xffff0000, v14
    v_mul_f32 v116, v116, v26
    v_mul_f32 v117, v117, v27
    v_lshlrev_b32 v26, 16, v15
    v_and_b32 v27, 0xffff0000, v15
    v_mul_f32 v118, v118, v26
    v_mul_f32 v119, v119, v27
    v_cvt_pk_bf16_f32 v112, v112, v113
    v_cvt_pk_bf16_f32 v113, v114, v115
    v_cvt_pk_bf16_f32 v114, v116, v117
    v_cvt_pk_bf16_f32 v115, v118, v119
    buffer_store_dwordx4 v[112:115], v1, s[20:23], s61 offen offset:2048 sc1
    s_mov_b64 exec, -1
    s_barrier
    s_add_u32 m0, s42, 0
    s_add_u32 s33, s38, 8192
    buffer_load_dwordx4 v1, s[24:27], s33 offen offset:0 sc1 lds
    buffer_load_dwordx4 v1, s[24:27], s33 offen offset:1024 sc1 lds
    buffer_load_dwordx4 v1, s[24:27], s33 offen offset:2048 sc1 lds
    buffer_load_dwordx4 v1, s[24:27], s33 offen offset:3072 sc1 lds
    s_add_u32 m0, s42, 16384
    s_add_u32 s33, s40, 131072
    buffer_load_dwordx4 v160, s[8:11], s33 offen offset:0 lds
    buffer_load_dwordx4 v161, s[8:11], s33 offen offset:1024 lds
    buffer_load_dwordx4 v162, s[8:11], s33 offen offset:2048 lds
    buffer_load_dwordx4 v163, s[8:11], s33 offen offset:3072 lds
    v_and_b32 v20, 31, v0
    v_lshrrev_b32 v21, 5, v0
    v_bfe_u32 v23, v0, 2, 2
    v_and_b32 v24, 3, v0
    v_bfe_u32 v25, v0, 4, 1
    s_mov_b32 s12, s68
    s_mov_b32 s13, s69
    s_mov_b32 s14, 0xac000
    s_mov_b32 s15, 0x20000
    s_mov_b32 s16, s66
    s_mov_b32 s17, s67
    s_mov_b32 s18, 0x200000
    s_mov_b32 s19, 0x20000
    s_mov_b32 s20, s70
    s_mov_b32 s21, s71
    s_mov_b32 s22, 0x200000
    s_mov_b32 s23, 0x20000
    s_mov_b32 s28, s72
    s_mov_b32 s29, s73
    s_mov_b32 s30, 0x100
    s_mov_b32 s31, 0x20000
    s_lshl_b32 s33, s43, 13
    v_add_u32 v6, s33, v1
    v_add_u32 v7, 0x10000, v6
    v_add_u32 v8, 0x20000, v6
    v_lshl_add_u32 v26, v21, 2, v23
    v_lshlrev_b32 v26, 8, v26
    v_lshl_add_u32 v26, v25, 5, v26
    v_lshl_add_u32 v26, v24, 3, v26
    v_add_u32 v26, 16384, v26
    s_lshl_b32 s33, s44, 1
    v_xor_b32 v27, s33, v23
    v_lshl_add_u32 v10, v27, 6, v26
    v_xor_b32 v27, 1, v27
    v_lshl_add_u32 v11, v27, 6, v26
    v_add_u32 v12, 65536, v10
    v_add_u32 v13, 65536, v11
    v_add_u32 v14, 131072, v10
    v_add_u32 v15, 131072, v11
    s_lshr_b32 s45, s2, 2
    s_lshl_b32 s45, s45, 17
    s_add_u32 s45, s45, 71303168
    s_lshr_b32 s46, s2, 2
    s_lshl_b32 s46, s46, 7
    s_add_u32 s46, s46, 42467328
    s_waitcnt vmcnt(19)
    s_barrier
    ds_read_b128 v[32:35], v7 offset:32768
    ds_read_b128 v[36:39], v7 offset:36864
    ds_read_b64_tr_b16 v[40:41], v12 offset:32768
    ds_read_b64_tr_b16 v[42:43], v12 offset:34816
    ds_read_b64_tr_b16 v[44:45], v13 offset:32768
    ds_read_b64_tr_b16 v[46:47], v13 offset:34816
    s_waitcnt lgkmcnt(0)
    v_mfma_f32_32x32x16_bf16 v[64:79], v[40:43], v[32:35], 0
    ds_read_b128 v[48:51], v7 offset:33792
    ds_read_b128 v[52:55], v7 offset:37888
    s_add_u32 m0, s42, 32768
    s_add_u32 s33, s38, 12288
    buffer_load_dwordx4 v1, s[24:27], s33 offen offset:0 sc1 lds
    v_mfma_f32_32x32x16_bf16 v[96:111], v[40:43], v[36:39], 0
    ds_read_b64_tr_b16 v[56:57], v12 offset:36864
    ds_read_b64_tr_b16 v[58:59], v12 offset:38912
    buffer_load_dwordx4 v1, s[24:27], s33 offen offset:1024 sc1 lds
    v_mfma_f32_32x32x16_bf16 v[80:95], v[44:47], v[32:35], 0
    ds_read_b64_tr_b16 v[60:61], v13 offset:36864
    ds_read_b64_tr_b16 v[62:63], v13 offset:38912
    buffer_load_dwordx4 v1, s[24:27], s33 offen offset:2048 sc1 lds
    v_mfma_f32_32x32x16_bf16 v[112:127], v[44:47], v[36:39], 0
    s_waitcnt lgkmcnt(0)
    v_mfma_f32_32x32x16_bf16 v[64:79], v[56:59], v[48:51], v[64:79]
    ds_read_b128 v[32:35], v7 offset:34816
    ds_read_b128 v[36:39], v7 offset:38912
    buffer_load_dwordx4 v1, s[24:27], s33 offen offset:3072 sc1 lds
    v_mfma_f32_32x32x16_bf16 v[96:111], v[56:59], v[52:55], v[96:111]
    ds_read_b64_tr_b16 v[40:41], v12 offset:40960
    ds_read_b64_tr_b16 v[42:43], v12 offset:43008
    s_add_u32 m0, s42, 49152
    s_add_u32 s33, s40, 196608
    buffer_load_dwordx4 v160, s[8:11], s33 offen offset:0 lds
    v_mfma_f32_32x32x16_bf16 v[80:95], v[60:63], v[48:51], v[80:95]
    ds_read_b64_tr_b16 v[44:45], v13 offset:40960
    ds_read_b64_tr_b16 v[46:47], v13 offset:43008
    buffer_load_dwordx4 v161, s[8:11], s33 offen offset:1024 lds
    v_mfma_f32_32x32x16_bf16 v[112:127], v[60:63], v[52:55], v[112:127]
    s_waitcnt lgkmcnt(0)
    v_mfma_f32_32x32x16_bf16 v[64:79], v[40:43], v[32:35], v[64:79]
    ds_read_b128 v[48:51], v7 offset:35840
    ds_read_b128 v[52:55], v7 offset:39936
    buffer_load_dwordx4 v162, s[8:11], s33 offen offset:2048 lds
    v_mfma_f32_32x32x16_bf16 v[96:111], v[40:43], v[36:39], v[96:111]
    ds_read_b64_tr_b16 v[56:57], v12 offset:45056
    ds_read_b64_tr_b16 v[58:59], v12 offset:47104
    buffer_load_dwordx4 v163, s[8:11], s33 offen offset:3072 lds
    v_mfma_f32_32x32x16_bf16 v[80:95], v[44:47], v[32:35], v[80:95]
    ds_read_b64_tr_b16 v[60:61], v13 offset:45056
    ds_read_b64_tr_b16 v[62:63], v13 offset:47104
    s_add_u32 m0, s42, 65536
    s_add_u32 s33, s38, 16384
    buffer_load_dwordx4 v1, s[24:27], s33 offen offset:0 sc1 lds
    v_mfma_f32_32x32x16_bf16 v[112:127], v[44:47], v[36:39], v[112:127]
    s_waitcnt lgkmcnt(0)
    s_waitcnt vmcnt(20)
    s_barrier
    v_mfma_f32_32x32x16_bf16 v[64:79], v[56:59], v[48:51], v[64:79]
    ds_read_b128 v[32:35], v8 offset:0
    ds_read_b128 v[36:39], v8 offset:4096
    buffer_load_dwordx4 v1, s[24:27], s33 offen offset:1024 sc1 lds
    v_mfma_f32_32x32x16_bf16 v[96:111], v[56:59], v[52:55], v[96:111]
    ds_read_b64_tr_b16 v[40:41], v14 offset:0
    ds_read_b64_tr_b16 v[42:43], v14 offset:2048
    buffer_load_dwordx4 v1, s[24:27], s33 offen offset:2048 sc1 lds
    v_mfma_f32_32x32x16_bf16 v[80:95], v[60:63], v[48:51], v[80:95]
    ds_read_b64_tr_b16 v[44:45], v15 offset:0
    ds_read_b64_tr_b16 v[46:47], v15 offset:2048
    buffer_load_dwordx4 v1, s[24:27], s33 offen offset:3072 sc1 lds
    v_mfma_f32_32x32x16_bf16 v[112:127], v[60:63], v[52:55], v[112:127]
    s_waitcnt lgkmcnt(0)
    v_mfma_f32_32x32x16_bf16 v[64:79], v[40:43], v[32:35], v[64:79]
    ds_read_b128 v[48:51], v8 offset:1024
    ds_read_b128 v[52:55], v8 offset:5120
    s_add_u32 m0, s42, 81920
    s_add_u32 s33, s40, 262144
    buffer_load_dwordx4 v160, s[8:11], s33 offen offset:0 lds
    v_mfma_f32_32x32x16_bf16 v[96:111], v[40:43], v[36:39], v[96:111]
    ds_read_b64_tr_b16 v[56:57], v14 offset:4096
    ds_read_b64_tr_b16 v[58:59], v14 offset:6144
    buffer_load_dwordx4 v161, s[8:11], s33 offen offset:1024 lds
    v_mfma_f32_32x32x16_bf16 v[80:95], v[44:47], v[32:35], v[80:95]
    ds_read_b64_tr_b16 v[60:61], v15 offset:4096
    ds_read_b64_tr_b16 v[62:63], v15 offset:6144
    buffer_load_dwordx4 v162, s[8:11], s33 offen offset:2048 lds
    v_mfma_f32_32x32x16_bf16 v[112:127], v[44:47], v[36:39], v[112:127]
    s_waitcnt lgkmcnt(0)
    v_mfma_f32_32x32x16_bf16 v[64:79], v[56:59], v[48:51], v[64:79]
    ds_read_b128 v[32:35], v8 offset:2048
    ds_read_b128 v[36:39], v8 offset:6144
    buffer_load_dwordx4 v163, s[8:11], s33 offen offset:3072 lds
    v_mfma_f32_32x32x16_bf16 v[96:111], v[56:59], v[52:55], v[96:111]
    ds_read_b64_tr_b16 v[40:41], v14 offset:8192
    ds_read_b64_tr_b16 v[42:43], v14 offset:10240
    s_add_u32 m0, s42, 98304
    s_add_u32 s33, s38, 20480
    buffer_load_dwordx4 v1, s[24:27], s33 offen offset:0 sc1 lds
    v_mfma_f32_32x32x16_bf16 v[80:95], v[60:63], v[48:51], v[80:95]
    ds_read_b64_tr_b16 v[44:45], v15 offset:8192
    ds_read_b64_tr_b16 v[46:47], v15 offset:10240
    buffer_load_dwordx4 v1, s[24:27], s33 offen offset:1024 sc1 lds
    v_mfma_f32_32x32x16_bf16 v[112:127], v[60:63], v[52:55], v[112:127]
    s_waitcnt lgkmcnt(0)
    v_mfma_f32_32x32x16_bf16 v[64:79], v[40:43], v[32:35], v[64:79]
    ds_read_b128 v[48:51], v8 offset:3072
    ds_read_b128 v[52:55], v8 offset:7168
    buffer_load_dwordx4 v1, s[24:27], s33 offen offset:2048 sc1 lds
    v_mfma_f32_32x32x16_bf16 v[96:111], v[40:43], v[36:39], v[96:111]
    ds_read_b64_tr_b16 v[56:57], v14 offset:12288
    ds_read_b64_tr_b16 v[58:59], v14 offset:14336
    v_mfma_f32_32x32x16_bf16 v[80:95], v[44:47], v[32:35], v[80:95]
    ds_read_b64_tr_b16 v[60:61], v15 offset:12288
    ds_read_b64_tr_b16 v[62:63], v15 offset:14336
    buffer_load_dwordx4 v1, s[24:27], s33 offen offset:3072 sc1 lds
    v_mfma_f32_32x32x16_bf16 v[112:127], v[44:47], v[36:39], v[112:127]
    s_waitcnt lgkmcnt(0)
    s_waitcnt vmcnt(20)
    s_barrier
    s_cmp_lg_u32 s32, 0
    s_cbranch_scc1 L_W0_27
    v_mov_b32 v140, 1
    v_mov_b32 v141, 0
    s_mov_b64 exec, 1
    buffer_store_byte v140, v141, s[24:27], s50 offen sc0 sc1
    s_mov_b64 exec, -1
L_W0_27:
    v_mfma_f32_32x32x16_bf16 v[64:79], v[56:59], v[48:51], v[64:79]
    ds_read_b128 v[32:35], v6 offset:0
    ds_read_b128 v[36:39], v6 offset:4096
    s_add_u32 m0, s42, 114688
    s_add_u32 s33, s40, 327680
    buffer_load_dwordx4 v160, s[8:11], s33 offen offset:0 lds
    v_mfma_f32_32x32x16_bf16 v[96:111], v[56:59], v[52:55], v[96:111]
    ds_read_b64_tr_b16 v[40:41], v10 offset:0
    ds_read_b64_tr_b16 v[42:43], v10 offset:2048
    buffer_load_dwordx4 v161, s[8:11], s33 offen offset:1024 lds
    v_mfma_f32_32x32x16_bf16 v[80:95], v[60:63], v[48:51], v[80:95]
    ds_read_b64_tr_b16 v[44:45], v11 offset:0
    ds_read_b64_tr_b16 v[46:47], v11 offset:2048
    buffer_load_dwordx4 v162, s[8:11], s33 offen offset:2048 lds
    v_mfma_f32_32x32x16_bf16 v[112:127], v[60:63], v[52:55], v[112:127]
    s_waitcnt lgkmcnt(0)
    v_mfma_f32_32x32x16_bf16 v[64:79], v[40:43], v[32:35], v[64:79]
    ds_read_b128 v[48:51], v6 offset:1024
    ds_read_b128 v[52:55], v6 offset:5120
    buffer_load_dwordx4 v163, s[8:11], s33 offen offset:3072 lds
    v_mfma_f32_32x32x16_bf16 v[96:111], v[40:43], v[36:39], v[96:111]
    ds_read_b64_tr_b16 v[56:57], v10 offset:4096
    ds_read_b64_tr_b16 v[58:59], v10 offset:6144
    s_add_u32 m0, s42, 131072
    s_add_u32 s33, s38, 24576
    buffer_load_dwordx4 v1, s[24:27], s33 offen offset:0 sc1 lds
    v_mfma_f32_32x32x16_bf16 v[80:95], v[44:47], v[32:35], v[80:95]
    ds_read_b64_tr_b16 v[60:61], v11 offset:4096
    ds_read_b64_tr_b16 v[62:63], v11 offset:6144
    buffer_load_dwordx4 v1, s[24:27], s33 offen offset:1024 sc1 lds
    v_mfma_f32_32x32x16_bf16 v[112:127], v[44:47], v[36:39], v[112:127]
    s_waitcnt lgkmcnt(0)
    v_mfma_f32_32x32x16_bf16 v[64:79], v[56:59], v[48:51], v[64:79]
    ds_read_b128 v[32:35], v6 offset:2048
    ds_read_b128 v[36:39], v6 offset:6144
    buffer_load_dwordx4 v1, s[24:27], s33 offen offset:2048 sc1 lds
    v_mfma_f32_32x32x16_bf16 v[96:111], v[56:59], v[52:55], v[96:111]
    ds_read_b64_tr_b16 v[40:41], v10 offset:8192
    ds_read_b64_tr_b16 v[42:43], v10 offset:10240
    v_mfma_f32_32x32x16_bf16 v[80:95], v[60:63], v[48:51], v[80:95]
    ds_read_b64_tr_b16 v[44:45], v11 offset:8192
    ds_read_b64_tr_b16 v[46:47], v11 offset:10240
    buffer_load_dwordx4 v1, s[24:27], s33 offen offset:3072 sc1 lds
    v_mfma_f32_32x32x16_bf16 v[112:127], v[60:63], v[52:55], v[112:127]
    s_waitcnt lgkmcnt(0)
    v_mfma_f32_32x32x16_bf16 v[64:79], v[40:43], v[32:35], v[64:79]
    ds_read_b128 v[48:51], v6 offset:3072
    ds_read_b128 v[52:55], v6 offset:7168
    s_add_u32 m0, s42, 147456
    s_add_u32 s33, s40, 393216
    buffer_load_dwordx4 v160, s[8:11], s33 offen offset:0 lds
    v_mfma_f32_32x32x16_bf16 v[96:111], v[40:43], v[36:39], v[96:111]
    ds_read_b64_tr_b16 v[56:57], v10 offset:12288
    ds_read_b64_tr_b16 v[58:59], v10 offset:14336
    v_mfma_f32_32x32x16_bf16 v[80:95], v[44:47], v[32:35], v[80:95]
    ds_read_b64_tr_b16 v[60:61], v11 offset:12288
    ds_read_b64_tr_b16 v[62:63], v11 offset:14336
    buffer_load_dwordx4 v161, s[8:11], s33 offen offset:1024 lds
    v_mfma_f32_32x32x16_bf16 v[112:127], v[44:47], v[36:39], v[112:127]
    s_waitcnt lgkmcnt(0)
    s_waitcnt vmcnt(22)
    s_barrier
    v_mfma_f32_32x32x16_bf16 v[64:79], v[56:59], v[48:51], v[64:79]
    ds_read_b128 v[32:35], v6 offset:32768
    ds_read_b128 v[36:39], v6 offset:36864
    buffer_load_dwordx4 v162, s[8:11], s33 offen offset:2048 lds
    v_mfma_f32_32x32x16_bf16 v[96:111], v[56:59], v[52:55], v[96:111]
    ds_read_b64_tr_b16 v[40:41], v10 offset:32768
    ds_read_b64_tr_b16 v[42:43], v10 offset:34816
    buffer_load_dwordx4 v163, s[8:11], s33 offen offset:3072 lds
    v_mfma_f32_32x32x16_bf16 v[80:95], v[60:63], v[48:51], v[80:95]
    ds_read_b64_tr_b16 v[44:45], v11 offset:32768
    ds_read_b64_tr_b16 v[46:47], v11 offset:34816
    s_add_u32 m0, s42, 0
    s_add_u32 s33, s38, 28672
    buffer_load_dwordx4 v1, s[24:27], s33 offen offset:0 sc1 lds
    v_mfma_f32_32x32x16_bf16 v[112:127], v[60:63], v[52:55], v[112:127]
    s_waitcnt lgkmcnt(0)
    v_mfma_f32_32x32x16_bf16 v[64:79], v[40:43], v[32:35], v[64:79]
    ds_read_b128 v[48:51], v6 offset:33792
    ds_read_b128 v[52:55], v6 offset:37888
    buffer_load_dwordx4 v1, s[24:27], s33 offen offset:1024 sc1 lds
    v_mfma_f32_32x32x16_bf16 v[96:111], v[40:43], v[36:39], v[96:111]
    ds_read_b64_tr_b16 v[56:57], v10 offset:36864
    ds_read_b64_tr_b16 v[58:59], v10 offset:38912
    v_mfma_f32_32x32x16_bf16 v[80:95], v[44:47], v[32:35], v[80:95]
    ds_read_b64_tr_b16 v[60:61], v11 offset:36864
    ds_read_b64_tr_b16 v[62:63], v11 offset:38912
    buffer_load_dwordx4 v1, s[24:27], s33 offen offset:2048 sc1 lds
    v_mfma_f32_32x32x16_bf16 v[112:127], v[44:47], v[36:39], v[112:127]
    s_waitcnt lgkmcnt(0)
    v_mfma_f32_32x32x16_bf16 v[64:79], v[56:59], v[48:51], v[64:79]
    ds_read_b128 v[32:35], v6 offset:34816
    ds_read_b128 v[36:39], v6 offset:38912
    buffer_load_dwordx4 v1, s[24:27], s33 offen offset:3072 sc1 lds
    v_mfma_f32_32x32x16_bf16 v[96:111], v[56:59], v[52:55], v[96:111]
    ds_read_b64_tr_b16 v[40:41], v10 offset:40960
    ds_read_b64_tr_b16 v[42:43], v10 offset:43008
    v_mfma_f32_32x32x16_bf16 v[80:95], v[60:63], v[48:51], v[80:95]
    ds_read_b64_tr_b16 v[44:45], v11 offset:40960
    ds_read_b64_tr_b16 v[46:47], v11 offset:43008
    s_add_u32 m0, s42, 16384
    s_add_u32 s33, s40, 458752
    buffer_load_dwordx4 v160, s[8:11], s33 offen offset:0 lds
    v_mfma_f32_32x32x16_bf16 v[112:127], v[60:63], v[52:55], v[112:127]
    s_waitcnt lgkmcnt(0)
    v_mfma_f32_32x32x16_bf16 v[64:79], v[40:43], v[32:35], v[64:79]
    ds_read_b128 v[48:51], v6 offset:35840
    ds_read_b128 v[52:55], v6 offset:39936
    buffer_load_dwordx4 v161, s[8:11], s33 offen offset:1024 lds
    v_mfma_f32_32x32x16_bf16 v[96:111], v[40:43], v[36:39], v[96:111]
    ds_read_b64_tr_b16 v[56:57], v10 offset:45056
    ds_read_b64_tr_b16 v[58:59], v10 offset:47104
    v_mfma_f32_32x32x16_bf16 v[80:95], v[44:47], v[32:35], v[80:95]
    ds_read_b64_tr_b16 v[60:61], v11 offset:45056
    ds_read_b64_tr_b16 v[62:63], v11 offset:47104
    buffer_load_dwordx4 v162, s[8:11], s33 offen offset:2048 lds
    v_mfma_f32_32x32x16_bf16 v[112:127], v[44:47], v[36:39], v[112:127]
    s_waitcnt lgkmcnt(0)
    s_waitcnt vmcnt(23)
    s_barrier
    v_mfma_f32_32x32x16_bf16 v[64:79], v[56:59], v[48:51], v[64:79]
    ds_read_b128 v[32:35], v7 offset:0
    ds_read_b128 v[36:39], v7 offset:4096
    buffer_load_dwordx4 v163, s[8:11], s33 offen offset:3072 lds
    v_mfma_f32_32x32x16_bf16 v[96:111], v[56:59], v[52:55], v[96:111]
    ds_read_b64_tr_b16 v[40:41], v12 offset:0
    ds_read_b64_tr_b16 v[42:43], v12 offset:2048
    s_add_u32 m0, s42, 32768
    s_add_u32 s33, s38, 32768
    buffer_load_dwordx4 v1, s[24:27], s33 offen offset:0 sc1 lds
    v_mfma_f32_32x32x16_bf16 v[80:95], v[60:63], v[48:51], v[80:95]
    ds_read_b64_tr_b16 v[44:45], v13 offset:0
    ds_read_b64_tr_b16 v[46:47], v13 offset:2048
    buffer_load_dwordx4 v1, s[24:27], s33 offen offset:1024 sc1 lds
    v_mfma_f32_32x32x16_bf16 v[112:127], v[60:63], v[52:55], v[112:127]
    s_waitcnt lgkmcnt(0)
    v_mfma_f32_32x32x16_bf16 v[64:79], v[40:43], v[32:35], v[64:79]
    ds_read_b128 v[48:51], v7 offset:1024
    ds_read_b128 v[52:55], v7 offset:5120
    buffer_load_dwordx4 v1, s[24:27], s33 offen offset:2048 sc1 lds
    v_mfma_f32_32x32x16_bf16 v[96:111], v[40:43], v[36:39], v[96:111]
    ds_read_b64_tr_b16 v[56:57], v12 offset:4096
    ds_read_b64_tr_b16 v[58:59], v12 offset:6144
    v_mfma_f32_32x32x16_bf16 v[80:95], v[44:47], v[32:35], v[80:95]
    ds_read_b64_tr_b16 v[60:61], v13 offset:4096
    ds_read_b64_tr_b16 v[62:63], v13 offset:6144
    buffer_load_dwordx4 v1, s[24:27], s33 offen offset:3072 sc1 lds
    v_mfma_f32_32x32x16_bf16 v[112:127], v[44:47], v[36:39], v[112:127]
    s_waitcnt lgkmcnt(0)
    v_mfma_f32_32x32x16_bf16 v[64:79], v[56:59], v[48:51], v[64:79]
    ds_read_b128 v[32:35], v7 offset:2048
    ds_read_b128 v[36:39], v7 offset:6144
    s_add_u32 m0, s42, 49152
    s_add_u32 s33, s40, 524288
    buffer_load_dwordx4 v160, s[8:11], s33 offen offset:0 lds
    v_mfma_f32_32x32x16_bf16 v[96:111], v[56:59], v[52:55], v[96:111]
    ds_read_b64_tr_b16 v[40:41], v12 offset:8192
    ds_read_b64_tr_b16 v[42:43], v12 offset:10240
    v_mfma_f32_32x32x16_bf16 v[80:95], v[60:63], v[48:51], v[80:95]
    ds_read_b64_tr_b16 v[44:45], v13 offset:8192
    ds_read_b64_tr_b16 v[46:47], v13 offset:10240
    buffer_load_dwordx4 v161, s[8:11], s33 offen offset:1024 lds
    v_mfma_f32_32x32x16_bf16 v[112:127], v[60:63], v[52:55], v[112:127]
    s_waitcnt lgkmcnt(0)
    v_mfma_f32_32x32x16_bf16 v[64:79], v[40:43], v[32:35], v[64:79]
    ds_read_b128 v[48:51], v7 offset:3072
    ds_read_b128 v[52:55], v7 offset:7168
    buffer_load_dwordx4 v162, s[8:11], s33 offen offset:2048 lds
    v_mfma_f32_32x32x16_bf16 v[96:111], v[40:43], v[36:39], v[96:111]
    ds_read_b64_tr_b16 v[56:57], v12 offset:12288
    ds_read_b64_tr_b16 v[58:59], v12 offset:14336
    v_mfma_f32_32x32x16_bf16 v[80:95], v[44:47], v[32:35], v[80:95]
    ds_read_b64_tr_b16 v[60:61], v13 offset:12288
    ds_read_b64_tr_b16 v[62:63], v13 offset:14336
    buffer_load_dwordx4 v163, s[8:11], s33 offen offset:3072 lds
    v_mfma_f32_32x32x16_bf16 v[112:127], v[44:47], v[36:39], v[112:127]
    s_waitcnt lgkmcnt(0)
    s_waitcnt vmcnt(24)
    s_barrier
    v_mfma_f32_32x32x16_bf16 v[64:79], v[56:59], v[48:51], v[64:79]
    ds_read_b128 v[32:35], v7 offset:32768
    ds_read_b128 v[36:39], v7 offset:36864
    s_add_u32 m0, s42, 65536
    s_add_u32 s33, s38, 36864
    buffer_load_dwordx4 v1, s[24:27], s33 offen offset:0 sc1 lds
    v_mfma_f32_32x32x16_bf16 v[96:111], v[56:59], v[52:55], v[96:111]
    ds_read_b64_tr_b16 v[40:41], v12 offset:32768
    ds_read_b64_tr_b16 v[42:43], v12 offset:34816
    v_mfma_f32_32x32x16_bf16 v[80:95], v[60:63], v[48:51], v[80:95]
    ds_read_b64_tr_b16 v[44:45], v13 offset:32768
    ds_read_b64_tr_b16 v[46:47], v13 offset:34816
    buffer_load_dwordx4 v1, s[24:27], s33 offen offset:1024 sc1 lds
    v_mfma_f32_32x32x16_bf16 v[112:127], v[60:63], v[52:55], v[112:127]
    s_waitcnt lgkmcnt(0)
    v_mfma_f32_32x32x16_bf16 v[64:79], v[40:43], v[32:35], v[64:79]
    ds_read_b128 v[48:51], v7 offset:33792
    ds_read_b128 v[52:55], v7 offset:37888
    buffer_load_dwordx4 v1, s[24:27], s33 offen offset:2048 sc1 lds
    v_mfma_f32_32x32x16_bf16 v[96:111], v[40:43], v[36:39], v[96:111]
    ds_read_b64_tr_b16 v[56:57], v12 offset:36864
    ds_read_b64_tr_b16 v[58:59], v12 offset:38912
    v_mfma_f32_32x32x16_bf16 v[80:95], v[44:47], v[32:35], v[80:95]
    ds_read_b64_tr_b16 v[60:61], v13 offset:36864
    ds_read_b64_tr_b16 v[62:63], v13 offset:38912
    buffer_load_dwordx4 v1, s[24:27], s33 offen offset:3072 sc1 lds
    v_mfma_f32_32x32x16_bf16 v[112:127], v[44:47], v[36:39], v[112:127]
    s_waitcnt lgkmcnt(0)
    v_mfma_f32_32x32x16_bf16 v[64:79], v[56:59], v[48:51], v[64:79]
    ds_read_b128 v[32:35], v7 offset:34816
    ds_read_b128 v[36:39], v7 offset:38912
    s_add_u32 m0, s42, 81920
    s_add_u32 s33, s40, 589824
    buffer_load_dwordx4 v160, s[8:11], s33 offen offset:0 lds
    v_mfma_f32_32x32x16_bf16 v[96:111], v[56:59], v[52:55], v[96:111]
    ds_read_b64_tr_b16 v[40:41], v12 offset:40960
    ds_read_b64_tr_b16 v[42:43], v12 offset:43008
    v_mfma_f32_32x32x16_bf16 v[80:95], v[60:63], v[48:51], v[80:95]
    ds_read_b64_tr_b16 v[44:45], v13 offset:40960
    ds_read_b64_tr_b16 v[46:47], v13 offset:43008
    buffer_load_dwordx4 v161, s[8:11], s33 offen offset:1024 lds
    v_mfma_f32_32x32x16_bf16 v[112:127], v[60:63], v[52:55], v[112:127]
    s_waitcnt lgkmcnt(0)
    v_mfma_f32_32x32x16_bf16 v[64:79], v[40:43], v[32:35], v[64:79]
    ds_read_b128 v[48:51], v7 offset:35840
    ds_read_b128 v[52:55], v7 offset:39936
    buffer_load_dwordx4 v162, s[8:11], s33 offen offset:2048 lds
    v_mfma_f32_32x32x16_bf16 v[96:111], v[40:43], v[36:39], v[96:111]
    ds_read_b64_tr_b16 v[56:57], v12 offset:45056
    ds_read_b64_tr_b16 v[58:59], v12 offset:47104
    v_mfma_f32_32x32x16_bf16 v[80:95], v[44:47], v[32:35], v[80:95]
    ds_read_b64_tr_b16 v[60:61], v13 offset:45056
    ds_read_b64_tr_b16 v[62:63], v13 offset:47104
    buffer_load_dwordx4 v163, s[8:11], s33 offen offset:3072 lds
    v_mfma_f32_32x32x16_bf16 v[112:127], v[44:47], v[36:39], v[112:127]
    s_waitcnt lgkmcnt(0)
    s_waitcnt vmcnt(24)
    s_barrier
    v_mfma_f32_32x32x16_bf16 v[64:79], v[56:59], v[48:51], v[64:79]
    ds_read_b128 v[32:35], v8 offset:0
    ds_read_b128 v[36:39], v8 offset:4096
    s_add_u32 m0, s42, 98304
    s_add_u32 s33, s38, 40960
    buffer_load_dwordx4 v1, s[24:27], s33 offen offset:0 sc1 lds
    v_mfma_f32_32x32x16_bf16 v[96:111], v[56:59], v[52:55], v[96:111]
    ds_read_b64_tr_b16 v[40:41], v14 offset:0
    ds_read_b64_tr_b16 v[42:43], v14 offset:2048
    v_mfma_f32_32x32x16_bf16 v[80:95], v[60:63], v[48:51], v[80:95]
    ds_read_b64_tr_b16 v[44:45], v15 offset:0
    ds_read_b64_tr_b16 v[46:47], v15 offset:2048
    buffer_load_dwordx4 v1, s[24:27], s33 offen offset:1024 sc1 lds
    v_mfma_f32_32x32x16_bf16 v[112:127], v[60:63], v[52:55], v[112:127]
    s_waitcnt lgkmcnt(0)
    v_mfma_f32_32x32x16_bf16 v[64:79], v[40:43], v[32:35], v[64:79]
    ds_read_b128 v[48:51], v8 offset:1024
    ds_read_b128 v[52:55], v8 offset:5120
    buffer_load_dwordx4 v1, s[24:27], s33 offen offset:2048 sc1 lds
    v_mfma_f32_32x32x16_bf16 v[96:111], v[40:43], v[36:39], v[96:111]
    ds_read_b64_tr_b16 v[56:57], v14 offset:4096
    ds_read_b64_tr_b16 v[58:59], v14 offset:6144
    v_mfma_f32_32x32x16_bf16 v[80:95], v[44:47], v[32:35], v[80:95]
    ds_read_b64_tr_b16 v[60:61], v15 offset:4096
    ds_read_b64_tr_b16 v[62:63], v15 offset:6144
    buffer_load_dwordx4 v1, s[24:27], s33 offen offset:3072 sc1 lds
    v_mfma_f32_32x32x16_bf16 v[112:127], v[44:47], v[36:39], v[112:127]
    s_waitcnt lgkmcnt(0)
    v_mfma_f32_32x32x16_bf16 v[64:79], v[56:59], v[48:51], v[64:79]
    ds_read_b128 v[32:35], v8 offset:2048
    ds_read_b128 v[36:39], v8 offset:6144
    s_add_u32 m0, s42, 114688
    s_add_u32 s33, s40, 655360
    buffer_load_dwordx4 v160, s[8:11], s33 offen offset:0 lds
    v_mfma_f32_32x32x16_bf16 v[96:111], v[56:59], v[52:55], v[96:111]
    ds_read_b64_tr_b16 v[40:41], v14 offset:8192
    ds_read_b64_tr_b16 v[42:43], v14 offset:10240
    v_mfma_f32_32x32x16_bf16 v[80:95], v[60:63], v[48:51], v[80:95]
    ds_read_b64_tr_b16 v[44:45], v15 offset:8192
    ds_read_b64_tr_b16 v[46:47], v15 offset:10240
    buffer_load_dwordx4 v161, s[8:11], s33 offen offset:1024 lds
    v_mfma_f32_32x32x16_bf16 v[112:127], v[60:63], v[52:55], v[112:127]
    s_waitcnt lgkmcnt(0)
    v_mfma_f32_32x32x16_bf16 v[64:79], v[40:43], v[32:35], v[64:79]
    ds_read_b128 v[48:51], v8 offset:3072
    ds_read_b128 v[52:55], v8 offset:7168
    buffer_load_dwordx4 v162, s[8:11], s33 offen offset:2048 lds
    v_mfma_f32_32x32x16_bf16 v[96:111], v[40:43], v[36:39], v[96:111]
    ds_read_b64_tr_b16 v[56:57], v14 offset:12288
    ds_read_b64_tr_b16 v[58:59], v14 offset:14336
    v_mfma_f32_32x32x16_bf16 v[80:95], v[44:47], v[32:35], v[80:95]
    ds_read_b64_tr_b16 v[60:61], v15 offset:12288
    ds_read_b64_tr_b16 v[62:63], v15 offset:14336
    buffer_load_dwordx4 v163, s[8:11], s33 offen offset:3072 lds
    v_mfma_f32_32x32x16_bf16 v[112:127], v[44:47], v[36:39], v[112:127]
    s_waitcnt lgkmcnt(0)
    s_waitcnt vmcnt(24)
    s_barrier
    v_mfma_f32_32x32x16_bf16 v[64:79], v[56:59], v[48:51], v[64:79]
    ds_read_b128 v[32:35], v6 offset:0
    ds_read_b128 v[36:39], v6 offset:4096
    s_add_u32 m0, s42, 131072
    s_add_u32 s33, s38, 45056
    buffer_load_dwordx4 v1, s[24:27], s33 offen offset:0 sc1 lds
    v_mfma_f32_32x32x16_bf16 v[96:111], v[56:59], v[52:55], v[96:111]
    ds_read_b64_tr_b16 v[40:41], v10 offset:0
    ds_read_b64_tr_b16 v[42:43], v10 offset:2048
    v_mfma_f32_32x32x16_bf16 v[80:95], v[60:63], v[48:51], v[80:95]
    ds_read_b64_tr_b16 v[44:45], v11 offset:0
    ds_read_b64_tr_b16 v[46:47], v11 offset:2048
    buffer_load_dwordx4 v1, s[24:27], s33 offen offset:1024 sc1 lds
    v_mfma_f32_32x32x16_bf16 v[112:127], v[60:63], v[52:55], v[112:127]
    s_waitcnt lgkmcnt(0)
    v_mfma_f32_32x32x16_bf16 v[64:79], v[40:43], v[32:35], v[64:79]
    ds_read_b128 v[48:51], v6 offset:1024
    ds_read_b128 v[52:55], v6 offset:5120
    buffer_load_dwordx4 v1, s[24:27], s33 offen offset:2048 sc1 lds
    v_mfma_f32_32x32x16_bf16 v[96:111], v[40:43], v[36:39], v[96:111]
    ds_read_b64_tr_b16 v[56:57], v10 offset:4096
    ds_read_b64_tr_b16 v[58:59], v10 offset:6144
    v_mfma_f32_32x32x16_bf16 v[80:95], v[44:47], v[32:35], v[80:95]
    ds_read_b64_tr_b16 v[60:61], v11 offset:4096
    ds_read_b64_tr_b16 v[62:63], v11 offset:6144
    buffer_load_dwordx4 v1, s[24:27], s33 offen offset:3072 sc1 lds
    v_mfma_f32_32x32x16_bf16 v[112:127], v[44:47], v[36:39], v[112:127]
    s_waitcnt lgkmcnt(0)
    v_mfma_f32_32x32x16_bf16 v[64:79], v[56:59], v[48:51], v[64:79]
    ds_read_b128 v[32:35], v6 offset:2048
    ds_read_b128 v[36:39], v6 offset:6144
    s_add_u32 m0, s42, 147456
    s_add_u32 s33, s40, 720896
    buffer_load_dwordx4 v160, s[8:11], s33 offen offset:0 lds
    v_mfma_f32_32x32x16_bf16 v[96:111], v[56:59], v[52:55], v[96:111]
    ds_read_b64_tr_b16 v[40:41], v10 offset:8192
    ds_read_b64_tr_b16 v[42:43], v10 offset:10240
    v_mfma_f32_32x32x16_bf16 v[80:95], v[60:63], v[48:51], v[80:95]
    ds_read_b64_tr_b16 v[44:45], v11 offset:8192
    ds_read_b64_tr_b16 v[46:47], v11 offset:10240
    buffer_load_dwordx4 v161, s[8:11], s33 offen offset:1024 lds
    v_mfma_f32_32x32x16_bf16 v[112:127], v[60:63], v[52:55], v[112:127]
    s_waitcnt lgkmcnt(0)
    v_mfma_f32_32x32x16_bf16 v[64:79], v[40:43], v[32:35], v[64:79]
    ds_read_b128 v[48:51], v6 offset:3072
    ds_read_b128 v[52:55], v6 offset:7168
    buffer_load_dwordx4 v162, s[8:11], s33 offen offset:2048 lds
    v_mfma_f32_32x32x16_bf16 v[96:111], v[40:43], v[36:39], v[96:111]
    ds_read_b64_tr_b16 v[56:57], v10 offset:12288
    ds_read_b64_tr_b16 v[58:59], v10 offset:14336
    v_mfma_f32_32x32x16_bf16 v[80:95], v[44:47], v[32:35], v[80:95]
    ds_read_b64_tr_b16 v[60:61], v11 offset:12288
    ds_read_b64_tr_b16 v[62:63], v11 offset:14336
    buffer_load_dwordx4 v163, s[8:11], s33 offen offset:3072 lds
    v_mfma_f32_32x32x16_bf16 v[112:127], v[44:47], v[36:39], v[112:127]
    s_waitcnt lgkmcnt(0)
    s_waitcnt vmcnt(24)
    s_barrier
    s_lshl_b32 s51, s35, 8
    s_lshl_b32 s52, s37, 5
    s_add_u32 s51, s51, s52
    s_add_u32 s51, s51, 42606592
    s_cmp_lg_u32 s32, 0
    s_cbranch_scc1 L_W0_28
    v_and_b32 v140, 1, v0
    v_lshlrev_b32 v140, 7, v140
    v_and_b32 v141, 2, v0
    v_lshl_add_u32 v140, v141, 3, v140
    buffer_load_ubyte v141, v140, s[24:27], s51 offen sc0 sc1
L_W0_28:
    v_mfma_f32_32x32x16_bf16 v[64:79], v[56:59], v[48:51], v[64:79]
    ds_read_b128 v[32:35], v6 offset:32768
    ds_read_b128 v[36:39], v6 offset:36864
    s_add_u32 m0, s42, 0
    s_add_u32 s33, s38, 49152
    buffer_load_dwordx4 v1, s[24:27], s33 offen offset:0 sc1 lds
    v_mfma_f32_32x32x16_bf16 v[96:111], v[56:59], v[52:55], v[96:111]
    ds_read_b64_tr_b16 v[40:41], v10 offset:32768
    ds_read_b64_tr_b16 v[42:43], v10 offset:34816
    v_mfma_f32_32x32x16_bf16 v[80:95], v[60:63], v[48:51], v[80:95]
    ds_read_b64_tr_b16 v[44:45], v11 offset:32768
    ds_read_b64_tr_b16 v[46:47], v11 offset:34816
    buffer_load_dwordx4 v1, s[24:27], s33 offen offset:1024 sc1 lds
    v_mfma_f32_32x32x16_bf16 v[112:127], v[60:63], v[52:55], v[112:127]
    s_waitcnt lgkmcnt(0)
    v_mfma_f32_32x32x16_bf16 v[64:79], v[40:43], v[32:35], v[64:79]
    ds_read_b128 v[48:51], v6 offset:33792
    ds_read_b128 v[52:55], v6 offset:37888
    buffer_load_dwordx4 v1, s[24:27], s33 offen offset:2048 sc1 lds
    v_mfma_f32_32x32x16_bf16 v[96:111], v[40:43], v[36:39], v[96:111]
    ds_read_b64_tr_b16 v[56:57], v10 offset:36864
    ds_read_b64_tr_b16 v[58:59], v10 offset:38912
    v_mfma_f32_32x32x16_bf16 v[80:95], v[44:47], v[32:35], v[80:95]
    ds_read_b64_tr_b16 v[60:61], v11 offset:36864
    ds_read_b64_tr_b16 v[62:63], v11 offset:38912
    buffer_load_dwordx4 v1, s[24:27], s33 offen offset:3072 sc1 lds
    v_mfma_f32_32x32x16_bf16 v[112:127], v[44:47], v[36:39], v[112:127]
    s_waitcnt lgkmcnt(0)
    v_mfma_f32_32x32x16_bf16 v[64:79], v[56:59], v[48:51], v[64:79]
    ds_read_b128 v[32:35], v6 offset:34816
    ds_read_b128 v[36:39], v6 offset:38912
    s_add_u32 m0, s42, 16384
    s_add_u32 s33, s40, 786432
    buffer_load_dwordx4 v160, s[8:11], s33 offen offset:0 lds
    v_mfma_f32_32x32x16_bf16 v[96:111], v[56:59], v[52:55], v[96:111]
    ds_read_b64_tr_b16 v[40:41], v10 offset:40960
    ds_read_b64_tr_b16 v[42:43], v10 offset:43008
    v_mfma_f32_32x32x16_bf16 v[80:95], v[60:63], v[48:51], v[80:95]
    ds_read_b64_tr_b16 v[44:45], v11 offset:40960
    ds_read_b64_tr_b16 v[46:47], v11 offset:43008
    buffer_load_dwordx4 v161, s[8:11], s33 offen offset:1024 lds
    v_mfma_f32_32x32x16_bf16 v[112:127], v[60:63], v[52:55], v[112:127]
    s_waitcnt lgkmcnt(0)
    v_mfma_f32_32x32x16_bf16 v[64:79], v[40:43], v[32:35], v[64:79]
    ds_read_b128 v[48:51], v6 offset:35840
    ds_read_b128 v[52:55], v6 offset:39936
    buffer_load_dwordx4 v162, s[8:11], s33 offen offset:2048 lds
    v_mfma_f32_32x32x16_bf16 v[96:111], v[40:43], v[36:39], v[96:111]
    ds_read_b64_tr_b16 v[56:57], v10 offset:45056
    ds_read_b64_tr_b16 v[58:59], v10 offset:47104
    v_mfma_f32_32x32x16_bf16 v[80:95], v[44:47], v[32:35], v[80:95]
    ds_read_b64_tr_b16 v[60:61], v11 offset:45056
    ds_read_b64_tr_b16 v[62:63], v11 offset:47104
    buffer_load_dwordx4 v163, s[8:11], s33 offen offset:3072 lds
    v_mfma_f32_32x32x16_bf16 v[112:127], v[44:47], v[36:39], v[112:127]
    s_waitcnt lgkmcnt(0)
    s_waitcnt vmcnt(24)
    s_barrier
    v_mfma_f32_32x32x16_bf16 v[64:79], v[56:59], v[48:51], v[64:79]
    ds_read_b128 v[32:35], v7 offset:0
    ds_read_b128 v[36:39], v7 offset:4096
    s_add_u32 m0, s42, 32768
    s_add_u32 s33, s38, 53248
    buffer_load_dwordx4 v1, s[24:27], s33 offen offset:0 sc1 lds
    v_mfma_f32_32x32x16_bf16 v[96:111], v[56:59], v[52:55], v[96:111]
    ds_read_b64_tr_b16 v[40:41], v12 offset:0
    ds_read_b64_tr_b16 v[42:43], v12 offset:2048
    v_mfma_f32_32x32x16_bf16 v[80:95], v[60:63], v[48:51], v[80:95]
    ds_read_b64_tr_b16 v[44:45], v13 offset:0
    ds_read_b64_tr_b16 v[46:47], v13 offset:2048
    buffer_load_dwordx4 v1, s[24:27], s33 offen offset:1024 sc1 lds
    v_mfma_f32_32x32x16_bf16 v[112:127], v[60:63], v[52:55], v[112:127]
    s_waitcnt lgkmcnt(0)
    v_mfma_f32_32x32x16_bf16 v[64:79], v[40:43], v[32:35], v[64:79]
    ds_read_b128 v[48:51], v7 offset:1024
    ds_read_b128 v[52:55], v7 offset:5120
    buffer_load_dwordx4 v1, s[24:27], s33 offen offset:2048 sc1 lds
    v_mfma_f32_32x32x16_bf16 v[96:111], v[40:43], v[36:39], v[96:111]
    ds_read_b64_tr_b16 v[56:57], v12 offset:4096
    ds_read_b64_tr_b16 v[58:59], v12 offset:6144
    v_mfma_f32_32x32x16_bf16 v[80:95], v[44:47], v[32:35], v[80:95]
    ds_read_b64_tr_b16 v[60:61], v13 offset:4096
    ds_read_b64_tr_b16 v[62:63], v13 offset:6144
    buffer_load_dwordx4 v1, s[24:27], s33 offen offset:3072 sc1 lds
    v_mfma_f32_32x32x16_bf16 v[112:127], v[44:47], v[36:39], v[112:127]
    s_waitcnt lgkmcnt(0)
    v_mfma_f32_32x32x16_bf16 v[64:79], v[56:59], v[48:51], v[64:79]
    ds_read_b128 v[32:35], v7 offset:2048
    ds_read_b128 v[36:39], v7 offset:6144
    s_add_u32 m0, s42, 49152
    s_add_u32 s33, s40, 851968
    buffer_load_dwordx4 v160, s[8:11], s33 offen offset:0 lds
    v_mfma_f32_32x32x16_bf16 v[96:111], v[56:59], v[52:55], v[96:111]
    ds_read_b64_tr_b16 v[40:41], v12 offset:8192
    ds_read_b64_tr_b16 v[42:43], v12 offset:10240
    v_mfma_f32_32x32x16_bf16 v[80:95], v[60:63], v[48:51], v[80:95]
    ds_read_b64_tr_b16 v[44:45], v13 offset:8192
    ds_read_b64_tr_b16 v[46:47], v13 offset:10240
    buffer_load_dwordx4 v161, s[8:11], s33 offen offset:1024 lds
    v_mfma_f32_32x32x16_bf16 v[112:127], v[60:63], v[52:55], v[112:127]
    s_waitcnt lgkmcnt(0)
    v_mfma_f32_32x32x16_bf16 v[64:79], v[40:43], v[32:35], v[64:79]
    ds_read_b128 v[48:51], v7 offset:3072
    ds_read_b128 v[52:55], v7 offset:7168
    buffer_load_dwordx4 v162, s[8:11], s33 offen offset:2048 lds
    v_mfma_f32_32x32x16_bf16 v[96:111], v[40:43], v[36:39], v[96:111]
    ds_read_b64_tr_b16 v[56:57], v12 offset:12288
    ds_read_b64_tr_b16 v[58:59], v12 offset:14336
    v_mfma_f32_32x32x16_bf16 v[80:95], v[44:47], v[32:35], v[80:95]
    ds_read_b64_tr_b16 v[60:61], v13 offset:12288
    ds_read_b64_tr_b16 v[62:63], v13 offset:14336
    buffer_load_dwordx4 v163, s[8:11], s33 offen offset:3072 lds
    v_mfma_f32_32x32x16_bf16 v[112:127], v[44:47], v[36:39], v[112:127]
    s_waitcnt lgkmcnt(0)
    s_waitcnt vmcnt(24)
    s_barrier
    v_mfma_f32_32x32x16_bf16 v[64:79], v[56:59], v[48:51], v[64:79]
    ds_read_b128 v[32:35], v7 offset:32768
    ds_read_b128 v[36:39], v7 offset:36864
    s_add_u32 m0, s42, 65536
    s_add_u32 s33, s38, 57344
    buffer_load_dwordx4 v1, s[24:27], s33 offen offset:0 sc1 lds
    v_mfma_f32_32x32x16_bf16 v[96:111], v[56:59], v[52:55], v[96:111]
    ds_read_b64_tr_b16 v[40:41], v12 offset:32768
    ds_read_b64_tr_b16 v[42:43], v12 offset:34816
    v_mfma_f32_32x32x16_bf16 v[80:95], v[60:63], v[48:51], v[80:95]
    ds_read_b64_tr_b16 v[44:45], v13 offset:32768
    ds_read_b64_tr_b16 v[46:47], v13 offset:34816
    buffer_load_dwordx4 v1, s[24:27], s33 offen offset:1024 sc1 lds
    v_mfma_f32_32x32x16_bf16 v[112:127], v[60:63], v[52:55], v[112:127]
    s_waitcnt lgkmcnt(0)
    v_mfma_f32_32x32x16_bf16 v[64:79], v[40:43], v[32:35], v[64:79]
    ds_read_b128 v[48:51], v7 offset:33792
    ds_read_b128 v[52:55], v7 offset:37888
    buffer_load_dwordx4 v1, s[24:27], s33 offen offset:2048 sc1 lds
    v_mfma_f32_32x32x16_bf16 v[96:111], v[40:43], v[36:39], v[96:111]
    ds_read_b64_tr_b16 v[56:57], v12 offset:36864
    ds_read_b64_tr_b16 v[58:59], v12 offset:38912
    v_mfma_f32_32x32x16_bf16 v[80:95], v[44:47], v[32:35], v[80:95]
    ds_read_b64_tr_b16 v[60:61], v13 offset:36864
    ds_read_b64_tr_b16 v[62:63], v13 offset:38912
    buffer_load_dwordx4 v1, s[24:27], s33 offen offset:3072 sc1 lds
    v_mfma_f32_32x32x16_bf16 v[112:127], v[44:47], v[36:39], v[112:127]
    s_waitcnt lgkmcnt(0)
    v_mfma_f32_32x32x16_bf16 v[64:79], v[56:59], v[48:51], v[64:79]
    ds_read_b128 v[32:35], v7 offset:34816
    ds_read_b128 v[36:39], v7 offset:38912
    s_add_u32 m0, s42, 81920
    s_add_u32 s33, s40, 917504
    buffer_load_dwordx4 v160, s[8:11], s33 offen offset:0 lds
    v_mfma_f32_32x32x16_bf16 v[96:111], v[56:59], v[52:55], v[96:111]
    ds_read_b64_tr_b16 v[40:41], v12 offset:40960
    ds_read_b64_tr_b16 v[42:43], v12 offset:43008
    v_mfma_f32_32x32x16_bf16 v[80:95], v[60:63], v[48:51], v[80:95]
    ds_read_b64_tr_b16 v[44:45], v13 offset:40960
    ds_read_b64_tr_b16 v[46:47], v13 offset:43008
    buffer_load_dwordx4 v161, s[8:11], s33 offen offset:1024 lds
    v_mfma_f32_32x32x16_bf16 v[112:127], v[60:63], v[52:55], v[112:127]
    s_waitcnt lgkmcnt(0)
    v_mfma_f32_32x32x16_bf16 v[64:79], v[40:43], v[32:35], v[64:79]
    ds_read_b128 v[48:51], v7 offset:35840
    ds_read_b128 v[52:55], v7 offset:39936
    buffer_load_dwordx4 v162, s[8:11], s33 offen offset:2048 lds
    v_mfma_f32_32x32x16_bf16 v[96:111], v[40:43], v[36:39], v[96:111]
    ds_read_b64_tr_b16 v[56:57], v12 offset:45056
    ds_read_b64_tr_b16 v[58:59], v12 offset:47104
    v_mfma_f32_32x32x16_bf16 v[80:95], v[44:47], v[32:35], v[80:95]
    ds_read_b64_tr_b16 v[60:61], v13 offset:45056
    ds_read_b64_tr_b16 v[62:63], v13 offset:47104
    buffer_load_dwordx4 v163, s[8:11], s33 offen offset:3072 lds
    v_mfma_f32_32x32x16_bf16 v[112:127], v[44:47], v[36:39], v[112:127]
    s_waitcnt lgkmcnt(0)
    s_waitcnt vmcnt(24)
    s_cmp_lg_u32 s32, 0
    s_cbranch_scc1 L_W0_30
    s_waitcnt vmcnt(24)
    v_cmp_ne_u32 vcc, 1, v141
    s_nop 1
    s_cbranch_vccz L_POK_29
L_PLP_29:
    s_sleep 2
    buffer_load_ubyte v141, v140, s[24:27], s51 offen sc0 sc1
    s_waitcnt vmcnt(0)
    v_cmp_ne_u32 vcc, 1, v141
    s_nop 1
    s_cbranch_vccnz L_PLP_29
L_POK_29:
L_W0_30:
    s_barrier
    v_mfma_f32_32x32x16_bf16 v[64:79], v[56:59], v[48:51], v[64:79]
    ds_read_b128 v[32:35], v8 offset:0
    ds_read_b128 v[36:39], v8 offset:4096
    s_add_u32 m0, s42, 98304
    s_add_u32 s33, s38, 61440
    buffer_load_dwordx4 v1, s[24:27], s33 offen offset:0 sc1 lds
    v_mfma_f32_32x32x16_bf16 v[96:111], v[56:59], v[52:55], v[96:111]
    ds_read_b64_tr_b16 v[40:41], v14 offset:0
    ds_read_b64_tr_b16 v[42:43], v14 offset:2048
    v_mfma_f32_32x32x16_bf16 v[80:95], v[60:63], v[48:51], v[80:95]
    ds_read_b64_tr_b16 v[44:45], v15 offset:0
    ds_read_b64_tr_b16 v[46:47], v15 offset:2048
    buffer_load_dwordx4 v1, s[24:27], s33 offen offset:1024 sc1 lds
    v_mfma_f32_32x32x16_bf16 v[112:127], v[60:63], v[52:55], v[112:127]
    s_waitcnt lgkmcnt(0)
    v_mfma_f32_32x32x16_bf16 v[64:79], v[40:43], v[32:35], v[64:79]
    ds_read_b128 v[48:51], v8 offset:1024
    ds_read_b128 v[52:55], v8 offset:5120
    buffer_load_dwordx4 v1, s[24:27], s33 offen offset:2048 sc1 lds
    v_mfma_f32_32x32x16_bf16 v[96:111], v[40:43], v[36:39], v[96:111]
    ds_read_b64_tr_b16 v[56:57], v14 offset:4096
    ds_read_b64_tr_b16 v[58:59], v14 offset:6144
    v_mfma_f32_32x32x16_bf16 v[80:95], v[44:47], v[32:35], v[80:95]
    ds_read_b64_tr_b16 v[60:61], v15 offset:4096
    ds_read_b64_tr_b16 v[62:63], v15 offset:6144
    buffer_load_dwordx4 v1, s[24:27], s33 offen offset:3072 sc1 lds
    v_mfma_f32_32x32x16_bf16 v[112:127], v[44:47], v[36:39], v[112:127]
    s_waitcnt lgkmcnt(0)
    v_mfma_f32_32x32x16_bf16 v[64:79], v[56:59], v[48:51], v[64:79]
    ds_read_b128 v[32:35], v8 offset:2048
    ds_read_b128 v[36:39], v8 offset:6144
    s_add_u32 m0, s42, 114688
    s_add_u32 s33, s40, 983040
    buffer_load_dwordx4 v160, s[8:11], s33 offen offset:0 lds
    v_mfma_f32_32x32x16_bf16 v[96:111], v[56:59], v[52:55], v[96:111]
    ds_read_b64_tr_b16 v[40:41], v14 offset:8192
    ds_read_b64_tr_b16 v[42:43], v14 offset:10240
    v_mfma_f32_32x32x16_bf16 v[80:95], v[60:63], v[48:51], v[80:95]
    ds_read_b64_tr_b16 v[44:45], v15 offset:8192
    ds_read_b64_tr_b16 v[46:47], v15 offset:10240
    buffer_load_dwordx4 v161, s[8:11], s33 offen offset:1024 lds
    v_mfma_f32_32x32x16_bf16 v[112:127], v[60:63], v[52:55], v[112:127]
    s_waitcnt lgkmcnt(0)
    v_mfma_f32_32x32x16_bf16 v[64:79], v[40:43], v[32:35], v[64:79]
    ds_read_b128 v[48:51], v8 offset:3072
    ds_read_b128 v[52:55], v8 offset:7168
    buffer_load_dwordx4 v162, s[8:11], s33 offen offset:2048 lds
    v_mfma_f32_32x32x16_bf16 v[96:111], v[40:43], v[36:39], v[96:111]
    ds_read_b64_tr_b16 v[56:57], v14 offset:12288
    ds_read_b64_tr_b16 v[58:59], v14 offset:14336
    v_mfma_f32_32x32x16_bf16 v[80:95], v[44:47], v[32:35], v[80:95]
    ds_read_b64_tr_b16 v[60:61], v15 offset:12288
    ds_read_b64_tr_b16 v[62:63], v15 offset:14336
    buffer_load_dwordx4 v163, s[8:11], s33 offen offset:3072 lds
    v_mfma_f32_32x32x16_bf16 v[112:127], v[44:47], v[36:39], v[112:127]
    s_waitcnt lgkmcnt(0)
    s_waitcnt vmcnt(24)
    s_barrier
    v_mfma_f32_32x32x16_bf16 v[64:79], v[56:59], v[48:51], v[64:79]
    ds_read_b128 v[32:35], v6 offset:0
    ds_read_b128 v[36:39], v6 offset:4096
    s_add_u32 m0, s42, 131072
    s_add_u32 s33, s39, 0
    buffer_load_dwordx4 v1, s[24:27], s33 offen offset:0 sc1 lds
    v_mfma_f32_32x32x16_bf16 v[96:111], v[56:59], v[52:55], v[96:111]
    ds_read_b64_tr_b16 v[40:41], v10 offset:0
    ds_read_b64_tr_b16 v[42:43], v10 offset:2048
    v_mfma_f32_32x32x16_bf16 v[80:95], v[60:63], v[48:51], v[80:95]
    ds_read_b64_tr_b16 v[44:45], v11 offset:0
    ds_read_b64_tr_b16 v[46:47], v11 offset:2048
    buffer_load_dwordx4 v1, s[24:27], s33 offen offset:1024 sc1 lds
    v_mfma_f32_32x32x16_bf16 v[112:127], v[60:63], v[52:55], v[112:127]
    s_waitcnt lgkmcnt(0)
    v_mfma_f32_32x32x16_bf16 v[64:79], v[40:43], v[32:35], v[64:79]
    ds_read_b128 v[48:51], v6 offset:1024
    ds_read_b128 v[52:55], v6 offset:5120
    buffer_load_dwordx4 v1, s[24:27], s33 offen offset:2048 sc1 lds
    v_mfma_f32_32x32x16_bf16 v[96:111], v[40:43], v[36:39], v[96:111]
    ds_read_b64_tr_b16 v[56:57], v10 offset:4096
    ds_read_b64_tr_b16 v[58:59], v10 offset:6144
    v_mfma_f32_32x32x16_bf16 v[80:95], v[44:47], v[32:35], v[80:95]
    ds_read_b64_tr_b16 v[60:61], v11 offset:4096
    ds_read_b64_tr_b16 v[62:63], v11 offset:6144
    buffer_load_dwordx4 v1, s[24:27], s33 offen offset:3072 sc1 lds
    v_mfma_f32_32x32x16_bf16 v[112:127], v[44:47], v[36:39], v[112:127]
    s_waitcnt lgkmcnt(0)
    v_mfma_f32_32x32x16_bf16 v[64:79], v[56:59], v[48:51], v[64:79]
    ds_read_b128 v[32:35], v6 offset:2048
    ds_read_b128 v[36:39], v6 offset:6144
    s_add_u32 m0, s42, 147456
    s_add_u32 s33, s41, 0
    buffer_load_dwordx4 v160, s[12:15], s33 offen offset:0 lds
    v_mfma_f32_32x32x16_bf16 v[96:111], v[56:59], v[52:55], v[96:111]
    ds_read_b64_tr_b16 v[40:41], v10 offset:8192
    ds_read_b64_tr_b16 v[42:43], v10 offset:10240
    v_mfma_f32_32x32x16_bf16 v[80:95], v[60:63], v[48:51], v[80:95]
    ds_read_b64_tr_b16 v[44:45], v11 offset:8192
    ds_read_b64_tr_b16 v[46:47], v11 offset:10240
    buffer_load_dwordx4 v161, s[12:15], s33 offen offset:1024 lds
    v_mfma_f32_32x32x16_bf16 v[112:127], v[60:63], v[52:55], v[112:127]
    s_waitcnt lgkmcnt(0)
    v_mfma_f32_32x32x16_bf16 v[64:79], v[40:43], v[32:35], v[64:79]
    ds_read_b128 v[48:51], v6 offset:3072
    ds_read_b128 v[52:55], v6 offset:7168
    buffer_load_dwordx4 v162, s[12:15], s33 offen offset:2048 lds
    v_mfma_f32_32x32x16_bf16 v[96:111], v[40:43], v[36:39], v[96:111]
    ds_read_b64_tr_b16 v[56:57], v10 offset:12288
    ds_read_b64_tr_b16 v[58:59], v10 offset:14336
    v_mfma_f32_32x32x16_bf16 v[80:95], v[44:47], v[32:35], v[80:95]
    ds_read_b64_tr_b16 v[60:61], v11 offset:12288
    ds_read_b64_tr_b16 v[62:63], v11 offset:14336
    buffer_load_dwordx4 v163, s[12:15], s33 offen offset:3072 lds
    v_mfma_f32_32x32x16_bf16 v[112:127], v[44:47], v[36:39], v[112:127]
    s_waitcnt lgkmcnt(0)
    s_waitcnt vmcnt(24)
    s_barrier
    v_mfma_f32_32x32x16_bf16 v[64:79], v[56:59], v[48:51], v[64:79]
    ds_read_b128 v[32:35], v6 offset:32768
    ds_read_b128 v[36:39], v6 offset:36864
    s_add_u32 m0, s42, 0
    s_add_u32 s33, s39, 4096
    buffer_load_dwordx4 v1, s[24:27], s33 offen offset:0 sc1 lds
    v_mfma_f32_32x32x16_bf16 v[96:111], v[56:59], v[52:55], v[96:111]
    ds_read_b64_tr_b16 v[40:41], v10 offset:32768
    ds_read_b64_tr_b16 v[42:43], v10 offset:34816
    v_mfma_f32_32x32x16_bf16 v[80:95], v[60:63], v[48:51], v[80:95]
    ds_read_b64_tr_b16 v[44:45], v11 offset:32768
    ds_read_b64_tr_b16 v[46:47], v11 offset:34816
    buffer_load_dwordx4 v1, s[24:27], s33 offen offset:1024 sc1 lds
    v_mfma_f32_32x32x16_bf16 v[112:127], v[60:63], v[52:55], v[112:127]
    s_waitcnt lgkmcnt(0)
    v_mfma_f32_32x32x16_bf16 v[64:79], v[40:43], v[32:35], v[64:79]
    ds_read_b128 v[48:51], v6 offset:33792
    ds_read_b128 v[52:55], v6 offset:37888
    buffer_load_dwordx4 v1, s[24:27], s33 offen offset:2048 sc1 lds
    v_mfma_f32_32x32x16_bf16 v[96:111], v[40:43], v[36:39], v[96:111]
    ds_read_b64_tr_b16 v[56:57], v10 offset:36864
    ds_read_b64_tr_b16 v[58:59], v10 offset:38912
    v_mfma_f32_32x32x16_bf16 v[80:95], v[44:47], v[32:35], v[80:95]
    ds_read_b64_tr_b16 v[60:61], v11 offset:36864
    ds_read_b64_tr_b16 v[62:63], v11 offset:38912
    buffer_load_dwordx4 v1, s[24:27], s33 offen offset:3072 sc1 lds
    v_mfma_f32_32x32x16_bf16 v[112:127], v[44:47], v[36:39], v[112:127]
    s_waitcnt lgkmcnt(0)
    v_mfma_f32_32x32x16_bf16 v[64:79], v[56:59], v[48:51], v[64:79]
    ds_read_b128 v[32:35], v6 offset:34816
    ds_read_b128 v[36:39], v6 offset:38912
    s_add_u32 m0, s42, 16384
    s_add_u32 s33, s41, 65536
    buffer_load_dwordx4 v160, s[12:15], s33 offen offset:0 lds
    v_mfma_f32_32x32x16_bf16 v[96:111], v[56:59], v[52:55], v[96:111]
    ds_read_b64_tr_b16 v[40:41], v10 offset:40960
    ds_read_b64_tr_b16 v[42:43], v10 offset:43008
    v_mfma_f32_32x32x16_bf16 v[80:95], v[60:63], v[48:51], v[80:95]
    ds_read_b64_tr_b16 v[44:45], v11 offset:40960
    ds_read_b64_tr_b16 v[46:47], v11 offset:43008
    buffer_load_dwordx4 v161, s[12:15], s33 offen offset:1024 lds
    v_mfma_f32_32x32x16_bf16 v[112:127], v[60:63], v[52:55], v[112:127]
    s_waitcnt lgkmcnt(0)
    v_mfma_f32_32x32x16_bf16 v[64:79], v[40:43], v[32:35], v[64:79]
    ds_read_b128 v[48:51], v6 offset:35840
    ds_read_b128 v[52:55], v6 offset:39936
    buffer_load_dwordx4 v162, s[12:15], s33 offen offset:2048 lds
    v_mfma_f32_32x32x16_bf16 v[96:111], v[40:43], v[36:39], v[96:111]
    ds_read_b64_tr_b16 v[56:57], v10 offset:45056
    ds_read_b64_tr_b16 v[58:59], v10 offset:47104
    v_mfma_f32_32x32x16_bf16 v[80:95], v[44:47], v[32:35], v[80:95]
    ds_read_b64_tr_b16 v[60:61], v11 offset:45056
    ds_read_b64_tr_b16 v[62:63], v11 offset:47104
    buffer_load_dwordx4 v163, s[12:15], s33 offen offset:3072 lds
    v_mfma_f32_32x32x16_bf16 v[112:127], v[44:47], v[36:39], v[112:127]
    s_waitcnt lgkmcnt(0)
    s_waitcnt vmcnt(24)
    s_barrier
    v_mfma_f32_32x32x16_bf16 v[64:79], v[56:59], v[48:51], v[64:79]
    ds_read_b128 v[32:35], v7 offset:0
    ds_read_b128 v[36:39], v7 offset:4096
    s_add_u32 m0, s42, 32768
    s_add_u32 s33, s39, 8192
    buffer_load_dwordx4 v1, s[24:27], s33 offen offset:0 sc1 lds
    v_mfma_f32_32x32x16_bf16 v[96:111], v[56:59], v[52:55], v[96:111]
    ds_read_b64_tr_b16 v[40:41], v12 offset:0
    ds_read_b64_tr_b16 v[42:43], v12 offset:2048
    v_mfma_f32_32x32x16_bf16 v[80:95], v[60:63], v[48:51], v[80:95]
    ds_read_b64_tr_b16 v[44:45], v13 offset:0
    ds_read_b64_tr_b16 v[46:47], v13 offset:2048
    buffer_load_dwordx4 v1, s[24:27], s33 offen offset:1024 sc1 lds
    v_mfma_f32_32x32x16_bf16 v[112:127], v[60:63], v[52:55], v[112:127]
    s_waitcnt lgkmcnt(0)
    v_mfma_f32_32x32x16_bf16 v[64:79], v[40:43], v[32:35], v[64:79]
    ds_read_b128 v[48:51], v7 offset:1024
    ds_read_b128 v[52:55], v7 offset:5120
    buffer_load_dwordx4 v1, s[24:27], s33 offen offset:2048 sc1 lds
    v_mfma_f32_32x32x16_bf16 v[96:111], v[40:43], v[36:39], v[96:111]
    ds_read_b64_tr_b16 v[56:57], v12 offset:4096
    ds_read_b64_tr_b16 v[58:59], v12 offset:6144
    v_mfma_f32_32x32x16_bf16 v[80:95], v[44:47], v[32:35], v[80:95]
    ds_read_b64_tr_b16 v[60:61], v13 offset:4096
    ds_read_b64_tr_b16 v[62:63], v13 offset:6144
    buffer_load_dwordx4 v1, s[24:27], s33 offen offset:3072 sc1 lds
    v_mfma_f32_32x32x16_bf16 v[112:127], v[44:47], v[36:39], v[112:127]
    s_waitcnt lgkmcnt(0)
    v_mfma_f32_32x32x16_bf16 v[64:79], v[56:59], v[48:51], v[64:79]
    ds_read_b128 v[32:35], v7 offset:2048
    ds_read_b128 v[36:39], v7 offset:6144
    s_add_u32 m0, s42, 49152
    s_add_u32 s33, s41, 131072
    buffer_load_dwordx4 v160, s[12:15], s33 offen offset:0 lds
    v_mfma_f32_32x32x16_bf16 v[96:111], v[56:59], v[52:55], v[96:111]
    ds_read_b64_tr_b16 v[40:41], v12 offset:8192
    ds_read_b64_tr_b16 v[42:43], v12 offset:10240
    v_mfma_f32_32x32x16_bf16 v[80:95], v[60:63], v[48:51], v[80:95]
    ds_read_b64_tr_b16 v[44:45], v13 offset:8192
    ds_read_b64_tr_b16 v[46:47], v13 offset:10240
    buffer_load_dwordx4 v161, s[12:15], s33 offen offset:1024 lds
    v_mfma_f32_32x32x16_bf16 v[112:127], v[60:63], v[52:55], v[112:127]
    s_waitcnt lgkmcnt(0)
    v_mfma_f32_32x32x16_bf16 v[64:79], v[40:43], v[32:35], v[64:79]
    ds_read_b128 v[48:51], v7 offset:3072
    ds_read_b128 v[52:55], v7 offset:7168
    buffer_load_dwordx4 v162, s[12:15], s33 offen offset:2048 lds
    v_mfma_f32_32x32x16_bf16 v[96:111], v[40:43], v[36:39], v[96:111]
    ds_read_b64_tr_b16 v[56:57], v12 offset:12288
    ds_read_b64_tr_b16 v[58:59], v12 offset:14336
    v_mfma_f32_32x32x16_bf16 v[80:95], v[44:47], v[32:35], v[80:95]
    ds_read_b64_tr_b16 v[60:61], v13 offset:12288
    ds_read_b64_tr_b16 v[62:63], v13 offset:14336
    buffer_load_dwordx4 v163, s[12:15], s33 offen offset:3072 lds
    v_mfma_f32_32x32x16_bf16 v[112:127], v[44:47], v[36:39], v[112:127]
    s_waitcnt lgkmcnt(0)
    s_waitcnt vmcnt(24)
    s_barrier
    v_mfma_f32_32x32x16_bf16 v[64:79], v[56:59], v[48:51], v[64:79]
    ds_read_b128 v[32:35], v7 offset:32768
    ds_read_b128 v[36:39], v7 offset:36864
    v_mfma_f32_32x32x16_bf16 v[96:111], v[56:59], v[52:55], v[96:111]
    ds_read_b64_tr_b16 v[40:41], v12 offset:32768
    ds_read_b64_tr_b16 v[42:43], v12 offset:34816
    v_mfma_f32_32x32x16_bf16 v[80:95], v[60:63], v[48:51], v[80:95]
    ds_read_b64_tr_b16 v[44:45], v13 offset:32768
    ds_read_b64_tr_b16 v[46:47], v13 offset:34816
    v_mfma_f32_32x32x16_bf16 v[112:127], v[60:63], v[52:55], v[112:127]
    s_waitcnt lgkmcnt(0)
    v_mfma_f32_32x32x16_bf16 v[64:79], v[40:43], v[32:35], v[64:79]
    ds_read_b128 v[48:51], v7 offset:33792
    ds_read_b128 v[52:55], v7 offset:37888
    v_mfma_f32_32x32x16_bf16 v[96:111], v[40:43], v[36:39], v[96:111]
    ds_read_b64_tr_b16 v[56:57], v12 offset:36864
    ds_read_b64_tr_b16 v[58:59], v12 offset:38912
    v_mfma_f32_32x32x16_bf16 v[80:95], v[44:47], v[32:35], v[80:95]
    ds_read_b64_tr_b16 v[60:61], v13 offset:36864
    ds_read_b64_tr_b16 v[62:63], v13 offset:38912
    v_mfma_f32_32x32x16_bf16 v[112:127], v[44:47], v[36:39], v[112:127]
    s_waitcnt lgkmcnt(0)
    v_mfma_f32_32x32x16_bf16 v[64:79], v[56:59], v[48:51], v[64:79]
    ds_read_b128 v[32:35], v7 offset:34816
    ds_read_b128 v[36:39], v7 offset:38912
    v_mfma_f32_32x32x16_bf16 v[96:111], v[56:59], v[52:55], v[96:111]
    ds_read_b64_tr_b16 v[40:41], v12 offset:40960
    ds_read_b64_tr_b16 v[42:43], v12 offset:43008
    v_mfma_f32_32x32x16_bf16 v[80:95], v[60:63], v[48:51], v[80:95]
    ds_read_b64_tr_b16 v[44:45], v13 offset:40960
    ds_read_b64_tr_b16 v[46:47], v13 offset:43008
    v_mfma_f32_32x32x16_bf16 v[112:127], v[60:63], v[52:55], v[112:127]
    s_waitcnt lgkmcnt(0)
    v_mfma_f32_32x32x16_bf16 v[64:79], v[40:43], v[32:35], v[64:79]
    ds_read_b128 v[48:51], v7 offset:35840
    ds_read_b128 v[52:55], v7 offset:39936
    v_mfma_f32_32x32x16_bf16 v[96:111], v[40:43], v[36:39], v[96:111]
    ds_read_b64_tr_b16 v[56:57], v12 offset:45056
    ds_read_b64_tr_b16 v[58:59], v12 offset:47104
    v_mfma_f32_32x32x16_bf16 v[80:95], v[44:47], v[32:35], v[80:95]
    ds_read_b64_tr_b16 v[60:61], v13 offset:45056
    ds_read_b64_tr_b16 v[62:63], v13 offset:47104
    v_mfma_f32_32x32x16_bf16 v[112:127], v[44:47], v[36:39], v[112:127]
    s_waitcnt lgkmcnt(0)
    s_waitcnt vmcnt(16)
    s_barrier
    v_mfma_f32_32x32x16_bf16 v[64:79], v[56:59], v[48:51], v[64:79]
    ds_read_b128 v[32:35], v8 offset:0
    ds_read_b128 v[36:39], v8 offset:4096
    v_mfma_f32_32x32x16_bf16 v[96:111], v[56:59], v[52:55], v[96:111]
    ds_read_b64_tr_b16 v[40:41], v14 offset:0
    ds_read_b64_tr_b16 v[42:43], v14 offset:2048
    v_mfma_f32_32x32x16_bf16 v[80:95], v[60:63], v[48:51], v[80:95]
    ds_read_b64_tr_b16 v[44:45], v15 offset:0
    ds_read_b64_tr_b16 v[46:47], v15 offset:2048
    v_mfma_f32_32x32x16_bf16 v[112:127], v[60:63], v[52:55], v[112:127]
    s_waitcnt lgkmcnt(0)
    v_mfma_f32_32x32x16_bf16 v[64:79], v[40:43], v[32:35], v[64:79]
    ds_read_b128 v[48:51], v8 offset:1024
    ds_read_b128 v[52:55], v8 offset:5120
    v_mfma_f32_32x32x16_bf16 v[96:111], v[40:43], v[36:39], v[96:111]
    ds_read_b64_tr_b16 v[56:57], v14 offset:4096
    ds_read_b64_tr_b16 v[58:59], v14 offset:6144
    v_mfma_f32_32x32x16_bf16 v[80:95], v[44:47], v[32:35], v[80:95]
    ds_read_b64_tr_b16 v[60:61], v15 offset:4096
    ds_read_b64_tr_b16 v[62:63], v15 offset:6144
    v_mfma_f32_32x32x16_bf16 v[112:127], v[44:47], v[36:39], v[112:127]
    s_waitcnt lgkmcnt(0)
    v_mfma_f32_32x32x16_bf16 v[64:79], v[56:59], v[48:51], v[64:79]
    ds_read_b128 v[32:35], v8 offset:2048
    ds_read_b128 v[36:39], v8 offset:6144
    v_mfma_f32_32x32x16_bf16 v[96:111], v[56:59], v[52:55], v[96:111]
    ds_read_b64_tr_b16 v[40:41], v14 offset:8192
    ds_read_b64_tr_b16 v[42:43], v14 offset:10240
    v_mfma_f32_32x32x16_bf16 v[80:95], v[60:63], v[48:51], v[80:95]
    ds_read_b64_tr_b16 v[44:45], v15 offset:8192
    ds_read_b64_tr_b16 v[46:47], v15 offset:10240
    v_mfma_f32_32x32x16_bf16 v[112:127], v[60:63], v[52:55], v[112:127]
    s_waitcnt lgkmcnt(0)
    v_mfma_f32_32x32x16_bf16 v[64:79], v[40:43], v[32:35], v[64:79]
    ds_read_b128 v[48:51], v8 offset:3072
    ds_read_b128 v[52:55], v8 offset:7168
    v_mfma_f32_32x32x16_bf16 v[96:111], v[40:43], v[36:39], v[96:111]
    ds_read_b64_tr_b16 v[56:57], v14 offset:12288
    ds_read_b64_tr_b16 v[58:59], v14 offset:14336
    v_mfma_f32_32x32x16_bf16 v[80:95], v[44:47], v[32:35], v[80:95]
    ds_read_b64_tr_b16 v[60:61], v15 offset:12288
    ds_read_b64_tr_b16 v[62:63], v15 offset:14336
    v_mfma_f32_32x32x16_bf16 v[112:127], v[44:47], v[36:39], v[112:127]
    s_waitcnt lgkmcnt(0)
    s_waitcnt vmcnt(8)
    s_barrier
    v_mfma_f32_32x32x16_bf16 v[64:79], v[56:59], v[48:51], v[64:79]
    ds_read_b128 v[32:35], v6 offset:0
    ds_read_b128 v[36:39], v6 offset:4096
    v_mfma_f32_32x32x16_bf16 v[96:111], v[56:59], v[52:55], v[96:111]
    ds_read_b64_tr_b16 v[40:41], v10 offset:0
    ds_read_b64_tr_b16 v[42:43], v10 offset:2048
    v_mfma_f32_32x32x16_bf16 v[80:95], v[60:63], v[48:51], v[80:95]
    ds_read_b64_tr_b16 v[44:45], v11 offset:0
    ds_read_b64_tr_b16 v[46:47], v11 offset:2048
    v_mfma_f32_32x32x16_bf16 v[112:127], v[60:63], v[52:55], v[112:127]
    s_waitcnt lgkmcnt(0)
    v_mfma_f32_32x32x16_bf16 v[64:79], v[40:43], v[32:35], v[64:79]
    ds_read_b128 v[48:51], v6 offset:1024
    ds_read_b128 v[52:55], v6 offset:5120
    v_mfma_f32_32x32x16_bf16 v[96:111], v[40:43], v[36:39], v[96:111]
    ds_read_b64_tr_b16 v[56:57], v10 offset:4096
    ds_read_b64_tr_b16 v[58:59], v10 offset:6144
    v_mfma_f32_32x32x16_bf16 v[80:95], v[44:47], v[32:35], v[80:95]
    ds_read_b64_tr_b16 v[60:61], v11 offset:4096
    ds_read_b64_tr_b16 v[62:63], v11 offset:6144
    v_mfma_f32_32x32x16_bf16 v[112:127], v[44:47], v[36:39], v[112:127]
    s_lshl_b32 s34, s35, 17
    s_lshl_b32 s33, s37, 15
    s_add_u32 s34, s34, s33
    s_lshl_b32 s33, s36, 8
    s_add_u32 s34, s34, s33
    s_lshl_b32 s33, s32, 6
    s_add_u32 s34, s34, s33
    v_lshlrev_b32 v26, 10, v20
    v_lshl_add_u32 v27, v21, 4, v26
    v_lshl_add_u32 v26, v21, 3, v26
    buffer_load_dwordx2 v[128:129], v26, s[16:19], s34 offen offset:0
    buffer_load_dwordx2 v[130:131], v26, s[16:19], s34 offen offset:16
    buffer_load_dwordx2 v[132:133], v26, s[16:19], s34 offen offset:32
    buffer_load_dwordx2 v[134:135], v26, s[16:19], s34 offen offset:48
    s_waitcnt lgkmcnt(0)
    v_mfma_f32_32x32x16_bf16 v[64:79], v[56:59], v[48:51], v[64:79]
    ds_read_b128 v[32:35], v6 offset:2048
    ds_read_b128 v[36:39], v6 offset:6144
    v_mfma_f32_32x32x16_bf16 v[96:111], v[56:59], v[52:55], v[96:111]
    ds_read_b64_tr_b16 v[40:41], v10 offset:8192
    ds_read_b64_tr_b16 v[42:43], v10 offset:10240
    v_mfma_f32_32x32x16_bf16 v[80:95], v[60:63], v[48:51], v[80:95]
    ds_read_b64_tr_b16 v[44:45], v11 offset:8192
    ds_read_b64_tr_b16 v[46:47], v11 offset:10240
    v_mfma_f32_32x32x16_bf16 v[112:127], v[60:63], v[52:55], v[112:127]
    s_waitcnt lgkmcnt(0)
    v_mfma_f32_32x32x16_bf16 v[64:79], v[40:43], v[32:35], v[64:79]
    ds_read_b128 v[48:51], v6 offset:3072
    ds_read_b128 v[52:55], v6 offset:7168
    v_mfma_f32_32x32x16_bf16 v[96:111], v[40:43], v[36:39], v[96:111]
    ds_read_b64_tr_b16 v[56:57], v10 offset:12288
    ds_read_b64_tr_b16 v[58:59], v10 offset:14336
    v_mfma_f32_32x32x16_bf16 v[80:95], v[44:47], v[32:35], v[80:95]
    ds_read_b64_tr_b16 v[60:61], v11 offset:12288
    ds_read_b64_tr_b16 v[62:63], v11 offset:14336
    v_mfma_f32_32x32x16_bf16 v[112:127], v[44:47], v[36:39], v[112:127]
    s_waitcnt lgkmcnt(0)
    s_waitcnt vmcnt(4)
    s_barrier
    v_mfma_f32_32x32x16_bf16 v[64:79], v[56:59], v[48:51], v[64:79]
    ds_read_b128 v[32:35], v6 offset:32768
    ds_read_b128 v[36:39], v6 offset:36864
    v_mfma_f32_32x32x16_bf16 v[96:111], v[56:59], v[52:55], v[96:111]
    ds_read_b64_tr_b16 v[40:41], v10 offset:32768
    ds_read_b64_tr_b16 v[42:43], v10 offset:34816
    v_mfma_f32_32x32x16_bf16 v[80:95], v[60:63], v[48:51], v[80:95]
    ds_read_b64_tr_b16 v[44:45], v11 offset:32768
    ds_read_b64_tr_b16 v[46:47], v11 offset:34816
    v_mfma_f32_32x32x16_bf16 v[112:127], v[60:63], v[52:55], v[112:127]
    s_waitcnt lgkmcnt(0)
    v_mfma_f32_32x32x16_bf16 v[64:79], v[40:43], v[32:35], v[64:79]
    ds_read_b128 v[48:51], v6 offset:33792
    ds_read_b128 v[52:55], v6 offset:37888
    v_mfma_f32_32x32x16_bf16 v[96:111], v[40:43], v[36:39], v[96:111]
    ds_read_b64_tr_b16 v[56:57], v10 offset:36864
    ds_read_b64_tr_b16 v[58:59], v10 offset:38912
    v_mfma_f32_32x32x16_bf16 v[80:95], v[44:47], v[32:35], v[80:95]
    ds_read_b64_tr_b16 v[60:61], v11 offset:36864
    ds_read_b64_tr_b16 v[62:63], v11 offset:38912
    v_mfma_f32_32x32x16_bf16 v[112:127], v[44:47], v[36:39], v[112:127]
    s_waitcnt lgkmcnt(0)
    v_mfma_f32_32x32x16_bf16 v[64:79], v[56:59], v[48:51], v[64:79]
    ds_read_b128 v[32:35], v6 offset:34816
    ds_read_b128 v[36:39], v6 offset:38912
    v_mfma_f32_32x32x16_bf16 v[96:111], v[56:59], v[52:55], v[96:111]
    ds_read_b64_tr_b16 v[40:41], v10 offset:40960
    ds_read_b64_tr_b16 v[42:43], v10 offset:43008
    v_mfma_f32_32x32x16_bf16 v[80:95], v[60:63], v[48:51], v[80:95]
    ds_read_b64_tr_b16 v[44:45], v11 offset:40960
    ds_read_b64_tr_b16 v[46:47], v11 offset:43008
    v_mfma_f32_32x32x16_bf16 v[112:127], v[60:63], v[52:55], v[112:127]
    s_waitcnt lgkmcnt(0)
    v_mfma_f32_32x32x16_bf16 v[64:79], v[40:43], v[32:35], v[64:79]
    ds_read_b128 v[48:51], v6 offset:35840
    ds_read_b128 v[52:55], v6 offset:39936
    v_mfma_f32_32x32x16_bf16 v[96:111], v[40:43], v[36:39], v[96:111]
    ds_read_b64_tr_b16 v[56:57], v10 offset:45056
    ds_read_b64_tr_b16 v[58:59], v10 offset:47104
    v_mfma_f32_32x32x16_bf16 v[80:95], v[44:47], v[32:35], v[80:95]
    ds_read_b64_tr_b16 v[60:61], v11 offset:45056
    ds_read_b64_tr_b16 v[62:63], v11 offset:47104
    v_mfma_f32_32x32x16_bf16 v[112:127], v[44:47], v[36:39], v[112:127]
    s_waitcnt lgkmcnt(0)
    v_mfma_f32_32x32x16_bf16 v[64:79], v[56:59], v[48:51], v[64:79]
    v_mfma_f32_32x32x16_bf16 v[96:111], v[56:59], v[52:55], v[96:111]
    v_mfma_f32_32x32x16_bf16 v[80:95], v[60:63], v[48:51], v[80:95]
    v_mfma_f32_32x32x16_bf16 v[112:127], v[60:63], v[52:55], v[112:127]
    s_barrier
    s_lshl_b32 s33, s44, 13
    v_add_u32 v28, s33, v1
    s_lshl_b32 s33, s44, 12
    v_add_u32 v31, s33, v1
    s_nop 7
    s_lshl_b32 s38, s43, 1
    s_add_u32 s38, s38, 0
    s_cmp_eq_u32 s38, s37
    s_cbranch_scc1 K3_OWN0
    s_lshl_b32 s38, s38, 2
    s_add_u32 s38, s38, s37
    s_lshl_b32 s38, s38, 13
    s_add_u32 s38, s38, s45
    v_cvt_pk_bf16_f32 v64, v64, v65
    v_cvt_pk_bf16_f32 v65, v66, v67
    v_cvt_pk_bf16_f32 v66, v68, v69
    v_cvt_pk_bf16_f32 v67, v70, v71
    v_cvt_pk_bf16_f32 v68, v72, v73
    v_cvt_pk_bf16_f32 v69, v74, v75
    v_cvt_pk_bf16_f32 v70, v76, v77
    v_cvt_pk_bf16_f32 v71, v78, v79
    buffer_store_dwordx4 v[64:67], v31, s[24:27], s38 offen offset:0 sc1
    buffer_store_dwordx4 v[68:71], v31, s[24:27], s38 offen offset:1024 sc1
    v_cvt_pk_bf16_f32 v80, v80, v81
    v_cvt_pk_bf16_f32 v81, v82, v83
    v_cvt_pk_bf16_f32 v82, v84, v85
    v_cvt_pk_bf16_f32 v83, v86, v87
    v_cvt_pk_bf16_f32 v84, v88, v89
    v_cvt_pk_bf16_f32 v85, v90, v91
    v_cvt_pk_bf16_f32 v86, v92, v93
    v_cvt_pk_bf16_f32 v87, v94, v95
    buffer_store_dwordx4 v[80:83], v31, s[24:27], s38 offen offset:2048 sc1
    buffer_store_dwordx4 v[84:87], v31, s[24:27], s38 offen offset:3072 sc1
    s_branch K3_SENT0
K3_OWN0:
    ds_write_b128 v28, v[64:67] offset:0
    ds_write_b128 v28, v[68:71] offset:1024
    ds_write_b128 v28, v[72:75] offset:2048
    ds_write_b128 v28, v[76:79] offset:3072
    ds_write_b128 v28, v[80:83] offset:4096
    ds_write_b128 v28, v[84:87] offset:5120
    ds_write_b128 v28, v[88:91] offset:6144
    ds_write_b128 v28, v[92:95] offset:7168
K3_SENT0:
    s_lshl_b32 s38, s43, 1
    s_add_u32 s38, s38, 1
    s_cmp_eq_u32 s38, s37
    s_cbranch_scc1 K3_OWN1
    s_lshl_b32 s38, s38, 2
    s_add_u32 s38, s38, s37
    s_lshl_b32 s38, s38, 13
    s_add_u32 s38, s38, s45
    v_cvt_pk_bf16_f32 v96, v96, v97
    v_cvt_pk_bf16_f32 v97, v98, v99
    v_cvt_pk_bf16_f32 v98, v100, v101
    v_cvt_pk_bf16_f32 v99, v102, v103
    v_cvt_pk_bf16_f32 v100, v104, v105
    v_cvt_pk_bf16_f32 v101, v106, v107
    v_cvt_pk_bf16_f32 v102, v108, v109
    v_cvt_pk_bf16_f32 v103, v110, v111
    buffer_store_dwordx4 v[96:99], v31, s[24:27], s38 offen offset:0 sc1
    buffer_store_dwordx4 v[100:103], v31, s[24:27], s38 offen offset:1024 sc1
    v_cvt_pk_bf16_f32 v112, v112, v113
    v_cvt_pk_bf16_f32 v113, v114, v115
    v_cvt_pk_bf16_f32 v114, v116, v117
    v_cvt_pk_bf16_f32 v115, v118, v119
    v_cvt_pk_bf16_f32 v116, v120, v121
    v_cvt_pk_bf16_f32 v117, v122, v123
    v_cvt_pk_bf16_f32 v118, v124, v125
    v_cvt_pk_bf16_f32 v119, v126, v127
    buffer_store_dwordx4 v[112:115], v31, s[24:27], s38 offen offset:2048 sc1
    buffer_store_dwordx4 v[116:119], v31, s[24:27], s38 offen offset:3072 sc1
    s_branch K3_SENT1
K3_OWN1:
    ds_write_b128 v28, v[96:99] offset:0
    ds_write_b128 v28, v[100:103] offset:1024
    ds_write_b128 v28, v[104:107] offset:2048
    ds_write_b128 v28, v[108:111] offset:3072
    ds_write_b128 v28, v[112:115] offset:4096
    ds_write_b128 v28, v[116:119] offset:5120
    ds_write_b128 v28, v[120:123] offset:6144
    ds_write_b128 v28, v[124:127] offset:7168
K3_SENT1:
    s_waitcnt vmcnt(0) lgkmcnt(0)
    s_barrier
    v_add_u32 v28, s42, v1
    v_mov_b32 v29, 0
    ds_read_b128 v[64:67], v28 offset:0
    ds_read_b128 v[68:71], v28 offset:1024
    ds_read_b128 v[72:75], v28 offset:2048
    ds_read_b128 v[76:79], v28 offset:3072
    s_cmp_lg_u32 s32, 0
    s_cbranch_scc1 K3_WAITED
    v_mov_b32 v30, 1
    s_add_u32 s33, s46, s37
    s_mov_b64 exec, 1
    buffer_store_byte v30, v29, s[24:27], s33 offen sc0 sc1
    s_mov_b64 exec, -1
K3_POLL:
    buffer_load_dword v30, v29, s[24:27], s46 offen sc0 sc1
    s_waitcnt vmcnt(0)
    v_readfirstlane_b32 s47, v30
    s_cmp_eq_u32 s47, 0x01010101
    s_cbranch_scc1 K3_WAITED
    s_sleep 1
    s_branch K3_POLL
K3_WAITED:
    s_barrier
    s_lshl_b32 s38, s37, 15
    s_add_u32 s38, s38, s45
    s_lshl_b32 s33, s32, 11
    s_add_u32 s38, s38, s33
    s_add_u32 s33, s37, 1
    s_and_b32 s33, s33, 3
    s_lshl_b32 s33, s33, 13
    s_add_u32 s33, s33, s38
    buffer_load_dwordx4 v[80:83], v1, s[24:27], s33 offen offset:0 sc1
    buffer_load_dwordx4 v[84:87], v1, s[24:27], s33 offen offset:1024 sc1
    s_add_u32 s33, s37, 2
    s_and_b32 s33, s33, 3
    s_lshl_b32 s33, s33, 13
    s_add_u32 s33, s33, s38
    buffer_load_dwordx4 v[96:99], v1, s[24:27], s33 offen offset:0 sc1
    buffer_load_dwordx4 v[100:103], v1, s[24:27], s33 offen offset:1024 sc1
    s_add_u32 s33, s37, 3
    s_and_b32 s33, s33, 3
    s_lshl_b32 s33, s33, 13
    s_add_u32 s33, s33, s38
    buffer_load_dwordx4 v[112:115], v1, s[24:27], s33 offen offset:0 sc1
    buffer_load_dwordx4 v[116:119], v1, s[24:27], s33 offen offset:1024 sc1
    s_waitcnt lgkmcnt(0)
    v_lshlrev_b32 v30, 16, v128
    v_and_b32 v31, 0xffff0000, v128
    v_add_f32 v64, v64, v30
    v_add_f32 v65, v65, v31
    v_lshlrev_b32 v30, 16, v129
    v_and_b32 v31, 0xffff0000, v129
    v_add_f32 v66, v66, v30
    v_add_f32 v67, v67, v31
    v_lshlrev_b32 v30, 16, v130
    v_and_b32 v31, 0xffff0000, v130
    v_add_f32 v68, v68, v30
    v_add_f32 v69, v69, v31
    v_lshlrev_b32 v30, 16, v131
    v_and_b32 v31, 0xffff0000, v131
    v_add_f32 v70, v70, v30
    v_add_f32 v71, v71, v31
    v_lshlrev_b32 v30, 16, v132
    v_and_b32 v31, 0xffff0000, v132
    v_add_f32 v72, v72, v30
    v_add_f32 v73, v73, v31
    v_lshlrev_b32 v30, 16, v133
    v_and_b32 v31, 0xffff0000, v133
    v_add_f32 v74, v74, v30
    v_add_f32 v75, v75, v31
    v_lshlrev_b32 v30, 16, v134
    v_and_b32 v31, 0xffff0000, v134
    v_add_f32 v76, v76, v30
    v_add_f32 v77, v77, v31
    v_lshlrev_b32 v30, 16, v135
    v_and_b32 v31, 0xffff0000, v135
    v_add_f32 v78, v78, v30
    v_add_f32 v79, v79, v31
    s_waitcnt vmcnt(4)
    v_lshlrev_b32 v30, 16, v80
    v_and_b32 v31, 0xffff0000, v80
    v_add_f32 v64, v64, v30
    v_add_f32 v65, v65, v31
    v_lshlrev_b32 v30, 16, v81
    v_and_b32 v31, 0xffff0000, v81
    v_add_f32 v66, v66, v30
    v_add_f32 v67, v67, v31
    v_lshlrev_b32 v30, 16, v82
    v_and_b32 v31, 0xffff0000, v82
    v_add_f32 v68, v68, v30
    v_add_f32 v69, v69, v31
    v_lshlrev_b32 v30, 16, v83
    v_and_b32 v31, 0xffff0000, v83
    v_add_f32 v70, v70, v30
    v_add_f32 v71, v71, v31
    v_lshlrev_b32 v30, 16, v84
    v_and_b32 v31, 0xffff0000, v84
    v_add_f32 v72, v72, v30
    v_add_f32 v73, v73, v31
    v_lshlrev_b32 v30, 16, v85
    v_and_b32 v31, 0xffff0000, v85
    v_add_f32 v74, v74, v30
    v_add_f32 v75, v75, v31
    v_lshlrev_b32 v30, 16, v86
    v_and_b32 v31, 0xffff0000, v86
    v_add_f32 v76, v76, v30
    v_add_f32 v77, v77, v31
    v_lshlrev_b32 v30, 16, v87
    v_and_b32 v31, 0xffff0000, v87
    v_add_f32 v78, v78, v30
    v_add_f32 v79, v79, v31
    s_waitcnt vmcnt(2)
    v_lshlrev_b32 v30, 16, v96
    v_and_b32 v31, 0xffff0000, v96
    v_add_f32 v64, v64, v30
    v_add_f32 v65, v65, v31
    v_lshlrev_b32 v30, 16, v97
    v_and_b32 v31, 0xffff0000, v97
    v_add_f32 v66, v66, v30
    v_add_f32 v67, v67, v31
    v_lshlrev_b32 v30, 16, v98
    v_and_b32 v31, 0xffff0000, v98
    v_add_f32 v68, v68, v30
    v_add_f32 v69, v69, v31
    v_lshlrev_b32 v30, 16, v99
    v_and_b32 v31, 0xffff0000, v99
    v_add_f32 v70, v70, v30
    v_add_f32 v71, v71, v31
    v_lshlrev_b32 v30, 16, v100
    v_and_b32 v31, 0xffff0000, v100
    v_add_f32 v72, v72, v30
    v_add_f32 v73, v73, v31
    v_lshlrev_b32 v30, 16, v101
    v_and_b32 v31, 0xffff0000, v101
    v_add_f32 v74, v74, v30
    v_add_f32 v75, v75, v31
    v_lshlrev_b32 v30, 16, v102
    v_and_b32 v31, 0xffff0000, v102
    v_add_f32 v76, v76, v30
    v_add_f32 v77, v77, v31
    v_lshlrev_b32 v30, 16, v103
    v_and_b32 v31, 0xffff0000, v103
    v_add_f32 v78, v78, v30
    v_add_f32 v79, v79, v31
    s_waitcnt vmcnt(0)
    v_lshlrev_b32 v30, 16, v112
    v_and_b32 v31, 0xffff0000, v112
    v_add_f32 v64, v64, v30
    v_add_f32 v65, v65, v31
    v_lshlrev_b32 v30, 16, v113
    v_and_b32 v31, 0xffff0000, v113
    v_add_f32 v66, v66, v30
    v_add_f32 v67, v67, v31
    v_lshlrev_b32 v30, 16, v114
    v_and_b32 v31, 0xffff0000, v114
    v_add_f32 v68, v68, v30
    v_add_f32 v69, v69, v31
    v_lshlrev_b32 v30, 16, v115
    v_and_b32 v31, 0xffff0000, v115
    v_add_f32 v70, v70, v30
    v_add_f32 v71, v71, v31
    v_lshlrev_b32 v30, 16, v116
    v_and_b32 v31, 0xffff0000, v116
    v_add_f32 v72, v72, v30
    v_add_f32 v73, v73, v31
    v_lshlrev_b32 v30, 16, v117
    v_and_b32 v31, 0xffff0000, v117
    v_add_f32 v74, v74, v30
    v_add_f32 v75, v75, v31
    v_lshlrev_b32 v30, 16, v118
    v_and_b32 v31, 0xffff0000, v118
    v_add_f32 v76, v76, v30
    v_add_f32 v77, v77, v31
    v_lshlrev_b32 v30, 16, v119
    v_and_b32 v31, 0xffff0000, v119
    v_add_f32 v78, v78, v30
    v_add_f32 v79, v79, v31
    v_cvt_pk_bf16_f32 v64, v64, v65
    v_cvt_pk_bf16_f32 v65, v66, v67
    v_cvt_pk_bf16_f32 v66, v68, v69
    v_cvt_pk_bf16_f32 v67, v70, v71
    v_cvt_pk_bf16_f32 v68, v72, v73
    v_cvt_pk_bf16_f32 v69, v74, v75
    v_cvt_pk_bf16_f32 v70, v76, v77
    v_cvt_pk_bf16_f32 v71, v78, v79
    s_nop 1
    v_permlane32_swap_b32 v64, v66
    v_permlane32_swap_b32 v65, v67
    v_permlane32_swap_b32 v68, v70
    v_permlane32_swap_b32 v69, v71
    s_nop 1
    buffer_store_dwordx4 v[64:67], v27, s[20:23], s34 offen offset:0
    buffer_store_dwordx4 v[68:71], v27, s[20:23], s34 offen offset:32
K2_END:
    s_endpgm
K2_RARE_0_0:
    s_mov_b32 s51, 0x42000000
    v_mov_b32 v20, v14
    s_nop 1
    v_permlane32_swap_b32 v14, v20
    s_nop 1
    v_max_f32 v20, v20, v14
    v_ceil_f32 v20, v20
    v_max_f32 v20, s53, v20
    v_sub_f32 v12, v12, v20
    v_sub_f32 v48, v48, v20
    v_mov_b32 v80, v12
    v_sub_f32 v49, v49, v20
    v_mov_b32 v81, v12
    v_sub_f32 v50, v50, v20
    v_mov_b32 v82, v12
    v_sub_f32 v51, v51, v20
    v_mov_b32 v83, v12
    v_sub_f32 v52, v52, v20
    v_mov_b32 v84, v12
    v_sub_f32 v53, v53, v20
    v_mov_b32 v85, v12
    v_sub_f32 v54, v54, v20
    v_mov_b32 v86, v12
    v_sub_f32 v55, v55, v20
    v_mov_b32 v87, v12
    v_sub_f32 v56, v56, v20
    v_mov_b32 v88, v12
    v_sub_f32 v57, v57, v20
    v_mov_b32 v89, v12
    v_sub_f32 v58, v58, v20
    v_mov_b32 v90, v12
    v_sub_f32 v59, v59, v20
    v_mov_b32 v91, v12
    v_sub_f32 v60, v60, v20
    v_mov_b32 v92, v12
    v_sub_f32 v61, v61, v20
    v_mov_b32 v93, v12
    v_sub_f32 v62, v62, v20
    v_mov_b32 v94, v12
    v_sub_f32 v63, v63, v20
    v_mov_b32 v95, v12
    s_cmp_eq_u32 s53, 0
    s_cbranch_scc1 K2_RSC_0_0
    v_add_f32 v30, v8, v9
    v_mov_b32 v8, 0
    v_mov_b32 v9, 0
    s_mov_b32 s53, 0
    s_cmp_eq_u32 s31, 0
    s_cbranch_scc1 K2_RET_0_0
    s_branch K2_RETD_0_0
K2_RSC_0_0:
    v_sub_f32 v21, 0, v20
    v_exp_f32 v21, v21
    s_nop 0
    v_mul_f32 v8, v8, v21
    v_mul_f32 v9, v9, v21
    v_lshlrev_b32 v22, 16, v128
    v_and_b32 v23, 0xffff0000, v128
    v_mul_f32 v22, v22, v21
    v_mul_f32 v23, v23, v21
    v_cvt_pk_bf16_f32 v128, v22, v23
    v_lshlrev_b32 v22, 16, v129
    v_and_b32 v23, 0xffff0000, v129
    v_mul_f32 v22, v22, v21
    v_mul_f32 v23, v23, v21
    v_cvt_pk_bf16_f32 v129, v22, v23
    v_lshlrev_b32 v22, 16, v130
    v_and_b32 v23, 0xffff0000, v130
    v_mul_f32 v22, v22, v21
    v_mul_f32 v23, v23, v21
    v_cvt_pk_bf16_f32 v130, v22, v23
    v_lshlrev_b32 v22, 16, v131
    v_and_b32 v23, 0xffff0000, v131
    v_mul_f32 v22, v22, v21
    v_mul_f32 v23, v23, v21
    v_cvt_pk_bf16_f32 v131, v22, v23
    v_lshlrev_b32 v22, 16, v132
    v_and_b32 v23, 0xffff0000, v132
    v_mul_f32 v22, v22, v21
    v_mul_f32 v23, v23, v21
    v_cvt_pk_bf16_f32 v132, v22, v23
    v_lshlrev_b32 v22, 16, v133
    v_and_b32 v23, 0xffff0000, v133
    v_mul_f32 v22, v22, v21
    v_mul_f32 v23, v23, v21
    v_cvt_pk_bf16_f32 v133, v22, v23
    v_lshlrev_b32 v22, 16, v134
    v_and_b32 v23, 0xffff0000, v134
    v_mul_f32 v22, v22, v21
    v_mul_f32 v23, v23, v21
    v_cvt_pk_bf16_f32 v134, v22, v23
    v_lshlrev_b32 v22, 16, v135
    v_and_b32 v23, 0xffff0000, v135
    v_mul_f32 v22, v22, v21
    v_mul_f32 v23, v23, v21
    v_cvt_pk_bf16_f32 v135, v22, v23
    s_nop 15
    v_accvgpr_read_b32 v22, a0
    v_accvgpr_read_b32 v23, a1
    v_accvgpr_read_b32 v24, a2
    v_accvgpr_read_b32 v25, a3
    v_mul_f32 v22, v22, v21
    v_mul_f32 v23, v23, v21
    v_mul_f32 v24, v24, v21
    v_mul_f32 v25, v25, v21
    v_accvgpr_write_b32 a0, v22
    v_accvgpr_write_b32 a1, v23
    v_accvgpr_write_b32 a2, v24
    v_accvgpr_write_b32 a3, v25
    v_accvgpr_read_b32 v22, a4
    v_accvgpr_read_b32 v23, a5
    v_accvgpr_read_b32 v24, a6
    v_accvgpr_read_b32 v25, a7
    v_mul_f32 v22, v22, v21
    v_mul_f32 v23, v23, v21
    v_mul_f32 v24, v24, v21
    v_mul_f32 v25, v25, v21
    v_accvgpr_write_b32 a4, v22
    v_accvgpr_write_b32 a5, v23
    v_accvgpr_write_b32 a6, v24
    v_accvgpr_write_b32 a7, v25
    v_accvgpr_read_b32 v22, a8
    v_accvgpr_read_b32 v23, a9
    v_accvgpr_read_b32 v24, a10
    v_accvgpr_read_b32 v25, a11
    v_mul_f32 v22, v22, v21
    v_mul_f32 v23, v23, v21
    v_mul_f32 v24, v24, v21
    v_mul_f32 v25, v25, v21
    v_accvgpr_write_b32 a8, v22
    v_accvgpr_write_b32 a9, v23
    v_accvgpr_write_b32 a10, v24
    v_accvgpr_write_b32 a11, v25
    v_accvgpr_read_b32 v22, a12
    v_accvgpr_read_b32 v23, a13
    v_accvgpr_read_b32 v24, a14
    v_accvgpr_read_b32 v25, a15
    v_mul_f32 v22, v22, v21
    v_mul_f32 v23, v23, v21
    v_mul_f32 v24, v24, v21
    v_mul_f32 v25, v25, v21
    v_accvgpr_write_b32 a12, v22
    v_accvgpr_write_b32 a13, v23
    v_accvgpr_write_b32 a14, v24
    v_accvgpr_write_b32 a15, v25
    v_accvgpr_read_b32 v22, a16
    v_accvgpr_read_b32 v23, a17
    v_accvgpr_read_b32 v24, a18
    v_accvgpr_read_b32 v25, a19
    v_mul_f32 v22, v22, v21
    v_mul_f32 v23, v23, v21
    v_mul_f32 v24, v24, v21
    v_mul_f32 v25, v25, v21
    v_accvgpr_write_b32 a16, v22
    v_accvgpr_write_b32 a17, v23
    v_accvgpr_write_b32 a18, v24
    v_accvgpr_write_b32 a19, v25
    v_accvgpr_read_b32 v22, a20
    v_accvgpr_read_b32 v23, a21
    v_accvgpr_read_b32 v24, a22
    v_accvgpr_read_b32 v25, a23
    v_mul_f32 v22, v22, v21
    v_mul_f32 v23, v23, v21
    v_mul_f32 v24, v24, v21
    v_mul_f32 v25, v25, v21
    v_accvgpr_write_b32 a20, v22
    v_accvgpr_write_b32 a21, v23
    v_accvgpr_write_b32 a22, v24
    v_accvgpr_write_b32 a23, v25
    v_accvgpr_read_b32 v22, a24
    v_accvgpr_read_b32 v23, a25
    v_accvgpr_read_b32 v24, a26
    v_accvgpr_read_b32 v25, a27
    v_mul_f32 v22, v22, v21
    v_mul_f32 v23, v23, v21
    v_mul_f32 v24, v24, v21
    v_mul_f32 v25, v25, v21
    v_accvgpr_write_b32 a24, v22
    v_accvgpr_write_b32 a25, v23
    v_accvgpr_write_b32 a26, v24
    v_accvgpr_write_b32 a27, v25
    v_accvgpr_read_b32 v22, a28
    v_accvgpr_read_b32 v23, a29
    v_accvgpr_read_b32 v24, a30
    v_accvgpr_read_b32 v25, a31
    v_mul_f32 v22, v22, v21
    v_mul_f32 v23, v23, v21
    v_mul_f32 v24, v24, v21
    v_mul_f32 v25, v25, v21
    v_accvgpr_write_b32 a28, v22
    v_accvgpr_write_b32 a29, v23
    v_accvgpr_write_b32 a30, v24
    v_accvgpr_write_b32 a31, v25
    v_accvgpr_read_b32 v22, a32
    v_accvgpr_read_b32 v23, a33
    v_accvgpr_read_b32 v24, a34
    v_accvgpr_read_b32 v25, a35
    v_mul_f32 v22, v22, v21
    v_mul_f32 v23, v23, v21
    v_mul_f32 v24, v24, v21
    v_mul_f32 v25, v25, v21
    v_accvgpr_write_b32 a32, v22
    v_accvgpr_write_b32 a33, v23
    v_accvgpr_write_b32 a34, v24
    v_accvgpr_write_b32 a35, v25
    v_accvgpr_read_b32 v22, a36
    v_accvgpr_read_b32 v23, a37
    v_accvgpr_read_b32 v24, a38
    v_accvgpr_read_b32 v25, a39
    v_mul_f32 v22, v22, v21
    v_mul_f32 v23, v23, v21
    v_mul_f32 v24, v24, v21
    v_mul_f32 v25, v25, v21
    v_accvgpr_write_b32 a36, v22
    v_accvgpr_write_b32 a37, v23
    v_accvgpr_write_b32 a38, v24
    v_accvgpr_write_b32 a39, v25
    v_accvgpr_read_b32 v22, a40
    v_accvgpr_read_b32 v23, a41
    v_accvgpr_read_b32 v24, a42
    v_accvgpr_read_b32 v25, a43
    v_mul_f32 v22, v22, v21
    v_mul_f32 v23, v23, v21
    v_mul_f32 v24, v24, v21
    v_mul_f32 v25, v25, v21
    v_accvgpr_write_b32 a40, v22
    v_accvgpr_write_b32 a41, v23
    v_accvgpr_write_b32 a42, v24
    v_accvgpr_write_b32 a43, v25
    v_accvgpr_read_b32 v22, a44
    v_accvgpr_read_b32 v23, a45
    v_accvgpr_read_b32 v24, a46
    v_accvgpr_read_b32 v25, a47
    v_mul_f32 v22, v22, v21
    v_mul_f32 v23, v23, v21
    v_mul_f32 v24, v24, v21
    v_mul_f32 v25, v25, v21
    v_accvgpr_write_b32 a44, v22
    v_accvgpr_write_b32 a45, v23
    v_accvgpr_write_b32 a46, v24
    v_accvgpr_write_b32 a47, v25
    v_accvgpr_read_b32 v22, a48
    v_accvgpr_read_b32 v23, a49
    v_accvgpr_read_b32 v24, a50
    v_accvgpr_read_b32 v25, a51
    v_mul_f32 v22, v22, v21
    v_mul_f32 v23, v23, v21
    v_mul_f32 v24, v24, v21
    v_mul_f32 v25, v25, v21
    v_accvgpr_write_b32 a48, v22
    v_accvgpr_write_b32 a49, v23
    v_accvgpr_write_b32 a50, v24
    v_accvgpr_write_b32 a51, v25
    v_accvgpr_read_b32 v22, a52
    v_accvgpr_read_b32 v23, a53
    v_accvgpr_read_b32 v24, a54
    v_accvgpr_read_b32 v25, a55
    v_mul_f32 v22, v22, v21
    v_mul_f32 v23, v23, v21
    v_mul_f32 v24, v24, v21
    v_mul_f32 v25, v25, v21
    v_accvgpr_write_b32 a52, v22
    v_accvgpr_write_b32 a53, v23
    v_accvgpr_write_b32 a54, v24
    v_accvgpr_write_b32 a55, v25
    v_accvgpr_read_b32 v22, a56
    v_accvgpr_read_b32 v23, a57
    v_accvgpr_read_b32 v24, a58
    v_accvgpr_read_b32 v25, a59
    v_mul_f32 v22, v22, v21
    v_mul_f32 v23, v23, v21
    v_mul_f32 v24, v24, v21
    v_mul_f32 v25, v25, v21
    v_accvgpr_write_b32 a56, v22
    v_accvgpr_write_b32 a57, v23
    v_accvgpr_write_b32 a58, v24
    v_accvgpr_write_b32 a59, v25
    v_accvgpr_read_b32 v22, a60
    v_accvgpr_read_b32 v23, a61
    v_accvgpr_read_b32 v24, a62
    v_accvgpr_read_b32 v25, a63
    v_mul_f32 v22, v22, v21
    v_mul_f32 v23, v23, v21
    v_mul_f32 v24, v24, v21
    v_mul_f32 v25, v25, v21
    v_accvgpr_write_b32 a60, v22
    v_accvgpr_write_b32 a61, v23
    v_accvgpr_write_b32 a62, v24
    v_accvgpr_write_b32 a63, v25
    s_cmp_eq_u32 s31, 0
    s_cbranch_scc1 K2_RET_0_0
    s_branch K2_RETD_0_0
K2_RARE_0_1:
    s_mov_b32 s51, 0x42000000
    v_mov_b32 v20, v14
    s_nop 1
    v_permlane32_swap_b32 v14, v20
    s_nop 1
    v_max_f32 v20, v20, v14
    v_ceil_f32 v20, v20
    v_max_f32 v20, s53, v20
    v_sub_f32 v12, v12, v20
    v_sub_f32 v48, v48, v20
    v_mov_b32 v80, v12
    v_sub_f32 v49, v49, v20
    v_mov_b32 v81, v12
    v_sub_f32 v50, v50, v20
    v_mov_b32 v82, v12
    v_sub_f32 v51, v51, v20
    v_mov_b32 v83, v12
    v_sub_f32 v52, v52, v20
    v_mov_b32 v84, v12
    v_sub_f32 v53, v53, v20
    v_mov_b32 v85, v12
    v_sub_f32 v54, v54, v20
    v_mov_b32 v86, v12
    v_sub_f32 v55, v55, v20
    v_mov_b32 v87, v12
    v_sub_f32 v56, v56, v20
    v_mov_b32 v88, v12
    v_sub_f32 v57, v57, v20
    v_mov_b32 v89, v12
    v_sub_f32 v58, v58, v20
    v_mov_b32 v90, v12
    v_sub_f32 v59, v59, v20
    v_mov_b32 v91, v12
    v_sub_f32 v60, v60, v20
    v_mov_b32 v92, v12
    v_sub_f32 v61, v61, v20
    v_mov_b32 v93, v12
    v_sub_f32 v62, v62, v20
    v_mov_b32 v94, v12
    v_sub_f32 v63, v63, v20
    v_mov_b32 v95, v12
    s_cmp_eq_u32 s53, 0
    s_cbranch_scc1 K2_RSC_0_1
    v_add_f32 v30, v8, v9
    v_mov_b32 v8, 0
    v_mov_b32 v9, 0
    s_mov_b32 s53, 0
    s_cmp_eq_u32 s31, 0
    s_cbranch_scc1 K2_RET_0_1
    s_branch K2_RETF_0_1
K2_RSC_0_1:
    v_sub_f32 v21, 0, v20
    v_exp_f32 v21, v21
    s_nop 0
    v_mul_f32 v8, v8, v21
    v_mul_f32 v9, v9, v21
    v_lshlrev_b32 v22, 16, v112
    v_and_b32 v23, 0xffff0000, v112
    v_mul_f32 v22, v22, v21
    v_mul_f32 v23, v23, v21
    v_cvt_pk_bf16_f32 v112, v22, v23
    v_lshlrev_b32 v22, 16, v113
    v_and_b32 v23, 0xffff0000, v113
    v_mul_f32 v22, v22, v21
    v_mul_f32 v23, v23, v21
    v_cvt_pk_bf16_f32 v113, v22, v23
    v_lshlrev_b32 v22, 16, v114
    v_and_b32 v23, 0xffff0000, v114
    v_mul_f32 v22, v22, v21
    v_mul_f32 v23, v23, v21
    v_cvt_pk_bf16_f32 v114, v22, v23
    v_lshlrev_b32 v22, 16, v115
    v_and_b32 v23, 0xffff0000, v115
    v_mul_f32 v22, v22, v21
    v_mul_f32 v23, v23, v21
    v_cvt_pk_bf16_f32 v115, v22, v23
    v_lshlrev_b32 v22, 16, v116
    v_and_b32 v23, 0xffff0000, v116
    v_mul_f32 v22, v22, v21
    v_mul_f32 v23, v23, v21
    v_cvt_pk_bf16_f32 v116, v22, v23
    v_lshlrev_b32 v22, 16, v117
    v_and_b32 v23, 0xffff0000, v117
    v_mul_f32 v22, v22, v21
    v_mul_f32 v23, v23, v21
    v_cvt_pk_bf16_f32 v117, v22, v23
    v_lshlrev_b32 v22, 16, v118
    v_and_b32 v23, 0xffff0000, v118
    v_mul_f32 v22, v22, v21
    v_mul_f32 v23, v23, v21
    v_cvt_pk_bf16_f32 v118, v22, v23
    v_lshlrev_b32 v22, 16, v119
    v_and_b32 v23, 0xffff0000, v119
    v_mul_f32 v22, v22, v21
    v_mul_f32 v23, v23, v21
    v_cvt_pk_bf16_f32 v119, v22, v23
    s_nop 15
    v_accvgpr_read_b32 v22, a0
    v_accvgpr_read_b32 v23, a1
    v_accvgpr_read_b32 v24, a2
    v_accvgpr_read_b32 v25, a3
    v_mul_f32 v22, v22, v21
    v_mul_f32 v23, v23, v21
    v_mul_f32 v24, v24, v21
    v_mul_f32 v25, v25, v21
    v_accvgpr_write_b32 a0, v22
    v_accvgpr_write_b32 a1, v23
    v_accvgpr_write_b32 a2, v24
    v_accvgpr_write_b32 a3, v25
    v_accvgpr_read_b32 v22, a4
    v_accvgpr_read_b32 v23, a5
    v_accvgpr_read_b32 v24, a6
    v_accvgpr_read_b32 v25, a7
    v_mul_f32 v22, v22, v21
    v_mul_f32 v23, v23, v21
    v_mul_f32 v24, v24, v21
    v_mul_f32 v25, v25, v21
    v_accvgpr_write_b32 a4, v22
    v_accvgpr_write_b32 a5, v23
    v_accvgpr_write_b32 a6, v24
    v_accvgpr_write_b32 a7, v25
    v_accvgpr_read_b32 v22, a8
    v_accvgpr_read_b32 v23, a9
    v_accvgpr_read_b32 v24, a10
    v_accvgpr_read_b32 v25, a11
    v_mul_f32 v22, v22, v21
    v_mul_f32 v23, v23, v21
    v_mul_f32 v24, v24, v21
    v_mul_f32 v25, v25, v21
    v_accvgpr_write_b32 a8, v22
    v_accvgpr_write_b32 a9, v23
    v_accvgpr_write_b32 a10, v24
    v_accvgpr_write_b32 a11, v25
    v_accvgpr_read_b32 v22, a12
    v_accvgpr_read_b32 v23, a13
    v_accvgpr_read_b32 v24, a14
    v_accvgpr_read_b32 v25, a15
    v_mul_f32 v22, v22, v21
    v_mul_f32 v23, v23, v21
    v_mul_f32 v24, v24, v21
    v_mul_f32 v25, v25, v21
    v_accvgpr_write_b32 a12, v22
    v_accvgpr_write_b32 a13, v23
    v_accvgpr_write_b32 a14, v24
    v_accvgpr_write_b32 a15, v25
    v_accvgpr_read_b32 v22, a16
    v_accvgpr_read_b32 v23, a17
    v_accvgpr_read_b32 v24, a18
    v_accvgpr_read_b32 v25, a19
    v_mul_f32 v22, v22, v21
    v_mul_f32 v23, v23, v21
    v_mul_f32 v24, v24, v21
    v_mul_f32 v25, v25, v21
    v_accvgpr_write_b32 a16, v22
    v_accvgpr_write_b32 a17, v23
    v_accvgpr_write_b32 a18, v24
    v_accvgpr_write_b32 a19, v25
    v_accvgpr_read_b32 v22, a20
    v_accvgpr_read_b32 v23, a21
    v_accvgpr_read_b32 v24, a22
    v_accvgpr_read_b32 v25, a23
    v_mul_f32 v22, v22, v21
    v_mul_f32 v23, v23, v21
    v_mul_f32 v24, v24, v21
    v_mul_f32 v25, v25, v21
    v_accvgpr_write_b32 a20, v22
    v_accvgpr_write_b32 a21, v23
    v_accvgpr_write_b32 a22, v24
    v_accvgpr_write_b32 a23, v25
    v_accvgpr_read_b32 v22, a24
    v_accvgpr_read_b32 v23, a25
    v_accvgpr_read_b32 v24, a26
    v_accvgpr_read_b32 v25, a27
    v_mul_f32 v22, v22, v21
    v_mul_f32 v23, v23, v21
    v_mul_f32 v24, v24, v21
    v_mul_f32 v25, v25, v21
    v_accvgpr_write_b32 a24, v22
    v_accvgpr_write_b32 a25, v23
    v_accvgpr_write_b32 a26, v24
    v_accvgpr_write_b32 a27, v25
    v_accvgpr_read_b32 v22, a28
    v_accvgpr_read_b32 v23, a29
    v_accvgpr_read_b32 v24, a30
    v_accvgpr_read_b32 v25, a31
    v_mul_f32 v22, v22, v21
    v_mul_f32 v23, v23, v21
    v_mul_f32 v24, v24, v21
    v_mul_f32 v25, v25, v21
    v_accvgpr_write_b32 a28, v22
    v_accvgpr_write_b32 a29, v23
    v_accvgpr_write_b32 a30, v24
    v_accvgpr_write_b32 a31, v25
    v_accvgpr_read_b32 v22, a32
    v_accvgpr_read_b32 v23, a33
    v_accvgpr_read_b32 v24, a34
    v_accvgpr_read_b32 v25, a35
    v_mul_f32 v22, v22, v21
    v_mul_f32 v23, v23, v21
    v_mul_f32 v24, v24, v21
    v_mul_f32 v25, v25, v21
    v_accvgpr_write_b32 a32, v22
    v_accvgpr_write_b32 a33, v23
    v_accvgpr_write_b32 a34, v24
    v_accvgpr_write_b32 a35, v25
    v_accvgpr_read_b32 v22, a36
    v_accvgpr_read_b32 v23, a37
    v_accvgpr_read_b32 v24, a38
    v_accvgpr_read_b32 v25, a39
    v_mul_f32 v22, v22, v21
    v_mul_f32 v23, v23, v21
    v_mul_f32 v24, v24, v21
    v_mul_f32 v25, v25, v21
    v_accvgpr_write_b32 a36, v22
    v_accvgpr_write_b32 a37, v23
    v_accvgpr_write_b32 a38, v24
    v_accvgpr_write_b32 a39, v25
    v_accvgpr_read_b32 v22, a40
    v_accvgpr_read_b32 v23, a41
    v_accvgpr_read_b32 v24, a42
    v_accvgpr_read_b32 v25, a43
    v_mul_f32 v22, v22, v21
    v_mul_f32 v23, v23, v21
    v_mul_f32 v24, v24, v21
    v_mul_f32 v25, v25, v21
    v_accvgpr_write_b32 a40, v22
    v_accvgpr_write_b32 a41, v23
    v_accvgpr_write_b32 a42, v24
    v_accvgpr_write_b32 a43, v25
    v_accvgpr_read_b32 v22, a44
    v_accvgpr_read_b32 v23, a45
    v_accvgpr_read_b32 v24, a46
    v_accvgpr_read_b32 v25, a47
    v_mul_f32 v22, v22, v21
    v_mul_f32 v23, v23, v21
    v_mul_f32 v24, v24, v21
    v_mul_f32 v25, v25, v21
    v_accvgpr_write_b32 a44, v22
    v_accvgpr_write_b32 a45, v23
    v_accvgpr_write_b32 a46, v24
    v_accvgpr_write_b32 a47, v25
    v_accvgpr_read_b32 v22, a48
    v_accvgpr_read_b32 v23, a49
    v_accvgpr_read_b32 v24, a50
    v_accvgpr_read_b32 v25, a51
    v_mul_f32 v22, v22, v21
    v_mul_f32 v23, v23, v21
    v_mul_f32 v24, v24, v21
    v_mul_f32 v25, v25, v21
    v_accvgpr_write_b32 a48, v22
    v_accvgpr_write_b32 a49, v23
    v_accvgpr_write_b32 a50, v24
    v_accvgpr_write_b32 a51, v25
    v_accvgpr_read_b32 v22, a52
    v_accvgpr_read_b32 v23, a53
    v_accvgpr_read_b32 v24, a54
    v_accvgpr_read_b32 v25, a55
    v_mul_f32 v22, v22, v21
    v_mul_f32 v23, v23, v21
    v_mul_f32 v24, v24, v21
    v_mul_f32 v25, v25, v21
    v_accvgpr_write_b32 a52, v22
    v_accvgpr_write_b32 a53, v23
    v_accvgpr_write_b32 a54, v24
    v_accvgpr_write_b32 a55, v25
    v_accvgpr_read_b32 v22, a56
    v_accvgpr_read_b32 v23, a57
    v_accvgpr_read_b32 v24, a58
    v_accvgpr_read_b32 v25, a59
    v_mul_f32 v22, v22, v21
    v_mul_f32 v23, v23, v21
    v_mul_f32 v24, v24, v21
    v_mul_f32 v25, v25, v21
    v_accvgpr_write_b32 a56, v22
    v_accvgpr_write_b32 a57, v23
    v_accvgpr_write_b32 a58, v24
    v_accvgpr_write_b32 a59, v25
    v_accvgpr_read_b32 v22, a60
    v_accvgpr_read_b32 v23, a61
    v_accvgpr_read_b32 v24, a62
    v_accvgpr_read_b32 v25, a63
    v_mul_f32 v22, v22, v21
    v_mul_f32 v23, v23, v21
    v_mul_f32 v24, v24, v21
    v_mul_f32 v25, v25, v21
    v_accvgpr_write_b32 a60, v22
    v_accvgpr_write_b32 a61, v23
    v_accvgpr_write_b32 a62, v24
    v_accvgpr_write_b32 a63, v25
    s_cmp_eq_u32 s31, 0
    s_cbranch_scc1 K2_RET_0_1
    s_branch K2_RETF_0_1
K2_RARE_1_0:
    s_mov_b32 s52, 0x42000000
    v_mov_b32 v20, v14
    s_nop 1
    v_permlane32_swap_b32 v14, v20
    s_nop 1
    v_max_f32 v20, v20, v14
    v_ceil_f32 v20, v20
    v_max_f32 v20, s54, v20
    v_sub_f32 v13, v13, v20
    v_sub_f32 v64, v64, v20
    v_mov_b32 v96, v13
    v_sub_f32 v65, v65, v20
    v_mov_b32 v97, v13
    v_sub_f32 v66, v66, v20
    v_mov_b32 v98, v13
    v_sub_f32 v67, v67, v20
    v_mov_b32 v99, v13
    v_sub_f32 v68, v68, v20
    v_mov_b32 v100, v13
    v_sub_f32 v69, v69, v20
    v_mov_b32 v101, v13
    v_sub_f32 v70, v70, v20
    v_mov_b32 v102, v13
    v_sub_f32 v71, v71, v20
    v_mov_b32 v103, v13
    v_sub_f32 v72, v72, v20
    v_mov_b32 v104, v13
    v_sub_f32 v73, v73, v20
    v_mov_b32 v105, v13
    v_sub_f32 v74, v74, v20
    v_mov_b32 v106, v13
    v_sub_f32 v75, v75, v20
    v_mov_b32 v107, v13
    v_sub_f32 v76, v76, v20
    v_mov_b32 v108, v13
    v_sub_f32 v77, v77, v20
    v_mov_b32 v109, v13
    v_sub_f32 v78, v78, v20
    v_mov_b32 v110, v13
    v_sub_f32 v79, v79, v20
    v_mov_b32 v111, v13
    s_cmp_eq_u32 s54, 0
    s_cbranch_scc1 K2_RSC_1_0
    v_add_f32 v31, v10, v11
    v_mov_b32 v10, 0
    v_mov_b32 v11, 0
    s_mov_b32 s54, 0
    s_cmp_eq_u32 s31, 0
    s_cbranch_scc1 K2_RET_1_0
    s_branch K2_RETD_1_0
K2_RSC_1_0:
    v_sub_f32 v21, 0, v20
    v_exp_f32 v21, v21
    s_nop 0
    v_mul_f32 v10, v10, v21
    v_mul_f32 v11, v11, v21
    v_lshlrev_b32 v22, 16, v136
    v_and_b32 v23, 0xffff0000, v136
    v_mul_f32 v22, v22, v21
    v_mul_f32 v23, v23, v21
    v_cvt_pk_bf16_f32 v136, v22, v23
    v_lshlrev_b32 v22, 16, v137
    v_and_b32 v23, 0xffff0000, v137
    v_mul_f32 v22, v22, v21
    v_mul_f32 v23, v23, v21
    v_cvt_pk_bf16_f32 v137, v22, v23
    v_lshlrev_b32 v22, 16, v138
    v_and_b32 v23, 0xffff0000, v138
    v_mul_f32 v22, v22, v21
    v_mul_f32 v23, v23, v21
    v_cvt_pk_bf16_f32 v138, v22, v23
    v_lshlrev_b32 v22, 16, v139
    v_and_b32 v23, 0xffff0000, v139
    v_mul_f32 v22, v22, v21
    v_mul_f32 v23, v23, v21
    v_cvt_pk_bf16_f32 v139, v22, v23
    v_lshlrev_b32 v22, 16, v140
    v_and_b32 v23, 0xffff0000, v140
    v_mul_f32 v22, v22, v21
    v_mul_f32 v23, v23, v21
    v_cvt_pk_bf16_f32 v140, v22, v23
    v_lshlrev_b32 v22, 16, v141
    v_and_b32 v23, 0xffff0000, v141
    v_mul_f32 v22, v22, v21
    v_mul_f32 v23, v23, v21
    v_cvt_pk_bf16_f32 v141, v22, v23
    v_lshlrev_b32 v22, 16, v142
    v_and_b32 v23, 0xffff0000, v142
    v_mul_f32 v22, v22, v21
    v_mul_f32 v23, v23, v21
    v_cvt_pk_bf16_f32 v142, v22, v23
    v_lshlrev_b32 v22, 16, v143
    v_and_b32 v23, 0xffff0000, v143
    v_mul_f32 v22, v22, v21
    v_mul_f32 v23, v23, v21
    v_cvt_pk_bf16_f32 v143, v22, v23
    s_nop 15
    v_accvgpr_read_b32 v22, a64
    v_accvgpr_read_b32 v23, a65
    v_accvgpr_read_b32 v24, a66
    v_accvgpr_read_b32 v25, a67
    v_mul_f32 v22, v22, v21
    v_mul_f32 v23, v23, v21
    v_mul_f32 v24, v24, v21
    v_mul_f32 v25, v25, v21
    v_accvgpr_write_b32 a64, v22
    v_accvgpr_write_b32 a65, v23
    v_accvgpr_write_b32 a66, v24
    v_accvgpr_write_b32 a67, v25
    v_accvgpr_read_b32 v22, a68
    v_accvgpr_read_b32 v23, a69
    v_accvgpr_read_b32 v24, a70
    v_accvgpr_read_b32 v25, a71
    v_mul_f32 v22, v22, v21
    v_mul_f32 v23, v23, v21
    v_mul_f32 v24, v24, v21
    v_mul_f32 v25, v25, v21
    v_accvgpr_write_b32 a68, v22
    v_accvgpr_write_b32 a69, v23
    v_accvgpr_write_b32 a70, v24
    v_accvgpr_write_b32 a71, v25
    v_accvgpr_read_b32 v22, a72
    v_accvgpr_read_b32 v23, a73
    v_accvgpr_read_b32 v24, a74
    v_accvgpr_read_b32 v25, a75
    v_mul_f32 v22, v22, v21
    v_mul_f32 v23, v23, v21
    v_mul_f32 v24, v24, v21
    v_mul_f32 v25, v25, v21
    v_accvgpr_write_b32 a72, v22
    v_accvgpr_write_b32 a73, v23
    v_accvgpr_write_b32 a74, v24
    v_accvgpr_write_b32 a75, v25
    v_accvgpr_read_b32 v22, a76
    v_accvgpr_read_b32 v23, a77
    v_accvgpr_read_b32 v24, a78
    v_accvgpr_read_b32 v25, a79
    v_mul_f32 v22, v22, v21
    v_mul_f32 v23, v23, v21
    v_mul_f32 v24, v24, v21
    v_mul_f32 v25, v25, v21
    v_accvgpr_write_b32 a76, v22
    v_accvgpr_write_b32 a77, v23
    v_accvgpr_write_b32 a78, v24
    v_accvgpr_write_b32 a79, v25
    v_accvgpr_read_b32 v22, a80
    v_accvgpr_read_b32 v23, a81
    v_accvgpr_read_b32 v24, a82
    v_accvgpr_read_b32 v25, a83
    v_mul_f32 v22, v22, v21
    v_mul_f32 v23, v23, v21
    v_mul_f32 v24, v24, v21
    v_mul_f32 v25, v25, v21
    v_accvgpr_write_b32 a80, v22
    v_accvgpr_write_b32 a81, v23
    v_accvgpr_write_b32 a82, v24
    v_accvgpr_write_b32 a83, v25
    v_accvgpr_read_b32 v22, a84
    v_accvgpr_read_b32 v23, a85
    v_accvgpr_read_b32 v24, a86
    v_accvgpr_read_b32 v25, a87
    v_mul_f32 v22, v22, v21
    v_mul_f32 v23, v23, v21
    v_mul_f32 v24, v24, v21
    v_mul_f32 v25, v25, v21
    v_accvgpr_write_b32 a84, v22
    v_accvgpr_write_b32 a85, v23
    v_accvgpr_write_b32 a86, v24
    v_accvgpr_write_b32 a87, v25
    v_accvgpr_read_b32 v22, a88
    v_accvgpr_read_b32 v23, a89
    v_accvgpr_read_b32 v24, a90
    v_accvgpr_read_b32 v25, a91
    v_mul_f32 v22, v22, v21
    v_mul_f32 v23, v23, v21
    v_mul_f32 v24, v24, v21
    v_mul_f32 v25, v25, v21
    v_accvgpr_write_b32 a88, v22
    v_accvgpr_write_b32 a89, v23
    v_accvgpr_write_b32 a90, v24
    v_accvgpr_write_b32 a91, v25
    v_accvgpr_read_b32 v22, a92
    v_accvgpr_read_b32 v23, a93
    v_accvgpr_read_b32 v24, a94
    v_accvgpr_read_b32 v25, a95
    v_mul_f32 v22, v22, v21
    v_mul_f32 v23, v23, v21
    v_mul_f32 v24, v24, v21
    v_mul_f32 v25, v25, v21
    v_accvgpr_write_b32 a92, v22
    v_accvgpr_write_b32 a93, v23
    v_accvgpr_write_b32 a94, v24
    v_accvgpr_write_b32 a95, v25
    v_accvgpr_read_b32 v22, a96
    v_accvgpr_read_b32 v23, a97
    v_accvgpr_read_b32 v24, a98
    v_accvgpr_read_b32 v25, a99
    v_mul_f32 v22, v22, v21
    v_mul_f32 v23, v23, v21
    v_mul_f32 v24, v24, v21
    v_mul_f32 v25, v25, v21
    v_accvgpr_write_b32 a96, v22
    v_accvgpr_write_b32 a97, v23
    v_accvgpr_write_b32 a98, v24
    v_accvgpr_write_b32 a99, v25
    v_accvgpr_read_b32 v22, a100
    v_accvgpr_read_b32 v23, a101
    v_accvgpr_read_b32 v24, a102
    v_accvgpr_read_b32 v25, a103
    v_mul_f32 v22, v22, v21
    v_mul_f32 v23, v23, v21
    v_mul_f32 v24, v24, v21
    v_mul_f32 v25, v25, v21
    v_accvgpr_write_b32 a100, v22
    v_accvgpr_write_b32 a101, v23
    v_accvgpr_write_b32 a102, v24
    v_accvgpr_write_b32 a103, v25
    v_accvgpr_read_b32 v22, a104
    v_accvgpr_read_b32 v23, a105
    v_accvgpr_read_b32 v24, a106
    v_accvgpr_read_b32 v25, a107
    v_mul_f32 v22, v22, v21
    v_mul_f32 v23, v23, v21
    v_mul_f32 v24, v24, v21
    v_mul_f32 v25, v25, v21
    v_accvgpr_write_b32 a104, v22
    v_accvgpr_write_b32 a105, v23
    v_accvgpr_write_b32 a106, v24
    v_accvgpr_write_b32 a107, v25
    v_accvgpr_read_b32 v22, a108
    v_accvgpr_read_b32 v23, a109
    v_accvgpr_read_b32 v24, a110
    v_accvgpr_read_b32 v25, a111
    v_mul_f32 v22, v22, v21
    v_mul_f32 v23, v23, v21
    v_mul_f32 v24, v24, v21
    v_mul_f32 v25, v25, v21
    v_accvgpr_write_b32 a108, v22
    v_accvgpr_write_b32 a109, v23
    v_accvgpr_write_b32 a110, v24
    v_accvgpr_write_b32 a111, v25
    v_accvgpr_read_b32 v22, a112
    v_accvgpr_read_b32 v23, a113
    v_accvgpr_read_b32 v24, a114
    v_accvgpr_read_b32 v25, a115
    v_mul_f32 v22, v22, v21
    v_mul_f32 v23, v23, v21
    v_mul_f32 v24, v24, v21
    v_mul_f32 v25, v25, v21
    v_accvgpr_write_b32 a112, v22
    v_accvgpr_write_b32 a113, v23
    v_accvgpr_write_b32 a114, v24
    v_accvgpr_write_b32 a115, v25
    v_accvgpr_read_b32 v22, a116
    v_accvgpr_read_b32 v23, a117
    v_accvgpr_read_b32 v24, a118
    v_accvgpr_read_b32 v25, a119
    v_mul_f32 v22, v22, v21
    v_mul_f32 v23, v23, v21
    v_mul_f32 v24, v24, v21
    v_mul_f32 v25, v25, v21
    v_accvgpr_write_b32 a116, v22
    v_accvgpr_write_b32 a117, v23
    v_accvgpr_write_b32 a118, v24
    v_accvgpr_write_b32 a119, v25
    v_accvgpr_read_b32 v22, a120
    v_accvgpr_read_b32 v23, a121
    v_accvgpr_read_b32 v24, a122
    v_accvgpr_read_b32 v25, a123
    v_mul_f32 v22, v22, v21
    v_mul_f32 v23, v23, v21
    v_mul_f32 v24, v24, v21
    v_mul_f32 v25, v25, v21
    v_accvgpr_write_b32 a120, v22
    v_accvgpr_write_b32 a121, v23
    v_accvgpr_write_b32 a122, v24
    v_accvgpr_write_b32 a123, v25
    v_accvgpr_read_b32 v22, a124
    v_accvgpr_read_b32 v23, a125
    v_accvgpr_read_b32 v24, a126
    v_accvgpr_read_b32 v25, a127
    v_mul_f32 v22, v22, v21
    v_mul_f32 v23, v23, v21
    v_mul_f32 v24, v24, v21
    v_mul_f32 v25, v25, v21
    v_accvgpr_write_b32 a124, v22
    v_accvgpr_write_b32 a125, v23
    v_accvgpr_write_b32 a126, v24
    v_accvgpr_write_b32 a127, v25
    s_cmp_eq_u32 s31, 0
    s_cbranch_scc1 K2_RET_1_0
    s_branch K2_RETD_1_0
K2_RARE_1_1:
    s_mov_b32 s52, 0x42000000
    v_mov_b32 v20, v14
    s_nop 1
    v_permlane32_swap_b32 v14, v20
    s_nop 1
    v_max_f32 v20, v20, v14
    v_ceil_f32 v20, v20
    v_max_f32 v20, s54, v20
    v_sub_f32 v13, v13, v20
    v_sub_f32 v64, v64, v20
    v_mov_b32 v96, v13
    v_sub_f32 v65, v65, v20
    v_mov_b32 v97, v13
    v_sub_f32 v66, v66, v20
    v_mov_b32 v98, v13
    v_sub_f32 v67, v67, v20
    v_mov_b32 v99, v13
    v_sub_f32 v68, v68, v20
    v_mov_b32 v100, v13
    v_sub_f32 v69, v69, v20
    v_mov_b32 v101, v13
    v_sub_f32 v70, v70, v20
    v_mov_b32 v102, v13
    v_sub_f32 v71, v71, v20
    v_mov_b32 v103, v13
    v_sub_f32 v72, v72, v20
    v_mov_b32 v104, v13
    v_sub_f32 v73, v73, v20
    v_mov_b32 v105, v13
    v_sub_f32 v74, v74, v20
    v_mov_b32 v106, v13
    v_sub_f32 v75, v75, v20
    v_mov_b32 v107, v13
    v_sub_f32 v76, v76, v20
    v_mov_b32 v108, v13
    v_sub_f32 v77, v77, v20
    v_mov_b32 v109, v13
    v_sub_f32 v78, v78, v20
    v_mov_b32 v110, v13
    v_sub_f32 v79, v79, v20
    v_mov_b32 v111, v13
    s_cmp_eq_u32 s54, 0
    s_cbranch_scc1 K2_RSC_1_1
    v_add_f32 v31, v10, v11
    v_mov_b32 v10, 0
    v_mov_b32 v11, 0
    s_mov_b32 s54, 0
    s_cmp_eq_u32 s31, 0
    s_cbranch_scc1 K2_RET_1_1
    s_cmp_eq_u32 s31, 2
    s_cbranch_scc1 K2_RETF_1_1
    s_branch K2_RETD_1_1
K2_RSC_1_1:
    v_sub_f32 v21, 0, v20
    v_exp_f32 v21, v21
    s_nop 0
    v_mul_f32 v10, v10, v21
    v_mul_f32 v11, v11, v21
    v_lshlrev_b32 v22, 16, v120
    v_and_b32 v23, 0xffff0000, v120
    v_mul_f32 v22, v22, v21
    v_mul_f32 v23, v23, v21
    v_cvt_pk_bf16_f32 v120, v22, v23
    v_lshlrev_b32 v22, 16, v121
    v_and_b32 v23, 0xffff0000, v121
    v_mul_f32 v22, v22, v21
    v_mul_f32 v23, v23, v21
    v_cvt_pk_bf16_f32 v121, v22, v23
    v_lshlrev_b32 v22, 16, v122
    v_and_b32 v23, 0xffff0000, v122
    v_mul_f32 v22, v22, v21
    v_mul_f32 v23, v23, v21
    v_cvt_pk_bf16_f32 v122, v22, v23
    v_lshlrev_b32 v22, 16, v123
    v_and_b32 v23, 0xffff0000, v123
    v_mul_f32 v22, v22, v21
    v_mul_f32 v23, v23, v21
    v_cvt_pk_bf16_f32 v123, v22, v23
    v_lshlrev_b32 v22, 16, v124
    v_and_b32 v23, 0xffff0000, v124
    v_mul_f32 v22, v22, v21
    v_mul_f32 v23, v23, v21
    v_cvt_pk_bf16_f32 v124, v22, v23
    v_lshlrev_b32 v22, 16, v125
    v_and_b32 v23, 0xffff0000, v125
    v_mul_f32 v22, v22, v21
    v_mul_f32 v23, v23, v21
    v_cvt_pk_bf16_f32 v125, v22, v23
    v_lshlrev_b32 v22, 16, v126
    v_and_b32 v23, 0xffff0000, v126
    v_mul_f32 v22, v22, v21
    v_mul_f32 v23, v23, v21
    v_cvt_pk_bf16_f32 v126, v22, v23
    v_lshlrev_b32 v22, 16, v127
    v_and_b32 v23, 0xffff0000, v127
    v_mul_f32 v22, v22, v21
    v_mul_f32 v23, v23, v21
    v_cvt_pk_bf16_f32 v127, v22, v23
    s_nop 15
    v_accvgpr_read_b32 v22, a64
    v_accvgpr_read_b32 v23, a65
    v_accvgpr_read_b32 v24, a66
    v_accvgpr_read_b32 v25, a67
    v_mul_f32 v22, v22, v21
    v_mul_f32 v23, v23, v21
    v_mul_f32 v24, v24, v21
    v_mul_f32 v25, v25, v21
    v_accvgpr_write_b32 a64, v22
    v_accvgpr_write_b32 a65, v23
    v_accvgpr_write_b32 a66, v24
    v_accvgpr_write_b32 a67, v25
    v_accvgpr_read_b32 v22, a68
    v_accvgpr_read_b32 v23, a69
    v_accvgpr_read_b32 v24, a70
    v_accvgpr_read_b32 v25, a71
    v_mul_f32 v22, v22, v21
    v_mul_f32 v23, v23, v21
    v_mul_f32 v24, v24, v21
    v_mul_f32 v25, v25, v21
    v_accvgpr_write_b32 a68, v22
    v_accvgpr_write_b32 a69, v23
    v_accvgpr_write_b32 a70, v24
    v_accvgpr_write_b32 a71, v25
    v_accvgpr_read_b32 v22, a72
    v_accvgpr_read_b32 v23, a73
    v_accvgpr_read_b32 v24, a74
    v_accvgpr_read_b32 v25, a75
    v_mul_f32 v22, v22, v21
    v_mul_f32 v23, v23, v21
    v_mul_f32 v24, v24, v21
    v_mul_f32 v25, v25, v21
    v_accvgpr_write_b32 a72, v22
    v_accvgpr_write_b32 a73, v23
    v_accvgpr_write_b32 a74, v24
    v_accvgpr_write_b32 a75, v25
    v_accvgpr_read_b32 v22, a76
    v_accvgpr_read_b32 v23, a77
    v_accvgpr_read_b32 v24, a78
    v_accvgpr_read_b32 v25, a79
    v_mul_f32 v22, v22, v21
    v_mul_f32 v23, v23, v21
    v_mul_f32 v24, v24, v21
    v_mul_f32 v25, v25, v21
    v_accvgpr_write_b32 a76, v22
    v_accvgpr_write_b32 a77, v23
    v_accvgpr_write_b32 a78, v24
    v_accvgpr_write_b32 a79, v25
    v_accvgpr_read_b32 v22, a80
    v_accvgpr_read_b32 v23, a81
    v_accvgpr_read_b32 v24, a82
    v_accvgpr_read_b32 v25, a83
    v_mul_f32 v22, v22, v21
    v_mul_f32 v23, v23, v21
    v_mul_f32 v24, v24, v21
    v_mul_f32 v25, v25, v21
    v_accvgpr_write_b32 a80, v22
    v_accvgpr_write_b32 a81, v23
    v_accvgpr_write_b32 a82, v24
    v_accvgpr_write_b32 a83, v25
    v_accvgpr_read_b32 v22, a84
    v_accvgpr_read_b32 v23, a85
    v_accvgpr_read_b32 v24, a86
    v_accvgpr_read_b32 v25, a87
    v_mul_f32 v22, v22, v21
    v_mul_f32 v23, v23, v21
    v_mul_f32 v24, v24, v21
    v_mul_f32 v25, v25, v21
    v_accvgpr_write_b32 a84, v22
    v_accvgpr_write_b32 a85, v23
    v_accvgpr_write_b32 a86, v24
    v_accvgpr_write_b32 a87, v25
    v_accvgpr_read_b32 v22, a88
    v_accvgpr_read_b32 v23, a89
    v_accvgpr_read_b32 v24, a90
    v_accvgpr_read_b32 v25, a91
    v_mul_f32 v22, v22, v21
    v_mul_f32 v23, v23, v21
    v_mul_f32 v24, v24, v21
    v_mul_f32 v25, v25, v21
    v_accvgpr_write_b32 a88, v22
    v_accvgpr_write_b32 a89, v23
    v_accvgpr_write_b32 a90, v24
    v_accvgpr_write_b32 a91, v25
    v_accvgpr_read_b32 v22, a92
    v_accvgpr_read_b32 v23, a93
    v_accvgpr_read_b32 v24, a94
    v_accvgpr_read_b32 v25, a95
    v_mul_f32 v22, v22, v21
    v_mul_f32 v23, v23, v21
    v_mul_f32 v24, v24, v21
    v_mul_f32 v25, v25, v21
    v_accvgpr_write_b32 a92, v22
    v_accvgpr_write_b32 a93, v23
    v_accvgpr_write_b32 a94, v24
    v_accvgpr_write_b32 a95, v25
    v_accvgpr_read_b32 v22, a96
    v_accvgpr_read_b32 v23, a97
    v_accvgpr_read_b32 v24, a98
    v_accvgpr_read_b32 v25, a99
    v_mul_f32 v22, v22, v21
    v_mul_f32 v23, v23, v21
    v_mul_f32 v24, v24, v21
    v_mul_f32 v25, v25, v21
    v_accvgpr_write_b32 a96, v22
    v_accvgpr_write_b32 a97, v23
    v_accvgpr_write_b32 a98, v24
    v_accvgpr_write_b32 a99, v25
    v_accvgpr_read_b32 v22, a100
    v_accvgpr_read_b32 v23, a101
    v_accvgpr_read_b32 v24, a102
    v_accvgpr_read_b32 v25, a103
    v_mul_f32 v22, v22, v21
    v_mul_f32 v23, v23, v21
    v_mul_f32 v24, v24, v21
    v_mul_f32 v25, v25, v21
    v_accvgpr_write_b32 a100, v22
    v_accvgpr_write_b32 a101, v23
    v_accvgpr_write_b32 a102, v24
    v_accvgpr_write_b32 a103, v25
    v_accvgpr_read_b32 v22, a104
    v_accvgpr_read_b32 v23, a105
    v_accvgpr_read_b32 v24, a106
    v_accvgpr_read_b32 v25, a107
    v_mul_f32 v22, v22, v21
    v_mul_f32 v23, v23, v21
    v_mul_f32 v24, v24, v21
    v_mul_f32 v25, v25, v21
    v_accvgpr_write_b32 a104, v22
    v_accvgpr_write_b32 a105, v23
    v_accvgpr_write_b32 a106, v24
    v_accvgpr_write_b32 a107, v25
    v_accvgpr_read_b32 v22, a108
    v_accvgpr_read_b32 v23, a109
    v_accvgpr_read_b32 v24, a110
    v_accvgpr_read_b32 v25, a111
    v_mul_f32 v22, v22, v21
    v_mul_f32 v23, v23, v21
    v_mul_f32 v24, v24, v21
    v_mul_f32 v25, v25, v21
    v_accvgpr_write_b32 a108, v22
    v_accvgpr_write_b32 a109, v23
    v_accvgpr_write_b32 a110, v24
    v_accvgpr_write_b32 a111, v25
    v_accvgpr_read_b32 v22, a112
    v_accvgpr_read_b32 v23, a113
    v_accvgpr_read_b32 v24, a114
    v_accvgpr_read_b32 v25, a115
    v_mul_f32 v22, v22, v21
    v_mul_f32 v23, v23, v21
    v_mul_f32 v24, v24, v21
    v_mul_f32 v25, v25, v21
    v_accvgpr_write_b32 a112, v22
    v_accvgpr_write_b32 a113, v23
    v_accvgpr_write_b32 a114, v24
    v_accvgpr_write_b32 a115, v25
    v_accvgpr_read_b32 v22, a116
    v_accvgpr_read_b32 v23, a117
    v_accvgpr_read_b32 v24, a118
    v_accvgpr_read_b32 v25, a119
    v_mul_f32 v22, v22, v21
    v_mul_f32 v23, v23, v21
    v_mul_f32 v24, v24, v21
    v_mul_f32 v25, v25, v21
    v_accvgpr_write_b32 a116, v22
    v_accvgpr_write_b32 a117, v23
    v_accvgpr_write_b32 a118, v24
    v_accvgpr_write_b32 a119, v25
    v_accvgpr_read_b32 v22, a120
    v_accvgpr_read_b32 v23, a121
    v_accvgpr_read_b32 v24, a122
    v_accvgpr_read_b32 v25, a123
    v_mul_f32 v22, v22, v21
    v_mul_f32 v23, v23, v21
    v_mul_f32 v24, v24, v21
    v_mul_f32 v25, v25, v21
    v_accvgpr_write_b32 a120, v22
    v_accvgpr_write_b32 a121, v23
    v_accvgpr_write_b32 a122, v24
    v_accvgpr_write_b32 a123, v25
    v_accvgpr_read_b32 v22, a124
    v_accvgpr_read_b32 v23, a125
    v_accvgpr_read_b32 v24, a126
    v_accvgpr_read_b32 v25, a127
    v_mul_f32 v22, v22, v21
    v_mul_f32 v23, v23, v21
    v_mul_f32 v24, v24, v21
    v_mul_f32 v25, v25, v21
    v_accvgpr_write_b32 a124, v22
    v_accvgpr_write_b32 a125, v23
    v_accvgpr_write_b32 a126, v24
    v_accvgpr_write_b32 a127, v25
    s_cmp_eq_u32 s31, 0
    s_cbranch_scc1 K2_RET_1_1
    s_cmp_eq_u32 s31, 2
    s_cbranch_scc1 K2_RETF_1_1
    s_branch K2_RETD_1_1
K2_EVENT:
    s_sub_u32 s37, s39, 3
    s_cmp_gt_u32 s37, 2
    s_cbranch_scc1 K2_EV0
    s_cmp_eq_u32 s37, 2
    s_cbranch_scc1 K2_ZN2
    s_cmp_eq_u32 s37, 1
    s_cbranch_scc1 K2_ZN0
    s_lshr_b32 s98, s2, 3
    s_lshl_b32 s98, s98, 7
    s_add_u32 s98, s98, 42622976
    v_and_b32 v240, 7, v0
    v_lshlrev_b32 v240, 4, v240
    buffer_load_ubyte v241, v240, s[20:23], s98 offen sc0 sc1
    s_branch K2_EV0
K2_ZN0:
    s_waitcnt vmcnt(17)
    v_cmp_ne_u32 vcc, 1, v241
    s_nop 1
    s_cbranch_vccz K2_ZN1
K2_ZNLP:
    s_sleep 2
    buffer_load_ubyte v241, v240, s[20:23], s98 offen sc0 sc1
    s_waitcnt vmcnt(0)
    v_cmp_ne_u32 vcc, 1, v241
    s_nop 1
    s_cbranch_vccnz K2_ZNLP
K2_ZN1:
    s_lshr_b32 s62, s2, 3
    s_and_b32 s60, s2, 7
    s_lshl_b32 s37, s62, 1
    s_add_u32 s37, s37, s35
    s_lshl_b32 s37, s37, 11
    s_add_u32 s37, s37, 41943040
    v_lshlrev_b32 v40, 2, v0
    buffer_load_dword v32, v40, s[20:23], s37 offen offset:0 sc1
    buffer_load_dword v33, v40, s[20:23], s37 offen offset:256 sc1
    buffer_load_dword v34, v40, s[20:23], s37 offen offset:512 sc1
    buffer_load_dword v35, v40, s[20:23], s37 offen offset:768 sc1
    buffer_load_dword v36, v40, s[20:23], s37 offen offset:1024 sc1
    buffer_load_dword v37, v40, s[20:23], s37 offen offset:1280 sc1
    buffer_load_dword v38, v40, s[20:23], s37 offen offset:1536 sc1
    buffer_load_dword v39, v40, s[20:23], s37 offen offset:1792 sc1
    s_mul_i32 s61, s60, 384
    s_lshl_b32 s37, s62, 2
    s_add_u32 s61, s61, s37
    s_add_u32 s61, s61, s32
    s_lshl_b32 s61, s61, 10
    s_add_u32 s37, s61, 67108864
    buffer_load_dwordx4 v[208:211], v1, s[20:23], s37 offen sc1
    s_add_u32 s37, s61, 67239936
    buffer_load_dwordx4 v[212:215], v1, s[20:23], s37 offen sc1
    s_add_u32 s37, s61, 67371008
    buffer_load_dwordx4 v[216:219], v1, s[20:23], s37 offen sc1
    s_lshl_b32 s60, s60, 8
    s_add_u32 s60, s60, s62
    s_add_u32 s60, s60, 42532864
    s_branch K2_EV0
K2_ZN2:
    s_waitcnt vmcnt(17)
    v_add_f32 v32, v32, v33
    v_add_f32 v34, v34, v35
    v_add_f32 v36, v36, v37
    v_add_f32 v38, v38, v39
    v_add_f32 v32, v32, v34
    v_add_f32 v36, v36, v38
    v_add_f32 v32, v32, v36
    v_mul_f32 v32, 0x3abe82fa, v32
    v_mov_b32 v33, v32
    s_lshl_b32 s37, s32, 8
    s_add_u32 s37, s37, 131072
    v_permlane32_swap_b32 v32, v33
    v_and_b32 v40, 31, v0
    v_lshrrev_b32 v41, 5, v0
    v_fma_f32 v33, -v32, v32, v33
    v_max_f32 v33, 0, v33
    v_add_f32 v33, 0x3727c5ac, v33
    v_rsq_f32 v33, v33
    v_lshlrev_b32 v40, 2, v40
    v_add_u32 v40, s37, v40
    v_mul_f32 v32, v32, v33
    v_sub_f32 v32, 0, v32
    ds_write_b32 v40, v33
    ds_write_b32 v40, v32 offset:128
    s_lshl_b32 s38, s36, 6
    s_add_u32 s37, s37, s38
    v_lshlrev_b32 v41, 5, v41
    v_add_u32 v41, s37, v41
    ds_read_b128 v[240:243], v41 offset:0
    ds_read_b128 v[220:223], v41 offset:128
    ds_read_b128 v[244:247], v41 offset:16
    ds_read_b128 v[44:47], v41 offset:144
    s_waitcnt lgkmcnt(0)
    v_lshlrev_b32 v32, 16, v208
    v_and_b32 v33, 0xffff0000, v208
    v_fma_f32 v32, v32, v240, v220
    v_fma_f32 v33, v33, v241, v221
    v_cvt_pk_bf16_f32 v208, v32, v33
    v_lshlrev_b32 v32, 16, v209
    v_and_b32 v33, 0xffff0000, v209
    v_fma_f32 v32, v32, v242, v222
    v_fma_f32 v33, v33, v243, v223
    v_cvt_pk_bf16_f32 v209, v32, v33
    v_lshlrev_b32 v32, 16, v210
    v_and_b32 v33, 0xffff0000, v210
    v_fma_f32 v32, v32, v244, v44
    v_fma_f32 v33, v33, v245, v45
    v_cvt_pk_bf16_f32 v210, v32, v33
    v_lshlrev_b32 v32, 16, v211
    v_and_b32 v33, 0xffff0000, v211
    v_fma_f32 v32, v32, v246, v46
    v_fma_f32 v33, v33, v247, v47
    v_cvt_pk_bf16_f32 v211, v32, v33
    s_add_u32 s37, s61, 38797312
    buffer_store_dwordx4 v[208:211], v1, s[20:23], s37 offen sc1
    v_lshlrev_b32 v32, 16, v212
    v_and_b32 v33, 0xffff0000, v212
    v_fma_f32 v32, v32, v240, v220
    v_fma_f32 v33, v33, v241, v221
    v_cvt_pk_bf16_f32 v212, v32, v33
    v_lshlrev_b32 v32, 16, v213
    v_and_b32 v33, 0xffff0000, v213
    v_fma_f32 v32, v32, v242, v222
    v_fma_f32 v33, v33, v243, v223
    v_cvt_pk_bf16_f32 v213, v32, v33
    v_lshlrev_b32 v32, 16, v214
    v_and_b32 v33, 0xffff0000, v214
    v_fma_f32 v32, v32, v244, v44
    v_fma_f32 v33, v33, v245, v45
    v_cvt_pk_bf16_f32 v214, v32, v33
    v_lshlrev_b32 v32, 16, v215
    v_and_b32 v33, 0xffff0000, v215
    v_fma_f32 v32, v32, v246, v46
    v_fma_f32 v33, v33, v247, v47
    v_cvt_pk_bf16_f32 v215, v32, v33
    s_add_u32 s37, s61, 38928384
    buffer_store_dwordx4 v[212:215], v1, s[20:23], s37 offen sc1
    v_lshlrev_b32 v32, 16, v216
    v_and_b32 v33, 0xffff0000, v216
    v_fma_f32 v32, v32, v240, v220
    v_fma_f32 v33, v33, v241, v221
    v_cvt_pk_bf16_f32 v216, v32, v33
    v_lshlrev_b32 v32, 16, v217
    v_and_b32 v33, 0xffff0000, v217
    v_fma_f32 v32, v32, v242, v222
    v_fma_f32 v33, v33, v243, v223
    v_cvt_pk_bf16_f32 v217, v32, v33
    v_lshlrev_b32 v32, 16, v218
    v_and_b32 v33, 0xffff0000, v218
    v_fma_f32 v32, v32, v244, v44
    v_fma_f32 v33, v33, v245, v45
    v_cvt_pk_bf16_f32 v218, v32, v33
    v_lshlrev_b32 v32, 16, v219
    v_and_b32 v33, 0xffff0000, v219
    v_fma_f32 v32, v32, v246, v46
    v_fma_f32 v33, v33, v247, v47
    v_cvt_pk_bf16_f32 v219, v32, v33
    s_add_u32 s37, s61, 39059456
    buffer_store_dwordx4 v[216:219], v1, s[20:23], s37 offen sc1
K2_EV0:
    s_add_u32 s37, s39, 1
    s_cmp_eq_u32 s37, s40
    s_cselect_b32 s37, s35, 0
    s_lshl_b32 s37, s37, 14
    v_add_u32 v3, s37, v3
    s_mov_b32 s31, 0
    s_cmp_lg_u32 s39, s40
    s_cbranch_scc1 K2_EV2
    s_cmp_eq_u32 s35, 0
    s_cbranch_scc1 K2_SW0
    v_add_u32 v2, 0x4000, v2
    v_add_u32 v5, 0x4000, v5
    s_mov_b32 s41, 15
    s_mov_b32 s42, 0x20000000
    v_accvgpr_write_b32 a128, v144
    v_accvgpr_write_b32 a129, v145
    v_accvgpr_write_b32 a130, v146
    v_accvgpr_write_b32 a131, v147
    v_accvgpr_write_b32 a132, v148
    v_accvgpr_write_b32 a133, v149
    v_accvgpr_write_b32 a134, v150
    v_accvgpr_write_b32 a135, v151
    v_accvgpr_write_b32 a136, v152
    v_accvgpr_write_b32 a137, v153
    v_accvgpr_write_b32 a138, v154
    v_accvgpr_write_b32 a139, v155
    v_accvgpr_write_b32 a140, v156
    v_accvgpr_write_b32 a141, v157
    v_accvgpr_write_b32 a142, v158
    v_accvgpr_write_b32 a143, v159
    v_accvgpr_write_b32 a144, v160
    v_accvgpr_write_b32 a145, v161
    v_accvgpr_write_b32 a146, v162
    v_accvgpr_write_b32 a147, v163
    v_accvgpr_write_b32 a148, v164
    v_accvgpr_write_b32 a149, v165
    v_accvgpr_write_b32 a150, v166
    v_accvgpr_write_b32 a151, v167
    v_accvgpr_write_b32 a152, v168
    v_accvgpr_write_b32 a153, v169
    v_accvgpr_write_b32 a154, v170
    v_accvgpr_write_b32 a155, v171
    v_accvgpr_write_b32 a156, v172
    v_accvgpr_write_b32 a157, v173
    v_accvgpr_write_b32 a158, v174
    v_accvgpr_write_b32 a159, v175
    v_accvgpr_write_b32 a160, v176
    v_accvgpr_write_b32 a161, v177
    v_accvgpr_write_b32 a162, v178
    v_accvgpr_write_b32 a163, v179
    v_accvgpr_write_b32 a164, v180
    v_accvgpr_write_b32 a165, v181
    v_accvgpr_write_b32 a166, v182
    v_accvgpr_write_b32 a167, v183
    v_accvgpr_write_b32 a168, v184
    v_accvgpr_write_b32 a169, v185
    v_accvgpr_write_b32 a170, v186
    v_accvgpr_write_b32 a171, v187
    v_accvgpr_write_b32 a172, v188
    v_accvgpr_write_b32 a173, v189
    v_accvgpr_write_b32 a174, v190
    v_accvgpr_write_b32 a175, v191
    v_accvgpr_write_b32 a176, v192
    v_accvgpr_write_b32 a177, v193
    v_accvgpr_write_b32 a178, v194
    v_accvgpr_write_b32 a179, v195
    v_accvgpr_write_b32 a180, v196
    v_accvgpr_write_b32 a181, v197
    v_accvgpr_write_b32 a182, v198
    v_accvgpr_write_b32 a183, v199
    v_accvgpr_write_b32 a184, v200
    v_accvgpr_write_b32 a185, v201
    v_accvgpr_write_b32 a186, v202
    v_accvgpr_write_b32 a187, v203
    v_accvgpr_write_b32 a188, v204
    v_accvgpr_write_b32 a189, v205
    v_accvgpr_write_b32 a190, v206
    v_accvgpr_write_b32 a191, v207
    v_mov_b32 v80, 0
    v_mov_b32 v81, 0
    v_mov_b32 v82, 0
    v_mov_b32 v83, 0
    v_mov_b32 v84, 0
    v_mov_b32 v85, 0
    v_mov_b32 v86, 0
    v_mov_b32 v87, 0
    v_mov_b32 v88, 0
    v_mov_b32 v89, 0
    v_mov_b32 v90, 0
    v_mov_b32 v91, 0
    v_mov_b32 v92, 0
    v_mov_b32 v93, 0
    v_mov_b32 v94, 0
    v_mov_b32 v95, 0
    v_mov_b32 v96, 0
    v_mov_b32 v97, 0
    v_mov_b32 v98, 0
    v_mov_b32 v99, 0
    v_mov_b32 v100, 0
    v_mov_b32 v101, 0
    v_mov_b32 v102, 0
    v_mov_b32 v103, 0
    v_mov_b32 v104, 0
    v_mov_b32 v105, 0
    v_mov_b32 v106, 0
    v_mov_b32 v107, 0
    v_mov_b32 v108, 0
    v_mov_b32 v109, 0
    v_mov_b32 v110, 0
    v_mov_b32 v111, 0
    v_mov_b32 v12, 0
    v_mov_b32 v13, 0
    s_mov_b32 s51, 0xff800000
    s_mov_b32 s53, 0xff800000
    s_mov_b32 s52, 0xff800000
    s_mov_b32 s54, 0xff800000
    s_mov_b32 s43, 17
    s_sub_u32 s44, 15, s34
    s_lshl_b32 s44, s44, 1
    s_add_u32 s44, s44, s36
    s_branch K2_EV2
K2_SW0:
    s_cmp_eq_u32 s39, 13
    s_cbranch_scc1 K2_SW1
    s_cmp_eq_u32 s39, 12
    s_cbranch_scc1 K2_SW2
    s_mov_b32 s24, s28
    s_mov_b32 s25, s29
    s_mov_b32 s26, 0x400000
    s_lshl_b32 s76, s2, 1
    s_add_u32 s76, s76, s32
    s_lshl_b32 s76, s76, 10
    s_mov_b32 s30, 0x80000
    s_mov_b32 s40, 12
    s_cmp_lg_u32 s32, 0
    s_cbranch_scc1 K2_EV2
    v_mov_b32 v240, 1
    v_mov_b32 v241, 0
    s_mov_b64 exec, 1
    buffer_store_byte v240, v241, s[20:23], s60 offen sc0 sc1
    s_mov_b64 exec, -1
    s_branch K2_EV2
K2_SW2:
    v_and_b32 v240, 31, v0
    buffer_load_ubyte v241, v240, s[20:23], s63 offen sc0 sc1
    s_mov_b32 s40, 13
    s_branch K2_EV2
K2_SW1:
    s_waitcnt vmcnt(17)
    v_cmp_ne_u32 vcc, 1, v241
    s_nop 1
    s_cbranch_vccz K2_EV2
K2_FBLP:
    s_sleep 2
    buffer_load_ubyte v241, v240, s[20:23], s63 offen sc0 sc1
    s_waitcnt vmcnt(0)
    v_cmp_ne_u32 vcc, 1, v241
    s_nop 1
    s_cbranch_vccnz K2_FBLP
K2_EV2:
    s_cmp_lt_u32 s43, s44
    s_cbranch_scc0 K2_EV3
    s_cmp_eq_u32 s53, 0
    s_cbranch_scc1 K2_EV4
    s_mov_b32 s51, 0x42000000
    s_mov_b32 s53, 0
    s_mov_b32 s52, 0x42000000
    s_mov_b32 s54, 0
    s_add_u32 s77, s39, 1
    s_mov_b32 s31, 2
    s_branch K2_SWRETF
K2_EV4:
    s_sub_u32 s77, s44, s43
    s_add_u32 s77, s77, s39
    s_cmp_gt_u32 s40, s39
    s_cselect_b32 s37, s40, 99
    s_min_u32 s77, s77, s37
    s_add_u32 s37, s39, 1
    s_max_u32 s37, s37, 3
    s_cmp_le_u32 s37, 5
    s_cselect_b32 s37, s37, 99
    s_min_u32 s77, s77, s37
    s_branch K2_SWRET
K2_EV3:
    s_add_u32 s77, s39, 1
    s_mov_b32 s31, 1
    s_cmp_eq_u32 s43, s44
    s_cbranch_scc1 K2_SWRETD
    s_mov_b32 s31, 3
    s_branch K2_SWRETX
K2_FINB:
K2_FBB:
    s_cmp_eq_u32 s53, 0
    s_cbranch_scc1 K2_FB1
    v_add_f32 v30, v8, v9
    v_mov_b32 v8, 0
    v_mov_b32 v9, 0
    v_sub_f32 v12, 0, v7
    v_add_f32 v31, v10, v11
    v_mov_b32 v10, 0
    v_mov_b32 v11, 0
    v_sub_f32 v13, 0, v7
K2_FB1:
    v_mov_b32 v144, v30
    v_mov_b32 v146, v31
    s_nop 1
    v_permlane32_swap_b32 v30, v144
    v_permlane32_swap_b32 v31, v146
    s_nop 1
    v_add_f32 v144, v144, v30
    v_rcp_f32 v144, v144
    v_add_f32 v146, v146, v31
    v_rcp_f32 v146, v146
    s_lshl_b32 s37, s34, 2
    s_lshl_b32 s38, s36, 1
    s_add_u32 s37, s37, s38
    v_mov_b32 v145, v144
    v_mov_b32 v147, v146
    s_mul_i32 s37, s37, 304
    s_lshl_b32 s38, s33, 3
    s_add_u32 s37, s37, s38
    s_lshl_b32 s37, s37, 10
    s_add_u32 s37, s37, 42991616
    v_mov_b32 v148, 0
    v_mov_b32 v149, 0
    v_mov_b32 v150, 0
    v_mov_b32 v151, 0
    v_accvgpr_read_b32 v152, a0
    v_accvgpr_read_b32 v153, a1
    v_accvgpr_read_b32 v154, a2
    v_accvgpr_read_b32 v155, a3
    v_accvgpr_read_b32 v156, a4
    v_accvgpr_read_b32 v157, a5
    v_accvgpr_read_b32 v158, a6
    v_accvgpr_read_b32 v159, a7
    v_pk_mul_f32 v[152:153], v[152:153], v[144:145]
    v_pk_mul_f32 v[154:155], v[154:155], v[144:145]
    v_pk_mul_f32 v[156:157], v[156:157], v[144:145]
    v_pk_mul_f32 v[158:159], v[158:159], v[144:145]
    v_cvt_pk_bf16_f32 v152, v152, v153
    v_cvt_pk_bf16_f32 v153, v154, v155
    v_cvt_pk_bf16_f32 v154, v156, v157
    v_cvt_pk_bf16_f32 v155, v158, v159
    buffer_store_dwordx4 v[152:155], v1, s[20:23], s37 offen offset:0 sc1
    v_accvgpr_read_b32 v160, a8
    v_accvgpr_read_b32 v161, a9
    v_accvgpr_read_b32 v162, a10
    v_accvgpr_read_b32 v163, a11
    v_accvgpr_read_b32 v164, a12
    v_accvgpr_read_b32 v165, a13
    v_accvgpr_read_b32 v166, a14
    v_accvgpr_read_b32 v167, a15
    v_mfma_f32_32x32x16_bf16 a[0:15], v[148:151], v[148:151], 0
    v_pk_mul_f32 v[160:161], v[160:161], v[144:145]
    v_pk_mul_f32 v[162:163], v[162:163], v[144:145]
    v_pk_mul_f32 v[164:165], v[164:165], v[144:145]
    v_pk_mul_f32 v[166:167], v[166:167], v[144:145]
    v_cvt_pk_bf16_f32 v160, v160, v161
    v_cvt_pk_bf16_f32 v161, v162, v163
    v_cvt_pk_bf16_f32 v162, v164, v165
    v_cvt_pk_bf16_f32 v163, v166, v167
    buffer_store_dwordx4 v[160:163], v1, s[20:23], s37 offen offset:1024 sc1
    v_accvgpr_read_b32 v168, a16
    v_accvgpr_read_b32 v169, a17
    v_accvgpr_read_b32 v170, a18
    v_accvgpr_read_b32 v171, a19
    v_accvgpr_read_b32 v172, a20
    v_accvgpr_read_b32 v173, a21
    v_accvgpr_read_b32 v174, a22
    v_accvgpr_read_b32 v175, a23
    v_pk_mul_f32 v[168:169], v[168:169], v[144:145]
    v_pk_mul_f32 v[170:171], v[170:171], v[144:145]
    v_pk_mul_f32 v[172:173], v[172:173], v[144:145]
    v_pk_mul_f32 v[174:175], v[174:175], v[144:145]
    v_cvt_pk_bf16_f32 v168, v168, v169
    v_cvt_pk_bf16_f32 v169, v170, v171
    v_cvt_pk_bf16_f32 v170, v172, v173
    v_cvt_pk_bf16_f32 v171, v174, v175
    buffer_store_dwordx4 v[168:171], v1, s[20:23], s37 offen offset:2048 sc1
    v_accvgpr_read_b32 v176, a24
    v_accvgpr_read_b32 v177, a25
    v_accvgpr_read_b32 v178, a26
    v_accvgpr_read_b32 v179, a27
    v_accvgpr_read_b32 v180, a28
    v_accvgpr_read_b32 v181, a29
    v_accvgpr_read_b32 v182, a30
    v_accvgpr_read_b32 v183, a31
    v_mfma_f32_32x32x16_bf16 a[16:31], v[148:151], v[148:151], 0
    v_pk_mul_f32 v[176:177], v[176:177], v[144:145]
    v_pk_mul_f32 v[178:179], v[178:179], v[144:145]
    v_pk_mul_f32 v[180:181], v[180:181], v[144:145]
    v_pk_mul_f32 v[182:183], v[182:183], v[144:145]
    v_cvt_pk_bf16_f32 v176, v176, v177
    v_cvt_pk_bf16_f32 v177, v178, v179
    v_cvt_pk_bf16_f32 v178, v180, v181
    v_cvt_pk_bf16_f32 v179, v182, v183
    buffer_store_dwordx4 v[176:179], v1, s[20:23], s37 offen offset:3072 sc1
    s_add_u32 s37, s37, 4096
    v_accvgpr_read_b32 v152, a32
    v_accvgpr_read_b32 v153, a33
    v_accvgpr_read_b32 v154, a34
    v_accvgpr_read_b32 v155, a35
    v_accvgpr_read_b32 v156, a36
    v_accvgpr_read_b32 v157, a37
    v_accvgpr_read_b32 v158, a38
    v_accvgpr_read_b32 v159, a39
    v_pk_mul_f32 v[152:153], v[152:153], v[144:145]
    v_pk_mul_f32 v[154:155], v[154:155], v[144:145]
    v_pk_mul_f32 v[156:157], v[156:157], v[144:145]
    v_pk_mul_f32 v[158:159], v[158:159], v[144:145]
    v_cvt_pk_bf16_f32 v152, v152, v153
    v_cvt_pk_bf16_f32 v153, v154, v155
    v_cvt_pk_bf16_f32 v154, v156, v157
    v_cvt_pk_bf16_f32 v155, v158, v159
    buffer_store_dwordx4 v[152:155], v1, s[20:23], s37 offen offset:0 sc1
    v_accvgpr_read_b32 v160, a40
    v_accvgpr_read_b32 v161, a41
    v_accvgpr_read_b32 v162, a42
    v_accvgpr_read_b32 v163, a43
    v_accvgpr_read_b32 v164, a44
    v_accvgpr_read_b32 v165, a45
    v_accvgpr_read_b32 v166, a46
    v_accvgpr_read_b32 v167, a47
    v_mfma_f32_32x32x16_bf16 a[32:47], v[148:151], v[148:151], 0
    v_pk_mul_f32 v[160:161], v[160:161], v[144:145]
    v_pk_mul_f32 v[162:163], v[162:163], v[144:145]
    v_pk_mul_f32 v[164:165], v[164:165], v[144:145]
    v_pk_mul_f32 v[166:167], v[166:167], v[144:145]
    v_cvt_pk_bf16_f32 v160, v160, v161
    v_cvt_pk_bf16_f32 v161, v162, v163
    v_cvt_pk_bf16_f32 v162, v164, v165
    v_cvt_pk_bf16_f32 v163, v166, v167
    buffer_store_dwordx4 v[160:163], v1, s[20:23], s37 offen offset:1024 sc1
    v_accvgpr_read_b32 v168, a48
    v_accvgpr_read_b32 v169, a49
    v_accvgpr_read_b32 v170, a50
    v_accvgpr_read_b32 v171, a51
    v_accvgpr_read_b32 v172, a52
    v_accvgpr_read_b32 v173, a53
    v_accvgpr_read_b32 v174, a54
    v_accvgpr_read_b32 v175, a55
    v_pk_mul_f32 v[168:169], v[168:169], v[144:145]
    v_pk_mul_f32 v[170:171], v[170:171], v[144:145]
    v_pk_mul_f32 v[172:173], v[172:173], v[144:145]
    v_pk_mul_f32 v[174:175], v[174:175], v[144:145]
    v_cvt_pk_bf16_f32 v168, v168, v169
    v_cvt_pk_bf16_f32 v169, v170, v171
    v_cvt_pk_bf16_f32 v170, v172, v173
    v_cvt_pk_bf16_f32 v171, v174, v175
    buffer_store_dwordx4 v[168:171], v1, s[20:23], s37 offen offset:2048 sc1
    v_accvgpr_read_b32 v176, a56
    v_accvgpr_read_b32 v177, a57
    v_accvgpr_read_b32 v178, a58
    v_accvgpr_read_b32 v179, a59
    v_accvgpr_read_b32 v180, a60
    v_accvgpr_read_b32 v181, a61
    v_accvgpr_read_b32 v182, a62
    v_accvgpr_read_b32 v183, a63
    v_mfma_f32_32x32x16_bf16 a[48:63], v[148:151], v[148:151], 0
    v_pk_mul_f32 v[176:177], v[176:177], v[144:145]
    v_pk_mul_f32 v[178:179], v[178:179], v[144:145]
    v_pk_mul_f32 v[180:181], v[180:181], v[144:145]
    v_pk_mul_f32 v[182:183], v[182:183], v[144:145]
    v_cvt_pk_bf16_f32 v176, v176, v177
    v_cvt_pk_bf16_f32 v177, v178, v179
    v_cvt_pk_bf16_f32 v178, v180, v181
    v_cvt_pk_bf16_f32 v179, v182, v183
    buffer_store_dwordx4 v[176:179], v1, s[20:23], s37 offen offset:3072 sc1
    s_add_u32 s37, s37, 307200
    v_accvgpr_read_b32 v152, a64
    v_accvgpr_read_b32 v153, a65
    v_accvgpr_read_b32 v154, a66
    v_accvgpr_read_b32 v155, a67
    v_accvgpr_read_b32 v156, a68
    v_accvgpr_read_b32 v157, a69
    v_accvgpr_read_b32 v158, a70
    v_accvgpr_read_b32 v159, a71
    v_pk_mul_f32 v[152:153], v[152:153], v[146:147]
    v_pk_mul_f32 v[154:155], v[154:155], v[146:147]
    v_pk_mul_f32 v[156:157], v[156:157], v[146:147]
    v_pk_mul_f32 v[158:159], v[158:159], v[146:147]
    v_cvt_pk_bf16_f32 v152, v152, v153
    v_cvt_pk_bf16_f32 v153, v154, v155
    v_cvt_pk_bf16_f32 v154, v156, v157
    v_cvt_pk_bf16_f32 v155, v158, v159
    buffer_store_dwordx4 v[152:155], v1, s[20:23], s37 offen offset:0 sc1
    v_accvgpr_read_b32 v160, a72
    v_accvgpr_read_b32 v161, a73
    v_accvgpr_read_b32 v162, a74
    v_accvgpr_read_b32 v163, a75
    v_accvgpr_read_b32 v164, a76
    v_accvgpr_read_b32 v165, a77
    v_accvgpr_read_b32 v166, a78
    v_accvgpr_read_b32 v167, a79
    v_mfma_f32_32x32x16_bf16 a[64:79], v[148:151], v[148:151], 0
    v_pk_mul_f32 v[160:161], v[160:161], v[146:147]
    v_pk_mul_f32 v[162:163], v[162:163], v[146:147]
    v_pk_mul_f32 v[164:165], v[164:165], v[146:147]
    v_pk_mul_f32 v[166:167], v[166:167], v[146:147]
    v_cvt_pk_bf16_f32 v160, v160, v161
    v_cvt_pk_bf16_f32 v161, v162, v163
    v_cvt_pk_bf16_f32 v162, v164, v165
    v_cvt_pk_bf16_f32 v163, v166, v167
    buffer_store_dwordx4 v[160:163], v1, s[20:23], s37 offen offset:1024 sc1
    v_accvgpr_read_b32 v168, a80
    v_accvgpr_read_b32 v169, a81
    v_accvgpr_read_b32 v170, a82
    v_accvgpr_read_b32 v171, a83
    v_accvgpr_read_b32 v172, a84
    v_accvgpr_read_b32 v173, a85
    v_accvgpr_read_b32 v174, a86
    v_accvgpr_read_b32 v175, a87
    v_pk_mul_f32 v[168:169], v[168:169], v[146:147]
    v_pk_mul_f32 v[170:171], v[170:171], v[146:147]
    v_pk_mul_f32 v[172:173], v[172:173], v[146:147]
    v_pk_mul_f32 v[174:175], v[174:175], v[146:147]
    v_cvt_pk_bf16_f32 v168, v168, v169
    v_cvt_pk_bf16_f32 v169, v170, v171
    v_cvt_pk_bf16_f32 v170, v172, v173
    v_cvt_pk_bf16_f32 v171, v174, v175
    buffer_store_dwordx4 v[168:171], v1, s[20:23], s37 offen offset:2048 sc1
    v_accvgpr_read_b32 v176, a88
    v_accvgpr_read_b32 v177, a89
    v_accvgpr_read_b32 v178, a90
    v_accvgpr_read_b32 v179, a91
    v_accvgpr_read_b32 v180, a92
    v_accvgpr_read_b32 v181, a93
    v_accvgpr_read_b32 v182, a94
    v_accvgpr_read_b32 v183, a95
    v_mfma_f32_32x32x16_bf16 a[80:95], v[148:151], v[148:151], 0
    v_pk_mul_f32 v[176:177], v[176:177], v[146:147]
    v_pk_mul_f32 v[178:179], v[178:179], v[146:147]
    v_pk_mul_f32 v[180:181], v[180:181], v[146:147]
    v_pk_mul_f32 v[182:183], v[182:183], v[146:147]
    v_cvt_pk_bf16_f32 v176, v176, v177
    v_cvt_pk_bf16_f32 v177, v178, v179
    v_cvt_pk_bf16_f32 v178, v180, v181
    v_cvt_pk_bf16_f32 v179, v182, v183
    buffer_store_dwordx4 v[176:179], v1, s[20:23], s37 offen offset:3072 sc1
    s_add_u32 s37, s37, 4096
    v_accvgpr_read_b32 v152, a96
    v_accvgpr_read_b32 v153, a97
    v_accvgpr_read_b32 v154, a98
    v_accvgpr_read_b32 v155, a99
    v_accvgpr_read_b32 v156, a100
    v_accvgpr_read_b32 v157, a101
    v_accvgpr_read_b32 v158, a102
    v_accvgpr_read_b32 v159, a103
    v_pk_mul_f32 v[152:153], v[152:153], v[146:147]
    v_pk_mul_f32 v[154:155], v[154:155], v[146:147]
    v_pk_mul_f32 v[156:157], v[156:157], v[146:147]
    v_pk_mul_f32 v[158:159], v[158:159], v[146:147]
    v_cvt_pk_bf16_f32 v152, v152, v153
    v_cvt_pk_bf16_f32 v153, v154, v155
    v_cvt_pk_bf16_f32 v154, v156, v157
    v_cvt_pk_bf16_f32 v155, v158, v159
    buffer_store_dwordx4 v[152:155], v1, s[20:23], s37 offen offset:0 sc1
    v_accvgpr_read_b32 v160, a104
    v_accvgpr_read_b32 v161, a105
    v_accvgpr_read_b32 v162, a106
    v_accvgpr_read_b32 v163, a107
    v_accvgpr_read_b32 v164, a108
    v_accvgpr_read_b32 v165, a109
    v_accvgpr_read_b32 v166, a110
    v_accvgpr_read_b32 v167, a111
    v_mfma_f32_32x32x16_bf16 a[96:111], v[148:151], v[148:151], 0
    v_pk_mul_f32 v[160:161], v[160:161], v[146:147]
    v_pk_mul_f32 v[162:163], v[162:163], v[146:147]
    v_pk_mul_f32 v[164:165], v[164:165], v[146:147]
    v_pk_mul_f32 v[166:167], v[166:167], v[146:147]
    v_cvt_pk_bf16_f32 v160, v160, v161
    v_cvt_pk_bf16_f32 v161, v162, v163
    v_cvt_pk_bf16_f32 v162, v164, v165
    v_cvt_pk_bf16_f32 v163, v166, v167
    buffer_store_dwordx4 v[160:163], v1, s[20:23], s37 offen offset:1024 sc1
    v_accvgpr_read_b32 v168, a112
    v_accvgpr_read_b32 v169, a113
    v_accvgpr_read_b32 v170, a114
    v_accvgpr_read_b32 v171, a115
    v_accvgpr_read_b32 v172, a116
    v_accvgpr_read_b32 v173, a117
    v_accvgpr_read_b32 v174, a118
    v_accvgpr_read_b32 v175, a119
    v_pk_mul_f32 v[168:169], v[168:169], v[146:147]
    v_pk_mul_f32 v[170:171], v[170:171], v[146:147]
    v_pk_mul_f32 v[172:173], v[172:173], v[146:147]
    v_pk_mul_f32 v[174:175], v[174:175], v[146:147]
    v_cvt_pk_bf16_f32 v168, v168, v169
    v_cvt_pk_bf16_f32 v169, v170, v171
    v_cvt_pk_bf16_f32 v170, v172, v173
    v_cvt_pk_bf16_f32 v171, v174, v175
    buffer_store_dwordx4 v[168:171], v1, s[20:23], s37 offen offset:2048 sc1
    v_accvgpr_read_b32 v176, a120
    v_accvgpr_read_b32 v177, a121
    v_accvgpr_read_b32 v178, a122
    v_accvgpr_read_b32 v179, a123
    v_accvgpr_read_b32 v180, a124
    v_accvgpr_read_b32 v181, a125
    v_accvgpr_read_b32 v182, a126
    v_accvgpr_read_b32 v183, a127
    v_mfma_f32_32x32x16_bf16 a[112:127], v[148:151], v[148:151], 0
    v_pk_mul_f32 v[176:177], v[176:177], v[146:147]
    v_pk_mul_f32 v[178:179], v[178:179], v[146:147]
    v_pk_mul_f32 v[180:181], v[180:181], v[146:147]
    v_pk_mul_f32 v[182:183], v[182:183], v[146:147]
    v_cvt_pk_bf16_f32 v176, v176, v177
    v_cvt_pk_bf16_f32 v177, v178, v179
    v_cvt_pk_bf16_f32 v178, v180, v181
    v_cvt_pk_bf16_f32 v179, v182, v183
    buffer_store_dwordx4 v[176:179], v1, s[20:23], s37 offen offset:3072 sc1
K2_FBX:
    s_cmp_eq_u32 s31, 2
    s_cbranch_scc1 K2_FBRETF
    s_cmp_eq_u32 s31, 3
    s_cbranch_scc1 K2_FBRETX
    s_branch K2_FBRETD
K2_SWRETD:
    s_waitcnt lgkmcnt(0)
    v_mfma_f32_32x32x16_bf16 v[48:63], a[192:195], a[128:131], v[80:95]
    ds_read_b128 a[224:227], v4 offset:8192
    v_exp_f32 v68, v68
    v_exp_f32 v69, v69
    v_add_f32 v10, v10, v64
    v_mfma_f32_32x32x16_bf16 v[48:63], a[196:199], a[132:135], v[48:63]
    ds_read_b128 a[232:235], v4 offset:10240
    v_exp_f32 v70, v70
    v_exp_f32 v71, v71
    v_add_f32 v11, v11, v65
    v_mfma_f32_32x32x16_bf16 v[48:63], a[200:203], a[136:139], v[48:63]
    v_exp_f32 v72, v72
    v_exp_f32 v73, v73
    v_exp_f32 v74, v74
    v_mfma_f32_32x32x16_bf16 v[48:63], a[204:207], a[140:143], v[48:63]
    ds_read_b128 a[240:243], v4 offset:12288
    v_exp_f32 v75, v75
    v_exp_f32 v76, v76
    v_cvt_pk_bf16_f32 v136, v64, v65
    v_mfma_f32_32x32x16_bf16 v[48:63], a[208:211], a[144:147], v[48:63]
    ds_read_b128 a[248:251], v4 offset:14336
    v_exp_f32 v77, v77
    v_exp_f32 v78, v78
    v_add_f32 v10, v10, v66
    v_mfma_f32_32x32x16_bf16 v[48:63], a[212:215], a[148:151], v[48:63]
    v_exp_f32 v79, v79
    v_add_f32 v11, v11, v67
    v_cvt_pk_bf16_f32 v137, v66, v67
    v_add_f32 v10, v10, v68
    v_add_f32 v11, v11, v69
    v_mfma_f32_32x32x16_bf16 v[48:63], a[216:219], a[152:155], v[48:63]
    ds_read_b128 a[228:231], v4 offset:9216
    v_cvt_pk_bf16_f32 v138, v68, v69
    v_add_f32 v10, v10, v70
    v_add_f32 v11, v11, v71
    v_cvt_pk_bf16_f32 v139, v70, v71
    v_add_f32 v10, v10, v72
    v_mfma_f32_32x32x16_bf16 v[48:63], a[220:223], a[156:159], v[48:63]
    v_add_f32 v11, v11, v73
    v_cvt_pk_bf16_f32 v140, v72, v73
    v_add_f32 v10, v10, v74
    v_add_f32 v11, v11, v75
    v_cvt_pk_bf16_f32 v141, v74, v75
    v_add_f32 v10, v10, v76
    v_add_f32 v11, v11, v77
    v_cvt_pk_bf16_f32 v142, v76, v77
    v_add_f32 v10, v10, v78
    v_add_f32 v11, v11, v79
    v_cvt_pk_bf16_f32 v143, v78, v79
    v_mfma_f32_32x32x16_bf16 v[64:79], a[192:195], a[160:163], v[96:111]
    ds_read_b128 a[236:239], v4 offset:11264
    v_mfma_f32_32x32x16_bf16 v[64:79], a[196:199], a[164:167], v[64:79]
    ds_read_b128 a[244:247], v4 offset:13312
    v_min_f32 v48, v48, v224
    v_min_f32 v49, v49, v225
    v_min_f32 v50, v50, v226
    v_min_f32 v51, v51, v227
    v_min_f32 v52, v52, v228
    v_mfma_f32_32x32x16_bf16 v[64:79], a[200:203], a[168:171], v[64:79]
    v_min_f32 v53, v53, v229
    v_min_f32 v54, v54, v230
    v_min_f32 v55, v55, v231
    v_min_f32 v56, v56, v232
    v_min_f32 v57, v57, v233
    v_min_f32 v58, v58, v234
    v_mfma_f32_32x32x16_bf16 v[64:79], a[204:207], a[172:175], v[64:79]
    ds_read_b128 a[252:255], v4 offset:15360
    v_min_f32 v59, v59, v235
    v_min_f32 v60, v60, v236
    v_min_f32 v61, v61, v237
    v_min_f32 v62, v62, v238
    v_min_f32 v63, v63, v239
    v_mfma_f32_32x32x16_bf16 v[64:79], a[208:211], a[176:179], v[64:79]
    v_max3_f32 v14, v48, v49, v50
    v_max3_f32 v15, v51, v52, v53
    v_max3_f32 v16, v54, v55, v56
    v_max3_f32 v17, v57, v58, v59
    v_max3_f32 v18, v60, v61, v62
    v_max3_f32 v14, v14, v15, v63
    v_mfma_f32_32x32x16_bf16 v[64:79], a[212:215], a[180:183], v[64:79]
    v_max3_f32 v16, v16, v17, v18
    v_max_f32 v14, v14, v16
    v_cmp_lt_f32 vcc, s51, v14
    s_add_u32 s47, s45, 16777216
    s_add_u32 s48, s45, 16781312
    s_mov_b32 m0, s49
    v_mfma_f32_32x32x16_bf16 v[64:79], a[216:219], a[184:187], v[64:79]
    s_cbranch_vccnz K2_RARE_0_0
K2_RETD_0_0:
    s_cmp_eq_u32 s39, s41
    s_cselect_b32 s46, s42, 0x4000
    s_add_u32 s45, s45, s46
    v_mfma_f32_32x32x16_bf16 v[64:79], a[220:223], a[188:191], v[64:79]
    s_add_u32 s46, s45, 4096
    v_exp_f32 v48, v48
    v_exp_f32 v49, v49
    s_waitcnt lgkmcnt(0)
    v_mfma_f32_32x32x16_bf16 a[0:15], a[224:227], v[128:131], a[0:15]
    ds_read_b128 a[192:195], v2 offset:8192
    v_exp_f32 v50, v50
    v_exp_f32 v51, v51
    v_add_f32 v8, v8, v48
    v_mfma_f32_32x32x16_bf16 a[16:31], a[232:235], v[128:131], a[16:31]
    ds_read_b128 a[196:199], v2 offset:9216
    v_max3_f32 v14, v64, v65, v66
    v_max3_f32 v15, v67, v68, v69
    v_max3_f32 v16, v70, v71, v72
    v_max3_f32 v17, v73, v74, v75
    v_max3_f32 v18, v76, v77, v78
    v_mfma_f32_32x32x16_bf16 a[32:47], a[240:243], v[128:131], a[32:47]
    ds_read_b128 a[200:203], v2 offset:10240
    v_max3_f32 v14, v14, v15, v79
    v_max3_f32 v16, v16, v17, v18
    v_max_f32 v14, v14, v16
    v_cmp_lt_f32 vcc, s52, v14
    v_add_f32 v9, v9, v49
    v_mfma_f32_32x32x16_bf16 a[48:63], a[248:251], v[128:131], a[48:63]
    ds_read_b128 a[204:207], v2 offset:11264
    s_cbranch_vccnz K2_RARE_1_0
K2_RETD_1_0:
    v_exp_f32 v52, v52
    v_mfma_f32_32x32x16_bf16 a[0:15], a[228:231], v[132:135], a[0:15]
    v_exp_f32 v53, v53
    v_exp_f32 v54, v54
    v_exp_f32 v55, v55
    v_mfma_f32_32x32x16_bf16 a[16:31], a[236:239], v[132:135], a[16:31]
    ds_read_b128 a[208:211], v2 offset:12288
    v_exp_f32 v56, v56
    v_exp_f32 v57, v57
    v_cvt_pk_bf16_f32 v112, v48, v49
    v_mfma_f32_32x32x16_bf16 a[32:47], a[244:247], v[132:135], a[32:47]
    ds_read_b128 a[212:215], v2 offset:13312
    v_exp_f32 v58, v58
    v_exp_f32 v59, v59
    v_add_f32 v8, v8, v50
    v_mfma_f32_32x32x16_bf16 a[48:63], a[252:255], v[132:135], a[48:63]
    ds_read_b128 a[216:219], v2 offset:14336
    v_exp_f32 v60, v60
    v_exp_f32 v61, v61
    v_add_f32 v9, v9, v51
    v_mfma_f32_32x32x16_bf16 a[64:79], a[224:227], v[136:139], a[64:79]
    ds_read_b128 a[220:223], v2 offset:15360
    v_exp_f32 v62, v62
    v_exp_f32 v63, v63
    v_cvt_pk_bf16_f32 v113, v50, v51
    v_mfma_f32_32x32x16_bf16 a[80:95], a[232:235], v[136:139], a[80:95]
    v_add_f32 v8, v8, v52
    v_add_f32 v9, v9, v53
    v_cvt_pk_bf16_f32 v114, v52, v53
    v_add_f32 v8, v8, v54
    v_add_f32 v9, v9, v55
    v_cvt_pk_bf16_f32 v115, v54, v55
    v_mfma_f32_32x32x16_bf16 a[96:111], a[240:243], v[136:139], a[96:111]
    v_add_f32 v8, v8, v56
    v_add_f32 v9, v9, v57
    v_cvt_pk_bf16_f32 v116, v56, v57
    v_add_f32 v8, v8, v58
    v_add_f32 v9, v9, v59
    v_cvt_pk_bf16_f32 v117, v58, v59
    v_mfma_f32_32x32x16_bf16 a[112:127], a[248:251], v[136:139], a[112:127]
    s_waitcnt vmcnt(1) lgkmcnt(0)
    s_barrier
    v_add_f32 v8, v8, v60
    v_add_f32 v9, v9, v61
    v_cvt_pk_bf16_f32 v118, v60, v61
    v_add_f32 v8, v8, v62
    v_mfma_f32_32x32x16_bf16 a[64:79], a[228:231], v[140:143], a[64:79]
    buffer_load_dwordx4 v1, s[20:23], s45 offen offset:0 sc1 lds
    v_add_f32 v9, v9, v63
    v_cvt_pk_bf16_f32 v119, v62, v63
    v_exp_f32 v64, v64
    v_mfma_f32_32x32x16_bf16 a[80:95], a[236:239], v[140:143], a[80:95]
    v_exp_f32 v65, v65
    v_exp_f32 v66, v66
    v_exp_f32 v67, v67
    v_mfma_f32_32x32x16_bf16 a[96:111], a[244:247], v[140:143], a[96:111]
    buffer_load_dwordx4 v1, s[20:23], s45 offen offset:1024 sc1 lds
    v_exp_f32 v68, v68
    v_exp_f32 v69, v69
    v_mfma_f32_32x32x16_bf16 a[112:127], a[252:255], v[140:143], a[112:127]
    v_exp_f32 v70, v70
    s_cmp_eq_u32 s39, s99
    s_cbranch_scc1 K2_FINB
K2_FBRETD:
    s_nop 0
    ds_read_b128 a[224:227], v5 offset:0
    buffer_load_dwordx4 v1, s[20:23], s45 offen offset:2048 sc1 lds
    v_exp_f32 v71, v71
    v_add_f32 v10, v10, v64
    s_nop 0
    ds_read_b128 a[232:235], v5 offset:2048
    v_exp_f32 v72, v72
    v_exp_f32 v73, v73
    v_add_f32 v11, v11, v65
    s_nop 0
    buffer_load_dwordx4 v1, s[20:23], s45 offen offset:3072 sc1 lds
    s_add_u32 m0, s49, 4096
    v_exp_f32 v74, v74
    v_cvt_pk_bf16_f32 v120, v64, v65
    s_nop 0
    ds_read_b128 a[240:243], v5 offset:4096
    v_exp_f32 v75, v75
    v_exp_f32 v76, v76
    v_add_f32 v10, v10, v66
    s_nop 0
    ds_read_b128 a[248:251], v5 offset:6144
    buffer_load_dwordx4 v1, s[20:23], s46 offen offset:0 sc1 lds
    v_exp_f32 v77, v77
    v_add_f32 v11, v11, v67
    s_nop 0
    v_exp_f32 v78, v78
    v_exp_f32 v79, v79
    v_cvt_pk_bf16_f32 v121, v66, v67
    v_add_f32 v10, v10, v68
    s_nop 0
    ds_read_b128 a[228:231], v5 offset:1024
    buffer_load_dwordx4 v1, s[20:23], s46 offen offset:1024 sc1 lds
    v_add_f32 v11, v11, v69
    v_cvt_pk_bf16_f32 v122, v68, v69
    v_add_f32 v10, v10, v70
    s_nop 0
    v_add_f32 v11, v11, v71
    v_cvt_pk_bf16_f32 v123, v70, v71
    v_add_f32 v10, v10, v72
    v_add_f32 v11, v11, v73
    v_cvt_pk_bf16_f32 v124, v72, v73
    v_add_f32 v10, v10, v74
    v_add_f32 v11, v11, v75
    v_cvt_pk_bf16_f32 v125, v74, v75
    v_add_f32 v10, v10, v76
    v_add_f32 v11, v11, v77
    v_cvt_pk_bf16_f32 v126, v76, v77
    v_add_f32 v10, v10, v78
    v_add_f32 v11, v11, v79
    v_cvt_pk_bf16_f32 v127, v78, v79
    v_mfma_f32_32x32x16_bf16 v[64:79], a[192:195], a[160:163], v[96:111]
    ds_read_b128 a[236:239], v5 offset:3072
    buffer_load_dwordx4 v1, s[20:23], s46 offen offset:2048 sc1 lds
    v_mov_b32 v4, v5
    v_mov_b32 v128, 0
    v_mov_b32 v129, 0
    v_mfma_f32_32x32x16_bf16 v[64:79], a[196:199], a[164:167], v[64:79]
    ds_read_b128 a[244:247], v5 offset:5120
    v_mov_b32 v130, 0
    v_mov_b32 v131, 0
    v_mov_b32 v132, 0
    v_mov_b32 v133, 0
    v_mov_b32 v134, 0
    v_mfma_f32_32x32x16_bf16 v[64:79], a[200:203], a[168:171], v[64:79]
    buffer_load_dwordx4 v1, s[20:23], s46 offen offset:3072 sc1 lds
    s_mov_b32 m0, s50
    v_mov_b32 v135, 0
    s_xor_b32 s49, s49, 0x8000
    v_xor_b32 v2, 0x8000, v2
    v_mfma_f32_32x32x16_bf16 v[64:79], a[204:207], a[172:175], v[64:79]
    ds_read_b128 a[252:255], v5 offset:7168
    s_add_u32 s39, s39, 1
    v_mfma_f32_32x32x16_bf16 v[64:79], a[208:211], a[176:179], v[64:79]
    buffer_load_dwordx4 v1, s[20:23], s47 offen offset:0 sc1 lds
    v_mfma_f32_32x32x16_bf16 v[64:79], a[212:215], a[180:183], v[64:79]
    v_xor_b32 v5, 0x8000, v5
    v_mfma_f32_32x32x16_bf16 v[64:79], a[216:219], a[184:187], v[64:79]
    buffer_load_dwordx4 v1, s[20:23], s47 offen offset:1024 sc1 lds
    v_mfma_f32_32x32x16_bf16 v[64:79], a[220:223], a[188:191], v[64:79]
    s_waitcnt lgkmcnt(0)
    v_mfma_f32_32x32x16_bf16 a[0:15], a[224:227], v[112:115], a[0:15]
    ds_read_b128 a[192:195], v3 offset:0
    buffer_load_dwordx4 v1, s[20:23], s47 offen offset:2048 sc1 lds
    v_mfma_f32_32x32x16_bf16 a[16:31], a[232:235], v[112:115], a[16:31]
    ds_read_b128 a[196:199], v3 offset:1024
    v_min_f32 v64, v64, v224
    v_min_f32 v65, v65, v225
    v_min_f32 v66, v66, v226
    v_min_f32 v67, v67, v227
    v_min_f32 v68, v68, v228
    v_mfma_f32_32x32x16_bf16 a[32:47], a[240:243], v[112:115], a[32:47]
    buffer_load_dwordx4 v1, s[20:23], s47 offen offset:3072 sc1 lds
    s_add_u32 m0, s50, 4096
    v_min_f32 v69, v69, v229
    v_min_f32 v70, v70, v230
    v_min_f32 v71, v71, v231
    v_mfma_f32_32x32x16_bf16 a[48:63], a[248:251], v[112:115], a[48:63]
    ds_read_b128 a[200:203], v3 offset:2048
    v_min_f32 v72, v72, v232
    v_min_f32 v73, v73, v233
    v_min_f32 v74, v74, v234
    v_min_f32 v75, v75, v235
    v_min_f32 v76, v76, v236
    v_mfma_f32_32x32x16_bf16 a[0:15], a[228:231], v[116:119], a[0:15]
    ds_read_b128 a[204:207], v3 offset:3072
    buffer_load_dwordx4 v1, s[20:23], s48 offen offset:0 sc1 lds
    v_min_f32 v77, v77, v237
    v_min_f32 v78, v78, v238
    v_min_f32 v79, v79, v239
    v_mfma_f32_32x32x16_bf16 a[16:31], a[236:239], v[116:119], a[16:31]
    v_max3_f32 v14, v64, v65, v66
    v_max3_f32 v15, v67, v68, v69
    v_max3_f32 v16, v70, v71, v72
    v_max3_f32 v17, v73, v74, v75
    v_max3_f32 v18, v76, v77, v78
    v_max3_f32 v14, v14, v15, v79
    v_mfma_f32_32x32x16_bf16 a[32:47], a[244:247], v[116:119], a[32:47]
    ds_read_b128 a[208:211], v3 offset:4096
    buffer_load_dwordx4 v1, s[20:23], s48 offen offset:1024 sc1 lds
    v_max3_f32 v16, v16, v17, v18
    v_max_f32 v14, v14, v16
    v_cmp_lt_f32 vcc, s52, v14
    v_mfma_f32_32x32x16_bf16 a[48:63], a[252:255], v[116:119], a[48:63]
    s_cbranch_vccnz K2_RARE_1_1
K2_RETD_1_1:
    s_xor_b32 s50, s50, 0x8000
    v_exp_f32 v64, v64
    v_mfma_f32_32x32x16_bf16 a[64:79], a[224:227], v[120:123], a[64:79]
    ds_read_b128 a[212:215], v3 offset:5120
    buffer_load_dwordx4 v1, s[20:23], s48 offen offset:2048 sc1 lds
    s_add_u32 s43, s43, 1
    v_exp_f32 v65, v65
    v_mfma_f32_32x32x16_bf16 a[80:95], a[232:235], v[120:123], a[80:95]
    ds_read_b128 a[216:219], v3 offset:6144
    v_exp_f32 v66, v66
    v_exp_f32 v67, v67
    v_mfma_f32_32x32x16_bf16 a[96:111], a[240:243], v[120:123], a[96:111]
    buffer_load_dwordx4 v1, s[20:23], s48 offen offset:3072 sc1 lds
    v_mfma_f32_32x32x16_bf16 a[112:127], a[248:251], v[120:123], a[112:127]
    ds_read_b128 a[220:223], v3 offset:7168
    v_mfma_f32_32x32x16_bf16 a[64:79], a[228:231], v[124:127], a[64:79]
    buffer_load_dword v248, v1, s[24:27], s76 offen
    s_add_u32 s76, s76, s30
    v_mfma_f32_32x32x16_bf16 a[80:95], a[236:239], v[124:127], a[80:95]
    v_xor_b32 v3, 0x8000, v3
    v_mfma_f32_32x32x16_bf16 a[96:111], a[244:247], v[124:127], a[96:111]
    v_mfma_f32_32x32x16_bf16 a[112:127], a[252:255], v[124:127], a[112:127]
    s_cmp_lt_u32 s39, 17
    s_cbranch_scc1 K2_LOOP
    s_branch K2_TAIL
K2_SWRETF:
    s_waitcnt lgkmcnt(0)
    v_mfma_f32_32x32x16_bf16 v[48:63], a[192:195], a[128:131], v[80:95]
    ds_read_b128 a[224:227], v4 offset:8192
    v_exp_f32 v68, v68
    v_exp_f32 v69, v69
    v_add_f32 v10, v10, v64
    v_mfma_f32_32x32x16_bf16 v[48:63], a[196:199], a[132:135], v[48:63]
    ds_read_b128 a[232:235], v4 offset:10240
    v_exp_f32 v70, v70
    v_exp_f32 v71, v71
    v_add_f32 v11, v11, v65
    v_mfma_f32_32x32x16_bf16 v[48:63], a[200:203], a[136:139], v[48:63]
    v_exp_f32 v72, v72
    v_exp_f32 v73, v73
    v_exp_f32 v74, v74
    v_mfma_f32_32x32x16_bf16 v[48:63], a[204:207], a[140:143], v[48:63]
    ds_read_b128 a[240:243], v4 offset:12288
    v_exp_f32 v75, v75
    v_exp_f32 v76, v76
    v_cvt_pk_bf16_f32 v136, v64, v65
    v_mfma_f32_32x32x16_bf16 v[48:63], a[208:211], a[144:147], v[48:63]
    ds_read_b128 a[248:251], v4 offset:14336
    v_exp_f32 v77, v77
    v_exp_f32 v78, v78
    v_add_f32 v10, v10, v66
    v_mfma_f32_32x32x16_bf16 v[48:63], a[212:215], a[148:151], v[48:63]
    v_exp_f32 v79, v79
    v_add_f32 v11, v11, v67
    v_cvt_pk_bf16_f32 v137, v66, v67
    v_add_f32 v10, v10, v68
    v_add_f32 v11, v11, v69
    v_mfma_f32_32x32x16_bf16 v[48:63], a[216:219], a[152:155], v[48:63]
    ds_read_b128 a[228:231], v4 offset:9216
    v_cvt_pk_bf16_f32 v138, v68, v69
    v_add_f32 v10, v10, v70
    v_add_f32 v11, v11, v71
    v_cvt_pk_bf16_f32 v139, v70, v71
    v_add_f32 v10, v10, v72
    v_mfma_f32_32x32x16_bf16 v[48:63], a[220:223], a[156:159], v[48:63]
    v_add_f32 v11, v11, v73
    v_cvt_pk_bf16_f32 v140, v72, v73
    v_add_f32 v10, v10, v74
    v_add_f32 v11, v11, v75
    v_cvt_pk_bf16_f32 v141, v74, v75
    v_add_f32 v10, v10, v76
    v_add_f32 v11, v11, v77
    v_cvt_pk_bf16_f32 v142, v76, v77
    v_add_f32 v10, v10, v78
    v_add_f32 v11, v11, v79
    v_cvt_pk_bf16_f32 v143, v78, v79
    v_mfma_f32_32x32x16_bf16 v[64:79], a[192:195], a[160:163], v[96:111]
    ds_read_b128 a[236:239], v4 offset:11264
    v_mfma_f32_32x32x16_bf16 v[64:79], a[196:199], a[164:167], v[64:79]
    ds_read_b128 a[244:247], v4 offset:13312
    v_max3_f32 v14, v48, v49, v50
    v_max3_f32 v15, v51, v52, v53
    v_max3_f32 v16, v54, v55, v56
    v_max3_f32 v17, v57, v58, v59
    v_max3_f32 v18, v60, v61, v62
    v_max3_f32 v14, v14, v15, v63
    v_mfma_f32_32x32x16_bf16 v[64:79], a[200:203], a[168:171], v[64:79]
    v_max3_f32 v16, v16, v17, v18
    v_max_f32 v14, v14, v16
    v_mov_b32 v20, v14
    v_add_f32 v30, v8, v9
    v_mov_b32 v8, 0
    v_mov_b32 v9, 0
    s_add_u32 s47, s45, 16777216
    v_mfma_f32_32x32x16_bf16 v[64:79], a[204:207], a[172:175], v[64:79]
    ds_read_b128 a[252:255], v4 offset:15360
    s_nop 0
    v_permlane32_swap_b32 v14, v20
    s_add_u32 s48, s45, 16781312
    s_mov_b32 m0, s49
    v_mfma_f32_32x32x16_bf16 v[64:79], a[208:211], a[176:179], v[64:79]
    v_max_f32 v20, v20, v14
    v_ceil_f32 v20, v20
    v_sub_f32 v12, 0, v20
    s_cmp_eq_u32 s39, s41
    s_cselect_b32 s46, s42, 0x4000
    s_add_u32 s45, s45, s46
    s_add_u32 s46, s45, 4096
    v_mfma_f32_32x32x16_bf16 v[64:79], a[212:215], a[180:183], v[64:79]
    v_sub_f32 v48, v48, v20
    v_sub_f32 v49, v49, v20
    v_sub_f32 v50, v50, v20
    v_sub_f32 v51, v51, v20
    v_sub_f32 v52, v52, v20
    v_sub_f32 v53, v53, v20
    v_sub_f32 v54, v54, v20
    v_mfma_f32_32x32x16_bf16 v[64:79], a[216:219], a[184:187], v[64:79]
    v_sub_f32 v55, v55, v20
    v_sub_f32 v56, v56, v20
    v_sub_f32 v57, v57, v20
    v_sub_f32 v58, v58, v20
    v_sub_f32 v59, v59, v20
    v_sub_f32 v60, v60, v20
    v_sub_f32 v61, v61, v20
    v_mfma_f32_32x32x16_bf16 v[64:79], a[220:223], a[188:191], v[64:79]
    v_sub_f32 v62, v62, v20
    v_sub_f32 v63, v63, v20
    v_mov_b32 v80, v12
    v_mov_b32 v81, v12
    v_mov_b32 v82, v12
    v_mov_b32 v83, v12
    s_waitcnt lgkmcnt(0)
    v_mfma_f32_32x32x16_bf16 a[0:15], a[224:227], v[128:131], a[0:15]
    ds_read_b128 a[192:195], v2 offset:8192
    v_mov_b32 v84, v12
    v_mov_b32 v85, v12
    v_mov_b32 v86, v12
    v_mov_b32 v87, v12
    v_mov_b32 v88, v12
    v_mov_b32 v89, v12
    v_mfma_f32_32x32x16_bf16 a[16:31], a[232:235], v[128:131], a[16:31]
    ds_read_b128 a[196:199], v2 offset:9216
    v_max3_f32 v14, v64, v65, v66
    v_max3_f32 v15, v67, v68, v69
    v_max3_f32 v16, v70, v71, v72
    v_max3_f32 v17, v73, v74, v75
    v_max3_f32 v18, v76, v77, v78
    v_max3_f32 v14, v14, v15, v79
    v_mfma_f32_32x32x16_bf16 a[32:47], a[240:243], v[128:131], a[32:47]
    ds_read_b128 a[200:203], v2 offset:10240
    v_max3_f32 v16, v16, v17, v18
    v_max_f32 v14, v14, v16
    v_mov_b32 v21, v14
    v_mov_b32 v90, v12
    v_mov_b32 v91, v12
    v_mov_b32 v92, v12
    v_mfma_f32_32x32x16_bf16 a[48:63], a[248:251], v[128:131], a[48:63]
    ds_read_b128 a[204:207], v2 offset:11264
    v_add_f32 v31, v10, v11
    v_mov_b32 v10, 0
    v_mov_b32 v11, 0
    s_nop 0
    v_permlane32_swap_b32 v14, v21
    v_mov_b32 v93, v12
    v_mfma_f32_32x32x16_bf16 a[0:15], a[228:231], v[132:135], a[0:15]
    v_max_f32 v21, v21, v14
    v_ceil_f32 v21, v21
    v_sub_f32 v13, 0, v21
    v_mov_b32 v94, v12
    v_mov_b32 v95, v12
    v_sub_f32 v64, v64, v21
    v_sub_f32 v65, v65, v21
    v_mfma_f32_32x32x16_bf16 a[16:31], a[236:239], v[132:135], a[16:31]
    ds_read_b128 a[208:211], v2 offset:12288
    v_exp_f32 v48, v48
    v_exp_f32 v49, v49
    v_add_f32 v8, v8, v48
    v_add_f32 v9, v9, v49
    v_mfma_f32_32x32x16_bf16 a[32:47], a[244:247], v[132:135], a[32:47]
    ds_read_b128 a[212:215], v2 offset:13312
    v_exp_f32 v50, v50
    v_exp_f32 v51, v51
    v_cvt_pk_bf16_f32 v112, v48, v49
    v_add_f32 v8, v8, v50
    v_mfma_f32_32x32x16_bf16 a[48:63], a[252:255], v[132:135], a[48:63]
    ds_read_b128 a[216:219], v2 offset:14336
    v_exp_f32 v52, v52
    v_exp_f32 v53, v53
    v_add_f32 v9, v9, v51
    v_cvt_pk_bf16_f32 v113, v50, v51
    v_mfma_f32_32x32x16_bf16 a[64:79], a[224:227], v[136:139], a[64:79]
    ds_read_b128 a[220:223], v2 offset:15360
    v_exp_f32 v54, v54
    v_exp_f32 v55, v55
    v_add_f32 v8, v8, v52
    v_add_f32 v9, v9, v53
    v_mfma_f32_32x32x16_bf16 a[80:95], a[232:235], v[136:139], a[80:95]
    v_exp_f32 v56, v56
    v_exp_f32 v57, v57
    v_exp_f32 v58, v58
    v_cvt_pk_bf16_f32 v114, v52, v53
    v_mfma_f32_32x32x16_bf16 a[96:111], a[240:243], v[136:139], a[96:111]
    v_exp_f32 v59, v59
    v_exp_f32 v60, v60
    v_exp_f32 v61, v61
    v_add_f32 v8, v8, v54
    v_mfma_f32_32x32x16_bf16 a[112:127], a[248:251], v[136:139], a[112:127]
    s_waitcnt vmcnt(1) lgkmcnt(0)
    s_barrier
    v_exp_f32 v62, v62
    v_exp_f32 v63, v63
    v_add_f32 v9, v9, v55
    v_mfma_f32_32x32x16_bf16 a[64:79], a[228:231], v[140:143], a[64:79]
    buffer_load_dwordx4 v1, s[20:23], s45 offen offset:0 sc1 lds
    v_cvt_pk_bf16_f32 v115, v54, v55
    v_add_f32 v8, v8, v56
    v_add_f32 v9, v9, v57
    v_cvt_pk_bf16_f32 v116, v56, v57
    v_add_f32 v8, v8, v58
    v_mfma_f32_32x32x16_bf16 a[80:95], a[236:239], v[140:143], a[80:95]
    v_add_f32 v9, v9, v59
    v_cvt_pk_bf16_f32 v117, v58, v59
    v_add_f32 v8, v8, v60
    v_add_f32 v9, v9, v61
    v_cvt_pk_bf16_f32 v118, v60, v61
    v_add_f32 v8, v8, v62
    v_add_f32 v9, v9, v63
    v_mfma_f32_32x32x16_bf16 a[96:111], a[244:247], v[140:143], a[96:111]
    buffer_load_dwordx4 v1, s[20:23], s45 offen offset:1024 sc1 lds
    v_cvt_pk_bf16_f32 v119, v62, v63
    v_sub_f32 v66, v66, v21
    v_sub_f32 v67, v67, v21
    v_sub_f32 v68, v68, v21
    v_sub_f32 v69, v69, v21
    v_mfma_f32_32x32x16_bf16 a[112:127], a[252:255], v[140:143], a[112:127]
    v_sub_f32 v70, v70, v21
    v_sub_f32 v71, v71, v21
    v_sub_f32 v72, v72, v21
    s_cmp_eq_u32 s39, s99
    s_cbranch_scc1 K2_FINB
K2_FBRETF:
    v_mfma_f32_32x32x16_bf16 v[48:63], a[192:195], a[128:131], v[80:95]
    ds_read_b128 a[224:227], v5 offset:0
    buffer_load_dwordx4 v1, s[20:23], s45 offen offset:2048 sc1 lds
    v_sub_f32 v73, v73, v21
    v_sub_f32 v74, v74, v21
    v_sub_f32 v75, v75, v21
    v_sub_f32 v76, v76, v21
    v_mfma_f32_32x32x16_bf16 v[48:63], a[196:199], a[132:135], v[48:63]
    ds_read_b128 a[232:235], v5 offset:2048
    v_sub_f32 v77, v77, v21
    v_sub_f32 v78, v78, v21
    v_sub_f32 v79, v79, v21
    v_mov_b32 v96, v13
    v_mov_b32 v97, v13
    v_mov_b32 v98, v13
    v_mfma_f32_32x32x16_bf16 v[48:63], a[200:203], a[136:139], v[48:63]
    buffer_load_dwordx4 v1, s[20:23], s45 offen offset:3072 sc1 lds
    s_add_u32 m0, s49, 4096
    v_mov_b32 v99, v13
    v_mov_b32 v100, v13
    v_mov_b32 v101, v13
    v_mov_b32 v102, v13
    v_mfma_f32_32x32x16_bf16 v[48:63], a[204:207], a[140:143], v[48:63]
    ds_read_b128 a[240:243], v5 offset:4096
    v_mov_b32 v103, v13
    v_mov_b32 v104, v13
    v_mov_b32 v105, v13
    v_mov_b32 v106, v13
    v_mov_b32 v107, v13
    v_mov_b32 v108, v13
    v_mfma_f32_32x32x16_bf16 v[48:63], a[208:211], a[144:147], v[48:63]
    ds_read_b128 a[248:251], v5 offset:6144
    buffer_load_dwordx4 v1, s[20:23], s46 offen offset:0 sc1 lds
    v_mov_b32 v109, v13
    v_mov_b32 v110, v13
    v_mov_b32 v111, v13
    v_mov_b32 v4, v5
    v_mfma_f32_32x32x16_bf16 v[48:63], a[212:215], a[148:151], v[48:63]
    v_exp_f32 v64, v64
    v_exp_f32 v65, v65
    v_exp_f32 v66, v66
    v_add_f32 v10, v10, v64
    v_mfma_f32_32x32x16_bf16 v[48:63], a[216:219], a[152:155], v[48:63]
    ds_read_b128 a[228:231], v5 offset:1024
    buffer_load_dwordx4 v1, s[20:23], s46 offen offset:1024 sc1 lds
    v_exp_f32 v67, v67
    v_add_f32 v11, v11, v65
    v_exp_f32 v68, v68
    v_exp_f32 v69, v69
    v_exp_f32 v70, v70
    v_exp_f32 v71, v71
    v_exp_f32 v72, v72
    v_exp_f32 v73, v73
    v_exp_f32 v74, v74
    v_exp_f32 v75, v75
    v_exp_f32 v76, v76
    v_exp_f32 v77, v77
    v_exp_f32 v78, v78
    v_exp_f32 v79, v79
    v_mfma_f32_32x32x16_bf16 v[48:63], a[220:223], a[156:159], v[48:63]
    v_cvt_pk_bf16_f32 v120, v64, v65
    v_add_f32 v10, v10, v66
    v_add_f32 v11, v11, v67
    v_cvt_pk_bf16_f32 v121, v66, v67
    v_add_f32 v10, v10, v68
    v_add_f32 v11, v11, v69
    v_cvt_pk_bf16_f32 v122, v68, v69
    v_add_f32 v10, v10, v70
    v_add_f32 v11, v11, v71
    v_cvt_pk_bf16_f32 v123, v70, v71
    v_add_f32 v10, v10, v72
    v_add_f32 v11, v11, v73
    v_cvt_pk_bf16_f32 v124, v72, v73
    v_add_f32 v10, v10, v74
    v_add_f32 v11, v11, v75
    v_cvt_pk_bf16_f32 v125, v74, v75
    v_add_f32 v10, v10, v76
    v_add_f32 v11, v11, v77
    v_cvt_pk_bf16_f32 v126, v76, v77
    v_add_f32 v10, v10, v78
    v_add_f32 v11, v11, v79
    v_cvt_pk_bf16_f32 v127, v78, v79
    v_mfma_f32_32x32x16_bf16 v[64:79], a[192:195], a[160:163], v[96:111]
    ds_read_b128 a[236:239], v5 offset:3072
    buffer_load_dwordx4 v1, s[20:23], s46 offen offset:2048 sc1 lds
    s_xor_b32 s49, s49, 0x8000
    v_xor_b32 v2, 0x8000, v2
    s_add_u32 s39, s39, 1
    v_mfma_f32_32x32x16_bf16 v[64:79], a[196:199], a[164:167], v[64:79]
    ds_read_b128 a[244:247], v5 offset:5120
    v_max3_f32 v14, v48, v49, v50
    v_max3_f32 v15, v51, v52, v53
    v_max3_f32 v16, v54, v55, v56
    v_max3_f32 v17, v57, v58, v59
    v_max3_f32 v18, v60, v61, v62
    v_mfma_f32_32x32x16_bf16 v[64:79], a[200:203], a[168:171], v[64:79]
    buffer_load_dwordx4 v1, s[20:23], s46 offen offset:3072 sc1 lds
    s_mov_b32 m0, s50
    v_max3_f32 v14, v14, v15, v63
    v_max3_f32 v16, v16, v17, v18
    v_max_f32 v14, v14, v16
    v_mfma_f32_32x32x16_bf16 v[64:79], a[204:207], a[172:175], v[64:79]
    ds_read_b128 a[252:255], v5 offset:7168
    v_cmp_lt_f32 vcc, s51, v14
    v_mfma_f32_32x32x16_bf16 v[64:79], a[208:211], a[176:179], v[64:79]
    buffer_load_dwordx4 v1, s[20:23], s47 offen offset:0 sc1 lds
    s_cbranch_vccnz K2_RARE_0_1
K2_RETF_0_1:
    v_mfma_f32_32x32x16_bf16 v[64:79], a[212:215], a[180:183], v[64:79]
    v_exp_f32 v48, v48
    v_exp_f32 v49, v49
    v_exp_f32 v50, v50
    v_mfma_f32_32x32x16_bf16 v[64:79], a[216:219], a[184:187], v[64:79]
    buffer_load_dwordx4 v1, s[20:23], s47 offen offset:1024 sc1 lds
    v_exp_f32 v51, v51
    v_exp_f32 v52, v52
    v_mfma_f32_32x32x16_bf16 v[64:79], a[220:223], a[188:191], v[64:79]
    v_exp_f32 v53, v53
    v_exp_f32 v54, v54
    v_xor_b32 v5, 0x8000, v5
    s_waitcnt lgkmcnt(0)
    v_mfma_f32_32x32x16_bf16 a[0:15], a[224:227], v[112:115], a[0:15]
    ds_read_b128 a[192:195], v3 offset:0
    buffer_load_dwordx4 v1, s[20:23], s47 offen offset:2048 sc1 lds
    v_exp_f32 v55, v55
    v_add_f32 v8, v8, v48
    v_mfma_f32_32x32x16_bf16 a[16:31], a[232:235], v[112:115], a[16:31]
    ds_read_b128 a[196:199], v3 offset:1024
    v_max3_f32 v14, v64, v65, v66
    v_max3_f32 v15, v67, v68, v69
    v_max3_f32 v16, v70, v71, v72
    v_max3_f32 v17, v73, v74, v75
    v_max3_f32 v18, v76, v77, v78
    v_mfma_f32_32x32x16_bf16 a[32:47], a[240:243], v[112:115], a[32:47]
    buffer_load_dwordx4 v1, s[20:23], s47 offen offset:3072 sc1 lds
    s_add_u32 m0, s50, 4096
    v_max3_f32 v14, v14, v15, v79
    v_max3_f32 v16, v16, v17, v18
    v_max_f32 v14, v14, v16
    v_mfma_f32_32x32x16_bf16 a[48:63], a[248:251], v[112:115], a[48:63]
    ds_read_b128 a[200:203], v3 offset:2048
    v_cmp_lt_f32 vcc, s52, v14
    v_exp_f32 v56, v56
    v_exp_f32 v57, v57
    v_mfma_f32_32x32x16_bf16 a[0:15], a[228:231], v[116:119], a[0:15]
    ds_read_b128 a[204:207], v3 offset:3072
    buffer_load_dwordx4 v1, s[20:23], s48 offen offset:0 sc1 lds
    s_cbranch_vccnz K2_RARE_1_1
K2_RETF_1_1:
    v_mfma_f32_32x32x16_bf16 a[16:31], a[236:239], v[116:119], a[16:31]
    v_exp_f32 v58, v58
    v_exp_f32 v59, v59
    v_exp_f32 v60, v60
    v_mfma_f32_32x32x16_bf16 a[32:47], a[244:247], v[116:119], a[32:47]
    ds_read_b128 a[208:211], v3 offset:4096
    buffer_load_dwordx4 v1, s[20:23], s48 offen offset:1024 sc1 lds
    v_exp_f32 v61, v61
    s_xor_b32 s50, s50, 0x8000
    v_mfma_f32_32x32x16_bf16 a[48:63], a[252:255], v[116:119], a[48:63]
    v_exp_f32 v62, v62
    v_exp_f32 v63, v63
    v_add_f32 v9, v9, v49
    v_cvt_pk_bf16_f32 v128, v48, v49
    v_mfma_f32_32x32x16_bf16 a[64:79], a[224:227], v[120:123], a[64:79]
    ds_read_b128 a[212:215], v3 offset:5120
    buffer_load_dwordx4 v1, s[20:23], s48 offen offset:2048 sc1 lds
    s_add_u32 s43, s43, 1
    v_add_f32 v8, v8, v50
    v_add_f32 v9, v9, v51
    v_mfma_f32_32x32x16_bf16 a[80:95], a[232:235], v[120:123], a[80:95]
    ds_read_b128 a[216:219], v3 offset:6144
    v_cvt_pk_bf16_f32 v129, v50, v51
    v_add_f32 v8, v8, v52
    v_add_f32 v9, v9, v53
    v_cvt_pk_bf16_f32 v130, v52, v53
    v_add_f32 v8, v8, v54
    v_mfma_f32_32x32x16_bf16 a[96:111], a[240:243], v[120:123], a[96:111]
    buffer_load_dwordx4 v1, s[20:23], s48 offen offset:3072 sc1 lds
    v_add_f32 v9, v9, v55
    v_cvt_pk_bf16_f32 v131, v54, v55
    v_add_f32 v8, v8, v56
    v_add_f32 v9, v9, v57
    v_mfma_f32_32x32x16_bf16 a[112:127], a[248:251], v[120:123], a[112:127]
    ds_read_b128 a[220:223], v3 offset:7168
    v_cvt_pk_bf16_f32 v132, v56, v57
    v_add_f32 v8, v8, v58
    v_add_f32 v9, v9, v59
    v_cvt_pk_bf16_f32 v133, v58, v59
    v_add_f32 v8, v8, v60
    v_mfma_f32_32x32x16_bf16 a[64:79], a[228:231], v[124:127], a[64:79]
    buffer_load_dword v248, v1, s[24:27], s76 offen
    s_add_u32 s76, s76, s30
    v_add_f32 v9, v9, v61
    v_cvt_pk_bf16_f32 v134, v60, v61
    v_add_f32 v8, v8, v62
    v_mfma_f32_32x32x16_bf16 a[80:95], a[236:239], v[124:127], a[80:95]
    v_xor_b32 v3, 0x8000, v3
    v_add_f32 v9, v9, v63
    v_cvt_pk_bf16_f32 v135, v62, v63
    v_exp_f32 v64, v64
    v_mfma_f32_32x32x16_bf16 a[96:111], a[244:247], v[124:127], a[96:111]
    v_exp_f32 v65, v65
    v_exp_f32 v66, v66
    v_exp_f32 v67, v67
    v_mfma_f32_32x32x16_bf16 a[112:127], a[252:255], v[124:127], a[112:127]
    s_cmp_lt_u32 s39, 17
    s_cbranch_scc1 K2_LOOP
    s_branch K2_TAIL
K2_SWRETX:
    s_waitcnt lgkmcnt(0)
    s_nop 0
    ds_read_b128 a[224:227], v4 offset:8192
    v_exp_f32 v68, v68
    v_exp_f32 v69, v69
    v_add_f32 v10, v10, v64
    s_nop 0
    ds_read_b128 a[232:235], v4 offset:10240
    v_exp_f32 v70, v70
    v_exp_f32 v71, v71
    v_add_f32 v11, v11, v65
    s_nop 0
    v_exp_f32 v72, v72
    v_exp_f32 v73, v73
    v_exp_f32 v74, v74
    s_nop 0
    ds_read_b128 a[240:243], v4 offset:12288
    v_exp_f32 v75, v75
    v_exp_f32 v76, v76
    v_cvt_pk_bf16_f32 v136, v64, v65
    s_nop 0
    ds_read_b128 a[248:251], v4 offset:14336
    v_exp_f32 v77, v77
    v_exp_f32 v78, v78
    v_add_f32 v10, v10, v66
    s_nop 0
    v_exp_f32 v79, v79
    v_add_f32 v11, v11, v67
    v_cvt_pk_bf16_f32 v137, v66, v67
    v_add_f32 v10, v10, v68
    v_add_f32 v11, v11, v69
    s_nop 0
    ds_read_b128 a[228:231], v4 offset:9216
    v_cvt_pk_bf16_f32 v138, v68, v69
    v_add_f32 v10, v10, v70
    v_add_f32 v11, v11, v71
    v_cvt_pk_bf16_f32 v139, v70, v71
    v_add_f32 v10, v10, v72
    s_nop 0
    v_add_f32 v11, v11, v73
    v_cvt_pk_bf16_f32 v140, v72, v73
    v_add_f32 v10, v10, v74
    v_add_f32 v11, v11, v75
    v_cvt_pk_bf16_f32 v141, v74, v75
    v_add_f32 v10, v10, v76
    v_add_f32 v11, v11, v77
    v_cvt_pk_bf16_f32 v142, v76, v77
    v_add_f32 v10, v10, v78
    v_add_f32 v11, v11, v79
    v_cvt_pk_bf16_f32 v143, v78, v79
    s_nop 0
    ds_read_b128 a[236:239], v4 offset:11264
    s_nop 0
    ds_read_b128 a[244:247], v4 offset:13312
    s_add_u32 s47, s45, 16777216
    s_add_u32 s48, s45, 16781312
    s_cmp_eq_u32 s39, s41
    s_cselect_b32 s46, s42, 0x4000
    s_add_u32 s45, s45, s46
    s_nop 0
    s_add_u32 s46, s45, 4096
    s_mov_b32 m0, s49
    v_mov_b32 v64, 0
    v_mov_b32 v65, 0
    v_mov_b32 v66, 0
    v_mov_b32 v67, 0
    s_nop 0
    ds_read_b128 a[252:255], v4 offset:15360
    v_mov_b32 v68, v7
    v_mov_b32 v69, v7
    v_mov_b32 v70, v7
    v_mov_b32 v71, v7
    v_mov_b32 v72, v7
    s_nop 0
    v_mov_b32 v73, v7
    v_mov_b32 v74, v7
    v_mov_b32 v75, v7
    v_mov_b32 v76, v7
    v_mov_b32 v77, v7
    v_mov_b32 v78, v7
    s_nop 0
    v_mov_b32 v4, v5
    v_mov_b32 v79, v7
    s_nop 0
    s_waitcnt lgkmcnt(0)
    v_mfma_f32_32x32x16_bf16 a[0:15], a[224:227], v[128:131], a[0:15]
    v_mfma_f32_32x32x16_bf16 a[16:31], a[232:235], v[128:131], a[16:31]
    v_mfma_f32_32x32x16_bf16 a[32:47], a[240:243], v[128:131], a[32:47]
    v_mfma_f32_32x32x16_bf16 a[48:63], a[248:251], v[128:131], a[48:63]
    v_mfma_f32_32x32x16_bf16 a[0:15], a[228:231], v[132:135], a[0:15]
    v_mfma_f32_32x32x16_bf16 a[16:31], a[236:239], v[132:135], a[16:31]
    v_mfma_f32_32x32x16_bf16 a[32:47], a[244:247], v[132:135], a[32:47]
    v_mfma_f32_32x32x16_bf16 a[48:63], a[252:255], v[132:135], a[48:63]
    v_mfma_f32_32x32x16_bf16 a[64:79], a[224:227], v[136:139], a[64:79]
    v_mfma_f32_32x32x16_bf16 a[80:95], a[232:235], v[136:139], a[80:95]
    v_mfma_f32_32x32x16_bf16 a[96:111], a[240:243], v[136:139], a[96:111]
    v_xor_b32 v2, 0x8000, v2
    v_mfma_f32_32x32x16_bf16 a[112:127], a[248:251], v[136:139], a[112:127]
    s_waitcnt vmcnt(1) lgkmcnt(0)
    s_barrier
    v_mfma_f32_32x32x16_bf16 a[64:79], a[228:231], v[140:143], a[64:79]
    buffer_load_dwordx4 v1, s[20:23], s45 offen offset:0 sc1 lds
    v_mfma_f32_32x32x16_bf16 a[80:95], a[236:239], v[140:143], a[80:95]
    v_mfma_f32_32x32x16_bf16 a[96:111], a[244:247], v[140:143], a[96:111]
    buffer_load_dwordx4 v1, s[20:23], s45 offen offset:1024 sc1 lds
    v_mfma_f32_32x32x16_bf16 a[112:127], a[252:255], v[140:143], a[112:127]
    s_cmp_eq_u32 s39, s99
    s_cbranch_scc1 K2_FINB
K2_FBRETX:
    s_nop 0
    buffer_load_dwordx4 v1, s[20:23], s45 offen offset:2048 sc1 lds
    s_add_u32 s39, s39, 1
    s_nop 0
    buffer_load_dwordx4 v1, s[20:23], s45 offen offset:3072 sc1 lds
    s_add_u32 m0, s49, 4096
    v_mov_b32 v128, 0
    v_mov_b32 v129, 0
    v_mov_b32 v130, 0
    s_nop 0
    v_mov_b32 v131, 0
    v_mov_b32 v132, 0
    v_mov_b32 v133, 0
    v_mov_b32 v134, 0
    v_mov_b32 v135, 0
    v_mov_b32 v136, 0
    s_nop 0
    buffer_load_dwordx4 v1, s[20:23], s46 offen offset:0 sc1 lds
    v_mov_b32 v137, 0
    v_mov_b32 v138, 0
    v_mov_b32 v139, 0
    v_mov_b32 v140, 0
    s_nop 0
    v_mov_b32 v141, 0
    v_mov_b32 v142, 0
    v_mov_b32 v143, 0
    s_xor_b32 s49, s49, 0x8000
    s_nop 0
    buffer_load_dwordx4 v1, s[20:23], s46 offen offset:1024 sc1 lds
    s_nop 0
    buffer_load_dwordx4 v1, s[20:23], s46 offen offset:2048 sc1 lds
    s_nop 0
    buffer_load_dwordx4 v1, s[20:23], s46 offen offset:3072 sc1 lds
    s_mov_b32 m0, s50
    s_nop 0
    buffer_load_dwordx4 v1, s[20:23], s47 offen offset:0 sc1 lds
    s_nop 0
    v_xor_b32 v5, 0x8000, v5
    s_nop 0
    buffer_load_dwordx4 v1, s[20:23], s47 offen offset:1024 sc1 lds
    s_nop 0
    s_nop 0
    ds_read_b128 a[192:195], v3 offset:0
    buffer_load_dwordx4 v1, s[20:23], s47 offen offset:2048 sc1 lds
    s_nop 0
    ds_read_b128 a[196:199], v3 offset:1024
    s_nop 0
    buffer_load_dwordx4 v1, s[20:23], s47 offen offset:3072 sc1 lds
    s_add_u32 m0, s50, 4096
    s_nop 0
    ds_read_b128 a[200:203], v3 offset:2048
    s_nop 0
    ds_read_b128 a[204:207], v3 offset:3072
    buffer_load_dwordx4 v1, s[20:23], s48 offen offset:0 sc1 lds
    s_xor_b32 s50, s50, 0x8000
    s_nop 0
    ds_read_b128 a[208:211], v3 offset:4096
    buffer_load_dwordx4 v1, s[20:23], s48 offen offset:1024 sc1 lds
    s_nop 0
    ds_read_b128 a[212:215], v3 offset:5120
    buffer_load_dwordx4 v1, s[20:23], s48 offen offset:2048 sc1 lds
    s_add_u32 s43, s43, 1
    s_nop 0
    ds_read_b128 a[216:219], v3 offset:6144
    s_nop 0
    buffer_load_dwordx4 v1, s[20:23], s48 offen offset:3072 sc1 lds
    s_nop 0
    ds_read_b128 a[220:223], v3 offset:7168
    s_nop 0
    buffer_load_dword v248, v1, s[24:27], s76 offen
    s_add_u32 s76, s76, s30
    s_nop 0
    v_xor_b32 v3, 0x8000, v3
    s_nop 0
    s_cmp_lt_u32 s39, 17
    s_cbranch_scc1 K2_LOOP
    s_branch K2_TAIL
L_CODE_END:
    s_endpgm
.section .rodata,"a"
.p2align 6
.amdhsa_kernel parallel_sum__compressed_kv_cla__mixer_gmlp__prompt_kernel
  .amdhsa_next_free_vgpr 512
  .amdhsa_next_free_sgpr 102
  .amdhsa_accum_offset 256
  .amdhsa_group_segment_fixed_size 0
  .amdhsa_kernarg_size 112
  .amdhsa_user_sgpr_count 2
  .amdhsa_user_sgpr_kernarg_segment_ptr 1
  .amdhsa_system_sgpr_workgroup_id_x 1
.end_amdhsa_kernel
```
